```python
import torch

def _softmax(x, axis=-1):
    return torch.softmax(x, dim=axis)

def _gelu(x):
    return torch.nn.functional.gelu(x, approximate='tanh')

def _silu(x):
    return torch.nn.functional.silu(x)

def _sigmoid(x):
    return torch.sigmoid(x)

def _layernorm(x, axis=-1, eps=1e-05):
    m = x.mean(dim=axis, keepdim=True)
    v = x.var(dim=axis, keepdim=True, unbiased=False)
    return (x - m) / torch.sqrt(v + eps)

def _scatter_add(tgt, idx, src, axis=0):
    return tgt.clone().index_add_(axis, idx, src)

def _segment_sum(src, seg, n):
    out = torch.zeros((n,) + src.shape[1:], dtype=src.dtype)
    return out.index_add_(0, seg, src)

def _pad(x, pw):
    flat = tuple((v for pair in reversed(pw) for v in pair))
    return torch.nn.functional.pad(x, flat)
kernel_name = 'adaLN_cond__memory_aug_recurrent_mem_tr__mixer_gmlp__prompt'

def setup_inputs():

    _w = lambda a: (lambda t: t.to(torch.bfloat16) if t.is_floating_point() else t)(torch.as_tensor(a))

    def _A_setup():
        B, S, Dm = (1, 2048, 576)
        H, Dh = (32, 128)
        M, seg = (8, 32)
        seg = min(seg, S)
        S = S // seg * seg
        return {'x': _w((lambda *s: torch.randn(*s, dtype=torch.bfloat16) * 0.05)(B, S, Dm)), 'mem0': _w((lambda *s: torch.randn(*s, dtype=torch.bfloat16) * 0.4)(B, M, Dm)), 'Wq': _w((lambda *s: torch.randn(*s, dtype=torch.bfloat16) * 3.2)(Dm, H, Dh) * Dm ** (-0.5)), 'Wk': _w((lambda *s: torch.randn(*s, dtype=torch.bfloat16) * 3.2)(Dm, H, Dh) * Dm ** (-0.5)), 'Wv': _w((lambda *s: torch.randn(*s, dtype=torch.bfloat16) * 0.4)(Dm, H, Dh) * Dm ** (-0.5)), 'Wo': _w((lambda *s: torch.randn(*s, dtype=torch.bfloat16) * 0.4)(H, Dh, Dm) * (H * Dh) ** (-0.5)), 'seg_len': seg}
    _A_in = _A_setup()

    def _B_setup():
        B, S, D, F = (1, 2048, 576, 4608)
        Fh = F // 2
        return {'x': _w((lambda *s: torch.randn(*s, dtype=torch.bfloat16) * 0.05)(B, S, D)), 'w_in': _w((lambda *s: torch.randn(*s, dtype=torch.bfloat16) * 0.8)(D, 2 * Fh)), 'w_sp': _w(0.01 * (lambda *s: torch.randn(*s, dtype=torch.bfloat16) * 0.8)(S, S)), 'b_sp': _w(1.0 + 0.01 * (lambda *s: torch.randn(*s, dtype=torch.bfloat16) * 0.05)(S)), 'w_out': _w((lambda *s: torch.randn(*s, dtype=torch.bfloat16) * 0.05)(Fh, D))}
    _B_in = _B_setup()
    return {'A_x': _A_in['x'], 'A_mem0': _A_in['mem0'], 'A_Wq': _A_in['Wq'], 'A_Wk': _A_in['Wk'], 'A_Wv': _A_in['Wv'], 'A_Wo': _A_in['Wo'], 'A_seg_len': _A_in['seg_len'], 'B_x': _B_in['x'], 'B_w_in': _B_in['w_in'], 'B_w_sp': _B_in['w_sp'], 'B_b_sp': _B_in['b_sp'], 'B_w_out': _B_in['w_out'], 'c': _w((lambda *s: torch.randn(*s, dtype=torch.bfloat16) * 0.1)(1, 576) * 8.0), 'w_mod': _w((lambda *s: torch.randn(*s, dtype=torch.bfloat16) * 0.1)(576, 6 * 576) * 576 ** (-0.5) * 8.0)}

def reference(A_x, A_mem0, A_Wq, A_Wk, A_Wv, A_Wo, A_seg_len, B_x, B_w_in, B_w_sp, B_b_sp, B_w_out, c, w_mod):

    def _A_ref(x, mem0, Wq, Wk, Wv, Wo, seg_len):
        B, S, Dm = x.shape
        H, Dh = (Wq.shape[1], Wq.shape[2])
        M = mem0.shape[1]
        scale = Dh ** (-0.5)
        n_seg = S // seg_len
        L = M + seg_len
        idx = torch.arange(L)
        mask = (idx[:, None] < M) | (idx[:, None] >= idx[None, :])
        mem = mem0
        outs = []
        for s in range(n_seg):
            xs = x[:, s * seg_len:(s + 1) * seg_len, :].clone()
            h = torch.concatenate([mem, xs], axis=1)
            q = torch.einsum('btd,dhe->bhte', h, Wq)
            k = torch.einsum('btd,dhe->bhte', h, Wk)
            v = torch.einsum('btd,dhe->bhte', h, Wv)
            scores = torch.einsum('bhqe,bhke->bhqk', q, k) * scale
            scores = torch.where(mask[None, None], scores, -1000000000.0)
            p = _softmax(scores, axis=-1)
            o = torch.einsum('bhqk,bhke->bhqe', p, v)
            o = torch.einsum('bhte,hed->btd', o, Wo)
            mem = o[:, :M, :].clone()
            outs.append(o[:, M:, :])
        return torch.concatenate(outs, axis=1)

    def _B_ref(x, w_in, w_sp, b_sp, w_out):
        B, S, D = x.shape
        F = w_in.shape[-1]
        Fh = F // 2
        z = _gelu(torch.einsum('bsd,df->bsf', x, w_in))
        z1 = z[..., :Fh].clone()
        z2 = _layernorm(z[..., Fh:], axis=-1)
        g = torch.einsum('ts,bsf->btf', w_sp, z2) + b_sp[None, :, None]
        return torch.einsum('bsf,fd->bsd', z1 * g, w_out)
    x = A_x
    mod = (_silu(c) @ w_mod).reshape(c.shape[0], 6, 1, -1)
    sa, ca, ga, sb, cb, gb = (mod[:, 0].clone(), mod[:, 1].clone(), mod[:, 2].clone(), mod[:, 3].clone(), mod[:, 4].clone(), mod[:, 5].clone())
    h = _layernorm(x, axis=-1) * (1 + ca) + sa
    x = x + ga * _A_ref(h, A_mem0, A_Wq, A_Wk, A_Wv, A_Wo, A_seg_len)
    h = _layernorm(x, axis=-1) * (1 + cb) + sb
    x = x + gb * _B_ref(h, B_w_in, B_w_sp, B_b_sp, B_w_out)
    return x
```

```asm
; @launch kernel=main_kernel grid=(256,1,1) block=(256,1,1) lds=163840
.amdgcn_target "amdgcn-amd-amdhsa--gfx950"
.text
.globl main_kernel
.p2align 8
.type main_kernel,@function
main_kernel:
    s_cmp_ge_u32 s2, 256
    s_cbranch_scc1 Ldone_main
    s_mov_b64 s[42:43], s[0:1]
    s_load_dwordx2 s[40:41], s[0:1], 120
    s_load_dwordx2 s[4:5], s[0:1], 128
    s_mov_b32 s12, s2
    s_mov_b32 s99, 0
    v_readfirstlane_b32 s13, v0
    s_nop 3
    s_lshr_b32 s13, s13, 6
    v_and_b32 v0, 63, v0
    v_lshlrev_b32 v0, 4, v0
    s_waitcnt lgkmcnt(0)
    s_mov_b32 s6, 268435456
    s_mov_b32 s7, 0x20000
    s_load_dwordx16 s[44:59], s[0:1], 0
    s_load_dwordx16 s[60:75], s[0:1], 64
    s_cmp_eq_u32 s13, 0
    s_cbranch_scc1 Lcwd_11_m
    s_getpc_b64 s[76:77]
    s_and_b32 s76, s76, 0xffffff00
    s_sub_u32 s19, s13, 1
    s_lshl_b32 s19, s19, 10
    v_add_u32 v8, s19, v0
    s_mov_b32 s20, (Lcode_end-main_kernel)/3072
Lcw_10_m:
    global_load_dwordx4 v[12:15], v8, s[76:77]
    v_add_u32 v8, 3072, v8
    s_sub_u32 s20, s20, 1
    s_cmp_lg_u32 s20, 0
    s_cbranch_scc1 Lcw_10_m
    s_waitcnt vmcnt(0)
Lcwd_11_m:
    s_cmp_lg_u32 s13, 0
    s_cbranch_scc1 Lsu0_2
    s_getreg_b32 s19, hwreg(HW_REG_XCC_ID, 0, 3)
    s_lshl_b32 s20, s19, 2
    v_mov_b32 v8, s20
    v_mov_b32 v9, 1
    s_mov_b64 exec, 1
    global_atomic_add v10, v8, v9, s[40:41] sc0
    s_cmp_lg_u32 s2, 0
    s_cbranch_scc1 Lsuz_5_m
    s_memrealtime s[76:77]
    s_waitcnt lgkmcnt(0)
    s_or_b32 s76, s76, 1
    v_mov_b32 v11, 0
    v_mov_b32 v12, s76
    global_store_dword v11, v12, s[40:41] offset:72 sc1
Lsuz_5_m:
    s_mov_b64 exec, -1
    v_lshrrev_b32 v11, 2, v0
    s_waitcnt lgkmcnt(0)
Lsup_3_m:
    global_load_dword v12, v11, s[40:41] sc1
    s_waitcnt vmcnt(0)
    v_readlane_b32 s44, v12, 0
    v_readlane_b32 s45, v12, 1
    v_readlane_b32 s46, v12, 2
    v_readlane_b32 s47, v12, 3
    v_readlane_b32 s48, v12, 4
    v_readlane_b32 s49, v12, 5
    v_readlane_b32 s50, v12, 6
    v_readlane_b32 s51, v12, 7
    v_readlane_b32 s90, v12, 18
    s_add_u32 s52, s44, s45
    s_add_u32 s52, s52, s46
    s_add_u32 s52, s52, s47
    s_add_u32 s52, s52, s48
    s_add_u32 s52, s52, s49
    s_add_u32 s52, s52, s50
    s_add_u32 s52, s52, s51
    v_readfirstlane_b32 s53, v10
    s_cmp_eq_u32 s90, 0
    s_cbranch_scc1 Lsua_6_m
    s_cmp_lg_u32 s19, 0
    s_cbranch_scc1 Lsus_7_m
    s_cmp_lt_u32 s44, 32
    s_cbranch_scc1 Lsus_7_m
    s_cmp_ge_u32 s53, 32
    s_cbranch_scc1 Lsus_7_m
    s_mov_b32 s57, s53
    s_mov_b32 s55, 0
    s_branch Lsuf_9_m
Lsus_7_m:
    s_cmp_ge_u32 s52, 256
    s_cbranch_scc1 Lsuo_4_m
Lsua_6_m:
    s_add_u32 s99, s99, 1
    s_cmp_lt_u32 s99, 4194304
    s_cbranch_scc1 Lsup_3_m
    s_endpgm
Lsuo_4_m:
    s_mov_b32 s54, 0
    s_cmp_ge_u32 s51, 32
    s_cselect_b32 s54, 7, s54
    s_cmp_ge_u32 s50, 32
    s_cselect_b32 s54, 6, s54
    s_cmp_ge_u32 s49, 32
    s_cselect_b32 s54, 5, s54
    s_cmp_ge_u32 s48, 32
    s_cselect_b32 s54, 4, s54
    s_cmp_ge_u32 s47, 32
    s_cselect_b32 s54, 3, s54
    s_cmp_ge_u32 s46, 32
    s_cselect_b32 s54, 2, s54
    s_cmp_ge_u32 s45, 32
    s_cselect_b32 s54, 1, s54
    s_cmp_ge_u32 s44, 32
    s_cselect_b32 s54, 0, s54
    s_mov_b32 s55, 0
    s_cmp_gt_u32 s19, 0
    s_cselect_b32 s56, s44, 0
    s_add_u32 s55, s55, s56
    s_cmp_gt_u32 s19, 1
    s_cselect_b32 s56, s45, 0
    s_add_u32 s55, s55, s56
    s_cmp_gt_u32 s19, 2
    s_cselect_b32 s56, s46, 0
    s_add_u32 s55, s55, s56
    s_cmp_gt_u32 s19, 3
    s_cselect_b32 s56, s47, 0
    s_add_u32 s55, s55, s56
    s_cmp_gt_u32 s19, 4
    s_cselect_b32 s56, s48, 0
    s_add_u32 s55, s55, s56
    s_cmp_gt_u32 s19, 5
    s_cselect_b32 s56, s49, 0
    s_add_u32 s55, s55, s56
    s_cmp_gt_u32 s19, 6
    s_cselect_b32 s56, s50, 0
    s_add_u32 s55, s55, s56
    s_cmp_gt_u32 s19, 7
    s_cselect_b32 s56, s51, 0
    s_add_u32 s55, s55, s56
    s_cmp_gt_u32 s19, s54
    s_cselect_b32 s56, 32, 0
    s_sub_u32 s55, s55, s56
    s_add_u32 s55, s55, s53
    s_cmp_eq_u32 s19, s54
    s_cbranch_scc0 Lsuw_8_m
    s_cmp_lt_u32 s53, 32
    s_cselect_b32 s57, s53, -1
    s_sub_u32 s55, s55, 32
    s_branch Lsuf_9_m
Lsuw_8_m:
    s_mov_b32 s57, -1
Lsuf_9_m:
    v_mov_b32 v8, 0
    v_mov_b32 v12, s57
    v_mov_b32 v13, s55
    v_mov_b32 v14, s90
    ds_write_b96 v8, v[12:14]
    s_waitcnt lgkmcnt(0)
Lsu0_2:
    s_barrier
    v_mov_b32 v8, 0
    ds_read_b96 v[12:14], v8
    s_waitcnt lgkmcnt(0)
    v_readfirstlane_b32 s12, v12
    v_readfirstlane_b32 s97, v13
    v_readfirstlane_b32 s90, v14
    s_barrier
    s_nop 0
    s_cmp_eq_u32 s12, -1
    s_cbranch_scc1 Lworker_1_m
    s_mov_b32 s30, 0xcccccccc
    s_mov_b32 s31, 0xcccccccc
    s_mov_b32 s32, 0x00ff00ff
    s_mov_b32 s33, 0
    s_mov_b32 s34, 0xffff
    s_mov_b32 s35, 0
    s_mov_b32 s24, 0x3e0293ee
    s_mul_i32 s26, s13, 73728
    s_lshl_b32 s19, s12, 7
    s_add_u32 s26, s26, s19
    s_lshl_b32 s27, s13, 11
    s_lshl_b32 s37, s13, 11
    s_add_u32 s37, s37, 16777216
    s_mov_b32 s23, 262144
    s_cmp_eq_u32 s13, 2
    s_cselect_b32 s23, 17039360, s23
    s_lshl_b32 s19, s13, 5
    s_add_u32 s19, s19, s12
    s_lshl_b32 s25, s19, 12
    s_lshr_b32 s20, s19, 1
    s_lshl_b32 s36, s20, 8
    s_and_b32 s21, s19, 1
    s_lshl_b32 s21, s21, 4
    s_add_u32 s36, s36, s21
    s_and_b32 s38, s20, 1
    s_lshl_b32 s38, s38, 7
    s_cmp_lt_u32 s19, 72
    s_cselect_b32 s25, s25, -1
    v_mov_b32 v12, -1
    v_mov_b32 v13, -1
    v_mov_b32 v14, -1
    v_mov_b32 v15, -1
    s_cmp_eq_u32 s25, -1
    s_cbranch_scc1 Lnofill_12_m
    v_mov_b32 v16, 0
    v_mov_b32 v17, 0
    v_mov_b32 v18, 0
    v_mov_b32 v19, 0
    s_add_u32 s19, s25, 58720256
    buffer_store_dwordx4 v[16:19], v0, s[4:7], s19 offen offset:0
    buffer_store_dwordx4 v[16:19], v0, s[4:7], s19 offen offset:1024
    buffer_store_dwordx4 v[16:19], v0, s[4:7], s19 offen offset:2048
    buffer_store_dwordx4 v[16:19], v0, s[4:7], s19 offen offset:3072
    s_add_u32 s19, s25, 59015168
    buffer_store_dwordx4 v[16:19], v0, s[4:7], s19 offen offset:0
    buffer_store_dwordx4 v[16:19], v0, s[4:7], s19 offen offset:1024
    buffer_store_dwordx4 v[16:19], v0, s[4:7], s19 offen offset:2048
    buffer_store_dwordx4 v[16:19], v0, s[4:7], s19 offen offset:3072
    v_lshrrev_b32 v72, 4, v0
    v_lshrrev_b32 v73, 3, v72
    v_mul_u32_u24 v73, 9216, v73
    v_and_b32 v72, 0x70, v0
    v_add_u32 v72, v72, v73
    s_lshr_b32 s19, s25, 5
    s_add_u32 s19, s19, 59768832
    buffer_store_dwordx4 v[12:15], v72, s[4:7], s19 offen
    s_add_u32 s19, s19, 73728
    buffer_store_dwordx4 v[12:15], v72, s[4:7], s19 offen
    s_add_u32 s19, s19, 73728
    buffer_store_dwordx4 v[12:15], v72, s[4:7], s19 offen
    s_add_u32 s19, s19, 73728
    buffer_store_dwordx4 v[12:15], v72, s[4:7], s19 offen
    s_add_u32 s19, s19, 73728
    buffer_store_dwordx4 v[12:15], v72, s[4:7], s19 offen
    s_add_u32 s19, s19, 73728
    buffer_store_dwordx4 v[12:15], v72, s[4:7], s19 offen
    s_add_u32 s19, s19, 73728
    buffer_store_dwordx4 v[12:15], v72, s[4:7], s19 offen
    s_add_u32 s19, s19, 73728
    buffer_store_dwordx4 v[12:15], v72, s[4:7], s19 offen
Lnofill_12_m:
    s_load_dwordx2 s[8:9], s[42:43], 8
    s_waitcnt lgkmcnt(0)
    s_mov_b32 s10, 9216
    s_mov_b32 s11, 0x20000
    v_lshrrev_b32 v72, 4, v0
    s_mul_i32 s19, s13, 2304
    v_lshlrev_b32 v73, 1, v72
    buffer_load_ushort v40, v73, s[8:11], s19 offen offset:0
    buffer_load_ushort v50, v73, s[8:11], s19 offen offset:1152
    buffer_load_ushort v41, v73, s[8:11], s19 offen offset:128
    buffer_load_ushort v51, v73, s[8:11], s19 offen offset:1280
    buffer_load_ushort v42, v73, s[8:11], s19 offen offset:256
    buffer_load_ushort v52, v73, s[8:11], s19 offen offset:1408
    buffer_load_ushort v43, v73, s[8:11], s19 offen offset:384
    buffer_load_ushort v53, v73, s[8:11], s19 offen offset:1536
    buffer_load_ushort v44, v73, s[8:11], s19 offen offset:512
    buffer_load_ushort v54, v73, s[8:11], s19 offen offset:1664
    buffer_load_ushort v45, v73, s[8:11], s19 offen offset:640
    buffer_load_ushort v55, v73, s[8:11], s19 offen offset:1792
    buffer_load_ushort v46, v73, s[8:11], s19 offen offset:768
    buffer_load_ushort v56, v73, s[8:11], s19 offen offset:1920
    buffer_load_ushort v47, v73, s[8:11], s19 offen offset:896
    buffer_load_ushort v57, v73, s[8:11], s19 offen offset:2048
    buffer_load_ushort v48, v73, s[8:11], s19 offen offset:1024
    buffer_load_ushort v58, v73, s[8:11], s19 offen offset:2176
    v_lshrrev_b32 v72, 4, v0
    v_lshrrev_b32 v73, 4, v72
    v_and_b32 v74, 15, v72
    v_lshrrev_b32 v75, 1, v74
    v_xor_b32 v75, v75, v73
    v_lshlrev_b32 v75, 5, v75
    v_and_b32 v74, 1, v74
    v_lshl_add_u32 v75, v74, 4, v75
    v_lshl_add_u32 v12, v73, 13, v75
    v_xor_b32 v13, 0x80, v12
    v_lshrrev_b32 v73, 4, v72
    v_bfe_u32 v74, v72, 2, 2
    v_and_b32 v75, 3, v72
    v_lshlrev_b32 v14, 3, v75
    v_lshrrev_b32 v75, 1, v74
    v_and_b32 v74, 1, v74
    v_lshl_add_u32 v74, v74, 1, v75
    v_lshl_add_u32 v75, v73, 3, v74
    v_lshl_add_u32 v14, v75, 8, v14
    v_and_b32 v73, 1, v73
    v_lshl_add_u32 v74, v73, 2, v74
    s_lshl_b32 s19, s13, 1
    v_xor_b32 v74, s19, v74
    v_lshl_add_u32 v14, v74, 5, v14
    v_xor_b32 v15, 32, v14
    v_add_u32 v16, 0x10000, v14
    v_add_u32 v17, 0x10000, v15
    v_add_u32 v18, 0x20000, v14
    v_add_u32 v19, 0x20000, v15
    s_load_dwordx2 s[8:9], s[42:43], 16
    s_waitcnt lgkmcnt(0)
    s_mov_b32 s10, 4718592
    s_mov_b32 s11, 0x20000
    s_mul_i32 s19, s13, 524288
    s_lshl_b32 s20, s12, 8
    s_add_u32 s19, s19, s20
    s_add_u32 s19, s19, 0
    s_mul_i32 s20, s13, 16384
    s_add_u32 s20, s20, 0
    s_mov_b32 s21, 4
Ldma_13_m:
    s_mov_b32 m0, s20
    s_nop 0
    buffer_load_dwordx4 v12, s[8:11], s19 offen lds
    s_add_u32 s19, s19, 32768
    s_add_u32 s20, s20, 1024
    s_mov_b32 m0, s20
    s_nop 0
    buffer_load_dwordx4 v12, s[8:11], s19 offen lds
    s_add_u32 s19, s19, 32768
    s_add_u32 s20, s20, 1024
    s_mov_b32 m0, s20
    s_nop 0
    buffer_load_dwordx4 v13, s[8:11], s19 offen lds
    s_add_u32 s19, s19, 32768
    s_add_u32 s20, s20, 1024
    s_mov_b32 m0, s20
    s_nop 0
    buffer_load_dwordx4 v13, s[8:11], s19 offen lds
    s_add_u32 s19, s19, 32768
    s_add_u32 s20, s20, 1024
    s_sub_u32 s21, s21, 1
    s_cmp_lg_u32 s21, 0
    s_cbranch_scc1 Ldma_13_m
    s_load_dwordx2 s[8:9], s[42:43], 16
    s_waitcnt lgkmcnt(0)
    s_mov_b32 s10, 4718592
    s_mov_b32 s11, 0x20000
    s_mul_i32 s19, s13, 655360
    s_lshl_b32 s20, s12, 8
    s_add_u32 s19, s19, s20
    s_add_u32 s19, s19, 2097152
    s_mul_i32 s20, s13, 20480
    s_add_u32 s20, s20, 65536
    s_mov_b32 s21, 5
Ldma_14_m:
    s_mov_b32 m0, s20
    s_nop 0
    buffer_load_dwordx4 v12, s[8:11], s19 offen lds
    s_add_u32 s19, s19, 32768
    s_add_u32 s20, s20, 1024
    s_mov_b32 m0, s20
    s_nop 0
    buffer_load_dwordx4 v12, s[8:11], s19 offen lds
    s_add_u32 s19, s19, 32768
    s_add_u32 s20, s20, 1024
    s_mov_b32 m0, s20
    s_nop 0
    buffer_load_dwordx4 v13, s[8:11], s19 offen lds
    s_add_u32 s19, s19, 32768
    s_add_u32 s20, s20, 1024
    s_mov_b32 m0, s20
    s_nop 0
    buffer_load_dwordx4 v13, s[8:11], s19 offen lds
    s_add_u32 s19, s19, 32768
    s_add_u32 s20, s20, 1024
    s_sub_u32 s21, s21, 1
    s_cmp_lg_u32 s21, 0
    s_cbranch_scc1 Ldma_14_m
    v_lshrrev_b32 v72, 4, v0
    v_lshrrev_b32 v74, 1, v72
    v_lshlrev_b32 v74, 5, v74
    v_and_b32 v75, 1, v72
    v_lshl_add_u32 v74, v75, 2, v74
    v_lshrrev_b32 v75, 1, v74
    v_and_b32 v75, 0x80, v75
    v_xor_b32 v74, v74, v75
    s_lshl_b32 s19, s13, 3
    s_add_u32 s19, s19, 147456
    v_add_u32 v74, s19, v74
    s_waitcnt vmcnt(36)
    v_lshl_or_b32 v40, v50, 16, v40
    v_lshl_or_b32 v41, v51, 16, v41
    v_lshl_or_b32 v42, v52, 16, v42
    v_lshl_or_b32 v43, v53, 16, v43
    v_lshl_or_b32 v44, v54, 16, v44
    v_lshl_or_b32 v45, v55, 16, v45
    v_lshl_or_b32 v46, v56, 16, v46
    v_lshl_or_b32 v47, v57, 16, v47
    v_lshl_or_b32 v48, v58, 16, v48
    ds_write_b32 v74, v40 offset:0
    ds_write_b32 v74, v41 offset:1024
    ds_write_b32 v74, v42 offset:2048
    ds_write_b32 v74, v43 offset:3072
    ds_write_b32 v74, v44 offset:4096
    ds_write_b32 v74, v45 offset:5120
    ds_write_b32 v74, v46 offset:6144
    ds_write_b32 v74, v47 offset:7168
    ds_write_b32 v74, v48 offset:8192
    v_lshrrev_b32 v72, 4, v0
    v_bfe_u32 v73, v72, 1, 1
    v_mul_u32_u24 v73, 0xAAAA, v73
    v_add_u32 v1, 0x4444, v73
    v_lshrrev_b32 v73, 4, v72
    v_and_b32 v74, 15, v72
    v_lshlrev_b32 v2, 3, v74
    v_lshl_add_u32 v2, v73, 8, v2
    v_lshrrev_b32 v75, 1, v2
    v_and_b32 v75, 0x80, v75
    v_xor_b32 v2, v2, v75
    v_add_u32 v2, 147456, v2
    v_xor_b32 v3, 0x80, v2
    v_lshlrev_b32 v4, 5, v74
    v_lshl_add_u32 v4, v73, 3, v4
    v_lshrrev_b32 v75, 1, v4
    v_and_b32 v75, 0x80, v75
    v_xor_b32 v4, v4, v75
    s_lshl_b32 s19, s13, 10
    s_add_u32 s19, s19, 156672
    v_add_u32 v4, s19, v4
    v_lshlrev_b32 v11, 2, v72
    s_lshl_b32 s19, s13, 9
    v_add_u32 v11, s19, v11
    v_lshrrev_b32 v5, 1, v73
    v_lshlrev_b32 v5, 8, v5
    v_and_b32 v75, 12, v74
    v_lshl_add_u32 v5, v75, 4, v5
    v_and_b32 v75, 1, v72
    v_lshl_add_u32 v5, v75, 4, v5
    v_and_b32 v75, 1, v73
    v_lshl_add_u32 v5, v75, 3, v5
    s_lshl_b32 s19, s13, 9
    s_add_u32 s19, s19, 160768
    v_add_u32 v5, s19, v5
    v_lshrrev_b32 v6, 5, v72
    v_lshlrev_b32 v6, 12, v6
    v_and_b32 v75, 31, v72
    v_lshl_add_u32 v6, v75, 2, v6
    s_add_u32 s19, s27, 147456
    v_add_u32 v7, s19, v0
    s_barrier
    s_cmp_lg_u32 s13, 0
    s_cbranch_scc1 Lgba_15_m
    v_mov_b32 v72, 0
    v_mov_b32 v73, 1
    s_mov_b64 exec, 1
    global_atomic_add v72, v73, s[40:41] offset:80
    s_mov_b64 exec, -1
Lgba_15_m:
    s_waitcnt vmcnt(20)
    s_barrier
    ds_read_b64_tr_b16 a[0:1], v14 offset:0
    ds_read_b64_tr_b16 a[2:3], v14 offset:1024
    ds_read_b64_tr_b16 a[4:5], v14 offset:8192
    ds_read_b64_tr_b16 a[6:7], v14 offset:9216
    ds_read_b64_tr_b16 v[184:185], v15 offset:0
    ds_read_b64_tr_b16 v[186:187], v15 offset:1024
    ds_read_b64_tr_b16 v[188:189], v15 offset:8192
    ds_read_b64_tr_b16 v[190:191], v15 offset:9216
    s_waitcnt lgkmcnt(4)
    ds_read_b64_tr_b16 a[8:9], v14 offset:16384
    ds_read_b64_tr_b16 a[10:11], v14 offset:17408
    ds_read_b64_tr_b16 a[12:13], v14 offset:24576
    ds_read_b64_tr_b16 a[14:15], v14 offset:25600
    ds_read_b64_tr_b16 v[192:193], v15 offset:16384
    ds_read_b64_tr_b16 v[194:195], v15 offset:17408
    ds_read_b64_tr_b16 v[196:197], v15 offset:24576
    ds_read_b64_tr_b16 v[198:199], v15 offset:25600
    s_waitcnt lgkmcnt(4)
    ds_read_b64_tr_b16 a[16:17], v14 offset:32768
    ds_read_b64_tr_b16 a[18:19], v14 offset:33792
    ds_read_b64_tr_b16 a[20:21], v14 offset:40960
    ds_read_b64_tr_b16 a[22:23], v14 offset:41984
    ds_read_b64_tr_b16 v[200:201], v15 offset:32768
    ds_read_b64_tr_b16 v[202:203], v15 offset:33792
    ds_read_b64_tr_b16 v[204:205], v15 offset:40960
    ds_read_b64_tr_b16 v[206:207], v15 offset:41984
    s_waitcnt lgkmcnt(4)
    ds_read_b64_tr_b16 a[24:25], v14 offset:49152
    ds_read_b64_tr_b16 a[26:27], v14 offset:50176
    ds_read_b64_tr_b16 a[28:29], v14 offset:57344
    ds_read_b64_tr_b16 a[30:31], v14 offset:58368
    ds_read_b64_tr_b16 v[208:209], v15 offset:49152
    ds_read_b64_tr_b16 v[210:211], v15 offset:50176
    ds_read_b64_tr_b16 v[212:213], v15 offset:57344
    ds_read_b64_tr_b16 v[214:215], v15 offset:58368
    s_waitcnt lgkmcnt(4)
    s_waitcnt lgkmcnt(0)
    s_barrier
    s_load_dwordx2 s[8:9], s[42:43], 24
    s_waitcnt lgkmcnt(0)
    s_mov_b32 s10, 4718592
    s_mov_b32 s11, 0x20000
    s_mul_i32 s19, s13, 524288
    s_lshl_b32 s20, s12, 8
    s_add_u32 s19, s19, s20
    s_add_u32 s19, s19, 0
    s_mul_i32 s20, s13, 16384
    s_add_u32 s20, s20, 0
    s_mov_b32 s21, 4
Ldma_16_m:
    s_mov_b32 m0, s20
    s_nop 0
    buffer_load_dwordx4 v12, s[8:11], s19 offen lds
    s_add_u32 s19, s19, 32768
    s_add_u32 s20, s20, 1024
    s_mov_b32 m0, s20
    s_nop 0
    buffer_load_dwordx4 v12, s[8:11], s19 offen lds
    s_add_u32 s19, s19, 32768
    s_add_u32 s20, s20, 1024
    s_mov_b32 m0, s20
    s_nop 0
    buffer_load_dwordx4 v13, s[8:11], s19 offen lds
    s_add_u32 s19, s19, 32768
    s_add_u32 s20, s20, 1024
    s_mov_b32 m0, s20
    s_nop 0
    buffer_load_dwordx4 v13, s[8:11], s19 offen lds
    s_add_u32 s19, s19, 32768
    s_add_u32 s20, s20, 1024
    s_sub_u32 s21, s21, 1
    s_cmp_lg_u32 s21, 0
    s_cbranch_scc1 Ldma_16_m
    s_waitcnt vmcnt(16)
    s_barrier
    ds_read_b64_tr_b16 a[32:33], v16 offset:0
    ds_read_b64_tr_b16 a[34:35], v16 offset:1024
    ds_read_b64_tr_b16 a[36:37], v16 offset:8192
    ds_read_b64_tr_b16 a[38:39], v16 offset:9216
    ds_read_b64_tr_b16 v[216:217], v17 offset:0
    ds_read_b64_tr_b16 v[218:219], v17 offset:1024
    ds_read_b64_tr_b16 v[220:221], v17 offset:8192
    ds_read_b64_tr_b16 v[222:223], v17 offset:9216
    s_waitcnt lgkmcnt(4)
    ds_read_b64_tr_b16 a[40:41], v16 offset:16384
    ds_read_b64_tr_b16 a[42:43], v16 offset:17408
    ds_read_b64_tr_b16 a[44:45], v16 offset:24576
    ds_read_b64_tr_b16 a[46:47], v16 offset:25600
    ds_read_b64_tr_b16 v[224:225], v17 offset:16384
    ds_read_b64_tr_b16 v[226:227], v17 offset:17408
    ds_read_b64_tr_b16 v[228:229], v17 offset:24576
    ds_read_b64_tr_b16 v[230:231], v17 offset:25600
    s_waitcnt lgkmcnt(4)
    ds_read_b64_tr_b16 a[48:49], v16 offset:32768
    ds_read_b64_tr_b16 a[50:51], v16 offset:33792
    ds_read_b64_tr_b16 a[52:53], v16 offset:40960
    ds_read_b64_tr_b16 a[54:55], v16 offset:41984
    ds_read_b64_tr_b16 v[232:233], v17 offset:32768
    ds_read_b64_tr_b16 v[234:235], v17 offset:33792
    ds_read_b64_tr_b16 v[236:237], v17 offset:40960
    ds_read_b64_tr_b16 v[238:239], v17 offset:41984
    s_waitcnt lgkmcnt(4)
    ds_read_b64_tr_b16 a[56:57], v16 offset:49152
    ds_read_b64_tr_b16 a[58:59], v16 offset:50176
    ds_read_b64_tr_b16 a[60:61], v16 offset:57344
    ds_read_b64_tr_b16 a[62:63], v16 offset:58368
    ds_read_b64_tr_b16 v[240:241], v17 offset:49152
    ds_read_b64_tr_b16 v[242:243], v17 offset:50176
    ds_read_b64_tr_b16 v[244:245], v17 offset:57344
    ds_read_b64_tr_b16 v[246:247], v17 offset:58368
    s_waitcnt lgkmcnt(4)
    ds_read_b64_tr_b16 a[64:65], v18 offset:0
    ds_read_b64_tr_b16 a[66:67], v18 offset:1024
    ds_read_b64_tr_b16 a[68:69], v18 offset:8192
    ds_read_b64_tr_b16 a[70:71], v18 offset:9216
    ds_read_b64_tr_b16 v[248:249], v19 offset:0
    ds_read_b64_tr_b16 v[250:251], v19 offset:1024
    ds_read_b64_tr_b16 v[252:253], v19 offset:8192
    ds_read_b64_tr_b16 v[254:255], v19 offset:9216
    s_waitcnt lgkmcnt(4)
    s_waitcnt lgkmcnt(0)
    s_barrier
    s_load_dwordx2 s[8:9], s[42:43], 24
    s_waitcnt lgkmcnt(0)
    s_mov_b32 s10, 4718592
    s_mov_b32 s11, 0x20000
    s_mul_i32 s19, s13, 655360
    s_lshl_b32 s20, s12, 8
    s_add_u32 s19, s19, s20
    s_add_u32 s19, s19, 2097152
    s_mul_i32 s20, s13, 20480
    s_add_u32 s20, s20, 65536
    s_mov_b32 s21, 5
Ldma_17_m:
    s_mov_b32 m0, s20
    s_nop 0
    buffer_load_dwordx4 v12, s[8:11], s19 offen lds
    s_add_u32 s19, s19, 32768
    s_add_u32 s20, s20, 1024
    s_mov_b32 m0, s20
    s_nop 0
    buffer_load_dwordx4 v12, s[8:11], s19 offen lds
    s_add_u32 s19, s19, 32768
    s_add_u32 s20, s20, 1024
    s_mov_b32 m0, s20
    s_nop 0
    buffer_load_dwordx4 v13, s[8:11], s19 offen lds
    s_add_u32 s19, s19, 32768
    s_add_u32 s20, s20, 1024
    s_mov_b32 m0, s20
    s_nop 0
    buffer_load_dwordx4 v13, s[8:11], s19 offen lds
    s_add_u32 s19, s19, 32768
    s_add_u32 s20, s20, 1024
    s_sub_u32 s21, s21, 1
    s_cmp_lg_u32 s21, 0
    s_cbranch_scc1 Ldma_17_m
    s_waitcnt vmcnt(20)
    s_barrier
    ds_read_b64_tr_b16 a[72:73], v14 offset:0
    ds_read_b64_tr_b16 a[74:75], v14 offset:1024
    ds_read_b64_tr_b16 a[76:77], v14 offset:8192
    ds_read_b64_tr_b16 a[78:79], v14 offset:9216
    ds_read_b64_tr_b16 a[144:145], v15 offset:0
    ds_read_b64_tr_b16 a[146:147], v15 offset:1024
    ds_read_b64_tr_b16 a[148:149], v15 offset:8192
    ds_read_b64_tr_b16 a[150:151], v15 offset:9216
    s_waitcnt lgkmcnt(4)
    ds_read_b64_tr_b16 a[80:81], v14 offset:16384
    ds_read_b64_tr_b16 a[82:83], v14 offset:17408
    ds_read_b64_tr_b16 a[84:85], v14 offset:24576
    ds_read_b64_tr_b16 a[86:87], v14 offset:25600
    ds_read_b64_tr_b16 a[152:153], v15 offset:16384
    ds_read_b64_tr_b16 a[154:155], v15 offset:17408
    ds_read_b64_tr_b16 a[156:157], v15 offset:24576
    ds_read_b64_tr_b16 a[158:159], v15 offset:25600
    s_waitcnt lgkmcnt(4)
    ds_read_b64_tr_b16 a[88:89], v14 offset:32768
    ds_read_b64_tr_b16 a[90:91], v14 offset:33792
    ds_read_b64_tr_b16 a[92:93], v14 offset:40960
    ds_read_b64_tr_b16 a[94:95], v14 offset:41984
    ds_read_b64_tr_b16 a[160:161], v15 offset:32768
    ds_read_b64_tr_b16 a[162:163], v15 offset:33792
    ds_read_b64_tr_b16 a[164:165], v15 offset:40960
    ds_read_b64_tr_b16 a[166:167], v15 offset:41984
    s_waitcnt lgkmcnt(4)
    ds_read_b64_tr_b16 a[96:97], v14 offset:49152
    ds_read_b64_tr_b16 a[98:99], v14 offset:50176
    ds_read_b64_tr_b16 a[100:101], v14 offset:57344
    ds_read_b64_tr_b16 a[102:103], v14 offset:58368
    ds_read_b64_tr_b16 a[168:169], v15 offset:49152
    ds_read_b64_tr_b16 a[170:171], v15 offset:50176
    ds_read_b64_tr_b16 a[172:173], v15 offset:57344
    ds_read_b64_tr_b16 a[174:175], v15 offset:58368
    s_waitcnt lgkmcnt(4)
    s_waitcnt lgkmcnt(0)
    s_barrier
    s_load_dwordx2 s[8:9], s[42:43], 32
    s_waitcnt lgkmcnt(0)
    s_mov_b32 s10, 4718592
    s_mov_b32 s11, 0x20000
    s_mul_i32 s19, s13, 524288
    s_lshl_b32 s20, s12, 8
    s_add_u32 s19, s19, s20
    s_add_u32 s19, s19, 0
    s_mul_i32 s20, s13, 16384
    s_add_u32 s20, s20, 0
    s_mov_b32 s21, 4
Ldma_18_m:
    s_mov_b32 m0, s20
    s_nop 0
    buffer_load_dwordx4 v12, s[8:11], s19 offen lds
    s_add_u32 s19, s19, 32768
    s_add_u32 s20, s20, 1024
    s_mov_b32 m0, s20
    s_nop 0
    buffer_load_dwordx4 v12, s[8:11], s19 offen lds
    s_add_u32 s19, s19, 32768
    s_add_u32 s20, s20, 1024
    s_mov_b32 m0, s20
    s_nop 0
    buffer_load_dwordx4 v13, s[8:11], s19 offen lds
    s_add_u32 s19, s19, 32768
    s_add_u32 s20, s20, 1024
    s_mov_b32 m0, s20
    s_nop 0
    buffer_load_dwordx4 v13, s[8:11], s19 offen lds
    s_add_u32 s19, s19, 32768
    s_add_u32 s20, s20, 1024
    s_sub_u32 s21, s21, 1
    s_cmp_lg_u32 s21, 0
    s_cbranch_scc1 Ldma_18_m
    s_waitcnt vmcnt(16)
    s_barrier
    ds_read_b64_tr_b16 a[104:105], v16 offset:0
    ds_read_b64_tr_b16 a[106:107], v16 offset:1024
    ds_read_b64_tr_b16 a[108:109], v16 offset:8192
    ds_read_b64_tr_b16 a[110:111], v16 offset:9216
    ds_read_b64_tr_b16 a[176:177], v17 offset:0
    ds_read_b64_tr_b16 a[178:179], v17 offset:1024
    ds_read_b64_tr_b16 a[180:181], v17 offset:8192
    ds_read_b64_tr_b16 a[182:183], v17 offset:9216
    s_waitcnt lgkmcnt(4)
    ds_read_b64_tr_b16 a[112:113], v16 offset:16384
    ds_read_b64_tr_b16 a[114:115], v16 offset:17408
    ds_read_b64_tr_b16 a[116:117], v16 offset:24576
    ds_read_b64_tr_b16 a[118:119], v16 offset:25600
    ds_read_b64_tr_b16 a[184:185], v17 offset:16384
    ds_read_b64_tr_b16 a[186:187], v17 offset:17408
    ds_read_b64_tr_b16 a[188:189], v17 offset:24576
    ds_read_b64_tr_b16 a[190:191], v17 offset:25600
    s_waitcnt lgkmcnt(4)
    ds_read_b64_tr_b16 a[120:121], v16 offset:32768
    ds_read_b64_tr_b16 a[122:123], v16 offset:33792
    ds_read_b64_tr_b16 a[124:125], v16 offset:40960
    ds_read_b64_tr_b16 a[126:127], v16 offset:41984
    ds_read_b64_tr_b16 a[192:193], v17 offset:32768
    ds_read_b64_tr_b16 a[194:195], v17 offset:33792
    ds_read_b64_tr_b16 a[196:197], v17 offset:40960
    ds_read_b64_tr_b16 a[198:199], v17 offset:41984
    s_waitcnt lgkmcnt(4)
    ds_read_b64_tr_b16 a[128:129], v16 offset:49152
    ds_read_b64_tr_b16 a[130:131], v16 offset:50176
    ds_read_b64_tr_b16 a[132:133], v16 offset:57344
    ds_read_b64_tr_b16 a[134:135], v16 offset:58368
    ds_read_b64_tr_b16 a[200:201], v17 offset:49152
    ds_read_b64_tr_b16 a[202:203], v17 offset:50176
    ds_read_b64_tr_b16 a[204:205], v17 offset:57344
    ds_read_b64_tr_b16 a[206:207], v17 offset:58368
    s_waitcnt lgkmcnt(4)
    ds_read_b64_tr_b16 a[136:137], v18 offset:0
    ds_read_b64_tr_b16 a[138:139], v18 offset:1024
    ds_read_b64_tr_b16 a[140:141], v18 offset:8192
    ds_read_b64_tr_b16 a[142:143], v18 offset:9216
    ds_read_b64_tr_b16 a[208:209], v19 offset:0
    ds_read_b64_tr_b16 a[210:211], v19 offset:1024
    ds_read_b64_tr_b16 a[212:213], v19 offset:8192
    ds_read_b64_tr_b16 a[214:215], v19 offset:9216
    s_waitcnt lgkmcnt(4)
    s_waitcnt lgkmcnt(0)
    s_barrier
    s_load_dwordx2 s[8:9], s[42:43], 32
    s_waitcnt lgkmcnt(0)
    s_mov_b32 s10, 4718592
    s_mov_b32 s11, 0x20000
    s_mul_i32 s19, s13, 655360
    s_lshl_b32 s20, s12, 8
    s_add_u32 s19, s19, s20
    s_add_u32 s19, s19, 2097152
    s_mul_i32 s20, s13, 20480
    s_add_u32 s20, s20, 65536
    s_mov_b32 s21, 5
Ldma_19_m:
    s_mov_b32 m0, s20
    s_nop 0
    buffer_load_dwordx4 v12, s[8:11], s19 offen lds
    s_add_u32 s19, s19, 32768
    s_add_u32 s20, s20, 1024
    s_mov_b32 m0, s20
    s_nop 0
    buffer_load_dwordx4 v12, s[8:11], s19 offen lds
    s_add_u32 s19, s19, 32768
    s_add_u32 s20, s20, 1024
    s_mov_b32 m0, s20
    s_nop 0
    buffer_load_dwordx4 v13, s[8:11], s19 offen lds
    s_add_u32 s19, s19, 32768
    s_add_u32 s20, s20, 1024
    s_mov_b32 m0, s20
    s_nop 0
    buffer_load_dwordx4 v13, s[8:11], s19 offen lds
    s_add_u32 s19, s19, 32768
    s_add_u32 s20, s20, 1024
    s_sub_u32 s21, s21, 1
    s_cmp_lg_u32 s21, 0
    s_cbranch_scc1 Ldma_19_m
    s_waitcnt vmcnt(20)
    s_barrier
    ds_read_b64_tr_b16 a[216:217], v14 offset:0
    ds_read_b64_tr_b16 a[218:219], v14 offset:1024
    ds_read_b64_tr_b16 a[220:221], v14 offset:8192
    ds_read_b64_tr_b16 a[222:223], v14 offset:9216
    ds_read_b64_tr_b16 v[112:113], v15 offset:0
    ds_read_b64_tr_b16 v[114:115], v15 offset:1024
    ds_read_b64_tr_b16 v[116:117], v15 offset:8192
    ds_read_b64_tr_b16 v[118:119], v15 offset:9216
    s_waitcnt lgkmcnt(4)
    ds_read_b64_tr_b16 a[224:225], v14 offset:16384
    ds_read_b64_tr_b16 a[226:227], v14 offset:17408
    ds_read_b64_tr_b16 a[228:229], v14 offset:24576
    ds_read_b64_tr_b16 a[230:231], v14 offset:25600
    ds_read_b64_tr_b16 v[120:121], v15 offset:16384
    ds_read_b64_tr_b16 v[122:123], v15 offset:17408
    ds_read_b64_tr_b16 v[124:125], v15 offset:24576
    ds_read_b64_tr_b16 v[126:127], v15 offset:25600
    s_waitcnt lgkmcnt(4)
    ds_read_b64_tr_b16 a[232:233], v14 offset:32768
    ds_read_b64_tr_b16 a[234:235], v14 offset:33792
    ds_read_b64_tr_b16 a[236:237], v14 offset:40960
    ds_read_b64_tr_b16 a[238:239], v14 offset:41984
    ds_read_b64_tr_b16 v[128:129], v15 offset:32768
    ds_read_b64_tr_b16 v[130:131], v15 offset:33792
    ds_read_b64_tr_b16 v[132:133], v15 offset:40960
    ds_read_b64_tr_b16 v[134:135], v15 offset:41984
    s_waitcnt lgkmcnt(4)
    ds_read_b64_tr_b16 a[240:241], v14 offset:49152
    ds_read_b64_tr_b16 a[242:243], v14 offset:50176
    ds_read_b64_tr_b16 a[244:245], v14 offset:57344
    ds_read_b64_tr_b16 a[246:247], v14 offset:58368
    ds_read_b64_tr_b16 v[136:137], v15 offset:49152
    ds_read_b64_tr_b16 v[138:139], v15 offset:50176
    ds_read_b64_tr_b16 v[140:141], v15 offset:57344
    ds_read_b64_tr_b16 v[142:143], v15 offset:58368
    s_waitcnt lgkmcnt(4)
    s_waitcnt lgkmcnt(0)
    s_barrier
    s_load_dwordx2 s[8:9], s[42:43], 40
    s_waitcnt lgkmcnt(0)
    s_mov_b32 s10, 4718592
    s_mov_b32 s11, 0x20000
    s_mul_i32 s19, s12, 147456
    s_lshl_b32 s20, s13, 10
    s_add_u32 s20, s20, 0
    s_add_u32 s19, s19, s20
    s_mov_b32 s21, 16
Ldmo_20_m:
    s_mov_b32 m0, s20
    s_nop 0
    buffer_load_dwordx4 v0, s[8:11], s19 offen lds
    s_add_u32 s19, s19, 4096
    s_add_u32 s20, s20, 4096
    s_sub_u32 s21, s21, 1
    s_cmp_lg_u32 s21, 0
    s_cbranch_scc1 Ldmo_20_m
    s_waitcnt vmcnt(16)
    s_barrier
    ds_read_b64_tr_b16 a[248:249], v16 offset:0
    ds_read_b64_tr_b16 a[250:251], v16 offset:1024
    ds_read_b64_tr_b16 a[252:253], v16 offset:8192
    ds_read_b64_tr_b16 a[254:255], v16 offset:9216
    ds_read_b64_tr_b16 v[144:145], v17 offset:0
    ds_read_b64_tr_b16 v[146:147], v17 offset:1024
    ds_read_b64_tr_b16 v[148:149], v17 offset:8192
    ds_read_b64_tr_b16 v[150:151], v17 offset:9216
    s_waitcnt lgkmcnt(4)
    ds_read_b64_tr_b16 v[80:81], v16 offset:16384
    ds_read_b64_tr_b16 v[82:83], v16 offset:17408
    ds_read_b64_tr_b16 v[84:85], v16 offset:24576
    ds_read_b64_tr_b16 v[86:87], v16 offset:25600
    ds_read_b64_tr_b16 v[152:153], v17 offset:16384
    ds_read_b64_tr_b16 v[154:155], v17 offset:17408
    ds_read_b64_tr_b16 v[156:157], v17 offset:24576
    ds_read_b64_tr_b16 v[158:159], v17 offset:25600
    s_waitcnt lgkmcnt(4)
    ds_read_b64_tr_b16 v[88:89], v16 offset:32768
    ds_read_b64_tr_b16 v[90:91], v16 offset:33792
    ds_read_b64_tr_b16 v[92:93], v16 offset:40960
    ds_read_b64_tr_b16 v[94:95], v16 offset:41984
    ds_read_b64_tr_b16 v[160:161], v17 offset:32768
    ds_read_b64_tr_b16 v[162:163], v17 offset:33792
    ds_read_b64_tr_b16 v[164:165], v17 offset:40960
    ds_read_b64_tr_b16 v[166:167], v17 offset:41984
    s_waitcnt lgkmcnt(4)
    ds_read_b64_tr_b16 v[96:97], v16 offset:49152
    ds_read_b64_tr_b16 v[98:99], v16 offset:50176
    ds_read_b64_tr_b16 v[100:101], v16 offset:57344
    ds_read_b64_tr_b16 v[102:103], v16 offset:58368
    ds_read_b64_tr_b16 v[168:169], v17 offset:49152
    ds_read_b64_tr_b16 v[170:171], v17 offset:50176
    ds_read_b64_tr_b16 v[172:173], v17 offset:57344
    ds_read_b64_tr_b16 v[174:175], v17 offset:58368
    s_waitcnt lgkmcnt(4)
    ds_read_b64_tr_b16 v[104:105], v18 offset:0
    ds_read_b64_tr_b16 v[106:107], v18 offset:1024
    ds_read_b64_tr_b16 v[108:109], v18 offset:8192
    ds_read_b64_tr_b16 v[110:111], v18 offset:9216
    ds_read_b64_tr_b16 v[176:177], v19 offset:0
    ds_read_b64_tr_b16 v[178:179], v19 offset:1024
    ds_read_b64_tr_b16 v[180:181], v19 offset:8192
    ds_read_b64_tr_b16 v[182:183], v19 offset:9216
    s_waitcnt lgkmcnt(4)
    s_waitcnt lgkmcnt(0)
    s_barrier
    s_load_dwordx2 s[8:9], s[42:43], 40
    s_waitcnt lgkmcnt(0)
    s_mov_b32 s10, 4718592
    s_mov_b32 s11, 0x20000
    s_mul_i32 s19, s12, 147456
    s_lshl_b32 s20, s13, 10
    s_add_u32 s20, s20, 65536
    s_add_u32 s19, s19, s20
    s_mov_b32 s21, 20
Ldmo_21_m:
    s_mov_b32 m0, s20
    s_nop 0
    buffer_load_dwordx4 v0, s[8:11], s19 offen lds
    s_add_u32 s19, s19, 4096
    s_add_u32 s20, s20, 4096
    s_sub_u32 s21, s21, 1
    s_cmp_lg_u32 s21, 0
    s_cbranch_scc1 Ldmo_21_m
    v_lshrrev_b32 v72, 4, v0
    v_lshrrev_b32 v73, 4, v72
    v_bfe_u32 v74, v72, 2, 2
    v_lshrrev_b32 v75, 1, v74
    v_lshlrev_b32 v75, 4, v75
    v_and_b32 v74, 1, v74
    v_add_u32 v75, v75, v74
    v_lshl_add_u32 v75, v73, 2, v75
    v_mul_u32_u24 v75, 1152, v75
    v_and_b32 v74, 3, v72
    v_lshl_add_u32 v75, v74, 3, v75
    s_mul_i32 s19, s13, 288
    v_add_u32 v14, s19, v75
    v_add_u32 v15, 73728, v14
    s_mul_i32 s19, s13, 9216
    v_add_u32 v8, s19, v0
    v_add_u32 v9, 73728, v8
    s_waitcnt vmcnt(27)
    s_barrier
    ds_read_b64_tr_b16 v[20:21], v14 offset:0
    ds_read_b64_tr_b16 v[22:23], v14 offset:2304
    ds_read_b64_tr_b16 v[24:25], v14 offset:32
    ds_read_b64_tr_b16 v[26:27], v14 offset:2336
    ds_read_b64_tr_b16 v[28:29], v14 offset:64
    ds_read_b64_tr_b16 v[30:31], v14 offset:2368
    s_waitcnt lgkmcnt(2)
    ds_read_b64_tr_b16 v[32:33], v14 offset:96
    ds_read_b64_tr_b16 v[34:35], v14 offset:2400
    ds_read_b64_tr_b16 v[36:37], v14 offset:128
    ds_read_b64_tr_b16 v[38:39], v14 offset:2432
    ds_read_b64_tr_b16 v[40:41], v14 offset:160
    ds_read_b64_tr_b16 v[42:43], v14 offset:2464
    s_waitcnt lgkmcnt(2)
    ds_read_b64_tr_b16 v[44:45], v14 offset:192
    ds_read_b64_tr_b16 v[46:47], v14 offset:2496
    ds_read_b64_tr_b16 v[48:49], v14 offset:224
    ds_read_b64_tr_b16 v[50:51], v14 offset:2528
    ds_read_b64_tr_b16 v[52:53], v14 offset:256
    ds_read_b64_tr_b16 v[54:55], v14 offset:2560
    s_waitcnt lgkmcnt(2)
    s_waitcnt lgkmcnt(0)
    s_barrier
    ds_write_b128 v8, v[184:187] offset:0
    ds_write_b128 v8, v[192:195] offset:1024
    ds_write_b128 v8, v[200:203] offset:2048
    ds_write_b128 v8, v[208:211] offset:3072
    ds_write_b128 v8, v[216:219] offset:4096
    ds_write_b128 v8, v[224:227] offset:5120
    ds_write_b128 v8, v[232:235] offset:6144
    ds_write_b128 v8, v[240:243] offset:7168
    ds_write_b128 v8, v[248:251] offset:8192
    s_waitcnt lgkmcnt(0)
    v_mov_b32 v184, v20
    v_mov_b32 v185, v21
    v_mov_b32 v186, v22
    v_mov_b32 v187, v23
    v_mov_b32 v192, v24
    v_mov_b32 v193, v25
    v_mov_b32 v194, v26
    v_mov_b32 v195, v27
    v_mov_b32 v200, v28
    v_mov_b32 v201, v29
    v_mov_b32 v202, v30
    v_mov_b32 v203, v31
    v_mov_b32 v208, v32
    v_mov_b32 v209, v33
    v_mov_b32 v210, v34
    v_mov_b32 v211, v35
    v_mov_b32 v216, v36
    v_mov_b32 v217, v37
    v_mov_b32 v218, v38
    v_mov_b32 v219, v39
    v_mov_b32 v224, v40
    v_mov_b32 v225, v41
    v_mov_b32 v226, v42
    v_mov_b32 v227, v43
    v_mov_b32 v232, v44
    v_mov_b32 v233, v45
    v_mov_b32 v234, v46
    v_mov_b32 v235, v47
    v_mov_b32 v240, v48
    v_mov_b32 v241, v49
    v_mov_b32 v242, v50
    v_mov_b32 v243, v51
    v_mov_b32 v248, v52
    v_mov_b32 v249, v53
    v_mov_b32 v250, v54
    v_mov_b32 v251, v55
    s_waitcnt lgkmcnt(0)
    s_waitcnt vmcnt(18)
    s_barrier
    ds_read_b64_tr_b16 v[20:21], v14 offset:36864
    ds_read_b64_tr_b16 v[22:23], v14 offset:39168
    ds_read_b64_tr_b16 v[24:25], v14 offset:36896
    ds_read_b64_tr_b16 v[26:27], v14 offset:39200
    ds_read_b64_tr_b16 v[28:29], v14 offset:36928
    ds_read_b64_tr_b16 v[30:31], v14 offset:39232
    s_waitcnt lgkmcnt(2)
    ds_read_b64_tr_b16 v[32:33], v14 offset:36960
    ds_read_b64_tr_b16 v[34:35], v14 offset:39264
    ds_read_b64_tr_b16 v[36:37], v14 offset:36992
    ds_read_b64_tr_b16 v[38:39], v14 offset:39296
    ds_read_b64_tr_b16 v[40:41], v14 offset:37024
    ds_read_b64_tr_b16 v[42:43], v14 offset:39328
    s_waitcnt lgkmcnt(2)
    ds_read_b64_tr_b16 v[44:45], v14 offset:37056
    ds_read_b64_tr_b16 v[46:47], v14 offset:39360
    ds_read_b64_tr_b16 v[48:49], v14 offset:37088
    ds_read_b64_tr_b16 v[50:51], v14 offset:39392
    ds_read_b64_tr_b16 v[52:53], v14 offset:37120
    ds_read_b64_tr_b16 v[54:55], v14 offset:39424
    s_waitcnt lgkmcnt(2)
    s_waitcnt lgkmcnt(0)
    s_barrier
    ds_write_b128 v8, v[188:191] offset:36864
    ds_write_b128 v8, v[196:199] offset:37888
    ds_write_b128 v8, v[204:207] offset:38912
    ds_write_b128 v8, v[212:215] offset:39936
    ds_write_b128 v8, v[220:223] offset:40960
    ds_write_b128 v8, v[228:231] offset:41984
    ds_write_b128 v8, v[236:239] offset:43008
    ds_write_b128 v8, v[244:247] offset:44032
    ds_write_b128 v8, v[252:255] offset:45056
    s_waitcnt lgkmcnt(0)
    v_mov_b32 v188, v20
    v_mov_b32 v189, v21
    v_mov_b32 v190, v22
    v_mov_b32 v191, v23
    v_mov_b32 v196, v24
    v_mov_b32 v197, v25
    v_mov_b32 v198, v26
    v_mov_b32 v199, v27
    v_mov_b32 v204, v28
    v_mov_b32 v205, v29
    v_mov_b32 v206, v30
    v_mov_b32 v207, v31
    v_mov_b32 v212, v32
    v_mov_b32 v213, v33
    v_mov_b32 v214, v34
    v_mov_b32 v215, v35
    v_mov_b32 v220, v36
    v_mov_b32 v221, v37
    v_mov_b32 v222, v38
    v_mov_b32 v223, v39
    v_mov_b32 v228, v40
    v_mov_b32 v229, v41
    v_mov_b32 v230, v42
    v_mov_b32 v231, v43
    v_mov_b32 v236, v44
    v_mov_b32 v237, v45
    v_mov_b32 v238, v46
    v_mov_b32 v239, v47
    v_mov_b32 v244, v48
    v_mov_b32 v245, v49
    v_mov_b32 v246, v50
    v_mov_b32 v247, v51
    v_mov_b32 v252, v52
    v_mov_b32 v253, v53
    v_mov_b32 v254, v54
    v_mov_b32 v255, v55
    s_waitcnt lgkmcnt(0)
    s_waitcnt vmcnt(9)
    s_barrier
    ds_read_b64_tr_b16 v[20:21], v15 offset:0
    ds_read_b64_tr_b16 v[22:23], v15 offset:2304
    ds_read_b64_tr_b16 v[24:25], v15 offset:32
    ds_read_b64_tr_b16 v[26:27], v15 offset:2336
    ds_read_b64_tr_b16 v[28:29], v15 offset:64
    ds_read_b64_tr_b16 v[30:31], v15 offset:2368
    s_waitcnt lgkmcnt(2)
    ds_read_b64_tr_b16 v[32:33], v15 offset:96
    ds_read_b64_tr_b16 v[34:35], v15 offset:2400
    ds_read_b64_tr_b16 v[36:37], v15 offset:128
    ds_read_b64_tr_b16 v[38:39], v15 offset:2432
    ds_read_b64_tr_b16 v[40:41], v15 offset:160
    ds_read_b64_tr_b16 v[42:43], v15 offset:2464
    s_waitcnt lgkmcnt(2)
    ds_read_b64_tr_b16 v[44:45], v15 offset:192
    ds_read_b64_tr_b16 v[46:47], v15 offset:2496
    ds_read_b64_tr_b16 v[48:49], v15 offset:224
    ds_read_b64_tr_b16 v[50:51], v15 offset:2528
    ds_read_b64_tr_b16 v[52:53], v15 offset:256
    ds_read_b64_tr_b16 v[54:55], v15 offset:2560
    s_waitcnt lgkmcnt(2)
    s_waitcnt lgkmcnt(0)
    s_barrier
    ds_write_b128 v9, v[20:23] offset:0
    ds_write_b128 v9, v[24:27] offset:1024
    ds_write_b128 v9, v[28:31] offset:2048
    ds_write_b128 v9, v[32:35] offset:3072
    ds_write_b128 v9, v[36:39] offset:4096
    ds_write_b128 v9, v[40:43] offset:5120
    ds_write_b128 v9, v[44:47] offset:6144
    ds_write_b128 v9, v[48:51] offset:7168
    ds_write_b128 v9, v[52:55] offset:8192
    s_waitcnt lgkmcnt(0)
    s_waitcnt vmcnt(0)
    s_barrier
    ds_read_b64_tr_b16 v[20:21], v15 offset:36864
    ds_read_b64_tr_b16 v[22:23], v15 offset:39168
    ds_read_b64_tr_b16 v[24:25], v15 offset:36896
    ds_read_b64_tr_b16 v[26:27], v15 offset:39200
    ds_read_b64_tr_b16 v[28:29], v15 offset:36928
    ds_read_b64_tr_b16 v[30:31], v15 offset:39232
    s_waitcnt lgkmcnt(2)
    ds_read_b64_tr_b16 v[32:33], v15 offset:36960
    ds_read_b64_tr_b16 v[34:35], v15 offset:39264
    ds_read_b64_tr_b16 v[36:37], v15 offset:36992
    ds_read_b64_tr_b16 v[38:39], v15 offset:39296
    ds_read_b64_tr_b16 v[40:41], v15 offset:37024
    ds_read_b64_tr_b16 v[42:43], v15 offset:39328
    s_waitcnt lgkmcnt(2)
    ds_read_b64_tr_b16 v[44:45], v15 offset:37056
    ds_read_b64_tr_b16 v[46:47], v15 offset:39360
    ds_read_b64_tr_b16 v[48:49], v15 offset:37088
    ds_read_b64_tr_b16 v[50:51], v15 offset:39392
    ds_read_b64_tr_b16 v[52:53], v15 offset:37120
    ds_read_b64_tr_b16 v[54:55], v15 offset:39424
    s_waitcnt lgkmcnt(2)
    s_waitcnt lgkmcnt(0)
    s_barrier
    ds_write_b128 v9, v[20:23] offset:36864
    ds_write_b128 v9, v[24:27] offset:37888
    ds_write_b128 v9, v[28:31] offset:38912
    ds_write_b128 v9, v[32:35] offset:39936
    ds_write_b128 v9, v[36:39] offset:40960
    ds_write_b128 v9, v[40:43] offset:41984
    ds_write_b128 v9, v[44:47] offset:43008
    ds_write_b128 v9, v[48:51] offset:44032
    ds_write_b128 v9, v[52:55] offset:45056
    s_waitcnt lgkmcnt(0)
    s_barrier
    s_mov_b32 s14, 0
    s_lshl_b32 s15, s12, 13
    s_add_u32 s15, s15, 0
    s_lshl_b32 s16, s12, 11
    s_add_u32 s16, s16, 50331648
    s_mov_b32 s17, 58720256
    s_mov_b32 s53, 1
    s_mov_b32 s18, 59778048
    v_mov_b32 v12, 0
    v_mov_b32 v13, 0
    v_mov_b32 v14, 0
    v_mov_b32 v15, 0
    v_mov_b32 v16, 0
    v_mov_b32 v17, 0
    v_mov_b32 v18, 0
    v_mov_b32 v19, 0
    v_mov_b32 v20, 0
    v_mov_b32 v21, 0
    v_mov_b32 v22, 0
    v_mov_b32 v23, 0
    v_mov_b32 v24, 0
    v_mov_b32 v25, 0
    v_mov_b32 v26, 0
    v_mov_b32 v27, 0
    v_mov_b32 v28, 0
    v_mov_b32 v29, 0
    v_mov_b32 v30, 0
    v_mov_b32 v31, 0
    v_mov_b32 v32, 0
    v_mov_b32 v33, 0
    v_mov_b32 v34, 0
    v_mov_b32 v35, 0
    s_waitcnt vmcnt(0) lgkmcnt(0)
    s_barrier
    v_mov_b32 v72, 0
Lgb_22_m:
    global_load_dword v74, v72, s[40:41] offset:80 sc1
    s_waitcnt vmcnt(0)
    v_cmp_gt_u32 vcc, 32, v74
    s_cbranch_vccz Lgbok_23_m
    s_add_u32 s99, s99, 1
    s_cmp_lt_u32 s99, 4194304
    s_cbranch_scc1 Lgb_22_m
    s_endpgm
Lgbok_23_m:
    s_mov_b32 s19, 0
    s_mul_i32 s98, s19, 64
    s_add_u32 s98, s98, s12
    s_lshl_b32 s98, s98, 2
    s_add_u32 s98, s98, 61959168
Lf1_26:
    buffer_load_dword v63, off, s[4:7], s98 sc1
    s_waitcnt vmcnt(0)
    v_cmp_ne_u32 vcc, s90, v63
    s_cbranch_vccz Lf1ok_27
    s_sleep 1
    s_add_u32 s99, s99, 1
    s_cmp_lt_u32 s99, 4194304
    s_cbranch_scc1 Lf1_26
    s_endpgm
Lf1ok_27:
    s_add_u32 s20, s12, 32
    s_mul_i32 s98, s19, 64
    s_add_u32 s98, s98, s20
    s_lshl_b32 s98, s98, 2
    s_add_u32 s98, s98, 61959168
Lf1_28:
    buffer_load_dword v63, off, s[4:7], s98 sc1
    s_waitcnt vmcnt(0)
    v_cmp_ne_u32 vcc, s90, v63
    s_cbranch_vccz Lf1ok_29
    s_sleep 1
    s_add_u32 s99, s99, 1
    s_cmp_lt_u32 s99, 4194304
    s_cbranch_scc1 Lf1_28
    s_endpgm
Lf1ok_29:
    s_add_u32 s34, s23, s15
    s_cmp_lt_u32 s13, 2
    s_cselect_b32 s34, 3758096384, s34
    s_mul_i32 s35, s14, 128
    s_lshl_b32 s21, s12, 2
    s_add_u32 s35, s35, s21
    s_add_u32 s35, s35, 61986688
    s_mul_i32 s54, s14, 256
    s_add_u32 s54, s54, s21
    s_add_u32 s54, s54, 61959680
    s_cmp_eq_u32 s14, 0
    s_cselect_b32 s34, 3758096384, s34
    s_cselect_b32 s35, 3758096384, s35
    s_cmp_lg_u32 s13, 3
    s_cselect_b32 s35, 3758096384, s35
    s_cselect_b32 s54, 3758096384, s54
    ds_read_b128 v[64:67], v8 offset:0
    ds_read_b128 v[68:71], v8 offset:36864
    ds_read_b128 v[72:75], v8 offset:1024
    ds_read_b128 v[76:79], v8 offset:37888
    s_waitcnt lgkmcnt(0)
Lstep_24_m:
    ds_read_b64_tr_b16 v[36:37], v2 offset:0
    ds_read_b64_tr_b16 v[38:39], v3 offset:0
    ds_read_b64_tr_b16 v[40:41], v2 offset:1024
    ds_read_b64_tr_b16 v[42:43], v3 offset:1024
    ds_read_b64_tr_b16 v[44:45], v2 offset:2048
    ds_read_b64_tr_b16 v[46:47], v3 offset:2048
    s_waitcnt lgkmcnt(4)
    v_smfmac_f32_16x16x64_bf16 v[12:15], v[36:39], a[0:7], v1
    v_smfmac_f32_16x16x64_bf16 v[20:23], v[36:39], a[72:79], v1
    v_smfmac_f32_16x16x64_bf16 v[24:27], v[36:39], a[144:151], v1
    v_smfmac_f32_16x16x64_bf16 v[16:19], v[36:39], v[64:71], v1
    ds_read_b64_tr_b16 v[36:37], v2 offset:3072
    ds_read_b64_tr_b16 v[38:39], v3 offset:3072
    ds_read_b128 v[64:67], v8 offset:2048
    ds_read_b128 v[68:71], v8 offset:38912
    s_waitcnt lgkmcnt(6)
    v_smfmac_f32_16x16x64_bf16 v[12:15], v[40:43], a[8:15], v1
    buffer_load_dwordx4 v[48:51], v0, s[4:7], s15 offen offset:0
    v_smfmac_f32_16x16x64_bf16 v[20:23], v[40:43], a[80:87], v1
    v_smfmac_f32_16x16x64_bf16 v[24:27], v[40:43], a[152:159], v1
    v_smfmac_f32_16x16x64_bf16 v[16:19], v[40:43], v[72:79], v1
    ds_read_b64_tr_b16 v[40:41], v2 offset:4096
    ds_read_b64_tr_b16 v[42:43], v3 offset:4096
    ds_read_b128 v[72:75], v8 offset:3072
    ds_read_b128 v[76:79], v8 offset:39936
    s_waitcnt lgkmcnt(4)
    v_smfmac_f32_16x16x64_bf16 v[12:15], v[44:47], a[16:23], v1
    buffer_load_dwordx4 v[52:55], v0, s[4:7], s15 offen offset:1024
    v_smfmac_f32_16x16x64_bf16 v[20:23], v[44:47], a[88:95], v1
    v_smfmac_f32_16x16x64_bf16 v[24:27], v[44:47], a[160:167], v1
    v_smfmac_f32_16x16x64_bf16 v[16:19], v[44:47], v[64:71], v1
    ds_read_b64_tr_b16 v[44:45], v2 offset:5120
    ds_read_b64_tr_b16 v[46:47], v3 offset:5120
    ds_read_b128 v[64:67], v8 offset:4096
    ds_read_b128 v[68:71], v8 offset:40960
    s_waitcnt lgkmcnt(4)
    v_smfmac_f32_16x16x64_bf16 v[12:15], v[36:39], a[24:31], v1
    buffer_load_dwordx4 v[56:59], v0, s[4:7], s15 offen offset:2048
    v_smfmac_f32_16x16x64_bf16 v[20:23], v[36:39], a[96:103], v1
    v_smfmac_f32_16x16x64_bf16 v[24:27], v[36:39], a[168:175], v1
    v_smfmac_f32_16x16x64_bf16 v[16:19], v[36:39], v[72:79], v1
    ds_read_b64_tr_b16 v[36:37], v2 offset:6144
    ds_read_b64_tr_b16 v[38:39], v3 offset:6144
    ds_read_b128 v[72:75], v8 offset:5120
    ds_read_b128 v[76:79], v8 offset:41984
    s_waitcnt lgkmcnt(4)
    v_smfmac_f32_16x16x64_bf16 v[12:15], v[40:43], a[32:39], v1
    buffer_load_dwordx4 v[60:63], v0, s[4:7], s15 offen offset:3072
    v_smfmac_f32_16x16x64_bf16 v[20:23], v[40:43], a[104:111], v1
    v_smfmac_f32_16x16x64_bf16 v[24:27], v[40:43], a[176:183], v1
    v_smfmac_f32_16x16x64_bf16 v[16:19], v[40:43], v[64:71], v1
    ds_read_b64_tr_b16 v[40:41], v2 offset:7168
    ds_read_b64_tr_b16 v[42:43], v3 offset:7168
    ds_read_b128 v[64:67], v8 offset:6144
    ds_read_b128 v[68:71], v8 offset:43008
    s_waitcnt lgkmcnt(4)
    v_smfmac_f32_16x16x64_bf16 v[12:15], v[44:47], a[40:47], v1
    v_smfmac_f32_16x16x64_bf16 v[20:23], v[44:47], a[112:119], v1
    v_smfmac_f32_16x16x64_bf16 v[24:27], v[44:47], a[184:191], v1
    v_smfmac_f32_16x16x64_bf16 v[16:19], v[44:47], v[72:79], v1
    ds_read_b64_tr_b16 v[44:45], v2 offset:8192
    ds_read_b64_tr_b16 v[46:47], v3 offset:8192
    ds_read_b128 v[72:75], v8 offset:7168
    ds_read_b128 v[76:79], v8 offset:44032
    s_waitcnt lgkmcnt(4)
    v_smfmac_f32_16x16x64_bf16 v[12:15], v[36:39], a[48:55], v1
    v_smfmac_f32_16x16x64_bf16 v[20:23], v[36:39], a[120:127], v1
    v_smfmac_f32_16x16x64_bf16 v[24:27], v[36:39], a[192:199], v1
    v_smfmac_f32_16x16x64_bf16 v[16:19], v[36:39], v[64:71], v1
    ds_read_b128 v[64:67], v8 offset:8192
    ds_read_b128 v[68:71], v8 offset:45056
    s_waitcnt lgkmcnt(2)
    v_smfmac_f32_16x16x64_bf16 v[12:15], v[40:43], a[56:63], v1
    v_smfmac_f32_16x16x64_bf16 v[20:23], v[40:43], a[128:135], v1
    s_waitcnt vmcnt(4)
    v_mov_b64 v[28:29], 0
    v_mov_b64 v[30:31], 0
    v_mov_b64 v[32:33], 0
    v_mov_b64 v[34:35], 0
    v_smfmac_f32_16x16x64_bf16 v[24:27], v[40:43], a[200:207], v1
    v_smfmac_f32_16x16x64_bf16 v[16:19], v[40:43], v[72:79], v1
    s_waitcnt lgkmcnt(0)
    v_smfmac_f32_16x16x64_bf16 v[12:15], v[44:47], a[64:71], v1
    v_smfmac_f32_16x16x64_bf16 v[20:23], v[44:47], a[136:143], v1
    v_smfmac_f32_16x16x64_bf16 v[24:27], v[44:47], a[208:215], v1
    v_smfmac_f32_16x16x64_bf16 v[16:19], v[44:47], v[64:71], v1
    s_add_u32 s20, s15, 4096
    v_smfmac_f32_16x16x64_bf16 v[28:31], v[36:39], v[88:95], v1
    v_smfmac_f32_16x16x64_bf16 v[32:35], v[36:39], v[160:167], v1
    ds_read_b64_tr_b16 v[36:37], v2 offset:0
    ds_read_b64_tr_b16 v[38:39], v3 offset:0
    v_pk_add_f32 v[12:13], v[12:13], v[14:15]
    v_pk_add_f32 v[20:21], v[20:21], v[22:23]
    s_nop 0
    v_pk_add_f32 v[16:17], v[16:17], v[18:19]
    v_pk_add_f32 v[24:25], v[24:25], v[26:27]
    v_cvt_pk_bf16_f32 v20, v20, v21
    v_cvt_pk_bf16_f32 v21, v12, v13
    v_cvt_pk_bf16_f32 v24, v24, v25
    v_cvt_pk_bf16_f32 v25, v16, v17
    ds_write_b64 v4, v[20:21] offset:0
    ds_write_b64 v4, v[24:25] offset:512
    v_smfmac_f32_16x16x64_bf16 v[28:31], v[40:43], v[96:103], v1
    v_smfmac_f32_16x16x64_bf16 v[32:35], v[40:43], v[168:175], v1
    ds_read_b64_tr_b16 v[40:41], v2 offset:1024
    ds_read_b64_tr_b16 v[42:43], v3 offset:1024
    buffer_load_dwordx4 v[64:67], v0, s[4:7], s20 offen offset:0
    buffer_load_dwordx4 v[68:71], v0, s[4:7], s20 offen offset:1024
    buffer_load_dwordx4 v[72:75], v0, s[4:7], s20 offen offset:2048
    buffer_load_dwordx4 v[76:79], v0, s[4:7], s20 offen offset:3072
    v_smfmac_f32_16x16x64_bf16 v[28:31], v[44:47], v[104:111], v1
    v_smfmac_f32_16x16x64_bf16 v[32:35], v[44:47], v[176:183], v1
    ds_read_b64_tr_b16 v[44:45], v2 offset:2048
    ds_read_b64_tr_b16 v[46:47], v3 offset:2048
    buffer_store_dword v20, v11, s[4:7], s16 offen offset:0 sc1
    buffer_store_dword v24, v11, s[4:7], s16 offen offset:256 sc1
    s_waitcnt lgkmcnt(4)
    s_barrier
    v_smfmac_f32_16x16x64_bf16 v[28:31], v[36:39], a[216:223], v1
    v_smfmac_f32_16x16x64_bf16 v[32:35], v[36:39], v[112:119], v1
    ds_read_b64_tr_b16 v[36:37], v2 offset:3072
    ds_read_b64_tr_b16 v[38:39], v3 offset:3072
    ds_read_b64_tr_b16 v[12:13], v2 offset:9216
    ds_read_b64_tr_b16 v[14:15], v3 offset:9216
    ds_read_b64_tr_b16 v[16:17], v2 offset:10240
    ds_read_b64_tr_b16 v[18:19], v3 offset:10240
    ds_read_b64_tr_b16 v[20:21], v2 offset:11264
    ds_read_b64_tr_b16 v[22:23], v3 offset:11264
    ds_read_b64_tr_b16 v[24:25], v2 offset:12288
    ds_read_b64_tr_b16 v[26:27], v3 offset:12288
    s_waitcnt lgkmcnt(12)
    v_smfmac_f32_16x16x64_bf16 v[28:31], v[40:43], a[224:231], v1
    v_smfmac_f32_16x16x64_bf16 v[32:35], v[40:43], v[120:127], v1
    s_waitcnt lgkmcnt(10)
    ds_read_b64_tr_b16 v[40:41], v2 offset:4096
    ds_read_b64_tr_b16 v[42:43], v3 offset:4096
    v_smfmac_f32_16x16x64_bf16 v[28:31], v[44:47], a[232:239], v1
    v_smfmac_f32_16x16x64_bf16 v[32:35], v[44:47], v[128:135], v1
    ds_read_b64_tr_b16 v[44:45], v2 offset:5120
    ds_read_b64_tr_b16 v[46:47], v3 offset:5120
    s_waitcnt lgkmcnt(12)
    v_smfmac_f32_16x16x64_bf16 v[28:31], v[36:39], a[240:247], v1
    v_smfmac_f32_16x16x64_bf16 v[32:35], v[36:39], v[136:143], v1
    s_waitcnt lgkmcnt(4)
    s_waitcnt vmcnt(6)
    v_mfma_f32_16x16x32_bf16 v[36:39], v[48:51], v[12:15], 0
    v_mfma_f32_16x16x32_bf16 v[36:39], v[52:55], v[16:19], v[36:39]
    v_mfma_f32_16x16x32_bf16 v[36:39], v[56:59], v[20:23], v[36:39]
    v_mfma_f32_16x16x32_bf16 v[36:39], v[60:63], v[24:27], v[36:39]
    s_waitcnt lgkmcnt(2)
    v_smfmac_f32_16x16x64_bf16 v[28:31], v[40:43], a[248:255], v1
    v_smfmac_f32_16x16x64_bf16 v[32:35], v[40:43], v[144:151], v1
    s_waitcnt lgkmcnt(0)
    v_smfmac_f32_16x16x64_bf16 v[28:31], v[44:47], v[80:87], v1
    v_smfmac_f32_16x16x64_bf16 v[32:35], v[44:47], v[152:159], v1
    s_add_u32 s19, s15, s37
    buffer_load_dwordx4 v[40:43], v0, s[4:7], s19 offen offset:0 sc1
    buffer_load_dwordx4 v[44:47], v0, s[4:7], s19 offen offset:1024 sc1
    v_mfma_f32_16x16x32_bf16 v[52:55], v[12:15], v[12:15], 0
    v_lshlrev_b32 v10, 3, v0
    buffer_load_dword v10, v10, s[4:7], s34 offen sc1
    v_mfma_f32_16x16x32_bf16 v[52:55], v[16:19], v[16:19], v[52:55]
    v_mov_b32 v62, s90
    v_lshlrev_b32 v63, 3, v0
    v_mfma_f32_16x16x32_bf16 v[52:55], v[20:23], v[20:23], v[52:55]
    s_mov_b64 exec, 1
    buffer_store_dword v62, off, s[4:7], s35 sc1
    s_mov_b64 exec, -1
    v_mfma_f32_16x16x32_bf16 v[52:55], v[24:27], v[24:27], v[52:55]
    s_mov_b64 exec, 3
    buffer_load_dword v10, v63, s[4:7], s54 offen sc1
    s_mov_b64 exec, -1
    s_waitcnt vmcnt(7)
    v_mfma_f32_16x16x32_bf16 v[48:51], v[64:67], v[12:15], 0
    v_pk_add_f32 v[28:29], v[28:29], v[30:31]
    v_pk_add_f32 v[32:33], v[32:33], v[34:35]
    v_mfma_f32_16x16x32_bf16 v[48:51], v[68:71], v[16:19], v[48:51]
    v_cvt_pk_bf16_f32 v28, v28, v29
    v_cvt_pk_bf16_f32 v30, v32, v33
    v_mfma_f32_16x16x32_bf16 v[48:51], v[72:75], v[20:23], v[48:51]
    v_mov_b32 v29, 0
    v_mov_b32 v31, 0
    v_mfma_f32_16x16x32_bf16 v[48:51], v[76:79], v[24:27], v[48:51]
    s_add_u32 s19, s16, 4194304
    buffer_store_dword v28, v11, s[4:7], s19 offen sc1
    buffer_store_dword v30, v11, s[4:7], s19 offen offset:256 sc1
    s_cmp_eq_u32 s14, 63
    s_cbranch_scc1 Lfin_25_m
    v_max3_f32 v62, v36, v37, v38
    v_max3_f32 v62, v62, v39, v52
    ds_read_b128 v[12:15], v9 offset:0
    ds_read_b128 v[16:19], v9 offset:36864
    v_max3_f32 v63, v53, v48, v49
    v_max3_f32 v63, v63, v50, v51
    v_max_f32 v62, v62, v63
    v_mov_b32 v63, v62
    v_mov_b32 v64, 0x3f803f80
    v_mov_b32 v65, 0x3f803f80
    v_permlane32_swap_b32 v62, v63
    v_max_f32 v62, v62, v63
    v_mov_b32 v63, v62
    v_mov_b32 v66, 0x3f803f80
    v_mov_b32 v67, 0x3f803f80
    v_permlane16_swap_b32 v62, v63
    v_max_f32 v62, v62, v63
    v_mul_f32 v62, s24, v62
    v_fma_f32 v36, v36, s24, -v62
    v_fma_f32 v37, v37, s24, -v62
    v_fma_f32 v38, v38, s24, -v62
    v_fma_f32 v39, v39, s24, -v62
    v_fma_f32 v52, v52, s24, -v62
    v_fma_f32 v53, v53, s24, -v62
    v_fma_f32 v48, v48, s24, -v62
    v_fma_f32 v49, v49, s24, -v62
    v_fma_f32 v50, v50, s24, -v62
    v_fma_f32 v51, v51, s24, -v62
    v_exp_f32 v36, v36
    v_exp_f32 v37, v37
    v_exp_f32 v38, v38
    v_exp_f32 v39, v39
    v_exp_f32 v52, v52
    v_exp_f32 v53, v53
    v_exp_f32 v48, v48
    v_exp_f32 v49, v49
    v_exp_f32 v50, v50
    v_exp_f32 v51, v51
    v_mov_b32 v61, 0
    v_cvt_pk_bf16_f32 v60, v52, v53
    v_cvt_pk_bf16_f32 v56, v36, v37
    v_cvt_pk_bf16_f32 v57, v38, v39
    v_cvt_pk_bf16_f32 v58, v48, v49
    v_cvt_pk_bf16_f32 v59, v50, v51
    s_waitcnt vmcnt(5)
    v_mfma_f32_16x16x16_bf16 v[76:79], v[64:65], v[60:61], 0
    v_mfma_f32_16x16x16_bf16 v[68:71], v[28:29], v[60:61], 0
    v_mfma_f32_16x16x16_bf16 v[72:75], v[30:31], v[60:61], 0
    ds_read_b128 v[20:23], v9 offset:1024
    ds_read_b128 v[24:27], v9 offset:37888
    s_nop 1
    v_mfma_f32_16x16x32_bf16 v[76:79], v[64:67], v[56:59], v[76:79]
    v_mfma_f32_16x16x32_bf16 v[68:71], v[40:43], v[56:59], v[68:71]
    v_mfma_f32_16x16x32_bf16 v[72:75], v[44:47], v[56:59], v[72:75]
    ds_read_b128 v[28:31], v9 offset:2048
    ds_read_b128 v[32:35], v9 offset:38912
    v_mov_b64 v[36:37], 0
    v_mov_b64 v[38:39], 0
    v_mov_b64 v[48:49], 0
    v_mov_b64 v[50:51], 0
    v_mov_b64 v[52:53], 0
    v_mov_b64 v[54:55], 0
    v_rcp_f32 v62, v76
    s_nop 0
    v_pk_mul_f32 v[68:69], v[68:69], v[62:63] op_sel_hi:[1,0]
    v_pk_mul_f32 v[70:71], v[70:71], v[62:63] op_sel_hi:[1,0]
    v_pk_mul_f32 v[72:73], v[72:73], v[62:63] op_sel_hi:[1,0]
    v_pk_mul_f32 v[74:75], v[74:75], v[62:63] op_sel_hi:[1,0]
    v_cvt_pk_bf16_f32 v56, v68, v69
    v_cvt_pk_bf16_f32 v57, v70, v71
    v_cvt_pk_bf16_f32 v58, v72, v73
    v_cvt_pk_bf16_f32 v59, v74, v75
    s_mov_b64 exec, s[30:31]
    ds_write_b64 v5, v[56:57]
    ds_write_b64 v5, v[58:59] offset:32
    s_mov_b64 exec, -1
    v_add_u32 v64, 160768, v0
    v_mov_b64 v[40:41], 0
    v_mov_b64 v[42:43], 0
    v_mov_b64 v[44:45], 0
    v_mov_b64 v[46:47], 0
    s_waitcnt lgkmcnt(0)
    s_barrier
    ds_read_b128 v[60:63], v64
    ds_read_b128 v[64:67], v64 offset:1024
    v_mov_b64 v[68:69], 0
    v_mov_b64 v[70:71], 0
    v_mov_b64 v[72:73], 0
    v_mov_b64 v[74:75], 0
    v_mov_b64 v[76:77], 0
    v_mov_b64 v[78:79], 0
    v_mov_b64 v[56:57], 0
    v_mov_b64 v[58:59], 0
    s_add_u32 s44, s17, s26
    s_add_u32 s45, s44, 8192
    s_add_u32 s46, s45, 8192
    s_add_u32 s47, s46, 8192
    s_add_u32 s48, s47, 8192
    s_add_u32 s49, s48, 8192
    s_add_u32 s50, s49, 8192
    s_add_u32 s51, s50, 8192
    s_add_u32 s52, s51, 8192
    s_waitcnt lgkmcnt(0)
    v_smfmac_f32_16x16x64_bf16 v[36:39], v[60:63], v[184:191], v1
    v_smfmac_f32_16x16x64_bf16 v[36:39], v[64:67], v[12:19], v1
    ds_read_b128 v[12:15], v9 offset:3072
    ds_read_b128 v[16:19], v9 offset:39936
    v_smfmac_f32_16x16x64_bf16 v[40:43], v[60:63], v[192:199], v1
    v_smfmac_f32_16x16x64_bf16 v[40:43], v[64:67], v[20:27], v1
    ds_read_b128 v[20:23], v9 offset:4096
    ds_read_b128 v[24:27], v9 offset:40960
    s_nop 1
    v_pk_add_f32 v[36:37], v[36:37], v[38:39]
    v_cvt_pk_bf16_f32 v36, v36, v37
    v_bfi_b32 v36, 1, s53, v36
    buffer_store_dword v36, v6, s[4:7], s44 offen
    v_smfmac_f32_16x16x64_bf16 v[44:47], v[60:63], v[200:207], v1
    v_smfmac_f32_16x16x64_bf16 v[44:47], v[64:67], v[28:35], v1
    ds_read_b128 v[28:31], v9 offset:5120
    ds_read_b128 v[32:35], v9 offset:41984
    v_pk_add_f32 v[40:41], v[40:41], v[42:43]
    v_cvt_pk_bf16_f32 v40, v40, v41
    v_bfi_b32 v40, 1, s53, v40
    buffer_store_dword v40, v6, s[4:7], s45 offen
    v_smfmac_f32_16x16x64_bf16 v[48:51], v[60:63], v[208:215], v1
    s_waitcnt lgkmcnt(4)
    v_smfmac_f32_16x16x64_bf16 v[48:51], v[64:67], v[12:19], v1
    ds_read_b128 v[12:15], v9 offset:6144
    ds_read_b128 v[16:19], v9 offset:43008
    v_pk_add_f32 v[44:45], v[44:45], v[46:47]
    v_cvt_pk_bf16_f32 v44, v44, v45
    v_bfi_b32 v44, 1, s53, v44
    buffer_store_dword v44, v6, s[4:7], s46 offen
    v_smfmac_f32_16x16x64_bf16 v[52:55], v[60:63], v[216:223], v1
    s_waitcnt lgkmcnt(4)
    v_smfmac_f32_16x16x64_bf16 v[52:55], v[64:67], v[20:27], v1
    ds_read_b128 v[20:23], v9 offset:7168
    ds_read_b128 v[24:27], v9 offset:44032
    v_pk_add_f32 v[48:49], v[48:49], v[50:51]
    v_cvt_pk_bf16_f32 v48, v48, v49
    v_bfi_b32 v48, 1, s53, v48
    buffer_store_dword v48, v6, s[4:7], s47 offen
    v_smfmac_f32_16x16x64_bf16 v[68:71], v[60:63], v[224:231], v1
    s_waitcnt lgkmcnt(4)
    v_smfmac_f32_16x16x64_bf16 v[68:71], v[64:67], v[28:35], v1
    ds_read_b128 v[28:31], v9 offset:8192
    ds_read_b128 v[32:35], v9 offset:45056
    v_pk_add_f32 v[52:53], v[52:53], v[54:55]
    v_cvt_pk_bf16_f32 v52, v52, v53
    v_bfi_b32 v52, 1, s53, v52
    buffer_store_dword v52, v6, s[4:7], s48 offen
    v_smfmac_f32_16x16x64_bf16 v[72:75], v[60:63], v[232:239], v1
    s_waitcnt lgkmcnt(4)
    v_smfmac_f32_16x16x64_bf16 v[72:75], v[64:67], v[12:19], v1
    v_pk_add_f32 v[68:69], v[68:69], v[70:71]
    v_cvt_pk_bf16_f32 v68, v68, v69
    v_bfi_b32 v68, 1, s53, v68
    buffer_store_dword v68, v6, s[4:7], s49 offen
    v_smfmac_f32_16x16x64_bf16 v[76:79], v[60:63], v[240:247], v1
    s_waitcnt lgkmcnt(2)
    v_smfmac_f32_16x16x64_bf16 v[76:79], v[64:67], v[20:27], v1
    s_nop 0
    v_pk_add_f32 v[72:73], v[72:73], v[74:75]
    v_cvt_pk_bf16_f32 v72, v72, v73
    v_bfi_b32 v72, 1, s53, v72
    buffer_store_dword v72, v6, s[4:7], s50 offen
    v_smfmac_f32_16x16x64_bf16 v[56:59], v[60:63], v[248:255], v1
    s_waitcnt lgkmcnt(0)
    v_smfmac_f32_16x16x64_bf16 v[56:59], v[64:67], v[28:35], v1
    v_pk_add_f32 v[76:77], v[76:77], v[78:79]
    v_cvt_pk_bf16_f32 v76, v76, v77
    v_bfi_b32 v76, 1, s53, v76
    buffer_store_dword v76, v6, s[4:7], s51 offen
    s_nop 3
    v_pk_add_f32 v[56:57], v[56:57], v[58:59]
    v_cvt_pk_bf16_f32 v56, v56, v57
    v_bfi_b32 v56, 1, s53, v56
    buffer_store_dword v56, v6, s[4:7], s52 offen
    s_cmp_eq_u32 s25, -1
    s_cbranch_scc1 Lnored_30_m
    s_add_u32 s19, s17, s25
    s_sleep 4
    buffer_load_dwordx4 v[12:15], v0, s[4:7], s19 offen offset:0 sc1
    buffer_load_dwordx4 v[16:19], v0, s[4:7], s19 offen offset:1024 sc1
    buffer_load_dwordx4 v[20:23], v0, s[4:7], s19 offen offset:2048 sc1
    buffer_load_dwordx4 v[24:27], v0, s[4:7], s19 offen offset:3072 sc1
    v_bfe_u32 v60, v0, 4, 1
    v_lshlrev_b32 v60, 4, v60
    v_mov_b32 v61, 0x3f80
    v_lshlrev_b32 v60, v60, v61
    v_bfe_u32 v61, v0, 5, 3
    v_cmp_eq_u32 vcc, 0, v61
    s_nop 1
    v_cndmask_b32 v44, 0, v60, vcc
    v_cmp_eq_u32 vcc, 1, v61
    s_nop 1
    v_cndmask_b32 v45, 0, v60, vcc
    v_cmp_eq_u32 vcc, 2, v61
    s_nop 1
    v_cndmask_b32 v46, 0, v60, vcc
    v_cmp_eq_u32 vcc, 3, v61
    s_nop 1
    v_cndmask_b32 v47, 0, v60, vcc
    v_bfe_u32 v60, v0, 4, 2
    v_lshlrev_b32 v60, 6, v60
    v_bfe_u32 v61, v0, 8, 1
    v_lshl_add_u32 v60, v61, 5, v60
    v_bfe_u32 v61, v0, 6, 1
    v_lshl_add_u32 v60, v61, 3, v60
    v_xor_b32 v60, s38, v60
    s_add_u32 s20, s36, s18
    s_cmp_eq_u32 s53, 0
    s_cbranch_scc1 Lrst0_33
Lrs_34_m:
    s_waitcnt vmcnt(0)
    v_mfma_f32_16x16x32_bf16 v[48:51], v[44:47], v[12:15], 0
    v_mfma_f32_16x16x32_bf16 v[48:51], v[44:47], v[16:19], v[48:51]
    v_mfma_f32_16x16x32_bf16 v[48:51], v[44:47], v[20:23], v[48:51]
    v_mfma_f32_16x16x32_bf16 v[48:51], v[44:47], v[24:27], v[48:51]
    v_bitop3_b32 v61, v12, v13, v14 bitop3:0x80
    v_bitop3_b32 v61, v61, v15, v16 bitop3:0x80
    v_bitop3_b32 v61, v61, v17, v18 bitop3:0x80
    v_bitop3_b32 v61, v61, v19, v20 bitop3:0x80
    v_bitop3_b32 v61, v61, v21, v22 bitop3:0x80
    v_bitop3_b32 v61, v61, v23, v24 bitop3:0x80
    v_bitop3_b32 v61, v61, v25, v26 bitop3:0x80
    v_and_b32 v61, v61, v27
    v_and_b32 v61, 1, v61
    v_cmp_ne_u32 vcc, 1, v61
    s_cbranch_vccz LrsJ_32_m
    buffer_load_dwordx4 v[12:15], v0, s[4:7], s19 offen offset:0 sc1
    buffer_load_dwordx4 v[16:19], v0, s[4:7], s19 offen offset:1024 sc1
    buffer_load_dwordx4 v[20:23], v0, s[4:7], s19 offen offset:2048 sc1
    buffer_load_dwordx4 v[24:27], v0, s[4:7], s19 offen offset:3072 sc1
    s_add_u32 s99, s99, 1
    s_cmp_lt_u32 s99, 4194304
    s_cbranch_scc1 Lrs_34_m
    s_endpgm
Lrst0_33:
Lrs_35_m:
    s_waitcnt vmcnt(0)
    v_mfma_f32_16x16x32_bf16 v[48:51], v[44:47], v[12:15], 0
    v_mfma_f32_16x16x32_bf16 v[48:51], v[44:47], v[16:19], v[48:51]
    v_mfma_f32_16x16x32_bf16 v[48:51], v[44:47], v[20:23], v[48:51]
    v_mfma_f32_16x16x32_bf16 v[48:51], v[44:47], v[24:27], v[48:51]
    v_or3_b32 v61, v12, v13, v14
    v_or3_b32 v61, v61, v15, v16
    v_or3_b32 v61, v61, v17, v18
    v_or3_b32 v61, v61, v19, v20
    v_or3_b32 v61, v61, v21, v22
    v_or3_b32 v61, v61, v23, v24
    v_or3_b32 v61, v61, v25, v26
    v_or_b32 v61, v61, v27
    v_and_b32 v61, 1, v61
    v_cmp_ne_u32 vcc, 0, v61
    s_cbranch_vccz LrsJ_32_m
    buffer_load_dwordx4 v[12:15], v0, s[4:7], s19 offen offset:0 sc1
    buffer_load_dwordx4 v[16:19], v0, s[4:7], s19 offen offset:1024 sc1
    buffer_load_dwordx4 v[20:23], v0, s[4:7], s19 offen offset:2048 sc1
    buffer_load_dwordx4 v[24:27], v0, s[4:7], s19 offen offset:3072 sc1
    s_add_u32 s99, s99, 1
    s_cmp_lt_u32 s99, 4194304
    s_cbranch_scc1 Lrs_35_m
    s_endpgm
LrsJ_32_m:
    v_add_f32_dpp v48, v48, v48 row_ror:8 row_mask:0xf bank_mask:0xf
    v_add_f32_dpp v49, v49, v49 row_ror:8 row_mask:0xf bank_mask:0xf
    v_add_f32_dpp v50, v50, v50 row_ror:8 row_mask:0xf bank_mask:0xf
    v_add_f32_dpp v51, v51, v51 row_ror:8 row_mask:0xf bank_mask:0xf
    v_cvt_pk_bf16_f32 v48, v48, v49
    v_cvt_pk_bf16_f32 v49, v50, v51
    s_mov_b64 exec, s[32:33]
    buffer_store_dwordx2 v[48:49], v60, s[4:7], s20 offen
    s_mov_b64 exec, -1
    s_branch Lagp_31_m
Lnored_30_m:
    s_sleep 10
Lagp_31_m:
    v_mov_b64 v[12:13], 0
    v_mov_b64 v[14:15], 0
    v_mov_b64 v[16:17], 0
    v_mov_b64 v[18:19], 0
    v_mov_b64 v[20:21], 0
    v_mov_b64 v[22:23], 0
    v_mov_b64 v[24:25], 0
    v_mov_b64 v[26:27], 0
    s_add_u32 s19, s18, s27
    s_add_u32 s22, s18, 8192
    s_cmp_eq_u32 s13, 3
    s_cselect_b32 s22, s22, 0xe0000000
    s_sleep 2
    buffer_load_dwordx4 v[48:51], v0, s[4:7], s19 offen sc1
    buffer_load_dwordx4 v[52:55], v0, s[4:7], s19 offen offset:1024 sc1
    buffer_load_dwordx4 v[56:59], v0, s[4:7], s22 offen sc1
    ds_read_b128 v[64:67], v8 offset:0
    ds_read_b128 v[68:71], v8 offset:36864
    ds_read_b128 v[72:75], v8 offset:1024
    ds_read_b128 v[76:79], v8 offset:37888
    s_add_u32 s14, s14, 1
    s_add_u32 s15, s15, 262144
    s_add_u32 s16, s16, 65536
    s_add_u32 s18, s18, 9216
    s_xor_b32 s17, s17, 294912
    s_lshr_b32 s53, s14, 1
    s_and_b32 s53, s53, 1
    s_xor_b32 s53, s53, 1
    s_add_u32 s34, s23, s15
    s_cmp_lt_u32 s13, 2
    s_cselect_b32 s34, 3758096384, s34
    s_mul_i32 s35, s14, 128
    s_lshl_b32 s21, s12, 2
    s_add_u32 s35, s35, s21
    s_add_u32 s35, s35, 61986688
    s_mul_i32 s54, s14, 256
    s_add_u32 s54, s54, s21
    s_add_u32 s54, s54, 61959680
    s_cmp_eq_u32 s14, 0
    s_cselect_b32 s34, 3758096384, s34
    s_cselect_b32 s35, 3758096384, s35
    s_cmp_lg_u32 s13, 3
    s_cselect_b32 s35, 3758096384, s35
    s_cselect_b32 s54, 3758096384, s54
Lag_36_m:
    s_waitcnt vmcnt(0)
    v_max3_u32 v36, v48, v49, v50
    v_max3_u32 v36, v36, v51, v52
    v_max3_u32 v36, v36, v53, v54
    v_max3_u32 v36, v36, v55, v56
    v_max3_u32 v36, v36, v57, v58
    v_max_u32 v36, v36, v59
    v_cmp_eq_u32 vcc, -1, v36
    s_cbranch_vccz LagA_37_m
    buffer_load_dwordx4 v[48:51], v0, s[4:7], s19 offen sc1
    buffer_load_dwordx4 v[52:55], v0, s[4:7], s19 offen offset:1024 sc1
    buffer_load_dwordx4 v[56:59], v0, s[4:7], s22 offen sc1
    s_add_u32 s99, s99, 1
    s_cmp_lt_u32 s99, 4194304
    s_cbranch_scc1 Lag_36_m
    s_endpgm
LagA_37_m:
    ds_write_b128 v7, v[48:51]
    ds_write_b128 v7, v[52:55] offset:1024
    s_cmp_lg_u32 s13, 3
    s_cbranch_scc1 Lag3_40
    ds_write_b128 v7, v[56:59] offset:2048
Lag3_40:
LagJ_39_m:
    s_cmp_lg_u32 s13, 3
    s_cbranch_scc1 Lkvok_41_m
    v_cmp_eq_u32 vcc, s90, v10
    s_nop 3
    s_and_b32 vcc_lo, vcc_lo, 3
    s_cmp_eq_u32 vcc_lo, 3
    s_cbranch_scc1 Lkvok_41_m
    s_add_u32 s21, s14, 1
    s_cmp_gt_u32 s21, 63
    s_cbranch_scc1 Lkvok_41_m
    s_mul_i32 s98, s21, 64
    s_add_u32 s98, s98, s12
    s_lshl_b32 s98, s98, 2
    s_add_u32 s98, s98, 61959168
Lf1_42:
    buffer_load_dword v10, off, s[4:7], s98 sc1
    s_waitcnt vmcnt(0)
    v_cmp_ne_u32 vcc, s90, v10
    s_cbranch_vccz Lf1ok_43
    s_sleep 2
    s_add_u32 s99, s99, 1
    s_cmp_lt_u32 s99, 4194304
    s_cbranch_scc1 Lf1_42
    s_endpgm
Lf1ok_43:
    s_add_u32 s20, s12, 32
    s_mul_i32 s98, s21, 64
    s_add_u32 s98, s98, s20
    s_lshl_b32 s98, s98, 2
    s_add_u32 s98, s98, 61959168
Lf1_44:
    buffer_load_dword v10, off, s[4:7], s98 sc1
    s_waitcnt vmcnt(0)
    v_cmp_ne_u32 vcc, s90, v10
    s_cbranch_vccz Lf1ok_45
    s_sleep 2
    s_add_u32 s99, s99, 1
    s_cmp_lt_u32 s99, 4194304
    s_cbranch_scc1 Lf1_44
    s_endpgm
Lf1ok_45:
Lkvok_41_m:
    s_waitcnt lgkmcnt(0)
    s_barrier
    s_branch Lstep_24_m
Lfin_25_m:
    s_waitcnt vmcnt(0)
    s_barrier
    s_cmp_lg_u32 s13, 0
    s_cbranch_scc1 Lfs0_46
    s_mul_i32 s98, s14, 32
    s_add_u32 s98, s98, s12
    s_lshl_b32 s98, s98, 2
    s_add_u32 s98, s98, 61986816
    v_mov_b32 v12, s90
    s_mov_b64 exec, 1
    buffer_store_dword v12, off, s[4:7], s98 offset:0 sc1
    s_mov_b64 exec, -1
Lfs0_46:
    s_add_u32 s12, s12, 152
    s_branch Lout_main
Lworker_1_m:
    s_sub_u32 s12, s97, 96
    s_cmp_lt_u32 s12, 54
    s_cbranch_scc0 Lnomod_47_m
    s_load_dwordx2 s[8:9], s[42:43], 104
    s_waitcnt lgkmcnt(0)
    s_mov_b32 s10, 3981312
    s_mov_b32 s11, 0x20000
    s_load_dwordx2 s[24:25], s[42:43], 96
    s_waitcnt lgkmcnt(0)
    s_mov_b32 s26, 1152
    s_mov_b32 s27, 0x20000
    v_lshrrev_b32 v1, 4, v0
    v_lshrrev_b32 v2, 3, v1
    v_and_b32 v3, 7, v1
    v_mul_u32_u24 v4, 6912, v2
    v_lshl_add_u32 v4, v3, 4, v4
    s_mul_i32 s19, s13, 995328
    s_lshl_b32 s20, s12, 7
    s_add_u32 s19, s19, s20
    s_mul_i32 s20, s13, 18432
    s_mov_b32 s21, 18
Lmd_49_m:
    s_mov_b32 m0, s20
    s_nop 0
    buffer_load_dwordx4 v4, s[8:11], s19 offen lds
    s_add_u32 s19, s19, 55296
    s_add_u32 s20, s20, 1024
    s_sub_u32 s21, s21, 1
    s_cmp_lg_u32 s21, 0
    s_cbranch_scc1 Lmd_49_m
    s_mul_i32 s19, s13, 288
    v_lshlrev_b32 v8, 1, v1
    buffer_load_ushort v10, v8, s[24:27], s19 offen offset:0
    buffer_load_ushort v11, v8, s[24:27], s19 offen offset:128
    buffer_load_ushort v12, v8, s[24:27], s19 offen offset:256
    s_mul_i32 s19, s13, 768
    s_add_u32 s19, s19, 73728
    v_lshlrev_b32 v5, 2, v1
    v_add_u32 v5, s19, v5
    s_waitcnt vmcnt(0)
    v_lshlrev_b32 v10, 16, v10
    v_mul_f32 v8, 0xbfb8aa3b, v10
    v_exp_f32 v8, v8
    s_nop 0
    v_add_f32 v8, 1.0, v8
    v_rcp_f32 v8, v8
    s_nop 0
    v_mul_f32 v10, v10, v8
    v_cvt_pk_bf16_f32 v8, v10, v10
    v_lshlrev_b32 v10, 16, v8
    ds_write_b32 v5, v10 offset:0
    v_lshlrev_b32 v11, 16, v11
    v_mul_f32 v8, 0xbfb8aa3b, v11
    v_exp_f32 v8, v8
    s_nop 0
    v_add_f32 v8, 1.0, v8
    v_rcp_f32 v8, v8
    s_nop 0
    v_mul_f32 v11, v11, v8
    v_cvt_pk_bf16_f32 v8, v11, v11
    v_lshlrev_b32 v11, 16, v8
    ds_write_b32 v5, v11 offset:256
    v_lshlrev_b32 v12, 16, v12
    v_mul_f32 v8, 0xbfb8aa3b, v12
    v_exp_f32 v8, v8
    s_nop 0
    v_add_f32 v8, 1.0, v8
    v_rcp_f32 v8, v8
    s_nop 0
    v_mul_f32 v12, v12, v8
    v_cvt_pk_bf16_f32 v8, v12, v12
    v_lshlrev_b32 v12, 16, v8
    ds_write_b32 v5, v12 offset:512
    v_mov_b32 v16, 0
    v_mov_b32 v17, 0
    v_mov_b32 v18, 0
    v_mov_b32 v19, 0
    v_mov_b32 v20, 0
    v_mov_b32 v21, 0
    v_mov_b32 v22, 0
    v_mov_b32 v23, 0
    s_mul_i32 s20, s13, 18432
    v_add_u32 v6, s20, v0
    v_lshlrev_b32 v5, 2, v2
    v_add_u32 v5, s19, v5
    s_mov_b32 s21, 18
    s_waitcnt lgkmcnt(0)
Lmc_50_m:
    ds_read_b128 v[24:27], v6
    ds_read_b32 v28, v5
    v_add_u32 v6, 1024, v6
    v_add_u32 v5, 32, v5
    s_waitcnt lgkmcnt(0)
    v_lshlrev_b32 v8, 16, v24
    v_and_b32 v9, 0xffff0000, v24
    v_fmac_f32 v16, v28, v8
    v_fmac_f32 v17, v28, v9
    v_lshlrev_b32 v8, 16, v25
    v_and_b32 v9, 0xffff0000, v25
    v_fmac_f32 v18, v28, v8
    v_fmac_f32 v19, v28, v9
    v_lshlrev_b32 v8, 16, v26
    v_and_b32 v9, 0xffff0000, v26
    v_fmac_f32 v20, v28, v8
    v_fmac_f32 v21, v28, v9
    v_lshlrev_b32 v8, 16, v27
    v_and_b32 v9, 0xffff0000, v27
    v_fmac_f32 v22, v28, v8
    v_fmac_f32 v23, v28, v9
    s_sub_u32 s21, s21, 1
    s_cmp_lg_u32 s21, 0
    s_cbranch_scc1 Lmc_50_m
    v_lshlrev_b32 v8, 8, v2
    v_lshl_add_u32 v8, v3, 5, v8
    s_lshl_b32 s19, s13, 11
    s_add_u32 s19, s19, 77824
    v_add_u32 v8, s19, v8
    ds_write_b128 v8, v[16:19]
    ds_write_b128 v8, v[20:23] offset:16
    v_lshlrev_b32 v8, 2, v1
    v_add_u32 v9, s19, v8
    s_waitcnt lgkmcnt(0)
    ds_read_b32 v24, v9 offset:0
    ds_read_b32 v25, v9 offset:256
    ds_read_b32 v26, v9 offset:512
    ds_read_b32 v27, v9 offset:768
    ds_read_b32 v28, v9 offset:1024
    ds_read_b32 v29, v9 offset:1280
    ds_read_b32 v30, v9 offset:1536
    ds_read_b32 v31, v9 offset:1792
    s_waitcnt lgkmcnt(0)
    v_add_f32 v24, v24, v25
    v_add_f32 v24, v24, v26
    v_add_f32 v24, v24, v27
    v_add_f32 v24, v24, v28
    v_add_f32 v24, v24, v29
    v_add_f32 v24, v24, v30
    v_add_f32 v24, v24, v31
    ds_write_b32 v9, v24
    s_waitcnt lgkmcnt(0)
    s_barrier
    s_cmp_lg_u32 s13, 0
    s_cbranch_scc1 Lmodskip_51_m
    ds_read_b32 v24, v9 offset:0
    ds_read_b32 v25, v9 offset:2048
    ds_read_b32 v26, v9 offset:4096
    ds_read_b32 v27, v9 offset:6144
    s_waitcnt lgkmcnt(0)
    v_add_f32 v24, v24, v25
    v_add_f32 v26, v26, v27
    v_add_f32 v24, v24, v26
    v_cvt_pk_bf16_f32 v9, v24, v24
    v_lshlrev_b32 v24, 16, v9
    s_lshl_b32 s19, s12, 8
    s_add_u32 s19, s19, 61865984
    buffer_store_dword v24, v8, s[4:7], s19 offen sc1
    s_waitcnt vmcnt(0)
    s_cmp_eq_u32 s12, 53
    s_cbranch_scc1 Lmodl_52_m
    s_lshl_b32 s98, s12, 2
    s_add_u32 s98, s98, 61931520
    v_mov_b32 v9, s90
    s_mov_b64 exec, 1
    buffer_store_dword v9, off, s[4:7], s98 offset:0 sc1
    s_mov_b64 exec, -1
    s_branch Lmodj_53_m
Lmodl_52_m:
    s_lshl_b32 s98, s12, 2
    s_add_u32 s98, s98, 61931520
    v_mov_b32 v9, s90
    s_mov_b64 exec, 1
    buffer_store_dword v9, off, s[4:7], s98 offset:0 sc1
    buffer_store_dword v9, off, s[4:7], s98 offset:4 sc1
    buffer_store_dword v9, off, s[4:7], s98 offset:8 sc1
    s_mov_b64 exec, -1
Lmodj_53_m:
Lmodskip_51_m:
    s_barrier
Lnomod_47_m:
    s_sub_u32 s12, s97, 150
    s_cmp_lt_u32 s12, 64
    s_cbranch_scc0 Lnoln1_48
    s_load_dwordx2 s[8:9], s[42:43], 0
    s_waitcnt lgkmcnt(0)
    s_mov_b32 s10, 2359296
    s_mov_b32 s11, 0x20000
    v_lshrrev_b32 v1, 4, v0
    v_cmp_gt_u32 vcc, 36, v1
    v_mov_b32 v8, 0x70000000
    s_nop 0
    v_cndmask_b32 v2, v8, v0, vcc
    v_lshlrev_b32 v3, 1, v0
    v_cndmask_b32 v3, v8, v3, vcc
    v_mov_b32 v8, 1.0
    v_cndmask_b32 v4, 0, v8, vcc
    s_mov_b32 s98, 61931520
Lfw_54_m:
    s_mov_b64 exec, 0x3fff
    buffer_load_dwordx4 v[160:163], v0, s[4:7], s98 offen sc1
    s_waitcnt vmcnt(0)
    v_xor_b32 v160, s90, v160
    v_xor_b32 v161, s90, v161
    v_xor_b32 v162, s90, v162
    v_xor_b32 v163, s90, v163
    v_or3_b32 v160, v160, v161, v162
    v_or_b32 v160, v160, v163
    v_cmp_ne_u32 vcc, 0, v160
    s_mov_b64 exec, -1
    s_nop 2
    s_and_b32 vcc_lo, vcc_lo, 0x3fff
    s_and_b32 vcc_hi, vcc_hi, 0x0
    s_ff1_i32_b64 s89, vcc
    s_cmp_eq_u32 s89, -1
    s_cselect_b32 s89, 16, s89
    s_lshr_b32 s89, s89, 4
    s_cmp_lg_u32 s89, 0
    s_cbranch_scc1 Lfwg_56_m
    s_sleep 2
    s_add_u32 s99, s99, 1
    s_cmp_lt_u32 s99, 4194304
    s_cbranch_scc1 Lfw_54_m
    s_endpgm
Lfwg_56_m:
Lfwok_55_m:
    s_mov_b32 s19, 61868288
    buffer_load_dwordx4 v[48:51], v3, s[4:7], s19 offen offset:0 sc1
    buffer_load_dwordx4 v[52:55], v3, s[4:7], s19 offen offset:16 sc1
    buffer_load_dwordx4 v[56:59], v3, s[4:7], s19 offen offset:1152 sc1
    buffer_load_dwordx4 v[60:63], v3, s[4:7], s19 offen offset:1168 sc1
    s_mov_b32 s19, 61865984
    buffer_load_dwordx4 v[64:67], v3, s[4:7], s19 offen offset:0 sc1
    buffer_load_dwordx4 v[68:71], v3, s[4:7], s19 offen offset:16 sc1
    buffer_load_dwordx4 v[72:75], v3, s[4:7], s19 offen offset:1152 sc1
    buffer_load_dwordx4 v[76:79], v3, s[4:7], s19 offen offset:1168 sc1
    s_waitcnt vmcnt(0)
    v_add_f32 v48, 1.0, v48
    v_add_f32 v49, 1.0, v49
    v_add_f32 v50, 1.0, v50
    v_add_f32 v51, 1.0, v51
    v_add_f32 v52, 1.0, v52
    v_add_f32 v53, 1.0, v53
    v_add_f32 v54, 1.0, v54
    v_add_f32 v55, 1.0, v55
    v_add_f32 v56, 1.0, v56
    v_add_f32 v57, 1.0, v57
    v_add_f32 v58, 1.0, v58
    v_add_f32 v59, 1.0, v59
    v_add_f32 v60, 1.0, v60
    v_add_f32 v61, 1.0, v61
    v_add_f32 v62, 1.0, v62
    v_add_f32 v63, 1.0, v63
    v_cvt_pk_bf16_f32 v8, v48, v49
    v_lshlrev_b32 v48, 16, v8
    v_and_b32 v49, 0xffff0000, v8
    v_cvt_pk_bf16_f32 v8, v50, v51
    v_lshlrev_b32 v50, 16, v8
    v_and_b32 v51, 0xffff0000, v8
    v_cvt_pk_bf16_f32 v8, v52, v53
    v_lshlrev_b32 v52, 16, v8
    v_and_b32 v53, 0xffff0000, v8
    v_cvt_pk_bf16_f32 v8, v54, v55
    v_lshlrev_b32 v54, 16, v8
    v_and_b32 v55, 0xffff0000, v8
    v_cvt_pk_bf16_f32 v8, v56, v57
    v_lshlrev_b32 v56, 16, v8
    v_and_b32 v57, 0xffff0000, v8
    v_cvt_pk_bf16_f32 v8, v58, v59
    v_lshlrev_b32 v58, 16, v8
    v_and_b32 v59, 0xffff0000, v8
    v_cvt_pk_bf16_f32 v8, v60, v61
    v_lshlrev_b32 v60, 16, v8
    v_and_b32 v61, 0xffff0000, v8
    v_cvt_pk_bf16_f32 v8, v62, v63
    v_lshlrev_b32 v62, 16, v8
    v_and_b32 v63, 0xffff0000, v8
    s_lshl_b32 s14, s12, 2
    s_add_u32 s14, s14, s13
    s_and_b32 s15, s14, 31
    s_lshr_b32 s16, s14, 5
Llntwo_57_m:
    s_lshl_b32 s17, s16, 5
    s_add_u32 s17, s17, s15
    s_mul_i32 s19, s17, 1152
    buffer_load_dwordx4 v[144:147], v2, s[8:11], s19 offen offset:0
    buffer_load_dwordx4 v[148:151], v2, s[8:11], s19 offen offset:576
    s_waitcnt vmcnt(0)
    v_lshlrev_b32 v16, 16, v144
    v_and_b32 v17, 0xffff0000, v144
    v_lshlrev_b32 v18, 16, v145
    v_and_b32 v19, 0xffff0000, v145
    v_lshlrev_b32 v20, 16, v146
    v_and_b32 v21, 0xffff0000, v146
    v_lshlrev_b32 v22, 16, v147
    v_and_b32 v23, 0xffff0000, v147
    v_lshlrev_b32 v24, 16, v148
    v_and_b32 v25, 0xffff0000, v148
    v_lshlrev_b32 v26, 16, v149
    v_and_b32 v27, 0xffff0000, v149
    v_lshlrev_b32 v28, 16, v150
    v_and_b32 v29, 0xffff0000, v150
    v_lshlrev_b32 v30, 16, v151
    v_and_b32 v31, 0xffff0000, v151
    v_add_f32 v8, v16, v17
    v_add_f32 v8, v8, v18
    v_add_f32 v8, v8, v19
    v_add_f32 v8, v8, v20
    v_add_f32 v8, v8, v21
    v_add_f32 v8, v8, v22
    v_add_f32 v8, v8, v23
    v_add_f32 v8, v8, v24
    v_add_f32 v8, v8, v25
    v_add_f32 v8, v8, v26
    v_add_f32 v8, v8, v27
    v_add_f32 v8, v8, v28
    v_add_f32 v8, v8, v29
    v_add_f32 v8, v8, v30
    v_add_f32 v8, v8, v31
    s_nop 1
    v_add_f32_dpp v8, v8, v8 quad_perm:[1,0,3,2] row_mask:0xf bank_mask:0xf
    s_nop 1
    v_add_f32_dpp v8, v8, v8 quad_perm:[2,3,0,1] row_mask:0xf bank_mask:0xf
    s_nop 1
    v_add_f32_dpp v8, v8, v8 row_half_mirror row_mask:0xf bank_mask:0xf
    s_nop 1
    v_add_f32_dpp v8, v8, v8 row_mirror row_mask:0xf bank_mask:0xf
    v_mov_b32 v12, v8
    s_nop 1
    v_permlane16_swap_b32 v8, v12
    v_add_f32 v8, v8, v12
    v_mov_b32 v12, v8
    s_nop 1
    v_permlane32_swap_b32 v8, v12
    v_add_f32 v8, v8, v12
    v_mul_f32 v10, 0x3ae38e39, v8
    v_mul_f32 v13, v10, v4
    v_sub_f32 v12, v16, v13
    v_mul_f32 v9, v12, v12
    v_sub_f32 v12, v17, v13
    v_fmac_f32 v9, v12, v12
    v_sub_f32 v12, v18, v13
    v_fmac_f32 v9, v12, v12
    v_sub_f32 v12, v19, v13
    v_fmac_f32 v9, v12, v12
    v_sub_f32 v12, v20, v13
    v_fmac_f32 v9, v12, v12
    v_sub_f32 v12, v21, v13
    v_fmac_f32 v9, v12, v12
    v_sub_f32 v12, v22, v13
    v_fmac_f32 v9, v12, v12
    v_sub_f32 v12, v23, v13
    v_fmac_f32 v9, v12, v12
    v_sub_f32 v12, v24, v13
    v_fmac_f32 v9, v12, v12
    v_sub_f32 v12, v25, v13
    v_fmac_f32 v9, v12, v12
    v_sub_f32 v12, v26, v13
    v_fmac_f32 v9, v12, v12
    v_sub_f32 v12, v27, v13
    v_fmac_f32 v9, v12, v12
    v_sub_f32 v12, v28, v13
    v_fmac_f32 v9, v12, v12
    v_sub_f32 v12, v29, v13
    v_fmac_f32 v9, v12, v12
    v_sub_f32 v12, v30, v13
    v_fmac_f32 v9, v12, v12
    v_sub_f32 v12, v31, v13
    v_fmac_f32 v9, v12, v12
    s_nop 1
    v_add_f32_dpp v9, v9, v9 quad_perm:[1,0,3,2] row_mask:0xf bank_mask:0xf
    s_nop 1
    v_add_f32_dpp v9, v9, v9 quad_perm:[2,3,0,1] row_mask:0xf bank_mask:0xf
    s_nop 1
    v_add_f32_dpp v9, v9, v9 row_half_mirror row_mask:0xf bank_mask:0xf
    s_nop 1
    v_add_f32_dpp v9, v9, v9 row_mirror row_mask:0xf bank_mask:0xf
    v_mov_b32 v12, v9
    s_nop 1
    v_permlane16_swap_b32 v9, v12
    v_add_f32 v9, v9, v12
    v_mov_b32 v12, v9
    s_nop 1
    v_permlane32_swap_b32 v9, v12
    v_add_f32 v9, v9, v12
    v_mul_f32 v9, 0x3ae38e39, v9
    v_cvt_pk_bf16_f32 v12, v9, v9
    v_lshlrev_b32 v9, 16, v12
    v_add_f32 v9, 0x3727c5ac, v9
    v_cvt_pk_bf16_f32 v12, v9, v9
    v_lshlrev_b32 v9, 16, v12
    v_sqrt_f32 v9, v9
    s_nop 0
    v_cvt_pk_bf16_f32 v12, v9, v9
    v_lshlrev_b32 v9, 16, v12
    v_rcp_f32 v11, v9
    v_cvt_pk_bf16_f32 v12, v10, v10
    v_lshlrev_b32 v10, 16, v12
    v_sub_f32 v16, v16, v10
    v_sub_f32 v17, v17, v10
    v_cvt_pk_bf16_f32 v12, v16, v17
    v_lshlrev_b32 v16, 16, v12
    v_and_b32 v17, 0xffff0000, v12
    v_mul_f32 v16, v16, v11
    v_mul_f32 v17, v17, v11
    v_cvt_pk_bf16_f32 v12, v16, v17
    v_lshlrev_b32 v16, 16, v12
    v_and_b32 v17, 0xffff0000, v12
    v_pk_mul_f32 v[16:17], v[16:17], v[48:49]
    v_cvt_pk_bf16_f32 v12, v16, v17
    v_lshlrev_b32 v16, 16, v12
    v_and_b32 v17, 0xffff0000, v12
    v_pk_add_f32 v[16:17], v[16:17], v[64:65]
    v_cvt_pk_bf16_f32 v144, v16, v17
    v_sub_f32 v18, v18, v10
    v_sub_f32 v19, v19, v10
    v_cvt_pk_bf16_f32 v12, v18, v19
    v_lshlrev_b32 v18, 16, v12
    v_and_b32 v19, 0xffff0000, v12
    v_mul_f32 v18, v18, v11
    v_mul_f32 v19, v19, v11
    v_cvt_pk_bf16_f32 v12, v18, v19
    v_lshlrev_b32 v18, 16, v12
    v_and_b32 v19, 0xffff0000, v12
    v_pk_mul_f32 v[18:19], v[18:19], v[50:51]
    v_cvt_pk_bf16_f32 v12, v18, v19
    v_lshlrev_b32 v18, 16, v12
    v_and_b32 v19, 0xffff0000, v12
    v_pk_add_f32 v[18:19], v[18:19], v[66:67]
    v_cvt_pk_bf16_f32 v145, v18, v19
    v_sub_f32 v20, v20, v10
    v_sub_f32 v21, v21, v10
    v_cvt_pk_bf16_f32 v12, v20, v21
    v_lshlrev_b32 v20, 16, v12
    v_and_b32 v21, 0xffff0000, v12
    v_mul_f32 v20, v20, v11
    v_mul_f32 v21, v21, v11
    v_cvt_pk_bf16_f32 v12, v20, v21
    v_lshlrev_b32 v20, 16, v12
    v_and_b32 v21, 0xffff0000, v12
    v_pk_mul_f32 v[20:21], v[20:21], v[52:53]
    v_cvt_pk_bf16_f32 v12, v20, v21
    v_lshlrev_b32 v20, 16, v12
    v_and_b32 v21, 0xffff0000, v12
    v_pk_add_f32 v[20:21], v[20:21], v[68:69]
    v_cvt_pk_bf16_f32 v146, v20, v21
    v_sub_f32 v22, v22, v10
    v_sub_f32 v23, v23, v10
    v_cvt_pk_bf16_f32 v12, v22, v23
    v_lshlrev_b32 v22, 16, v12
    v_and_b32 v23, 0xffff0000, v12
    v_mul_f32 v22, v22, v11
    v_mul_f32 v23, v23, v11
    v_cvt_pk_bf16_f32 v12, v22, v23
    v_lshlrev_b32 v22, 16, v12
    v_and_b32 v23, 0xffff0000, v12
    v_pk_mul_f32 v[22:23], v[22:23], v[54:55]
    v_cvt_pk_bf16_f32 v12, v22, v23
    v_lshlrev_b32 v22, 16, v12
    v_and_b32 v23, 0xffff0000, v12
    v_pk_add_f32 v[22:23], v[22:23], v[70:71]
    v_cvt_pk_bf16_f32 v147, v22, v23
    v_sub_f32 v24, v24, v10
    v_sub_f32 v25, v25, v10
    v_cvt_pk_bf16_f32 v12, v24, v25
    v_lshlrev_b32 v24, 16, v12
    v_and_b32 v25, 0xffff0000, v12
    v_mul_f32 v24, v24, v11
    v_mul_f32 v25, v25, v11
    v_cvt_pk_bf16_f32 v12, v24, v25
    v_lshlrev_b32 v24, 16, v12
    v_and_b32 v25, 0xffff0000, v12
    v_pk_mul_f32 v[24:25], v[24:25], v[56:57]
    v_cvt_pk_bf16_f32 v12, v24, v25
    v_lshlrev_b32 v24, 16, v12
    v_and_b32 v25, 0xffff0000, v12
    v_pk_add_f32 v[24:25], v[24:25], v[72:73]
    v_cvt_pk_bf16_f32 v148, v24, v25
    v_sub_f32 v26, v26, v10
    v_sub_f32 v27, v27, v10
    v_cvt_pk_bf16_f32 v12, v26, v27
    v_lshlrev_b32 v26, 16, v12
    v_and_b32 v27, 0xffff0000, v12
    v_mul_f32 v26, v26, v11
    v_mul_f32 v27, v27, v11
    v_cvt_pk_bf16_f32 v12, v26, v27
    v_lshlrev_b32 v26, 16, v12
    v_and_b32 v27, 0xffff0000, v12
    v_pk_mul_f32 v[26:27], v[26:27], v[58:59]
    v_cvt_pk_bf16_f32 v12, v26, v27
    v_lshlrev_b32 v26, 16, v12
    v_and_b32 v27, 0xffff0000, v12
    v_pk_add_f32 v[26:27], v[26:27], v[74:75]
    v_cvt_pk_bf16_f32 v149, v26, v27
    v_sub_f32 v28, v28, v10
    v_sub_f32 v29, v29, v10
    v_cvt_pk_bf16_f32 v12, v28, v29
    v_lshlrev_b32 v28, 16, v12
    v_and_b32 v29, 0xffff0000, v12
    v_mul_f32 v28, v28, v11
    v_mul_f32 v29, v29, v11
    v_cvt_pk_bf16_f32 v12, v28, v29
    v_lshlrev_b32 v28, 16, v12
    v_and_b32 v29, 0xffff0000, v12
    v_pk_mul_f32 v[28:29], v[28:29], v[60:61]
    v_cvt_pk_bf16_f32 v12, v28, v29
    v_lshlrev_b32 v28, 16, v12
    v_and_b32 v29, 0xffff0000, v12
    v_pk_add_f32 v[28:29], v[28:29], v[76:77]
    v_cvt_pk_bf16_f32 v150, v28, v29
    v_sub_f32 v30, v30, v10
    v_sub_f32 v31, v31, v10
    v_cvt_pk_bf16_f32 v12, v30, v31
    v_lshlrev_b32 v30, 16, v12
    v_and_b32 v31, 0xffff0000, v12
    v_mul_f32 v30, v30, v11
    v_mul_f32 v31, v31, v11
    v_cvt_pk_bf16_f32 v12, v30, v31
    v_lshlrev_b32 v30, 16, v12
    v_and_b32 v31, 0xffff0000, v12
    v_pk_mul_f32 v[30:31], v[30:31], v[62:63]
    v_cvt_pk_bf16_f32 v12, v30, v31
    v_lshlrev_b32 v30, 16, v12
    v_and_b32 v31, 0xffff0000, v12
    v_pk_add_f32 v[30:31], v[30:31], v[78:79]
    v_cvt_pk_bf16_f32 v151, v30, v31
    s_add_u32 s20, s19, 62914560
    buffer_store_dwordx4 v[144:147], v2, s[4:7], s20 offen offset:0 sc1
    buffer_store_dwordx4 v[148:151], v2, s[4:7], s20 offen offset:576 sc1
    s_waitcnt vmcnt(0)
    s_mul_i32 s98, s16, 32
    s_add_u32 s98, s98, s15
    s_lshl_b32 s98, s98, 2
    s_add_u32 s98, s98, 61949952
    v_mov_b32 v7, s90
    s_mov_b64 exec, 1
    buffer_store_dword v7, off, s[4:7], s98 offset:0 sc1
    s_mov_b64 exec, -1
    s_add_u32 s16, s16, 8
    s_cmp_lt_u32 s16, 64
    s_cbranch_scc1 Llntwo_57_m
Lnoln1_48:
    s_mov_b32 s92, 0
    s_mov_b32 s93, 0
    s_cmp_ge_u32 s97, 224
    s_cbranch_scc1 Ldone_main
    s_cmp_ge_u32 s97, 216
    s_cbranch_scc1 Lrolelnz_62_m
    s_cmp_ge_u32 s97, 200
    s_cbranch_scc1 Lrolelntwo_61_m
    s_cmp_ge_u32 s97, 164
    s_cbranch_scc1 Lrolewin_60_m
    s_cmp_ge_u32 s97, 128
    s_cbranch_scc1 Lrolewo_59_m
    s_cmp_ge_u32 s97, 96
    s_cbranch_scc1 Lroleatt_58_m
    s_mov_b32 s12, s97
    s_cmp_ge_u32 s12, 96
    s_cselect_b32 s17, 1, 0
    s_mul_i32 s19, s17, 96
    s_sub_u32 s14, s12, s19
    s_lshr_b32 s15, s14, 5
    s_and_b32 s16, s14, 31
    s_load_dwordx2 s[24:25], s[42:43], 24
    s_load_dwordx2 s[26:27], s[42:43], 32
    s_load_dwordx2 s[28:29], s[42:43], 16
    s_waitcnt lgkmcnt(0)
    s_cmp_eq_u32 s15, 1
    s_cselect_b32 s8, s26, s24
    s_cselect_b32 s9, s27, s25
    s_cmp_eq_u32 s15, 2
    s_cselect_b32 s8, s28, s8
    s_cselect_b32 s9, s29, s9
    s_mov_b32 s10, 4718592
    s_mov_b32 s11, 0x20000
    s_lshl_b32 s18, s16, 8
    v_lshrrev_b32 v1, 4, v0
    v_lshrrev_b32 v2, 4, v1
    v_bfe_u32 v3, v1, 2, 2
    v_xor_b32 v3, v3, v2
    v_lshlrev_b32 v3, 6, v3
    v_and_b32 v4, 3, v1
    v_lshl_add_u32 v3, v4, 4, v3
    s_mov_b32 s19, 8192
    v_mul_lo_u32 v5, v2, s19
    v_add_u32 v5, v5, v3
    s_mul_i32 s19, s13, 1179648
    s_add_u32 s19, s19, s18
    s_mul_i32 s20, s13, 36864
    s_mov_b32 s21, 36
Ldmw_63_m:
    s_mov_b32 m0, s20
    s_nop 0
    buffer_load_dwordx4 v5, s[8:11], s19 offen lds
    s_add_u32 s19, s19, 32768
    s_add_u32 s20, s20, 1024
    s_sub_u32 s21, s21, 1
    s_cmp_lg_u32 s21, 0
    s_cbranch_scc1 Ldmw_63_m
    v_lshrrev_b32 v2, 5, v1
    v_lshlrev_b32 v2, 3, v2
    v_bfe_u32 v3, v1, 2, 2
    v_add_u32 v2, v2, v3
    v_lshlrev_b32 v6, 8, v2
    v_xor_b32 v3, s13, v3
    v_lshl_add_u32 v6, v3, 6, v6
    v_bfe_u32 v4, v1, 4, 1
    v_lshl_add_u32 v6, v4, 5, v6
    v_and_b32 v4, 3, v1
    v_lshl_add_u32 v6, v4, 3, v6
    v_add_u32 v7, 0x10000, v6
    v_add_u32 v8, 0x20000, v6
    s_waitcnt vmcnt(0)
    s_barrier
    ds_read_b64_tr_b16 v[112:113], v6 offset:0
    ds_read_b64_tr_b16 v[114:115], v6 offset:1024
    ds_read_b64_tr_b16 v[116:117], v6 offset:4096
    ds_read_b64_tr_b16 v[118:119], v6 offset:5120
    ds_read_b64_tr_b16 v[120:121], v6 offset:8192
    ds_read_b64_tr_b16 v[122:123], v6 offset:9216
    ds_read_b64_tr_b16 v[124:125], v6 offset:12288
    ds_read_b64_tr_b16 v[126:127], v6 offset:13312
    s_waitcnt lgkmcnt(4)
    ds_read_b64_tr_b16 v[128:129], v6 offset:16384
    ds_read_b64_tr_b16 v[130:131], v6 offset:17408
    ds_read_b64_tr_b16 v[132:133], v6 offset:20480
    ds_read_b64_tr_b16 v[134:135], v6 offset:21504
    ds_read_b64_tr_b16 v[136:137], v6 offset:24576
    ds_read_b64_tr_b16 v[138:139], v6 offset:25600
    ds_read_b64_tr_b16 v[140:141], v6 offset:28672
    ds_read_b64_tr_b16 v[142:143], v6 offset:29696
    s_waitcnt lgkmcnt(4)
    ds_read_b64_tr_b16 v[144:145], v6 offset:32768
    ds_read_b64_tr_b16 v[146:147], v6 offset:33792
    ds_read_b64_tr_b16 v[148:149], v6 offset:36864
    ds_read_b64_tr_b16 v[150:151], v6 offset:37888
    ds_read_b64_tr_b16 v[152:153], v6 offset:40960
    ds_read_b64_tr_b16 v[154:155], v6 offset:41984
    ds_read_b64_tr_b16 v[156:157], v6 offset:45056
    ds_read_b64_tr_b16 v[158:159], v6 offset:46080
    s_waitcnt lgkmcnt(4)
    ds_read_b64_tr_b16 v[160:161], v6 offset:49152
    ds_read_b64_tr_b16 v[162:163], v6 offset:50176
    ds_read_b64_tr_b16 v[164:165], v6 offset:53248
    ds_read_b64_tr_b16 v[166:167], v6 offset:54272
    ds_read_b64_tr_b16 v[168:169], v6 offset:57344
    ds_read_b64_tr_b16 v[170:171], v6 offset:58368
    ds_read_b64_tr_b16 v[172:173], v6 offset:61440
    ds_read_b64_tr_b16 v[174:175], v6 offset:62464
    s_waitcnt lgkmcnt(4)
    ds_read_b64_tr_b16 v[176:177], v7 offset:0
    ds_read_b64_tr_b16 v[178:179], v7 offset:1024
    ds_read_b64_tr_b16 v[180:181], v7 offset:4096
    ds_read_b64_tr_b16 v[182:183], v7 offset:5120
    ds_read_b64_tr_b16 v[184:185], v7 offset:8192
    ds_read_b64_tr_b16 v[186:187], v7 offset:9216
    ds_read_b64_tr_b16 v[188:189], v7 offset:12288
    ds_read_b64_tr_b16 v[190:191], v7 offset:13312
    s_waitcnt lgkmcnt(4)
    ds_read_b64_tr_b16 v[192:193], v7 offset:16384
    ds_read_b64_tr_b16 v[194:195], v7 offset:17408
    ds_read_b64_tr_b16 v[196:197], v7 offset:20480
    ds_read_b64_tr_b16 v[198:199], v7 offset:21504
    ds_read_b64_tr_b16 v[200:201], v7 offset:24576
    ds_read_b64_tr_b16 v[202:203], v7 offset:25600
    ds_read_b64_tr_b16 v[204:205], v7 offset:28672
    ds_read_b64_tr_b16 v[206:207], v7 offset:29696
    s_waitcnt lgkmcnt(4)
    ds_read_b64_tr_b16 v[208:209], v7 offset:32768
    ds_read_b64_tr_b16 v[210:211], v7 offset:33792
    ds_read_b64_tr_b16 v[212:213], v7 offset:36864
    ds_read_b64_tr_b16 v[214:215], v7 offset:37888
    ds_read_b64_tr_b16 v[216:217], v7 offset:40960
    ds_read_b64_tr_b16 v[218:219], v7 offset:41984
    ds_read_b64_tr_b16 v[220:221], v7 offset:45056
    ds_read_b64_tr_b16 v[222:223], v7 offset:46080
    s_waitcnt lgkmcnt(4)
    ds_read_b64_tr_b16 v[224:225], v7 offset:49152
    ds_read_b64_tr_b16 v[226:227], v7 offset:50176
    ds_read_b64_tr_b16 v[228:229], v7 offset:53248
    ds_read_b64_tr_b16 v[230:231], v7 offset:54272
    ds_read_b64_tr_b16 v[232:233], v7 offset:57344
    ds_read_b64_tr_b16 v[234:235], v7 offset:58368
    ds_read_b64_tr_b16 v[236:237], v7 offset:61440
    ds_read_b64_tr_b16 v[238:239], v7 offset:62464
    s_waitcnt lgkmcnt(4)
    ds_read_b64_tr_b16 v[240:241], v8 offset:0
    ds_read_b64_tr_b16 v[242:243], v8 offset:1024
    ds_read_b64_tr_b16 v[244:245], v8 offset:4096
    ds_read_b64_tr_b16 v[246:247], v8 offset:5120
    ds_read_b64_tr_b16 v[248:249], v8 offset:8192
    ds_read_b64_tr_b16 v[250:251], v8 offset:9216
    ds_read_b64_tr_b16 v[252:253], v8 offset:12288
    ds_read_b64_tr_b16 v[254:255], v8 offset:13312
    s_waitcnt lgkmcnt(4)
    s_waitcnt lgkmcnt(0)
    s_barrier
    s_lshl_b32 s18, s15, 24
    s_lshl_b32 s19, s16, 13
    s_add_u32 s18, s18, s19
    s_add_u32 s18, s18, 0
    v_lshrrev_b32 v1, 4, v0
    v_and_b32 v8, 15, v1
    v_lshlrev_b32 v8, 4, v8
    v_bfe_u32 v2, v1, 4, 1
    v_lshl_add_u32 v8, v2, 12, v8
    v_lshrrev_b32 v2, 5, v1
    v_lshl_add_u32 v8, v2, 8, v8
    s_lshl_b32 s19, s13, 10
    v_add_u32 v8, s19, v8
    v_and_b32 v9, 15, v1
    v_lshlrev_b32 v9, 4, v9
    v_bfe_u32 v2, v1, 4, 1
    v_lshl_add_u32 v9, v2, 10, v9
    v_lshrrev_b32 v2, 5, v1
    v_lshl_add_u32 v9, v2, 8, v9
    s_lshl_b32 s19, s13, 11
    v_add_u32 v9, s19, v9
    s_cmp_eq_u32 s15, 1
    s_cbranch_scc1 Lisv_64_m
    s_cmp_eq_u32 s15, 2
    s_cbranch_scc1 Lisq_65_m
    v_lshrrev_b32 v10, 9, v0
    v_mul_u32_u24 v12, 544, v10
    v_and_b32 v10, 0x1f0, v0
    v_add_u32 v12, v12, v10
    v_add_u32 v10, 39168, v12
    v_lshrrev_b32 v7, 4, v0
    s_mul_i32 s19, s13, 576
    s_add_u32 s19, s19, 0
    v_add_u32 v7, s19, v7
    v_mul_u32_u24 v32, 3641, v7
    v_lshrrev_b32 v32, 18, v32
    v_mul_u32_u24 v13, 72, v32
    v_sub_u32 v7, v7, v13
    v_lshlrev_b32 v32, 4, v32
    v_mul_u32_u24 v13, 544, v7
    v_add_u32 v32, v32, v13
    v_lshrrev_b32 v7, 4, v0
    s_mul_i32 s19, s13, 576
    s_add_u32 s19, s19, 64
    v_add_u32 v7, s19, v7
    v_mul_u32_u24 v33, 3641, v7
    v_lshrrev_b32 v33, 18, v33
    v_mul_u32_u24 v13, 72, v33
    v_sub_u32 v7, v7, v13
    v_lshlrev_b32 v33, 4, v33
    v_mul_u32_u24 v13, 544, v7
    v_add_u32 v33, v33, v13
    v_lshrrev_b32 v7, 4, v0
    s_mul_i32 s19, s13, 576
    s_add_u32 s19, s19, 128
    v_add_u32 v7, s19, v7
    v_mul_u32_u24 v34, 3641, v7
    v_lshrrev_b32 v34, 18, v34
    v_mul_u32_u24 v13, 72, v34
    v_sub_u32 v7, v7, v13
    v_lshlrev_b32 v34, 4, v34
    v_mul_u32_u24 v13, 544, v7
    v_add_u32 v34, v34, v13
    v_lshrrev_b32 v7, 4, v0
    s_mul_i32 s19, s13, 576
    s_add_u32 s19, s19, 192
    v_add_u32 v7, s19, v7
    v_mul_u32_u24 v35, 3641, v7
    v_lshrrev_b32 v35, 18, v35
    v_mul_u32_u24 v13, 72, v35
    v_sub_u32 v7, v7, v13
    v_lshlrev_b32 v35, 4, v35
    v_mul_u32_u24 v13, 544, v7
    v_add_u32 v35, v35, v13
    v_lshrrev_b32 v7, 4, v0
    s_mul_i32 s19, s13, 576
    s_add_u32 s19, s19, 256
    v_add_u32 v7, s19, v7
    v_mul_u32_u24 v36, 3641, v7
    v_lshrrev_b32 v36, 18, v36
    v_mul_u32_u24 v13, 72, v36
    v_sub_u32 v7, v7, v13
    v_lshlrev_b32 v36, 4, v36
    v_mul_u32_u24 v13, 544, v7
    v_add_u32 v36, v36, v13
    v_lshrrev_b32 v7, 4, v0
    s_mul_i32 s19, s13, 576
    s_add_u32 s19, s19, 320
    v_add_u32 v7, s19, v7
    v_mul_u32_u24 v37, 3641, v7
    v_lshrrev_b32 v37, 18, v37
    v_mul_u32_u24 v13, 72, v37
    v_sub_u32 v7, v7, v13
    v_lshlrev_b32 v37, 4, v37
    v_mul_u32_u24 v13, 544, v7
    v_add_u32 v37, v37, v13
    v_lshrrev_b32 v7, 4, v0
    s_mul_i32 s19, s13, 576
    s_add_u32 s19, s19, 384
    v_add_u32 v7, s19, v7
    v_mul_u32_u24 v38, 3641, v7
    v_lshrrev_b32 v38, 18, v38
    v_mul_u32_u24 v13, 72, v38
    v_sub_u32 v7, v7, v13
    v_lshlrev_b32 v38, 4, v38
    v_mul_u32_u24 v13, 544, v7
    v_add_u32 v38, v38, v13
    v_lshrrev_b32 v7, 4, v0
    s_mul_i32 s19, s13, 576
    s_add_u32 s19, s19, 448
    v_add_u32 v7, s19, v7
    v_mul_u32_u24 v39, 3641, v7
    v_lshrrev_b32 v39, 18, v39
    v_mul_u32_u24 v13, 72, v39
    v_sub_u32 v7, v7, v13
    v_lshlrev_b32 v39, 4, v39
    v_mul_u32_u24 v13, 544, v7
    v_add_u32 v39, v39, v13
    v_lshrrev_b32 v7, 4, v0
    s_mul_i32 s19, s13, 576
    s_add_u32 s19, s19, 512
    v_add_u32 v7, s19, v7
    v_mul_u32_u24 v76, 3641, v7
    v_lshrrev_b32 v76, 18, v76
    v_mul_u32_u24 v13, 72, v76
    v_sub_u32 v7, v7, v13
    v_lshlrev_b32 v76, 4, v76
    v_mul_u32_u24 v13, 544, v7
    v_add_u32 v76, v76, v13
    s_mov_b32 s27, 0
    s_mov_b32 s30, -1
    s_cmp_lg_u32 s13, 0
    s_cbranch_scc1 Lur_67_m
    s_cmp_lt_u32 s17, s92
    s_cbranch_scc1 Lfwok_69_m
    s_mul_i32 s98, s17, 128
    s_add_u32 s98, s98, 61949952
Lfw_68_m:
    buffer_load_dwordx4 v[108:111], v0, s[4:7], s98 offen sc1
    s_waitcnt vmcnt(0)
    v_xor_b32 v108, s90, v108
    v_xor_b32 v109, s90, v109
    v_xor_b32 v110, s90, v110
    v_xor_b32 v111, s90, v111
    v_or3_b32 v108, v108, v109, v110
    v_or_b32 v108, v108, v111
    v_cmp_ne_u32 vcc, 0, v108
    s_nop 3
    s_and_b32 vcc_lo, vcc_lo, 0xffffffff
    s_and_b32 vcc_hi, vcc_hi, 0xffffffff
    s_ff1_i32_b64 s92, vcc
    s_cmp_eq_u32 s92, -1
    s_cselect_b32 s92, 64, s92
    s_lshr_b32 s92, s92, 3
    s_cmp_lg_u32 s92, 0
    s_cbranch_scc1 Lfwg_70_m
    s_sleep 2
    s_add_u32 s99, s99, 1
    s_cmp_lt_u32 s99, 4194304
    s_cbranch_scc1 Lfw_68_m
    s_endpgm
Lfwg_70_m:
    s_add_u32 s92, s92, s17
Lfwok_69_m:
    v_mov_b32 v14, 163832
    v_mov_b32 v15, s92
    ds_write_b32 v14, v15
    s_waitcnt lgkmcnt(0)
Lur_67_m:
    s_barrier
    v_mov_b32 v14, 163832
    ds_read_b32 v15, v14
    s_waitcnt lgkmcnt(0)
    v_readfirstlane_b32 s92, v15
    s_mul_i32 s28, s17, 36864
    s_mul_i32 s19, s13, 9216
    s_add_u32 s28, s28, s19
    s_add_u32 s28, s28, 62914560
    s_add_u32 s20, s28, 4096
    s_add_u32 s21, s28, 8192
    buffer_load_dwordx4 v[40:43], v0, s[4:7], s28 offen offset:0 sc1
    buffer_load_dwordx4 v[44:47], v0, s[4:7], s28 offen offset:1024 sc1
    buffer_load_dwordx4 v[48:51], v0, s[4:7], s28 offen offset:2048 sc1
    buffer_load_dwordx4 v[52:55], v0, s[4:7], s28 offen offset:3072 sc1
    buffer_load_dwordx4 v[56:59], v0, s[4:7], s20 offen offset:0 sc1
    buffer_load_dwordx4 v[60:63], v0, s[4:7], s20 offen offset:1024 sc1
    buffer_load_dwordx4 v[64:67], v0, s[4:7], s20 offen offset:2048 sc1
    buffer_load_dwordx4 v[68:71], v0, s[4:7], s20 offen offset:3072 sc1
    buffer_load_dwordx4 v[72:75], v0, s[4:7], s21 offen offset:0 sc1
    s_waitcnt vmcnt(0)
    ds_write_b128 v32, v[40:43] offset:0
    ds_write_b128 v33, v[44:47] offset:0
    ds_write_b128 v34, v[48:51] offset:0
    ds_write_b128 v35, v[52:55] offset:0
    ds_write_b128 v36, v[56:59] offset:0
    ds_write_b128 v37, v[60:63] offset:0
    ds_write_b128 v38, v[64:67] offset:0
    ds_write_b128 v39, v[68:71] offset:0
    ds_write_b128 v76, v[72:75] offset:0
    s_waitcnt lgkmcnt(0)
    s_barrier
Lsg_71_m:
    s_add_u32 s27, s27, 1
    s_mov_b32 s29, s17
    s_mov_b32 s31, 0
    s_add_u32 s17, s17, 1
    s_cmp_ge_u32 s17, 64
    s_cbranch_scc1 Lsgl_73_m
    s_cmp_lt_u32 s17, s92
    s_cbranch_scc0 Lsgl_73_m
    s_mul_i32 s28, s17, 36864
    s_mul_i32 s19, s13, 9216
    s_add_u32 s28, s28, s19
    s_add_u32 s28, s28, 62914560
    s_add_u32 s20, s28, 4096
    s_add_u32 s21, s28, 8192
    buffer_load_dwordx4 v[40:43], v0, s[4:7], s28 offen offset:0 sc1
    buffer_load_dwordx4 v[44:47], v0, s[4:7], s28 offen offset:1024 sc1
    buffer_load_dwordx4 v[48:51], v0, s[4:7], s28 offen offset:2048 sc1
    buffer_load_dwordx4 v[52:55], v0, s[4:7], s28 offen offset:3072 sc1
    buffer_load_dwordx4 v[56:59], v0, s[4:7], s20 offen offset:0 sc1
    buffer_load_dwordx4 v[60:63], v0, s[4:7], s20 offen offset:1024 sc1
    buffer_load_dwordx4 v[64:67], v0, s[4:7], s20 offen offset:2048 sc1
    buffer_load_dwordx4 v[68:71], v0, s[4:7], s20 offen offset:3072 sc1
    buffer_load_dwordx4 v[72:75], v0, s[4:7], s21 offen offset:0 sc1
    s_mov_b32 s31, 1
Lsgl_73_m:
    ds_read_b128 v[80:83], v12 offset:0
    ds_read_b128 v[84:87], v12 offset:1088
    ds_read_b128 v[88:91], v12 offset:2176
    ds_read_b128 v[92:95], v12 offset:3264
    s_waitcnt lgkmcnt(3)
    v_mfma_f32_32x32x16_bf16 v[16:31], v[112:115], v[80:83], 0
    ds_read_b128 v[80:83], v12 offset:4352
    s_waitcnt lgkmcnt(3)
    v_mfma_f32_32x32x16_bf16 v[16:31], v[116:119], v[84:87], v[16:31]
    ds_read_b128 v[84:87], v12 offset:5440
    s_waitcnt lgkmcnt(3)
    v_mfma_f32_32x32x16_bf16 v[16:31], v[120:123], v[88:91], v[16:31]
    ds_read_b128 v[88:91], v12 offset:6528
    s_waitcnt lgkmcnt(3)
    v_mfma_f32_32x32x16_bf16 v[16:31], v[124:127], v[92:95], v[16:31]
    ds_read_b128 v[92:95], v12 offset:7616
    s_waitcnt lgkmcnt(3)
    v_mfma_f32_32x32x16_bf16 v[16:31], v[128:131], v[80:83], v[16:31]
    ds_read_b128 v[80:83], v12 offset:8704
    s_waitcnt lgkmcnt(3)
    v_mfma_f32_32x32x16_bf16 v[16:31], v[132:135], v[84:87], v[16:31]
    ds_read_b128 v[84:87], v12 offset:9792
    s_waitcnt lgkmcnt(3)
    v_mfma_f32_32x32x16_bf16 v[16:31], v[136:139], v[88:91], v[16:31]
    ds_read_b128 v[88:91], v12 offset:10880
    s_waitcnt lgkmcnt(3)
    v_mfma_f32_32x32x16_bf16 v[16:31], v[140:143], v[92:95], v[16:31]
    ds_read_b128 v[92:95], v12 offset:11968
    s_waitcnt lgkmcnt(3)
    v_mfma_f32_32x32x16_bf16 v[16:31], v[144:147], v[80:83], v[16:31]
    ds_read_b128 v[80:83], v12 offset:13056
    s_waitcnt lgkmcnt(3)
    v_mfma_f32_32x32x16_bf16 v[16:31], v[148:151], v[84:87], v[16:31]
    ds_read_b128 v[84:87], v12 offset:14144
    s_waitcnt lgkmcnt(3)
    v_mfma_f32_32x32x16_bf16 v[16:31], v[152:155], v[88:91], v[16:31]
    ds_read_b128 v[88:91], v12 offset:15232
    s_waitcnt lgkmcnt(3)
    v_mfma_f32_32x32x16_bf16 v[16:31], v[156:159], v[92:95], v[16:31]
    ds_read_b128 v[92:95], v12 offset:16320
    s_waitcnt lgkmcnt(3)
    v_mfma_f32_32x32x16_bf16 v[16:31], v[160:163], v[80:83], v[16:31]
    ds_read_b128 v[80:83], v12 offset:17408
    s_waitcnt lgkmcnt(3)
    v_mfma_f32_32x32x16_bf16 v[16:31], v[164:167], v[84:87], v[16:31]
    ds_read_b128 v[84:87], v12 offset:18496
    s_waitcnt lgkmcnt(3)
    v_mfma_f32_32x32x16_bf16 v[16:31], v[168:171], v[88:91], v[16:31]
    ds_read_b128 v[88:91], v12 offset:19584
    s_waitcnt lgkmcnt(3)
    v_mfma_f32_32x32x16_bf16 v[16:31], v[172:175], v[92:95], v[16:31]
    ds_read_b128 v[92:95], v12 offset:20672
    s_waitcnt lgkmcnt(3)
    v_mfma_f32_32x32x16_bf16 v[16:31], v[176:179], v[80:83], v[16:31]
    ds_read_b128 v[80:83], v12 offset:21760
    s_waitcnt lgkmcnt(3)
    v_mfma_f32_32x32x16_bf16 v[16:31], v[180:183], v[84:87], v[16:31]
    ds_read_b128 v[84:87], v12 offset:22848
    s_waitcnt lgkmcnt(3)
    v_mfma_f32_32x32x16_bf16 v[16:31], v[184:187], v[88:91], v[16:31]
    ds_read_b128 v[88:91], v12 offset:23936
    s_waitcnt lgkmcnt(3)
    v_mfma_f32_32x32x16_bf16 v[16:31], v[188:191], v[92:95], v[16:31]
    ds_read_b128 v[92:95], v12 offset:25024
    s_waitcnt lgkmcnt(3)
    v_mfma_f32_32x32x16_bf16 v[16:31], v[192:195], v[80:83], v[16:31]
    ds_read_b128 v[80:83], v12 offset:26112
    s_waitcnt lgkmcnt(3)
    v_mfma_f32_32x32x16_bf16 v[16:31], v[196:199], v[84:87], v[16:31]
    ds_read_b128 v[84:87], v12 offset:27200
    s_waitcnt lgkmcnt(3)
    v_mfma_f32_32x32x16_bf16 v[16:31], v[200:203], v[88:91], v[16:31]
    ds_read_b128 v[88:91], v12 offset:28288
    s_waitcnt lgkmcnt(3)
    v_mfma_f32_32x32x16_bf16 v[16:31], v[204:207], v[92:95], v[16:31]
    ds_read_b128 v[92:95], v12 offset:29376
    s_waitcnt lgkmcnt(3)
    v_mfma_f32_32x32x16_bf16 v[16:31], v[208:211], v[80:83], v[16:31]
    ds_read_b128 v[80:83], v12 offset:30464
    s_waitcnt lgkmcnt(3)
    v_mfma_f32_32x32x16_bf16 v[16:31], v[212:215], v[84:87], v[16:31]
    ds_read_b128 v[84:87], v12 offset:31552
    s_waitcnt lgkmcnt(3)
    v_mfma_f32_32x32x16_bf16 v[16:31], v[216:219], v[88:91], v[16:31]
    ds_read_b128 v[88:91], v12 offset:32640
    s_waitcnt lgkmcnt(3)
    v_mfma_f32_32x32x16_bf16 v[16:31], v[220:223], v[92:95], v[16:31]
    ds_read_b128 v[92:95], v12 offset:33728
    s_waitcnt lgkmcnt(3)
    v_mfma_f32_32x32x16_bf16 v[16:31], v[224:227], v[80:83], v[16:31]
    ds_read_b128 v[80:83], v12 offset:34816
    s_waitcnt lgkmcnt(3)
    v_mfma_f32_32x32x16_bf16 v[16:31], v[228:231], v[84:87], v[16:31]
    ds_read_b128 v[84:87], v12 offset:35904
    s_waitcnt lgkmcnt(3)
    v_mfma_f32_32x32x16_bf16 v[16:31], v[232:235], v[88:91], v[16:31]
    ds_read_b128 v[88:91], v12 offset:36992
    s_waitcnt lgkmcnt(3)
    v_mfma_f32_32x32x16_bf16 v[16:31], v[236:239], v[92:95], v[16:31]
    ds_read_b128 v[92:95], v12 offset:38080
    s_waitcnt lgkmcnt(3)
    v_mfma_f32_32x32x16_bf16 v[16:31], v[240:243], v[80:83], v[16:31]
    s_waitcnt lgkmcnt(2)
    v_mfma_f32_32x32x16_bf16 v[16:31], v[244:247], v[84:87], v[16:31]
    s_waitcnt lgkmcnt(1)
    v_mfma_f32_32x32x16_bf16 v[16:31], v[248:251], v[88:91], v[16:31]
    s_waitcnt lgkmcnt(0)
    v_mfma_f32_32x32x16_bf16 v[16:31], v[252:255], v[92:95], v[16:31]
    s_nop 11
    v_cvt_pk_bf16_f32 v96, v16, v17
    v_cvt_pk_bf16_f32 v97, v18, v19
    v_cvt_pk_bf16_f32 v98, v20, v21
    v_cvt_pk_bf16_f32 v99, v22, v23
    v_cvt_pk_bf16_f32 v100, v24, v25
    v_cvt_pk_bf16_f32 v101, v26, v27
    v_cvt_pk_bf16_f32 v102, v28, v29
    v_cvt_pk_bf16_f32 v103, v30, v31
    s_lshl_b32 s19, s29, 18
    s_add_u32 s19, s19, s18
    v_permlane32_swap_b32 v96, v98
    v_permlane32_swap_b32 v97, v99
    v_permlane32_swap_b32 v100, v102
    v_permlane32_swap_b32 v101, v103
    buffer_store_dwordx4 v[96:99], v8, s[4:7], s19 offen sc1
    buffer_store_dwordx4 v[100:103], v8, s[4:7], s19 offen offset:512 sc1
    s_cmp_eq_u32 s31, 1
    s_cbranch_scc0 Lsgn_74_m
    s_waitcnt vmcnt(2)
    ds_write_b128 v32, v[40:43] offset:39168
    ds_write_b128 v33, v[44:47] offset:39168
    ds_write_b128 v34, v[48:51] offset:39168
    ds_write_b128 v35, v[52:55] offset:39168
    ds_write_b128 v36, v[56:59] offset:39168
    ds_write_b128 v37, v[60:63] offset:39168
    ds_write_b128 v38, v[64:67] offset:39168
    ds_write_b128 v39, v[68:71] offset:39168
    ds_write_b128 v76, v[72:75] offset:39168
    s_cmp_le_u32 s27, 3
    s_cbranch_scc0 Lsgz_77_m
    s_waitcnt vmcnt(0) lgkmcnt(0)
    s_barrier
    s_cmp_lg_u32 s13, 0
    s_cbranch_scc1 Lfs0_78
    s_mul_i32 s98, s29, 64
    s_add_u32 s98, s98, s97
    s_lshl_b32 s98, s98, 2
    s_add_u32 s98, s98, 61959168
    v_mov_b32 v11, s90
    s_mov_b64 exec, 1
    buffer_store_dword v11, off, s[4:7], s98 offset:0 sc1
    s_mov_b64 exec, -1
Lfs0_78:
    s_mov_b32 s30, -1
    s_branch Lsgj_75_m
Lsgz_77_m:
    s_waitcnt lgkmcnt(0)
    s_barrier
    s_cmp_eq_u32 s30, -1
    s_cbranch_scc1 Lsgd_79_m
    s_cmp_lg_u32 s13, 0
    s_cbranch_scc1 Lfs0_80
    s_mul_i32 s98, s30, 64
    s_add_u32 s98, s98, s97
    s_lshl_b32 s98, s98, 2
    s_add_u32 s98, s98, 61959168
    v_mov_b32 v11, s90
    s_mov_b64 exec, 1
    buffer_store_dword v11, off, s[4:7], s98 offset:0 sc1
    s_mov_b64 exec, -1
Lfs0_80:
Lsgd_79_m:
    s_mov_b32 s30, s29
    s_branch Lsgj_75_m
Lsgn_74_m:
    s_waitcnt vmcnt(0)
    s_barrier
    s_cmp_eq_u32 s30, -1
    s_cbranch_scc1 Lsgd_81_m
    s_cmp_lg_u32 s13, 0
    s_cbranch_scc1 Lfs0_82
    s_mul_i32 s98, s30, 64
    s_add_u32 s98, s98, s97
    s_lshl_b32 s98, s98, 2
    s_add_u32 s98, s98, 61959168
    v_mov_b32 v11, s90
    s_mov_b64 exec, 1
    buffer_store_dword v11, off, s[4:7], s98 offset:0 sc1
    s_mov_b64 exec, -1
Lfs0_82:
Lsgd_81_m:
    s_cmp_lg_u32 s13, 0
    s_cbranch_scc1 Lfs0_83
    s_mul_i32 s98, s29, 64
    s_add_u32 s98, s98, s97
    s_lshl_b32 s98, s98, 2
    s_add_u32 s98, s98, 61959168
    v_mov_b32 v11, s90
    s_mov_b64 exec, 1
    buffer_store_dword v11, off, s[4:7], s98 offset:0 sc1
    s_mov_b64 exec, -1
Lfs0_83:
    s_mov_b32 s30, -1
    s_cmp_ge_u32 s17, 64
    s_cbranch_scc1 Lsge_72_m
    s_cmp_lg_u32 s13, 0
    s_cbranch_scc1 Lur_84_m
    s_cmp_lt_u32 s17, s92
    s_cbranch_scc1 Lfwok_86_m
    s_mul_i32 s98, s17, 128
    s_add_u32 s98, s98, 61949952
Lfw_85_m:
    buffer_load_dwordx4 v[108:111], v0, s[4:7], s98 offen sc1
    s_waitcnt vmcnt(0)
    v_xor_b32 v108, s90, v108
    v_xor_b32 v109, s90, v109
    v_xor_b32 v110, s90, v110
    v_xor_b32 v111, s90, v111
    v_or3_b32 v108, v108, v109, v110
    v_or_b32 v108, v108, v111
    v_cmp_ne_u32 vcc, 0, v108
    s_nop 3
    s_and_b32 vcc_lo, vcc_lo, 0xffffffff
    s_and_b32 vcc_hi, vcc_hi, 0xffffffff
    s_ff1_i32_b64 s92, vcc
    s_cmp_eq_u32 s92, -1
    s_cselect_b32 s92, 64, s92
    s_lshr_b32 s92, s92, 3
    s_cmp_lg_u32 s92, 0
    s_cbranch_scc1 Lfwg_87_m
    s_sleep 2
    s_add_u32 s99, s99, 1
    s_cmp_lt_u32 s99, 4194304
    s_cbranch_scc1 Lfw_85_m
    s_endpgm
Lfwg_87_m:
    s_add_u32 s92, s92, s17
Lfwok_86_m:
    v_mov_b32 v14, 163832
    v_mov_b32 v15, s92
    ds_write_b32 v14, v15
    s_waitcnt lgkmcnt(0)
Lur_84_m:
    s_barrier
    v_mov_b32 v14, 163832
    ds_read_b32 v15, v14
    s_waitcnt lgkmcnt(0)
    v_readfirstlane_b32 s92, v15
    s_mul_i32 s28, s17, 36864
    s_mul_i32 s19, s13, 9216
    s_add_u32 s28, s28, s19
    s_add_u32 s28, s28, 62914560
    s_add_u32 s20, s28, 4096
    s_add_u32 s21, s28, 8192
    buffer_load_dwordx4 v[40:43], v0, s[4:7], s28 offen offset:0 sc1
    buffer_load_dwordx4 v[44:47], v0, s[4:7], s28 offen offset:1024 sc1
    buffer_load_dwordx4 v[48:51], v0, s[4:7], s28 offen offset:2048 sc1
    buffer_load_dwordx4 v[52:55], v0, s[4:7], s28 offen offset:3072 sc1
    buffer_load_dwordx4 v[56:59], v0, s[4:7], s20 offen offset:0 sc1
    buffer_load_dwordx4 v[60:63], v0, s[4:7], s20 offen offset:1024 sc1
    buffer_load_dwordx4 v[64:67], v0, s[4:7], s20 offen offset:2048 sc1
    buffer_load_dwordx4 v[68:71], v0, s[4:7], s20 offen offset:3072 sc1
    buffer_load_dwordx4 v[72:75], v0, s[4:7], s21 offen offset:0 sc1
    s_waitcnt vmcnt(0)
    ds_write_b128 v32, v[40:43] offset:39168
    ds_write_b128 v33, v[44:47] offset:39168
    ds_write_b128 v34, v[48:51] offset:39168
    ds_write_b128 v35, v[52:55] offset:39168
    ds_write_b128 v36, v[56:59] offset:39168
    ds_write_b128 v37, v[60:63] offset:39168
    ds_write_b128 v38, v[64:67] offset:39168
    ds_write_b128 v39, v[68:71] offset:39168
    ds_write_b128 v76, v[72:75] offset:39168
    s_waitcnt lgkmcnt(0)
    s_barrier
Lsgj_75_m:
    s_add_u32 s27, s27, 1
    s_mov_b32 s29, s17
    s_mov_b32 s31, 0
    s_add_u32 s17, s17, 1
    s_cmp_ge_u32 s17, 64
    s_cbranch_scc1 Lsgl_88_m
    s_cmp_lt_u32 s17, s92
    s_cbranch_scc0 Lsgl_88_m
    s_mul_i32 s28, s17, 36864
    s_mul_i32 s19, s13, 9216
    s_add_u32 s28, s28, s19
    s_add_u32 s28, s28, 62914560
    s_add_u32 s20, s28, 4096
    s_add_u32 s21, s28, 8192
    buffer_load_dwordx4 v[40:43], v0, s[4:7], s28 offen offset:0 sc1
    buffer_load_dwordx4 v[44:47], v0, s[4:7], s28 offen offset:1024 sc1
    buffer_load_dwordx4 v[48:51], v0, s[4:7], s28 offen offset:2048 sc1
    buffer_load_dwordx4 v[52:55], v0, s[4:7], s28 offen offset:3072 sc1
    buffer_load_dwordx4 v[56:59], v0, s[4:7], s20 offen offset:0 sc1
    buffer_load_dwordx4 v[60:63], v0, s[4:7], s20 offen offset:1024 sc1
    buffer_load_dwordx4 v[64:67], v0, s[4:7], s20 offen offset:2048 sc1
    buffer_load_dwordx4 v[68:71], v0, s[4:7], s20 offen offset:3072 sc1
    buffer_load_dwordx4 v[72:75], v0, s[4:7], s21 offen offset:0 sc1
    s_mov_b32 s31, 1
Lsgl_88_m:
    ds_read_b128 v[80:83], v10 offset:0
    ds_read_b128 v[84:87], v10 offset:1088
    ds_read_b128 v[88:91], v10 offset:2176
    ds_read_b128 v[92:95], v10 offset:3264
    s_waitcnt lgkmcnt(3)
    v_mfma_f32_32x32x16_bf16 v[16:31], v[112:115], v[80:83], 0
    ds_read_b128 v[80:83], v10 offset:4352
    s_waitcnt lgkmcnt(3)
    v_mfma_f32_32x32x16_bf16 v[16:31], v[116:119], v[84:87], v[16:31]
    ds_read_b128 v[84:87], v10 offset:5440
    s_waitcnt lgkmcnt(3)
    v_mfma_f32_32x32x16_bf16 v[16:31], v[120:123], v[88:91], v[16:31]
    ds_read_b128 v[88:91], v10 offset:6528
    s_waitcnt lgkmcnt(3)
    v_mfma_f32_32x32x16_bf16 v[16:31], v[124:127], v[92:95], v[16:31]
    ds_read_b128 v[92:95], v10 offset:7616
    s_waitcnt lgkmcnt(3)
    v_mfma_f32_32x32x16_bf16 v[16:31], v[128:131], v[80:83], v[16:31]
    ds_read_b128 v[80:83], v10 offset:8704
    s_waitcnt lgkmcnt(3)
    v_mfma_f32_32x32x16_bf16 v[16:31], v[132:135], v[84:87], v[16:31]
    ds_read_b128 v[84:87], v10 offset:9792
    s_waitcnt lgkmcnt(3)
    v_mfma_f32_32x32x16_bf16 v[16:31], v[136:139], v[88:91], v[16:31]
    ds_read_b128 v[88:91], v10 offset:10880
    s_waitcnt lgkmcnt(3)
    v_mfma_f32_32x32x16_bf16 v[16:31], v[140:143], v[92:95], v[16:31]
    ds_read_b128 v[92:95], v10 offset:11968
    s_waitcnt lgkmcnt(3)
    v_mfma_f32_32x32x16_bf16 v[16:31], v[144:147], v[80:83], v[16:31]
    ds_read_b128 v[80:83], v10 offset:13056
    s_waitcnt lgkmcnt(3)
    v_mfma_f32_32x32x16_bf16 v[16:31], v[148:151], v[84:87], v[16:31]
    ds_read_b128 v[84:87], v10 offset:14144
    s_waitcnt lgkmcnt(3)
    v_mfma_f32_32x32x16_bf16 v[16:31], v[152:155], v[88:91], v[16:31]
    ds_read_b128 v[88:91], v10 offset:15232
    s_waitcnt lgkmcnt(3)
    v_mfma_f32_32x32x16_bf16 v[16:31], v[156:159], v[92:95], v[16:31]
    ds_read_b128 v[92:95], v10 offset:16320
    s_waitcnt lgkmcnt(3)
    v_mfma_f32_32x32x16_bf16 v[16:31], v[160:163], v[80:83], v[16:31]
    ds_read_b128 v[80:83], v10 offset:17408
    s_waitcnt lgkmcnt(3)
    v_mfma_f32_32x32x16_bf16 v[16:31], v[164:167], v[84:87], v[16:31]
    ds_read_b128 v[84:87], v10 offset:18496
    s_waitcnt lgkmcnt(3)
    v_mfma_f32_32x32x16_bf16 v[16:31], v[168:171], v[88:91], v[16:31]
    ds_read_b128 v[88:91], v10 offset:19584
    s_waitcnt lgkmcnt(3)
    v_mfma_f32_32x32x16_bf16 v[16:31], v[172:175], v[92:95], v[16:31]
    ds_read_b128 v[92:95], v10 offset:20672
    s_waitcnt lgkmcnt(3)
    v_mfma_f32_32x32x16_bf16 v[16:31], v[176:179], v[80:83], v[16:31]
    ds_read_b128 v[80:83], v10 offset:21760
    s_waitcnt lgkmcnt(3)
    v_mfma_f32_32x32x16_bf16 v[16:31], v[180:183], v[84:87], v[16:31]
    ds_read_b128 v[84:87], v10 offset:22848
    s_waitcnt lgkmcnt(3)
    v_mfma_f32_32x32x16_bf16 v[16:31], v[184:187], v[88:91], v[16:31]
    ds_read_b128 v[88:91], v10 offset:23936
    s_waitcnt lgkmcnt(3)
    v_mfma_f32_32x32x16_bf16 v[16:31], v[188:191], v[92:95], v[16:31]
    ds_read_b128 v[92:95], v10 offset:25024
    s_waitcnt lgkmcnt(3)
    v_mfma_f32_32x32x16_bf16 v[16:31], v[192:195], v[80:83], v[16:31]
    ds_read_b128 v[80:83], v10 offset:26112
    s_waitcnt lgkmcnt(3)
    v_mfma_f32_32x32x16_bf16 v[16:31], v[196:199], v[84:87], v[16:31]
    ds_read_b128 v[84:87], v10 offset:27200
    s_waitcnt lgkmcnt(3)
    v_mfma_f32_32x32x16_bf16 v[16:31], v[200:203], v[88:91], v[16:31]
    ds_read_b128 v[88:91], v10 offset:28288
    s_waitcnt lgkmcnt(3)
    v_mfma_f32_32x32x16_bf16 v[16:31], v[204:207], v[92:95], v[16:31]
    ds_read_b128 v[92:95], v10 offset:29376
    s_waitcnt lgkmcnt(3)
    v_mfma_f32_32x32x16_bf16 v[16:31], v[208:211], v[80:83], v[16:31]
    ds_read_b128 v[80:83], v10 offset:30464
    s_waitcnt lgkmcnt(3)
    v_mfma_f32_32x32x16_bf16 v[16:31], v[212:215], v[84:87], v[16:31]
    ds_read_b128 v[84:87], v10 offset:31552
    s_waitcnt lgkmcnt(3)
    v_mfma_f32_32x32x16_bf16 v[16:31], v[216:219], v[88:91], v[16:31]
    ds_read_b128 v[88:91], v10 offset:32640
    s_waitcnt lgkmcnt(3)
    v_mfma_f32_32x32x16_bf16 v[16:31], v[220:223], v[92:95], v[16:31]
    ds_read_b128 v[92:95], v10 offset:33728
    s_waitcnt lgkmcnt(3)
    v_mfma_f32_32x32x16_bf16 v[16:31], v[224:227], v[80:83], v[16:31]
    ds_read_b128 v[80:83], v10 offset:34816
    s_waitcnt lgkmcnt(3)
    v_mfma_f32_32x32x16_bf16 v[16:31], v[228:231], v[84:87], v[16:31]
    ds_read_b128 v[84:87], v10 offset:35904
    s_waitcnt lgkmcnt(3)
    v_mfma_f32_32x32x16_bf16 v[16:31], v[232:235], v[88:91], v[16:31]
    ds_read_b128 v[88:91], v10 offset:36992
    s_waitcnt lgkmcnt(3)
    v_mfma_f32_32x32x16_bf16 v[16:31], v[236:239], v[92:95], v[16:31]
    ds_read_b128 v[92:95], v10 offset:38080
    s_waitcnt lgkmcnt(3)
    v_mfma_f32_32x32x16_bf16 v[16:31], v[240:243], v[80:83], v[16:31]
    s_waitcnt lgkmcnt(2)
    v_mfma_f32_32x32x16_bf16 v[16:31], v[244:247], v[84:87], v[16:31]
    s_waitcnt lgkmcnt(1)
    v_mfma_f32_32x32x16_bf16 v[16:31], v[248:251], v[88:91], v[16:31]
    s_waitcnt lgkmcnt(0)
    v_mfma_f32_32x32x16_bf16 v[16:31], v[252:255], v[92:95], v[16:31]
    s_nop 11
    v_cvt_pk_bf16_f32 v96, v16, v17
    v_cvt_pk_bf16_f32 v97, v18, v19
    v_cvt_pk_bf16_f32 v98, v20, v21
    v_cvt_pk_bf16_f32 v99, v22, v23
    v_cvt_pk_bf16_f32 v100, v24, v25
    v_cvt_pk_bf16_f32 v101, v26, v27
    v_cvt_pk_bf16_f32 v102, v28, v29
    v_cvt_pk_bf16_f32 v103, v30, v31
    s_lshl_b32 s19, s29, 18
    s_add_u32 s19, s19, s18
    v_permlane32_swap_b32 v96, v98
    v_permlane32_swap_b32 v97, v99
    v_permlane32_swap_b32 v100, v102
    v_permlane32_swap_b32 v101, v103
    buffer_store_dwordx4 v[96:99], v8, s[4:7], s19 offen sc1
    buffer_store_dwordx4 v[100:103], v8, s[4:7], s19 offen offset:512 sc1
    s_cmp_eq_u32 s31, 1
    s_cbranch_scc0 Lsgn_89_m
    s_waitcnt vmcnt(2)
    ds_write_b128 v32, v[40:43] offset:0
    ds_write_b128 v33, v[44:47] offset:0
    ds_write_b128 v34, v[48:51] offset:0
    ds_write_b128 v35, v[52:55] offset:0
    ds_write_b128 v36, v[56:59] offset:0
    ds_write_b128 v37, v[60:63] offset:0
    ds_write_b128 v38, v[64:67] offset:0
    ds_write_b128 v39, v[68:71] offset:0
    ds_write_b128 v76, v[72:75] offset:0
    s_cmp_le_u32 s27, 3
    s_cbranch_scc0 Lsgz_92_m
    s_waitcnt vmcnt(0) lgkmcnt(0)
    s_barrier
    s_cmp_lg_u32 s13, 0
    s_cbranch_scc1 Lfs0_93
    s_mul_i32 s98, s29, 64
    s_add_u32 s98, s98, s97
    s_lshl_b32 s98, s98, 2
    s_add_u32 s98, s98, 61959168
    v_mov_b32 v11, s90
    s_mov_b64 exec, 1
    buffer_store_dword v11, off, s[4:7], s98 offset:0 sc1
    s_mov_b64 exec, -1
Lfs0_93:
    s_mov_b32 s30, -1
    s_branch Lsgj_90_m
Lsgz_92_m:
    s_waitcnt lgkmcnt(0)
    s_barrier
    s_cmp_eq_u32 s30, -1
    s_cbranch_scc1 Lsgd_94_m
    s_cmp_lg_u32 s13, 0
    s_cbranch_scc1 Lfs0_95
    s_mul_i32 s98, s30, 64
    s_add_u32 s98, s98, s97
    s_lshl_b32 s98, s98, 2
    s_add_u32 s98, s98, 61959168
    v_mov_b32 v11, s90
    s_mov_b64 exec, 1
    buffer_store_dword v11, off, s[4:7], s98 offset:0 sc1
    s_mov_b64 exec, -1
Lfs0_95:
Lsgd_94_m:
    s_mov_b32 s30, s29
    s_branch Lsgj_90_m
Lsgn_89_m:
    s_waitcnt vmcnt(0)
    s_barrier
    s_cmp_eq_u32 s30, -1
    s_cbranch_scc1 Lsgd_96_m
    s_cmp_lg_u32 s13, 0
    s_cbranch_scc1 Lfs0_97
    s_mul_i32 s98, s30, 64
    s_add_u32 s98, s98, s97
    s_lshl_b32 s98, s98, 2
    s_add_u32 s98, s98, 61959168
    v_mov_b32 v11, s90
    s_mov_b64 exec, 1
    buffer_store_dword v11, off, s[4:7], s98 offset:0 sc1
    s_mov_b64 exec, -1
Lfs0_97:
Lsgd_96_m:
    s_cmp_lg_u32 s13, 0
    s_cbranch_scc1 Lfs0_98
    s_mul_i32 s98, s29, 64
    s_add_u32 s98, s98, s97
    s_lshl_b32 s98, s98, 2
    s_add_u32 s98, s98, 61959168
    v_mov_b32 v11, s90
    s_mov_b64 exec, 1
    buffer_store_dword v11, off, s[4:7], s98 offset:0 sc1
    s_mov_b64 exec, -1
Lfs0_98:
    s_mov_b32 s30, -1
    s_cmp_ge_u32 s17, 64
    s_cbranch_scc1 Lsge_72_m
    s_cmp_lg_u32 s13, 0
    s_cbranch_scc1 Lur_99_m
    s_cmp_lt_u32 s17, s92
    s_cbranch_scc1 Lfwok_101_m
    s_mul_i32 s98, s17, 128
    s_add_u32 s98, s98, 61949952
Lfw_100_m:
    buffer_load_dwordx4 v[108:111], v0, s[4:7], s98 offen sc1
    s_waitcnt vmcnt(0)
    v_xor_b32 v108, s90, v108
    v_xor_b32 v109, s90, v109
    v_xor_b32 v110, s90, v110
    v_xor_b32 v111, s90, v111
    v_or3_b32 v108, v108, v109, v110
    v_or_b32 v108, v108, v111
    v_cmp_ne_u32 vcc, 0, v108
    s_nop 3
    s_and_b32 vcc_lo, vcc_lo, 0xffffffff
    s_and_b32 vcc_hi, vcc_hi, 0xffffffff
    s_ff1_i32_b64 s92, vcc
    s_cmp_eq_u32 s92, -1
    s_cselect_b32 s92, 64, s92
    s_lshr_b32 s92, s92, 3
    s_cmp_lg_u32 s92, 0
    s_cbranch_scc1 Lfwg_102_m
    s_sleep 2
    s_add_u32 s99, s99, 1
    s_cmp_lt_u32 s99, 4194304
    s_cbranch_scc1 Lfw_100_m
    s_endpgm
Lfwg_102_m:
    s_add_u32 s92, s92, s17
Lfwok_101_m:
    v_mov_b32 v14, 163832
    v_mov_b32 v15, s92
    ds_write_b32 v14, v15
    s_waitcnt lgkmcnt(0)
Lur_99_m:
    s_barrier
    v_mov_b32 v14, 163832
    ds_read_b32 v15, v14
    s_waitcnt lgkmcnt(0)
    v_readfirstlane_b32 s92, v15
    s_mul_i32 s28, s17, 36864
    s_mul_i32 s19, s13, 9216
    s_add_u32 s28, s28, s19
    s_add_u32 s28, s28, 62914560
    s_add_u32 s20, s28, 4096
    s_add_u32 s21, s28, 8192
    buffer_load_dwordx4 v[40:43], v0, s[4:7], s28 offen offset:0 sc1
    buffer_load_dwordx4 v[44:47], v0, s[4:7], s28 offen offset:1024 sc1
    buffer_load_dwordx4 v[48:51], v0, s[4:7], s28 offen offset:2048 sc1
    buffer_load_dwordx4 v[52:55], v0, s[4:7], s28 offen offset:3072 sc1
    buffer_load_dwordx4 v[56:59], v0, s[4:7], s20 offen offset:0 sc1
    buffer_load_dwordx4 v[60:63], v0, s[4:7], s20 offen offset:1024 sc1
    buffer_load_dwordx4 v[64:67], v0, s[4:7], s20 offen offset:2048 sc1
    buffer_load_dwordx4 v[68:71], v0, s[4:7], s20 offen offset:3072 sc1
    buffer_load_dwordx4 v[72:75], v0, s[4:7], s21 offen offset:0 sc1
    s_waitcnt vmcnt(0)
    ds_write_b128 v32, v[40:43] offset:0
    ds_write_b128 v33, v[44:47] offset:0
    ds_write_b128 v34, v[48:51] offset:0
    ds_write_b128 v35, v[52:55] offset:0
    ds_write_b128 v36, v[56:59] offset:0
    ds_write_b128 v37, v[60:63] offset:0
    ds_write_b128 v38, v[64:67] offset:0
    ds_write_b128 v39, v[68:71] offset:0
    ds_write_b128 v76, v[72:75] offset:0
    s_waitcnt lgkmcnt(0)
    s_barrier
Lsgj_90_m:
    s_branch Lsg_71_m
Lsge_72_m:
    s_branch Lqkvend_66_m
Lisq_65_m:
    v_lshrrev_b32 v10, 9, v0
    v_mul_u32_u24 v12, 544, v10
    v_and_b32 v10, 0x1f0, v0
    v_add_u32 v12, v12, v10
    v_add_u32 v10, 39168, v12
    v_lshrrev_b32 v7, 4, v0
    s_mul_i32 s19, s13, 576
    s_add_u32 s19, s19, 0
    v_add_u32 v7, s19, v7
    v_mul_u32_u24 v32, 3641, v7
    v_lshrrev_b32 v32, 18, v32
    v_mul_u32_u24 v13, 72, v32
    v_sub_u32 v7, v7, v13
    v_lshlrev_b32 v32, 4, v32
    v_mul_u32_u24 v13, 544, v7
    v_add_u32 v32, v32, v13
    v_lshrrev_b32 v7, 4, v0
    s_mul_i32 s19, s13, 576
    s_add_u32 s19, s19, 64
    v_add_u32 v7, s19, v7
    v_mul_u32_u24 v33, 3641, v7
    v_lshrrev_b32 v33, 18, v33
    v_mul_u32_u24 v13, 72, v33
    v_sub_u32 v7, v7, v13
    v_lshlrev_b32 v33, 4, v33
    v_mul_u32_u24 v13, 544, v7
    v_add_u32 v33, v33, v13
    v_lshrrev_b32 v7, 4, v0
    s_mul_i32 s19, s13, 576
    s_add_u32 s19, s19, 128
    v_add_u32 v7, s19, v7
    v_mul_u32_u24 v34, 3641, v7
    v_lshrrev_b32 v34, 18, v34
    v_mul_u32_u24 v13, 72, v34
    v_sub_u32 v7, v7, v13
    v_lshlrev_b32 v34, 4, v34
    v_mul_u32_u24 v13, 544, v7
    v_add_u32 v34, v34, v13
    v_lshrrev_b32 v7, 4, v0
    s_mul_i32 s19, s13, 576
    s_add_u32 s19, s19, 192
    v_add_u32 v7, s19, v7
    v_mul_u32_u24 v35, 3641, v7
    v_lshrrev_b32 v35, 18, v35
    v_mul_u32_u24 v13, 72, v35
    v_sub_u32 v7, v7, v13
    v_lshlrev_b32 v35, 4, v35
    v_mul_u32_u24 v13, 544, v7
    v_add_u32 v35, v35, v13
    v_lshrrev_b32 v7, 4, v0
    s_mul_i32 s19, s13, 576
    s_add_u32 s19, s19, 256
    v_add_u32 v7, s19, v7
    v_mul_u32_u24 v36, 3641, v7
    v_lshrrev_b32 v36, 18, v36
    v_mul_u32_u24 v13, 72, v36
    v_sub_u32 v7, v7, v13
    v_lshlrev_b32 v36, 4, v36
    v_mul_u32_u24 v13, 544, v7
    v_add_u32 v36, v36, v13
    v_lshrrev_b32 v7, 4, v0
    s_mul_i32 s19, s13, 576
    s_add_u32 s19, s19, 320
    v_add_u32 v7, s19, v7
    v_mul_u32_u24 v37, 3641, v7
    v_lshrrev_b32 v37, 18, v37
    v_mul_u32_u24 v13, 72, v37
    v_sub_u32 v7, v7, v13
    v_lshlrev_b32 v37, 4, v37
    v_mul_u32_u24 v13, 544, v7
    v_add_u32 v37, v37, v13
    v_lshrrev_b32 v7, 4, v0
    s_mul_i32 s19, s13, 576
    s_add_u32 s19, s19, 384
    v_add_u32 v7, s19, v7
    v_mul_u32_u24 v38, 3641, v7
    v_lshrrev_b32 v38, 18, v38
    v_mul_u32_u24 v13, 72, v38
    v_sub_u32 v7, v7, v13
    v_lshlrev_b32 v38, 4, v38
    v_mul_u32_u24 v13, 544, v7
    v_add_u32 v38, v38, v13
    v_lshrrev_b32 v7, 4, v0
    s_mul_i32 s19, s13, 576
    s_add_u32 s19, s19, 448
    v_add_u32 v7, s19, v7
    v_mul_u32_u24 v39, 3641, v7
    v_lshrrev_b32 v39, 18, v39
    v_mul_u32_u24 v13, 72, v39
    v_sub_u32 v7, v7, v13
    v_lshlrev_b32 v39, 4, v39
    v_mul_u32_u24 v13, 544, v7
    v_add_u32 v39, v39, v13
    v_lshrrev_b32 v7, 4, v0
    s_mul_i32 s19, s13, 576
    s_add_u32 s19, s19, 512
    v_add_u32 v7, s19, v7
    v_mul_u32_u24 v76, 3641, v7
    v_lshrrev_b32 v76, 18, v76
    v_mul_u32_u24 v13, 72, v76
    v_sub_u32 v7, v7, v13
    v_lshlrev_b32 v76, 4, v76
    v_mul_u32_u24 v13, 544, v7
    v_add_u32 v76, v76, v13
    s_mov_b32 s27, 0
    s_mov_b32 s30, -1
    s_cmp_lg_u32 s13, 0
    s_cbranch_scc1 Lur_103_m
    s_cmp_lt_u32 s17, s92
    s_cbranch_scc1 Lfwok_105_m
    s_mul_i32 s98, s17, 128
    s_add_u32 s98, s98, 61949952
Lfw_104_m:
    buffer_load_dwordx4 v[108:111], v0, s[4:7], s98 offen sc1
    s_waitcnt vmcnt(0)
    v_xor_b32 v108, s90, v108
    v_xor_b32 v109, s90, v109
    v_xor_b32 v110, s90, v110
    v_xor_b32 v111, s90, v111
    v_or3_b32 v108, v108, v109, v110
    v_or_b32 v108, v108, v111
    v_cmp_ne_u32 vcc, 0, v108
    s_nop 3
    s_and_b32 vcc_lo, vcc_lo, 0xffffffff
    s_and_b32 vcc_hi, vcc_hi, 0xffffffff
    s_ff1_i32_b64 s92, vcc
    s_cmp_eq_u32 s92, -1
    s_cselect_b32 s92, 64, s92
    s_lshr_b32 s92, s92, 3
    s_cmp_lg_u32 s92, 0
    s_cbranch_scc1 Lfwg_106_m
    s_sleep 2
    s_add_u32 s99, s99, 1
    s_cmp_lt_u32 s99, 4194304
    s_cbranch_scc1 Lfw_104_m
    s_endpgm
Lfwg_106_m:
    s_add_u32 s92, s92, s17
Lfwok_105_m:
    v_mov_b32 v14, 163832
    v_mov_b32 v15, s92
    ds_write_b32 v14, v15
    s_waitcnt lgkmcnt(0)
Lur_103_m:
    s_barrier
    v_mov_b32 v14, 163832
    ds_read_b32 v15, v14
    s_waitcnt lgkmcnt(0)
    v_readfirstlane_b32 s92, v15
    s_mul_i32 s28, s17, 36864
    s_mul_i32 s19, s13, 9216
    s_add_u32 s28, s28, s19
    s_add_u32 s28, s28, 62914560
    s_add_u32 s20, s28, 4096
    s_add_u32 s21, s28, 8192
    buffer_load_dwordx4 v[40:43], v0, s[4:7], s28 offen offset:0 sc1
    buffer_load_dwordx4 v[44:47], v0, s[4:7], s28 offen offset:1024 sc1
    buffer_load_dwordx4 v[48:51], v0, s[4:7], s28 offen offset:2048 sc1
    buffer_load_dwordx4 v[52:55], v0, s[4:7], s28 offen offset:3072 sc1
    buffer_load_dwordx4 v[56:59], v0, s[4:7], s20 offen offset:0 sc1
    buffer_load_dwordx4 v[60:63], v0, s[4:7], s20 offen offset:1024 sc1
    buffer_load_dwordx4 v[64:67], v0, s[4:7], s20 offen offset:2048 sc1
    buffer_load_dwordx4 v[68:71], v0, s[4:7], s20 offen offset:3072 sc1
    buffer_load_dwordx4 v[72:75], v0, s[4:7], s21 offen offset:0 sc1
    s_waitcnt vmcnt(0)
    ds_write_b128 v32, v[40:43] offset:0
    ds_write_b128 v33, v[44:47] offset:0
    ds_write_b128 v34, v[48:51] offset:0
    ds_write_b128 v35, v[52:55] offset:0
    ds_write_b128 v36, v[56:59] offset:0
    ds_write_b128 v37, v[60:63] offset:0
    ds_write_b128 v38, v[64:67] offset:0
    ds_write_b128 v39, v[68:71] offset:0
    ds_write_b128 v76, v[72:75] offset:0
    s_waitcnt lgkmcnt(0)
    s_barrier
Lsg_107_m:
    s_add_u32 s27, s27, 1
    s_mov_b32 s29, s17
    s_mov_b32 s31, 0
    s_add_u32 s17, s17, 1
    s_cmp_ge_u32 s17, 64
    s_cbranch_scc1 Lsgl_109_m
    s_cmp_lt_u32 s17, s92
    s_cbranch_scc0 Lsgl_109_m
    s_mul_i32 s28, s17, 36864
    s_mul_i32 s19, s13, 9216
    s_add_u32 s28, s28, s19
    s_add_u32 s28, s28, 62914560
    s_add_u32 s20, s28, 4096
    s_add_u32 s21, s28, 8192
    buffer_load_dwordx4 v[40:43], v0, s[4:7], s28 offen offset:0 sc1
    buffer_load_dwordx4 v[44:47], v0, s[4:7], s28 offen offset:1024 sc1
    buffer_load_dwordx4 v[48:51], v0, s[4:7], s28 offen offset:2048 sc1
    buffer_load_dwordx4 v[52:55], v0, s[4:7], s28 offen offset:3072 sc1
    buffer_load_dwordx4 v[56:59], v0, s[4:7], s20 offen offset:0 sc1
    buffer_load_dwordx4 v[60:63], v0, s[4:7], s20 offen offset:1024 sc1
    buffer_load_dwordx4 v[64:67], v0, s[4:7], s20 offen offset:2048 sc1
    buffer_load_dwordx4 v[68:71], v0, s[4:7], s20 offen offset:3072 sc1
    buffer_load_dwordx4 v[72:75], v0, s[4:7], s21 offen offset:0 sc1
    s_mov_b32 s31, 1
Lsgl_109_m:
    ds_read_b128 v[80:83], v12 offset:0
    ds_read_b128 v[84:87], v12 offset:1088
    ds_read_b128 v[88:91], v12 offset:2176
    ds_read_b128 v[92:95], v12 offset:3264
    s_waitcnt lgkmcnt(3)
    v_mfma_f32_32x32x16_bf16 v[16:31], v[112:115], v[80:83], 0
    ds_read_b128 v[80:83], v12 offset:4352
    s_waitcnt lgkmcnt(3)
    v_mfma_f32_32x32x16_bf16 v[16:31], v[116:119], v[84:87], v[16:31]
    ds_read_b128 v[84:87], v12 offset:5440
    s_waitcnt lgkmcnt(3)
    v_mfma_f32_32x32x16_bf16 v[16:31], v[120:123], v[88:91], v[16:31]
    ds_read_b128 v[88:91], v12 offset:6528
    s_waitcnt lgkmcnt(3)
    v_mfma_f32_32x32x16_bf16 v[16:31], v[124:127], v[92:95], v[16:31]
    ds_read_b128 v[92:95], v12 offset:7616
    s_waitcnt lgkmcnt(3)
    v_mfma_f32_32x32x16_bf16 v[16:31], v[128:131], v[80:83], v[16:31]
    ds_read_b128 v[80:83], v12 offset:8704
    s_waitcnt lgkmcnt(3)
    v_mfma_f32_32x32x16_bf16 v[16:31], v[132:135], v[84:87], v[16:31]
    ds_read_b128 v[84:87], v12 offset:9792
    s_waitcnt lgkmcnt(3)
    v_mfma_f32_32x32x16_bf16 v[16:31], v[136:139], v[88:91], v[16:31]
    ds_read_b128 v[88:91], v12 offset:10880
    s_waitcnt lgkmcnt(3)
    v_mfma_f32_32x32x16_bf16 v[16:31], v[140:143], v[92:95], v[16:31]
    ds_read_b128 v[92:95], v12 offset:11968
    s_waitcnt lgkmcnt(3)
    v_mfma_f32_32x32x16_bf16 v[16:31], v[144:147], v[80:83], v[16:31]
    ds_read_b128 v[80:83], v12 offset:13056
    s_waitcnt lgkmcnt(3)
    v_mfma_f32_32x32x16_bf16 v[16:31], v[148:151], v[84:87], v[16:31]
    ds_read_b128 v[84:87], v12 offset:14144
    s_waitcnt lgkmcnt(3)
    v_mfma_f32_32x32x16_bf16 v[16:31], v[152:155], v[88:91], v[16:31]
    ds_read_b128 v[88:91], v12 offset:15232
    s_waitcnt lgkmcnt(3)
    v_mfma_f32_32x32x16_bf16 v[16:31], v[156:159], v[92:95], v[16:31]
    ds_read_b128 v[92:95], v12 offset:16320
    s_waitcnt lgkmcnt(3)
    v_mfma_f32_32x32x16_bf16 v[16:31], v[160:163], v[80:83], v[16:31]
    ds_read_b128 v[80:83], v12 offset:17408
    s_waitcnt lgkmcnt(3)
    v_mfma_f32_32x32x16_bf16 v[16:31], v[164:167], v[84:87], v[16:31]
    ds_read_b128 v[84:87], v12 offset:18496
    s_waitcnt lgkmcnt(3)
    v_mfma_f32_32x32x16_bf16 v[16:31], v[168:171], v[88:91], v[16:31]
    ds_read_b128 v[88:91], v12 offset:19584
    s_waitcnt lgkmcnt(3)
    v_mfma_f32_32x32x16_bf16 v[16:31], v[172:175], v[92:95], v[16:31]
    ds_read_b128 v[92:95], v12 offset:20672
    s_waitcnt lgkmcnt(3)
    v_mfma_f32_32x32x16_bf16 v[16:31], v[176:179], v[80:83], v[16:31]
    ds_read_b128 v[80:83], v12 offset:21760
    s_waitcnt lgkmcnt(3)
    v_mfma_f32_32x32x16_bf16 v[16:31], v[180:183], v[84:87], v[16:31]
    ds_read_b128 v[84:87], v12 offset:22848
    s_waitcnt lgkmcnt(3)
    v_mfma_f32_32x32x16_bf16 v[16:31], v[184:187], v[88:91], v[16:31]
    ds_read_b128 v[88:91], v12 offset:23936
    s_waitcnt lgkmcnt(3)
    v_mfma_f32_32x32x16_bf16 v[16:31], v[188:191], v[92:95], v[16:31]
    ds_read_b128 v[92:95], v12 offset:25024
    s_waitcnt lgkmcnt(3)
    v_mfma_f32_32x32x16_bf16 v[16:31], v[192:195], v[80:83], v[16:31]
    ds_read_b128 v[80:83], v12 offset:26112
    s_waitcnt lgkmcnt(3)
    v_mfma_f32_32x32x16_bf16 v[16:31], v[196:199], v[84:87], v[16:31]
    ds_read_b128 v[84:87], v12 offset:27200
    s_waitcnt lgkmcnt(3)
    v_mfma_f32_32x32x16_bf16 v[16:31], v[200:203], v[88:91], v[16:31]
    ds_read_b128 v[88:91], v12 offset:28288
    s_waitcnt lgkmcnt(3)
    v_mfma_f32_32x32x16_bf16 v[16:31], v[204:207], v[92:95], v[16:31]
    ds_read_b128 v[92:95], v12 offset:29376
    s_waitcnt lgkmcnt(3)
    v_mfma_f32_32x32x16_bf16 v[16:31], v[208:211], v[80:83], v[16:31]
    ds_read_b128 v[80:83], v12 offset:30464
    s_waitcnt lgkmcnt(3)
    v_mfma_f32_32x32x16_bf16 v[16:31], v[212:215], v[84:87], v[16:31]
    ds_read_b128 v[84:87], v12 offset:31552
    s_waitcnt lgkmcnt(3)
    v_mfma_f32_32x32x16_bf16 v[16:31], v[216:219], v[88:91], v[16:31]
    ds_read_b128 v[88:91], v12 offset:32640
    s_waitcnt lgkmcnt(3)
    v_mfma_f32_32x32x16_bf16 v[16:31], v[220:223], v[92:95], v[16:31]
    ds_read_b128 v[92:95], v12 offset:33728
    s_waitcnt lgkmcnt(3)
    v_mfma_f32_32x32x16_bf16 v[16:31], v[224:227], v[80:83], v[16:31]
    ds_read_b128 v[80:83], v12 offset:34816
    s_waitcnt lgkmcnt(3)
    v_mfma_f32_32x32x16_bf16 v[16:31], v[228:231], v[84:87], v[16:31]
    ds_read_b128 v[84:87], v12 offset:35904
    s_waitcnt lgkmcnt(3)
    v_mfma_f32_32x32x16_bf16 v[16:31], v[232:235], v[88:91], v[16:31]
    ds_read_b128 v[88:91], v12 offset:36992
    s_waitcnt lgkmcnt(3)
    v_mfma_f32_32x32x16_bf16 v[16:31], v[236:239], v[92:95], v[16:31]
    ds_read_b128 v[92:95], v12 offset:38080
    s_waitcnt lgkmcnt(3)
    v_mfma_f32_32x32x16_bf16 v[16:31], v[240:243], v[80:83], v[16:31]
    s_waitcnt lgkmcnt(2)
    v_mfma_f32_32x32x16_bf16 v[16:31], v[244:247], v[84:87], v[16:31]
    s_waitcnt lgkmcnt(1)
    v_mfma_f32_32x32x16_bf16 v[16:31], v[248:251], v[88:91], v[16:31]
    s_waitcnt lgkmcnt(0)
    v_mfma_f32_32x32x16_bf16 v[16:31], v[252:255], v[92:95], v[16:31]
    s_nop 11
    v_cvt_pk_bf16_f32 v96, v16, v17
    v_cvt_pk_bf16_f32 v97, v18, v19
    v_cvt_pk_bf16_f32 v98, v20, v21
    v_cvt_pk_bf16_f32 v99, v22, v23
    v_cvt_pk_bf16_f32 v100, v24, v25
    v_cvt_pk_bf16_f32 v101, v26, v27
    v_cvt_pk_bf16_f32 v102, v28, v29
    v_cvt_pk_bf16_f32 v103, v30, v31
    s_lshl_b32 s19, s29, 18
    s_add_u32 s19, s19, s18
    v_permlane32_swap_b32 v96, v98
    v_permlane32_swap_b32 v97, v99
    v_permlane32_swap_b32 v100, v102
    v_permlane32_swap_b32 v101, v103
    buffer_store_dwordx4 v[96:99], v8, s[4:7], s19 offen sc1
    buffer_store_dwordx4 v[100:103], v8, s[4:7], s19 offen offset:512 sc1
    s_cmp_eq_u32 s31, 1
    s_cbranch_scc0 Lsgn_110_m
    s_waitcnt vmcnt(2)
    ds_write_b128 v32, v[40:43] offset:39168
    ds_write_b128 v33, v[44:47] offset:39168
    ds_write_b128 v34, v[48:51] offset:39168
    ds_write_b128 v35, v[52:55] offset:39168
    ds_write_b128 v36, v[56:59] offset:39168
    ds_write_b128 v37, v[60:63] offset:39168
    ds_write_b128 v38, v[64:67] offset:39168
    ds_write_b128 v39, v[68:71] offset:39168
    ds_write_b128 v76, v[72:75] offset:39168
    s_cmp_le_u32 s27, 3
    s_cbranch_scc0 Lsgz_113_m
    s_waitcnt vmcnt(0) lgkmcnt(0)
    s_barrier
    s_cmp_lg_u32 s13, 0
    s_cbranch_scc1 Lfs0_114
    s_mul_i32 s98, s29, 32
    s_add_u32 s98, s98, s97
    s_lshl_b32 s98, s98, 2
    s_add_u32 s98, s98, 61977344
    v_mov_b32 v11, s90
    s_mov_b64 exec, 1
    buffer_store_dword v11, off, s[4:7], s98 offset:0 sc1
    s_mov_b64 exec, -1
Lfs0_114:
    s_mov_b32 s30, -1
    s_branch Lsgj_111_m
Lsgz_113_m:
    s_waitcnt lgkmcnt(0)
    s_barrier
    s_cmp_eq_u32 s30, -1
    s_cbranch_scc1 Lsgd_115_m
    s_cmp_lg_u32 s13, 0
    s_cbranch_scc1 Lfs0_116
    s_mul_i32 s98, s30, 32
    s_add_u32 s98, s98, s97
    s_lshl_b32 s98, s98, 2
    s_add_u32 s98, s98, 61977344
    v_mov_b32 v11, s90
    s_mov_b64 exec, 1
    buffer_store_dword v11, off, s[4:7], s98 offset:0 sc1
    s_mov_b64 exec, -1
Lfs0_116:
Lsgd_115_m:
    s_mov_b32 s30, s29
    s_branch Lsgj_111_m
Lsgn_110_m:
    s_waitcnt vmcnt(0)
    s_barrier
    s_cmp_eq_u32 s30, -1
    s_cbranch_scc1 Lsgd_117_m
    s_cmp_lg_u32 s13, 0
    s_cbranch_scc1 Lfs0_118
    s_mul_i32 s98, s30, 32
    s_add_u32 s98, s98, s97
    s_lshl_b32 s98, s98, 2
    s_add_u32 s98, s98, 61977344
    v_mov_b32 v11, s90
    s_mov_b64 exec, 1
    buffer_store_dword v11, off, s[4:7], s98 offset:0 sc1
    s_mov_b64 exec, -1
Lfs0_118:
Lsgd_117_m:
    s_cmp_lg_u32 s13, 0
    s_cbranch_scc1 Lfs0_119
    s_mul_i32 s98, s29, 32
    s_add_u32 s98, s98, s97
    s_lshl_b32 s98, s98, 2
    s_add_u32 s98, s98, 61977344
    v_mov_b32 v11, s90
    s_mov_b64 exec, 1
    buffer_store_dword v11, off, s[4:7], s98 offset:0 sc1
    s_mov_b64 exec, -1
Lfs0_119:
    s_mov_b32 s30, -1
    s_cmp_ge_u32 s17, 64
    s_cbranch_scc1 Lsge_108_m
    s_cmp_lg_u32 s13, 0
    s_cbranch_scc1 Lur_120_m
    s_cmp_lt_u32 s17, s92
    s_cbranch_scc1 Lfwok_122_m
    s_mul_i32 s98, s17, 128
    s_add_u32 s98, s98, 61949952
Lfw_121_m:
    buffer_load_dwordx4 v[108:111], v0, s[4:7], s98 offen sc1
    s_waitcnt vmcnt(0)
    v_xor_b32 v108, s90, v108
    v_xor_b32 v109, s90, v109
    v_xor_b32 v110, s90, v110
    v_xor_b32 v111, s90, v111
    v_or3_b32 v108, v108, v109, v110
    v_or_b32 v108, v108, v111
    v_cmp_ne_u32 vcc, 0, v108
    s_nop 3
    s_and_b32 vcc_lo, vcc_lo, 0xffffffff
    s_and_b32 vcc_hi, vcc_hi, 0xffffffff
    s_ff1_i32_b64 s92, vcc
    s_cmp_eq_u32 s92, -1
    s_cselect_b32 s92, 64, s92
    s_lshr_b32 s92, s92, 3
    s_cmp_lg_u32 s92, 0
    s_cbranch_scc1 Lfwg_123_m
    s_sleep 2
    s_add_u32 s99, s99, 1
    s_cmp_lt_u32 s99, 4194304
    s_cbranch_scc1 Lfw_121_m
    s_endpgm
Lfwg_123_m:
    s_add_u32 s92, s92, s17
Lfwok_122_m:
    v_mov_b32 v14, 163832
    v_mov_b32 v15, s92
    ds_write_b32 v14, v15
    s_waitcnt lgkmcnt(0)
Lur_120_m:
    s_barrier
    v_mov_b32 v14, 163832
    ds_read_b32 v15, v14
    s_waitcnt lgkmcnt(0)
    v_readfirstlane_b32 s92, v15
    s_mul_i32 s28, s17, 36864
    s_mul_i32 s19, s13, 9216
    s_add_u32 s28, s28, s19
    s_add_u32 s28, s28, 62914560
    s_add_u32 s20, s28, 4096
    s_add_u32 s21, s28, 8192
    buffer_load_dwordx4 v[40:43], v0, s[4:7], s28 offen offset:0 sc1
    buffer_load_dwordx4 v[44:47], v0, s[4:7], s28 offen offset:1024 sc1
    buffer_load_dwordx4 v[48:51], v0, s[4:7], s28 offen offset:2048 sc1
    buffer_load_dwordx4 v[52:55], v0, s[4:7], s28 offen offset:3072 sc1
    buffer_load_dwordx4 v[56:59], v0, s[4:7], s20 offen offset:0 sc1
    buffer_load_dwordx4 v[60:63], v0, s[4:7], s20 offen offset:1024 sc1
    buffer_load_dwordx4 v[64:67], v0, s[4:7], s20 offen offset:2048 sc1
    buffer_load_dwordx4 v[68:71], v0, s[4:7], s20 offen offset:3072 sc1
    buffer_load_dwordx4 v[72:75], v0, s[4:7], s21 offen offset:0 sc1
    s_waitcnt vmcnt(0)
    ds_write_b128 v32, v[40:43] offset:39168
    ds_write_b128 v33, v[44:47] offset:39168
    ds_write_b128 v34, v[48:51] offset:39168
    ds_write_b128 v35, v[52:55] offset:39168
    ds_write_b128 v36, v[56:59] offset:39168
    ds_write_b128 v37, v[60:63] offset:39168
    ds_write_b128 v38, v[64:67] offset:39168
    ds_write_b128 v39, v[68:71] offset:39168
    ds_write_b128 v76, v[72:75] offset:39168
    s_waitcnt lgkmcnt(0)
    s_barrier
Lsgj_111_m:
    s_add_u32 s27, s27, 1
    s_mov_b32 s29, s17
    s_mov_b32 s31, 0
    s_add_u32 s17, s17, 1
    s_cmp_ge_u32 s17, 64
    s_cbranch_scc1 Lsgl_124_m
    s_cmp_lt_u32 s17, s92
    s_cbranch_scc0 Lsgl_124_m
    s_mul_i32 s28, s17, 36864
    s_mul_i32 s19, s13, 9216
    s_add_u32 s28, s28, s19
    s_add_u32 s28, s28, 62914560
    s_add_u32 s20, s28, 4096
    s_add_u32 s21, s28, 8192
    buffer_load_dwordx4 v[40:43], v0, s[4:7], s28 offen offset:0 sc1
    buffer_load_dwordx4 v[44:47], v0, s[4:7], s28 offen offset:1024 sc1
    buffer_load_dwordx4 v[48:51], v0, s[4:7], s28 offen offset:2048 sc1
    buffer_load_dwordx4 v[52:55], v0, s[4:7], s28 offen offset:3072 sc1
    buffer_load_dwordx4 v[56:59], v0, s[4:7], s20 offen offset:0 sc1
    buffer_load_dwordx4 v[60:63], v0, s[4:7], s20 offen offset:1024 sc1
    buffer_load_dwordx4 v[64:67], v0, s[4:7], s20 offen offset:2048 sc1
    buffer_load_dwordx4 v[68:71], v0, s[4:7], s20 offen offset:3072 sc1
    buffer_load_dwordx4 v[72:75], v0, s[4:7], s21 offen offset:0 sc1
    s_mov_b32 s31, 1
Lsgl_124_m:
    ds_read_b128 v[80:83], v10 offset:0
    ds_read_b128 v[84:87], v10 offset:1088
    ds_read_b128 v[88:91], v10 offset:2176
    ds_read_b128 v[92:95], v10 offset:3264
    s_waitcnt lgkmcnt(3)
    v_mfma_f32_32x32x16_bf16 v[16:31], v[112:115], v[80:83], 0
    ds_read_b128 v[80:83], v10 offset:4352
    s_waitcnt lgkmcnt(3)
    v_mfma_f32_32x32x16_bf16 v[16:31], v[116:119], v[84:87], v[16:31]
    ds_read_b128 v[84:87], v10 offset:5440
    s_waitcnt lgkmcnt(3)
    v_mfma_f32_32x32x16_bf16 v[16:31], v[120:123], v[88:91], v[16:31]
    ds_read_b128 v[88:91], v10 offset:6528
    s_waitcnt lgkmcnt(3)
    v_mfma_f32_32x32x16_bf16 v[16:31], v[124:127], v[92:95], v[16:31]
    ds_read_b128 v[92:95], v10 offset:7616
    s_waitcnt lgkmcnt(3)
    v_mfma_f32_32x32x16_bf16 v[16:31], v[128:131], v[80:83], v[16:31]
    ds_read_b128 v[80:83], v10 offset:8704
    s_waitcnt lgkmcnt(3)
    v_mfma_f32_32x32x16_bf16 v[16:31], v[132:135], v[84:87], v[16:31]
    ds_read_b128 v[84:87], v10 offset:9792
    s_waitcnt lgkmcnt(3)
    v_mfma_f32_32x32x16_bf16 v[16:31], v[136:139], v[88:91], v[16:31]
    ds_read_b128 v[88:91], v10 offset:10880
    s_waitcnt lgkmcnt(3)
    v_mfma_f32_32x32x16_bf16 v[16:31], v[140:143], v[92:95], v[16:31]
    ds_read_b128 v[92:95], v10 offset:11968
    s_waitcnt lgkmcnt(3)
    v_mfma_f32_32x32x16_bf16 v[16:31], v[144:147], v[80:83], v[16:31]
    ds_read_b128 v[80:83], v10 offset:13056
    s_waitcnt lgkmcnt(3)
    v_mfma_f32_32x32x16_bf16 v[16:31], v[148:151], v[84:87], v[16:31]
    ds_read_b128 v[84:87], v10 offset:14144
    s_waitcnt lgkmcnt(3)
    v_mfma_f32_32x32x16_bf16 v[16:31], v[152:155], v[88:91], v[16:31]
    ds_read_b128 v[88:91], v10 offset:15232
    s_waitcnt lgkmcnt(3)
    v_mfma_f32_32x32x16_bf16 v[16:31], v[156:159], v[92:95], v[16:31]
    ds_read_b128 v[92:95], v10 offset:16320
    s_waitcnt lgkmcnt(3)
    v_mfma_f32_32x32x16_bf16 v[16:31], v[160:163], v[80:83], v[16:31]
    ds_read_b128 v[80:83], v10 offset:17408
    s_waitcnt lgkmcnt(3)
    v_mfma_f32_32x32x16_bf16 v[16:31], v[164:167], v[84:87], v[16:31]
    ds_read_b128 v[84:87], v10 offset:18496
    s_waitcnt lgkmcnt(3)
    v_mfma_f32_32x32x16_bf16 v[16:31], v[168:171], v[88:91], v[16:31]
    ds_read_b128 v[88:91], v10 offset:19584
    s_waitcnt lgkmcnt(3)
    v_mfma_f32_32x32x16_bf16 v[16:31], v[172:175], v[92:95], v[16:31]
    ds_read_b128 v[92:95], v10 offset:20672
    s_waitcnt lgkmcnt(3)
    v_mfma_f32_32x32x16_bf16 v[16:31], v[176:179], v[80:83], v[16:31]
    ds_read_b128 v[80:83], v10 offset:21760
    s_waitcnt lgkmcnt(3)
    v_mfma_f32_32x32x16_bf16 v[16:31], v[180:183], v[84:87], v[16:31]
    ds_read_b128 v[84:87], v10 offset:22848
    s_waitcnt lgkmcnt(3)
    v_mfma_f32_32x32x16_bf16 v[16:31], v[184:187], v[88:91], v[16:31]
    ds_read_b128 v[88:91], v10 offset:23936
    s_waitcnt lgkmcnt(3)
    v_mfma_f32_32x32x16_bf16 v[16:31], v[188:191], v[92:95], v[16:31]
    ds_read_b128 v[92:95], v10 offset:25024
    s_waitcnt lgkmcnt(3)
    v_mfma_f32_32x32x16_bf16 v[16:31], v[192:195], v[80:83], v[16:31]
    ds_read_b128 v[80:83], v10 offset:26112
    s_waitcnt lgkmcnt(3)
    v_mfma_f32_32x32x16_bf16 v[16:31], v[196:199], v[84:87], v[16:31]
    ds_read_b128 v[84:87], v10 offset:27200
    s_waitcnt lgkmcnt(3)
    v_mfma_f32_32x32x16_bf16 v[16:31], v[200:203], v[88:91], v[16:31]
    ds_read_b128 v[88:91], v10 offset:28288
    s_waitcnt lgkmcnt(3)
    v_mfma_f32_32x32x16_bf16 v[16:31], v[204:207], v[92:95], v[16:31]
    ds_read_b128 v[92:95], v10 offset:29376
    s_waitcnt lgkmcnt(3)
    v_mfma_f32_32x32x16_bf16 v[16:31], v[208:211], v[80:83], v[16:31]
    ds_read_b128 v[80:83], v10 offset:30464
    s_waitcnt lgkmcnt(3)
    v_mfma_f32_32x32x16_bf16 v[16:31], v[212:215], v[84:87], v[16:31]
    ds_read_b128 v[84:87], v10 offset:31552
    s_waitcnt lgkmcnt(3)
    v_mfma_f32_32x32x16_bf16 v[16:31], v[216:219], v[88:91], v[16:31]
    ds_read_b128 v[88:91], v10 offset:32640
    s_waitcnt lgkmcnt(3)
    v_mfma_f32_32x32x16_bf16 v[16:31], v[220:223], v[92:95], v[16:31]
    ds_read_b128 v[92:95], v10 offset:33728
    s_waitcnt lgkmcnt(3)
    v_mfma_f32_32x32x16_bf16 v[16:31], v[224:227], v[80:83], v[16:31]
    ds_read_b128 v[80:83], v10 offset:34816
    s_waitcnt lgkmcnt(3)
    v_mfma_f32_32x32x16_bf16 v[16:31], v[228:231], v[84:87], v[16:31]
    ds_read_b128 v[84:87], v10 offset:35904
    s_waitcnt lgkmcnt(3)
    v_mfma_f32_32x32x16_bf16 v[16:31], v[232:235], v[88:91], v[16:31]
    ds_read_b128 v[88:91], v10 offset:36992
    s_waitcnt lgkmcnt(3)
    v_mfma_f32_32x32x16_bf16 v[16:31], v[236:239], v[92:95], v[16:31]
    ds_read_b128 v[92:95], v10 offset:38080
    s_waitcnt lgkmcnt(3)
    v_mfma_f32_32x32x16_bf16 v[16:31], v[240:243], v[80:83], v[16:31]
    s_waitcnt lgkmcnt(2)
    v_mfma_f32_32x32x16_bf16 v[16:31], v[244:247], v[84:87], v[16:31]
    s_waitcnt lgkmcnt(1)
    v_mfma_f32_32x32x16_bf16 v[16:31], v[248:251], v[88:91], v[16:31]
    s_waitcnt lgkmcnt(0)
    v_mfma_f32_32x32x16_bf16 v[16:31], v[252:255], v[92:95], v[16:31]
    s_nop 11
    v_cvt_pk_bf16_f32 v96, v16, v17
    v_cvt_pk_bf16_f32 v97, v18, v19
    v_cvt_pk_bf16_f32 v98, v20, v21
    v_cvt_pk_bf16_f32 v99, v22, v23
    v_cvt_pk_bf16_f32 v100, v24, v25
    v_cvt_pk_bf16_f32 v101, v26, v27
    v_cvt_pk_bf16_f32 v102, v28, v29
    v_cvt_pk_bf16_f32 v103, v30, v31
    s_lshl_b32 s19, s29, 18
    s_add_u32 s19, s19, s18
    v_permlane32_swap_b32 v96, v98
    v_permlane32_swap_b32 v97, v99
    v_permlane32_swap_b32 v100, v102
    v_permlane32_swap_b32 v101, v103
    buffer_store_dwordx4 v[96:99], v8, s[4:7], s19 offen sc1
    buffer_store_dwordx4 v[100:103], v8, s[4:7], s19 offen offset:512 sc1
    s_cmp_eq_u32 s31, 1
    s_cbranch_scc0 Lsgn_125_m
    s_waitcnt vmcnt(2)
    ds_write_b128 v32, v[40:43] offset:0
    ds_write_b128 v33, v[44:47] offset:0
    ds_write_b128 v34, v[48:51] offset:0
    ds_write_b128 v35, v[52:55] offset:0
    ds_write_b128 v36, v[56:59] offset:0
    ds_write_b128 v37, v[60:63] offset:0
    ds_write_b128 v38, v[64:67] offset:0
    ds_write_b128 v39, v[68:71] offset:0
    ds_write_b128 v76, v[72:75] offset:0
    s_cmp_le_u32 s27, 3
    s_cbranch_scc0 Lsgz_128_m
    s_waitcnt vmcnt(0) lgkmcnt(0)
    s_barrier
    s_cmp_lg_u32 s13, 0
    s_cbranch_scc1 Lfs0_129
    s_mul_i32 s98, s29, 32
    s_add_u32 s98, s98, s97
    s_lshl_b32 s98, s98, 2
    s_add_u32 s98, s98, 61977344
    v_mov_b32 v11, s90
    s_mov_b64 exec, 1
    buffer_store_dword v11, off, s[4:7], s98 offset:0 sc1
    s_mov_b64 exec, -1
Lfs0_129:
    s_mov_b32 s30, -1
    s_branch Lsgj_126_m
Lsgz_128_m:
    s_waitcnt lgkmcnt(0)
    s_barrier
    s_cmp_eq_u32 s30, -1
    s_cbranch_scc1 Lsgd_130_m
    s_cmp_lg_u32 s13, 0
    s_cbranch_scc1 Lfs0_131
    s_mul_i32 s98, s30, 32
    s_add_u32 s98, s98, s97
    s_lshl_b32 s98, s98, 2
    s_add_u32 s98, s98, 61977344
    v_mov_b32 v11, s90
    s_mov_b64 exec, 1
    buffer_store_dword v11, off, s[4:7], s98 offset:0 sc1
    s_mov_b64 exec, -1
Lfs0_131:
Lsgd_130_m:
    s_mov_b32 s30, s29
    s_branch Lsgj_126_m
Lsgn_125_m:
    s_waitcnt vmcnt(0)
    s_barrier
    s_cmp_eq_u32 s30, -1
    s_cbranch_scc1 Lsgd_132_m
    s_cmp_lg_u32 s13, 0
    s_cbranch_scc1 Lfs0_133
    s_mul_i32 s98, s30, 32
    s_add_u32 s98, s98, s97
    s_lshl_b32 s98, s98, 2
    s_add_u32 s98, s98, 61977344
    v_mov_b32 v11, s90
    s_mov_b64 exec, 1
    buffer_store_dword v11, off, s[4:7], s98 offset:0 sc1
    s_mov_b64 exec, -1
Lfs0_133:
Lsgd_132_m:
    s_cmp_lg_u32 s13, 0
    s_cbranch_scc1 Lfs0_134
    s_mul_i32 s98, s29, 32
    s_add_u32 s98, s98, s97
    s_lshl_b32 s98, s98, 2
    s_add_u32 s98, s98, 61977344
    v_mov_b32 v11, s90
    s_mov_b64 exec, 1
    buffer_store_dword v11, off, s[4:7], s98 offset:0 sc1
    s_mov_b64 exec, -1
Lfs0_134:
    s_mov_b32 s30, -1
    s_cmp_ge_u32 s17, 64
    s_cbranch_scc1 Lsge_108_m
    s_cmp_lg_u32 s13, 0
    s_cbranch_scc1 Lur_135_m
    s_cmp_lt_u32 s17, s92
    s_cbranch_scc1 Lfwok_137_m
    s_mul_i32 s98, s17, 128
    s_add_u32 s98, s98, 61949952
Lfw_136_m:
    buffer_load_dwordx4 v[108:111], v0, s[4:7], s98 offen sc1
    s_waitcnt vmcnt(0)
    v_xor_b32 v108, s90, v108
    v_xor_b32 v109, s90, v109
    v_xor_b32 v110, s90, v110
    v_xor_b32 v111, s90, v111
    v_or3_b32 v108, v108, v109, v110
    v_or_b32 v108, v108, v111
    v_cmp_ne_u32 vcc, 0, v108
    s_nop 3
    s_and_b32 vcc_lo, vcc_lo, 0xffffffff
    s_and_b32 vcc_hi, vcc_hi, 0xffffffff
    s_ff1_i32_b64 s92, vcc
    s_cmp_eq_u32 s92, -1
    s_cselect_b32 s92, 64, s92
    s_lshr_b32 s92, s92, 3
    s_cmp_lg_u32 s92, 0
    s_cbranch_scc1 Lfwg_138_m
    s_sleep 2
    s_add_u32 s99, s99, 1
    s_cmp_lt_u32 s99, 4194304
    s_cbranch_scc1 Lfw_136_m
    s_endpgm
Lfwg_138_m:
    s_add_u32 s92, s92, s17
Lfwok_137_m:
    v_mov_b32 v14, 163832
    v_mov_b32 v15, s92
    ds_write_b32 v14, v15
    s_waitcnt lgkmcnt(0)
Lur_135_m:
    s_barrier
    v_mov_b32 v14, 163832
    ds_read_b32 v15, v14
    s_waitcnt lgkmcnt(0)
    v_readfirstlane_b32 s92, v15
    s_mul_i32 s28, s17, 36864
    s_mul_i32 s19, s13, 9216
    s_add_u32 s28, s28, s19
    s_add_u32 s28, s28, 62914560
    s_add_u32 s20, s28, 4096
    s_add_u32 s21, s28, 8192
    buffer_load_dwordx4 v[40:43], v0, s[4:7], s28 offen offset:0 sc1
    buffer_load_dwordx4 v[44:47], v0, s[4:7], s28 offen offset:1024 sc1
    buffer_load_dwordx4 v[48:51], v0, s[4:7], s28 offen offset:2048 sc1
    buffer_load_dwordx4 v[52:55], v0, s[4:7], s28 offen offset:3072 sc1
    buffer_load_dwordx4 v[56:59], v0, s[4:7], s20 offen offset:0 sc1
    buffer_load_dwordx4 v[60:63], v0, s[4:7], s20 offen offset:1024 sc1
    buffer_load_dwordx4 v[64:67], v0, s[4:7], s20 offen offset:2048 sc1
    buffer_load_dwordx4 v[68:71], v0, s[4:7], s20 offen offset:3072 sc1
    buffer_load_dwordx4 v[72:75], v0, s[4:7], s21 offen offset:0 sc1
    s_waitcnt vmcnt(0)
    ds_write_b128 v32, v[40:43] offset:0
    ds_write_b128 v33, v[44:47] offset:0
    ds_write_b128 v34, v[48:51] offset:0
    ds_write_b128 v35, v[52:55] offset:0
    ds_write_b128 v36, v[56:59] offset:0
    ds_write_b128 v37, v[60:63] offset:0
    ds_write_b128 v38, v[64:67] offset:0
    ds_write_b128 v39, v[68:71] offset:0
    ds_write_b128 v76, v[72:75] offset:0
    s_waitcnt lgkmcnt(0)
    s_barrier
Lsgj_126_m:
    s_branch Lsg_107_m
Lsge_108_m:
    s_branch Lqkvend_66_m
Lisv_64_m:
    v_lshrrev_b32 v10, 9, v0
    v_mul_u32_u24 v12, 544, v10
    v_and_b32 v10, 0x1f0, v0
    v_add_u32 v12, v12, v10
    v_add_u32 v10, 39168, v12
    v_lshrrev_b32 v7, 4, v0
    s_mul_i32 s19, s13, 576
    s_add_u32 s19, s19, 0
    v_add_u32 v7, s19, v7
    v_mul_u32_u24 v32, 3641, v7
    v_lshrrev_b32 v32, 18, v32
    v_mul_u32_u24 v13, 72, v32
    v_sub_u32 v7, v7, v13
    v_lshlrev_b32 v32, 4, v32
    v_mul_u32_u24 v13, 544, v7
    v_add_u32 v32, v32, v13
    v_lshrrev_b32 v7, 4, v0
    s_mul_i32 s19, s13, 576
    s_add_u32 s19, s19, 64
    v_add_u32 v7, s19, v7
    v_mul_u32_u24 v33, 3641, v7
    v_lshrrev_b32 v33, 18, v33
    v_mul_u32_u24 v13, 72, v33
    v_sub_u32 v7, v7, v13
    v_lshlrev_b32 v33, 4, v33
    v_mul_u32_u24 v13, 544, v7
    v_add_u32 v33, v33, v13
    v_lshrrev_b32 v7, 4, v0
    s_mul_i32 s19, s13, 576
    s_add_u32 s19, s19, 128
    v_add_u32 v7, s19, v7
    v_mul_u32_u24 v34, 3641, v7
    v_lshrrev_b32 v34, 18, v34
    v_mul_u32_u24 v13, 72, v34
    v_sub_u32 v7, v7, v13
    v_lshlrev_b32 v34, 4, v34
    v_mul_u32_u24 v13, 544, v7
    v_add_u32 v34, v34, v13
    v_lshrrev_b32 v7, 4, v0
    s_mul_i32 s19, s13, 576
    s_add_u32 s19, s19, 192
    v_add_u32 v7, s19, v7
    v_mul_u32_u24 v35, 3641, v7
    v_lshrrev_b32 v35, 18, v35
    v_mul_u32_u24 v13, 72, v35
    v_sub_u32 v7, v7, v13
    v_lshlrev_b32 v35, 4, v35
    v_mul_u32_u24 v13, 544, v7
    v_add_u32 v35, v35, v13
    v_lshrrev_b32 v7, 4, v0
    s_mul_i32 s19, s13, 576
    s_add_u32 s19, s19, 256
    v_add_u32 v7, s19, v7
    v_mul_u32_u24 v36, 3641, v7
    v_lshrrev_b32 v36, 18, v36
    v_mul_u32_u24 v13, 72, v36
    v_sub_u32 v7, v7, v13
    v_lshlrev_b32 v36, 4, v36
    v_mul_u32_u24 v13, 544, v7
    v_add_u32 v36, v36, v13
    v_lshrrev_b32 v7, 4, v0
    s_mul_i32 s19, s13, 576
    s_add_u32 s19, s19, 320
    v_add_u32 v7, s19, v7
    v_mul_u32_u24 v37, 3641, v7
    v_lshrrev_b32 v37, 18, v37
    v_mul_u32_u24 v13, 72, v37
    v_sub_u32 v7, v7, v13
    v_lshlrev_b32 v37, 4, v37
    v_mul_u32_u24 v13, 544, v7
    v_add_u32 v37, v37, v13
    v_lshrrev_b32 v7, 4, v0
    s_mul_i32 s19, s13, 576
    s_add_u32 s19, s19, 384
    v_add_u32 v7, s19, v7
    v_mul_u32_u24 v38, 3641, v7
    v_lshrrev_b32 v38, 18, v38
    v_mul_u32_u24 v13, 72, v38
    v_sub_u32 v7, v7, v13
    v_lshlrev_b32 v38, 4, v38
    v_mul_u32_u24 v13, 544, v7
    v_add_u32 v38, v38, v13
    v_lshrrev_b32 v7, 4, v0
    s_mul_i32 s19, s13, 576
    s_add_u32 s19, s19, 448
    v_add_u32 v7, s19, v7
    v_mul_u32_u24 v39, 3641, v7
    v_lshrrev_b32 v39, 18, v39
    v_mul_u32_u24 v13, 72, v39
    v_sub_u32 v7, v7, v13
    v_lshlrev_b32 v39, 4, v39
    v_mul_u32_u24 v13, 544, v7
    v_add_u32 v39, v39, v13
    v_lshrrev_b32 v7, 4, v0
    s_mul_i32 s19, s13, 576
    s_add_u32 s19, s19, 512
    v_add_u32 v7, s19, v7
    v_mul_u32_u24 v76, 3641, v7
    v_lshrrev_b32 v76, 18, v76
    v_mul_u32_u24 v13, 72, v76
    v_sub_u32 v7, v7, v13
    v_lshlrev_b32 v76, 4, v76
    v_mul_u32_u24 v13, 544, v7
    v_add_u32 v76, v76, v13
    s_mov_b32 s27, 0
    s_mov_b32 s30, -1
    s_cmp_lg_u32 s13, 0
    s_cbranch_scc1 Lur_139_m
    s_cmp_lt_u32 s17, s92
    s_cbranch_scc1 Lfwok_141_m
    s_mul_i32 s98, s17, 128
    s_add_u32 s98, s98, 61949952
Lfw_140_m:
    buffer_load_dwordx4 v[108:111], v0, s[4:7], s98 offen sc1
    s_waitcnt vmcnt(0)
    v_xor_b32 v108, s90, v108
    v_xor_b32 v109, s90, v109
    v_xor_b32 v110, s90, v110
    v_xor_b32 v111, s90, v111
    v_or3_b32 v108, v108, v109, v110
    v_or_b32 v108, v108, v111
    v_cmp_ne_u32 vcc, 0, v108
    s_nop 3
    s_and_b32 vcc_lo, vcc_lo, 0xffffffff
    s_and_b32 vcc_hi, vcc_hi, 0xffffffff
    s_ff1_i32_b64 s92, vcc
    s_cmp_eq_u32 s92, -1
    s_cselect_b32 s92, 64, s92
    s_lshr_b32 s92, s92, 3
    s_cmp_lg_u32 s92, 0
    s_cbranch_scc1 Lfwg_142_m
    s_sleep 2
    s_add_u32 s99, s99, 1
    s_cmp_lt_u32 s99, 4194304
    s_cbranch_scc1 Lfw_140_m
    s_endpgm
Lfwg_142_m:
    s_add_u32 s92, s92, s17
Lfwok_141_m:
    v_mov_b32 v14, 163832
    v_mov_b32 v15, s92
    ds_write_b32 v14, v15
    s_waitcnt lgkmcnt(0)
Lur_139_m:
    s_barrier
    v_mov_b32 v14, 163832
    ds_read_b32 v15, v14
    s_waitcnt lgkmcnt(0)
    v_readfirstlane_b32 s92, v15
    s_mul_i32 s28, s17, 36864
    s_mul_i32 s19, s13, 9216
    s_add_u32 s28, s28, s19
    s_add_u32 s28, s28, 62914560
    s_add_u32 s20, s28, 4096
    s_add_u32 s21, s28, 8192
    buffer_load_dwordx4 v[40:43], v0, s[4:7], s28 offen offset:0 sc1
    buffer_load_dwordx4 v[44:47], v0, s[4:7], s28 offen offset:1024 sc1
    buffer_load_dwordx4 v[48:51], v0, s[4:7], s28 offen offset:2048 sc1
    buffer_load_dwordx4 v[52:55], v0, s[4:7], s28 offen offset:3072 sc1
    buffer_load_dwordx4 v[56:59], v0, s[4:7], s20 offen offset:0 sc1
    buffer_load_dwordx4 v[60:63], v0, s[4:7], s20 offen offset:1024 sc1
    buffer_load_dwordx4 v[64:67], v0, s[4:7], s20 offen offset:2048 sc1
    buffer_load_dwordx4 v[68:71], v0, s[4:7], s20 offen offset:3072 sc1
    buffer_load_dwordx4 v[72:75], v0, s[4:7], s21 offen offset:0 sc1
    s_waitcnt vmcnt(0)
    ds_write_b128 v32, v[40:43] offset:0
    ds_write_b128 v33, v[44:47] offset:0
    ds_write_b128 v34, v[48:51] offset:0
    ds_write_b128 v35, v[52:55] offset:0
    ds_write_b128 v36, v[56:59] offset:0
    ds_write_b128 v37, v[60:63] offset:0
    ds_write_b128 v38, v[64:67] offset:0
    ds_write_b128 v39, v[68:71] offset:0
    ds_write_b128 v76, v[72:75] offset:0
    s_waitcnt lgkmcnt(0)
    s_barrier
Lsg_143_m:
    s_add_u32 s27, s27, 1
    s_mov_b32 s29, s17
    s_mov_b32 s31, 0
    s_add_u32 s17, s17, 1
    s_cmp_ge_u32 s17, 64
    s_cbranch_scc1 Lsgl_145_m
    s_cmp_lt_u32 s17, s92
    s_cbranch_scc0 Lsgl_145_m
    s_mul_i32 s28, s17, 36864
    s_mul_i32 s19, s13, 9216
    s_add_u32 s28, s28, s19
    s_add_u32 s28, s28, 62914560
    s_add_u32 s20, s28, 4096
    s_add_u32 s21, s28, 8192
    buffer_load_dwordx4 v[40:43], v0, s[4:7], s28 offen offset:0 sc1
    buffer_load_dwordx4 v[44:47], v0, s[4:7], s28 offen offset:1024 sc1
    buffer_load_dwordx4 v[48:51], v0, s[4:7], s28 offen offset:2048 sc1
    buffer_load_dwordx4 v[52:55], v0, s[4:7], s28 offen offset:3072 sc1
    buffer_load_dwordx4 v[56:59], v0, s[4:7], s20 offen offset:0 sc1
    buffer_load_dwordx4 v[60:63], v0, s[4:7], s20 offen offset:1024 sc1
    buffer_load_dwordx4 v[64:67], v0, s[4:7], s20 offen offset:2048 sc1
    buffer_load_dwordx4 v[68:71], v0, s[4:7], s20 offen offset:3072 sc1
    buffer_load_dwordx4 v[72:75], v0, s[4:7], s21 offen offset:0 sc1
    s_mov_b32 s31, 1
Lsgl_145_m:
    ds_read_b128 v[80:83], v12 offset:0
    ds_read_b128 v[84:87], v12 offset:1088
    ds_read_b128 v[88:91], v12 offset:2176
    ds_read_b128 v[92:95], v12 offset:3264
    s_waitcnt lgkmcnt(3)
    v_mfma_f32_32x32x16_bf16 v[16:31], v[80:83], v[112:115], 0
    ds_read_b128 v[80:83], v12 offset:4352
    s_waitcnt lgkmcnt(3)
    v_mfma_f32_32x32x16_bf16 v[16:31], v[84:87], v[116:119], v[16:31]
    ds_read_b128 v[84:87], v12 offset:5440
    s_waitcnt lgkmcnt(3)
    v_mfma_f32_32x32x16_bf16 v[16:31], v[88:91], v[120:123], v[16:31]
    ds_read_b128 v[88:91], v12 offset:6528
    s_waitcnt lgkmcnt(3)
    v_mfma_f32_32x32x16_bf16 v[16:31], v[92:95], v[124:127], v[16:31]
    ds_read_b128 v[92:95], v12 offset:7616
    s_waitcnt lgkmcnt(3)
    v_mfma_f32_32x32x16_bf16 v[16:31], v[80:83], v[128:131], v[16:31]
    ds_read_b128 v[80:83], v12 offset:8704
    s_waitcnt lgkmcnt(3)
    v_mfma_f32_32x32x16_bf16 v[16:31], v[84:87], v[132:135], v[16:31]
    ds_read_b128 v[84:87], v12 offset:9792
    s_waitcnt lgkmcnt(3)
    v_mfma_f32_32x32x16_bf16 v[16:31], v[88:91], v[136:139], v[16:31]
    ds_read_b128 v[88:91], v12 offset:10880
    s_waitcnt lgkmcnt(3)
    v_mfma_f32_32x32x16_bf16 v[16:31], v[92:95], v[140:143], v[16:31]
    ds_read_b128 v[92:95], v12 offset:11968
    s_waitcnt lgkmcnt(3)
    v_mfma_f32_32x32x16_bf16 v[16:31], v[80:83], v[144:147], v[16:31]
    ds_read_b128 v[80:83], v12 offset:13056
    s_waitcnt lgkmcnt(3)
    v_mfma_f32_32x32x16_bf16 v[16:31], v[84:87], v[148:151], v[16:31]
    ds_read_b128 v[84:87], v12 offset:14144
    s_waitcnt lgkmcnt(3)
    v_mfma_f32_32x32x16_bf16 v[16:31], v[88:91], v[152:155], v[16:31]
    ds_read_b128 v[88:91], v12 offset:15232
    s_waitcnt lgkmcnt(3)
    v_mfma_f32_32x32x16_bf16 v[16:31], v[92:95], v[156:159], v[16:31]
    ds_read_b128 v[92:95], v12 offset:16320
    s_waitcnt lgkmcnt(3)
    v_mfma_f32_32x32x16_bf16 v[16:31], v[80:83], v[160:163], v[16:31]
    ds_read_b128 v[80:83], v12 offset:17408
    s_waitcnt lgkmcnt(3)
    v_mfma_f32_32x32x16_bf16 v[16:31], v[84:87], v[164:167], v[16:31]
    ds_read_b128 v[84:87], v12 offset:18496
    s_waitcnt lgkmcnt(3)
    v_mfma_f32_32x32x16_bf16 v[16:31], v[88:91], v[168:171], v[16:31]
    ds_read_b128 v[88:91], v12 offset:19584
    s_waitcnt lgkmcnt(3)
    v_mfma_f32_32x32x16_bf16 v[16:31], v[92:95], v[172:175], v[16:31]
    ds_read_b128 v[92:95], v12 offset:20672
    s_waitcnt lgkmcnt(3)
    v_mfma_f32_32x32x16_bf16 v[16:31], v[80:83], v[176:179], v[16:31]
    ds_read_b128 v[80:83], v12 offset:21760
    s_waitcnt lgkmcnt(3)
    v_mfma_f32_32x32x16_bf16 v[16:31], v[84:87], v[180:183], v[16:31]
    ds_read_b128 v[84:87], v12 offset:22848
    s_waitcnt lgkmcnt(3)
    v_mfma_f32_32x32x16_bf16 v[16:31], v[88:91], v[184:187], v[16:31]
    ds_read_b128 v[88:91], v12 offset:23936
    s_waitcnt lgkmcnt(3)
    v_mfma_f32_32x32x16_bf16 v[16:31], v[92:95], v[188:191], v[16:31]
    ds_read_b128 v[92:95], v12 offset:25024
    s_waitcnt lgkmcnt(3)
    v_mfma_f32_32x32x16_bf16 v[16:31], v[80:83], v[192:195], v[16:31]
    ds_read_b128 v[80:83], v12 offset:26112
    s_waitcnt lgkmcnt(3)
    v_mfma_f32_32x32x16_bf16 v[16:31], v[84:87], v[196:199], v[16:31]
    ds_read_b128 v[84:87], v12 offset:27200
    s_waitcnt lgkmcnt(3)
    v_mfma_f32_32x32x16_bf16 v[16:31], v[88:91], v[200:203], v[16:31]
    ds_read_b128 v[88:91], v12 offset:28288
    s_waitcnt lgkmcnt(3)
    v_mfma_f32_32x32x16_bf16 v[16:31], v[92:95], v[204:207], v[16:31]
    ds_read_b128 v[92:95], v12 offset:29376
    s_waitcnt lgkmcnt(3)
    v_mfma_f32_32x32x16_bf16 v[16:31], v[80:83], v[208:211], v[16:31]
    ds_read_b128 v[80:83], v12 offset:30464
    s_waitcnt lgkmcnt(3)
    v_mfma_f32_32x32x16_bf16 v[16:31], v[84:87], v[212:215], v[16:31]
    ds_read_b128 v[84:87], v12 offset:31552
    s_waitcnt lgkmcnt(3)
    v_mfma_f32_32x32x16_bf16 v[16:31], v[88:91], v[216:219], v[16:31]
    ds_read_b128 v[88:91], v12 offset:32640
    s_waitcnt lgkmcnt(3)
    v_mfma_f32_32x32x16_bf16 v[16:31], v[92:95], v[220:223], v[16:31]
    ds_read_b128 v[92:95], v12 offset:33728
    s_waitcnt lgkmcnt(3)
    v_mfma_f32_32x32x16_bf16 v[16:31], v[80:83], v[224:227], v[16:31]
    ds_read_b128 v[80:83], v12 offset:34816
    s_waitcnt lgkmcnt(3)
    v_mfma_f32_32x32x16_bf16 v[16:31], v[84:87], v[228:231], v[16:31]
    ds_read_b128 v[84:87], v12 offset:35904
    s_waitcnt lgkmcnt(3)
    v_mfma_f32_32x32x16_bf16 v[16:31], v[88:91], v[232:235], v[16:31]
    ds_read_b128 v[88:91], v12 offset:36992
    s_waitcnt lgkmcnt(3)
    v_mfma_f32_32x32x16_bf16 v[16:31], v[92:95], v[236:239], v[16:31]
    ds_read_b128 v[92:95], v12 offset:38080
    s_waitcnt lgkmcnt(3)
    v_mfma_f32_32x32x16_bf16 v[16:31], v[80:83], v[240:243], v[16:31]
    s_waitcnt lgkmcnt(2)
    v_mfma_f32_32x32x16_bf16 v[16:31], v[84:87], v[244:247], v[16:31]
    s_waitcnt lgkmcnt(1)
    v_mfma_f32_32x32x16_bf16 v[16:31], v[88:91], v[248:251], v[16:31]
    s_waitcnt lgkmcnt(0)
    v_mfma_f32_32x32x16_bf16 v[16:31], v[92:95], v[252:255], v[16:31]
    s_nop 11
    v_cvt_pk_bf16_f32 v96, v16, v17
    v_cvt_pk_bf16_f32 v97, v18, v19
    v_cvt_pk_bf16_f32 v98, v24, v25
    v_cvt_pk_bf16_f32 v99, v26, v27
    v_cvt_pk_bf16_f32 v100, v20, v21
    v_cvt_pk_bf16_f32 v101, v22, v23
    v_cvt_pk_bf16_f32 v102, v28, v29
    v_cvt_pk_bf16_f32 v103, v30, v31
    s_lshl_b32 s19, s29, 18
    s_add_u32 s19, s19, s18
    buffer_store_dwordx4 v[96:99], v9, s[4:7], s19 offen sc1
    buffer_store_dwordx4 v[100:103], v9, s[4:7], s19 offen offset:512 sc1
    s_cmp_eq_u32 s31, 1
    s_cbranch_scc0 Lsgn_146_m
    s_waitcnt vmcnt(2)
    ds_write_b128 v32, v[40:43] offset:39168
    ds_write_b128 v33, v[44:47] offset:39168
    ds_write_b128 v34, v[48:51] offset:39168
    ds_write_b128 v35, v[52:55] offset:39168
    ds_write_b128 v36, v[56:59] offset:39168
    ds_write_b128 v37, v[60:63] offset:39168
    ds_write_b128 v38, v[64:67] offset:39168
    ds_write_b128 v39, v[68:71] offset:39168
    ds_write_b128 v76, v[72:75] offset:39168
    s_cmp_le_u32 s27, 3
    s_cbranch_scc0 Lsgz_149_m
    s_waitcnt vmcnt(0) lgkmcnt(0)
    s_barrier
    s_cmp_lg_u32 s13, 0
    s_cbranch_scc1 Lfs0_150
    s_mul_i32 s98, s29, 64
    s_add_u32 s98, s98, s97
    s_lshl_b32 s98, s98, 2
    s_add_u32 s98, s98, 61959168
    v_mov_b32 v11, s90
    s_mov_b64 exec, 1
    buffer_store_dword v11, off, s[4:7], s98 offset:0 sc1
    s_mov_b64 exec, -1
Lfs0_150:
    s_mov_b32 s30, -1
    s_branch Lsgj_147_m
Lsgz_149_m:
    s_waitcnt lgkmcnt(0)
    s_barrier
    s_cmp_eq_u32 s30, -1
    s_cbranch_scc1 Lsgd_151_m
    s_cmp_lg_u32 s13, 0
    s_cbranch_scc1 Lfs0_152
    s_mul_i32 s98, s30, 64
    s_add_u32 s98, s98, s97
    s_lshl_b32 s98, s98, 2
    s_add_u32 s98, s98, 61959168
    v_mov_b32 v11, s90
    s_mov_b64 exec, 1
    buffer_store_dword v11, off, s[4:7], s98 offset:0 sc1
    s_mov_b64 exec, -1
Lfs0_152:
Lsgd_151_m:
    s_mov_b32 s30, s29
    s_branch Lsgj_147_m
Lsgn_146_m:
    s_waitcnt vmcnt(0)
    s_barrier
    s_cmp_eq_u32 s30, -1
    s_cbranch_scc1 Lsgd_153_m
    s_cmp_lg_u32 s13, 0
    s_cbranch_scc1 Lfs0_154
    s_mul_i32 s98, s30, 64
    s_add_u32 s98, s98, s97
    s_lshl_b32 s98, s98, 2
    s_add_u32 s98, s98, 61959168
    v_mov_b32 v11, s90
    s_mov_b64 exec, 1
    buffer_store_dword v11, off, s[4:7], s98 offset:0 sc1
    s_mov_b64 exec, -1
Lfs0_154:
Lsgd_153_m:
    s_cmp_lg_u32 s13, 0
    s_cbranch_scc1 Lfs0_155
    s_mul_i32 s98, s29, 64
    s_add_u32 s98, s98, s97
    s_lshl_b32 s98, s98, 2
    s_add_u32 s98, s98, 61959168
    v_mov_b32 v11, s90
    s_mov_b64 exec, 1
    buffer_store_dword v11, off, s[4:7], s98 offset:0 sc1
    s_mov_b64 exec, -1
Lfs0_155:
    s_mov_b32 s30, -1
    s_cmp_ge_u32 s17, 64
    s_cbranch_scc1 Lsge_144_m
    s_cmp_lg_u32 s13, 0
    s_cbranch_scc1 Lur_156_m
    s_cmp_lt_u32 s17, s92
    s_cbranch_scc1 Lfwok_158_m
    s_mul_i32 s98, s17, 128
    s_add_u32 s98, s98, 61949952
Lfw_157_m:
    buffer_load_dwordx4 v[108:111], v0, s[4:7], s98 offen sc1
    s_waitcnt vmcnt(0)
    v_xor_b32 v108, s90, v108
    v_xor_b32 v109, s90, v109
    v_xor_b32 v110, s90, v110
    v_xor_b32 v111, s90, v111
    v_or3_b32 v108, v108, v109, v110
    v_or_b32 v108, v108, v111
    v_cmp_ne_u32 vcc, 0, v108
    s_nop 3
    s_and_b32 vcc_lo, vcc_lo, 0xffffffff
    s_and_b32 vcc_hi, vcc_hi, 0xffffffff
    s_ff1_i32_b64 s92, vcc
    s_cmp_eq_u32 s92, -1
    s_cselect_b32 s92, 64, s92
    s_lshr_b32 s92, s92, 3
    s_cmp_lg_u32 s92, 0
    s_cbranch_scc1 Lfwg_159_m
    s_sleep 2
    s_add_u32 s99, s99, 1
    s_cmp_lt_u32 s99, 4194304
    s_cbranch_scc1 Lfw_157_m
    s_endpgm
Lfwg_159_m:
    s_add_u32 s92, s92, s17
Lfwok_158_m:
    v_mov_b32 v14, 163832
    v_mov_b32 v15, s92
    ds_write_b32 v14, v15
    s_waitcnt lgkmcnt(0)
Lur_156_m:
    s_barrier
    v_mov_b32 v14, 163832
    ds_read_b32 v15, v14
    s_waitcnt lgkmcnt(0)
    v_readfirstlane_b32 s92, v15
    s_mul_i32 s28, s17, 36864
    s_mul_i32 s19, s13, 9216
    s_add_u32 s28, s28, s19
    s_add_u32 s28, s28, 62914560
    s_add_u32 s20, s28, 4096
    s_add_u32 s21, s28, 8192
    buffer_load_dwordx4 v[40:43], v0, s[4:7], s28 offen offset:0 sc1
    buffer_load_dwordx4 v[44:47], v0, s[4:7], s28 offen offset:1024 sc1
    buffer_load_dwordx4 v[48:51], v0, s[4:7], s28 offen offset:2048 sc1
    buffer_load_dwordx4 v[52:55], v0, s[4:7], s28 offen offset:3072 sc1
    buffer_load_dwordx4 v[56:59], v0, s[4:7], s20 offen offset:0 sc1
    buffer_load_dwordx4 v[60:63], v0, s[4:7], s20 offen offset:1024 sc1
    buffer_load_dwordx4 v[64:67], v0, s[4:7], s20 offen offset:2048 sc1
    buffer_load_dwordx4 v[68:71], v0, s[4:7], s20 offen offset:3072 sc1
    buffer_load_dwordx4 v[72:75], v0, s[4:7], s21 offen offset:0 sc1
    s_waitcnt vmcnt(0)
    ds_write_b128 v32, v[40:43] offset:39168
    ds_write_b128 v33, v[44:47] offset:39168
    ds_write_b128 v34, v[48:51] offset:39168
    ds_write_b128 v35, v[52:55] offset:39168
    ds_write_b128 v36, v[56:59] offset:39168
    ds_write_b128 v37, v[60:63] offset:39168
    ds_write_b128 v38, v[64:67] offset:39168
    ds_write_b128 v39, v[68:71] offset:39168
    ds_write_b128 v76, v[72:75] offset:39168
    s_waitcnt lgkmcnt(0)
    s_barrier
Lsgj_147_m:
    s_add_u32 s27, s27, 1
    s_mov_b32 s29, s17
    s_mov_b32 s31, 0
    s_add_u32 s17, s17, 1
    s_cmp_ge_u32 s17, 64
    s_cbranch_scc1 Lsgl_160_m
    s_cmp_lt_u32 s17, s92
    s_cbranch_scc0 Lsgl_160_m
    s_mul_i32 s28, s17, 36864
    s_mul_i32 s19, s13, 9216
    s_add_u32 s28, s28, s19
    s_add_u32 s28, s28, 62914560
    s_add_u32 s20, s28, 4096
    s_add_u32 s21, s28, 8192
    buffer_load_dwordx4 v[40:43], v0, s[4:7], s28 offen offset:0 sc1
    buffer_load_dwordx4 v[44:47], v0, s[4:7], s28 offen offset:1024 sc1
    buffer_load_dwordx4 v[48:51], v0, s[4:7], s28 offen offset:2048 sc1
    buffer_load_dwordx4 v[52:55], v0, s[4:7], s28 offen offset:3072 sc1
    buffer_load_dwordx4 v[56:59], v0, s[4:7], s20 offen offset:0 sc1
    buffer_load_dwordx4 v[60:63], v0, s[4:7], s20 offen offset:1024 sc1
    buffer_load_dwordx4 v[64:67], v0, s[4:7], s20 offen offset:2048 sc1
    buffer_load_dwordx4 v[68:71], v0, s[4:7], s20 offen offset:3072 sc1
    buffer_load_dwordx4 v[72:75], v0, s[4:7], s21 offen offset:0 sc1
    s_mov_b32 s31, 1
Lsgl_160_m:
    ds_read_b128 v[80:83], v10 offset:0
    ds_read_b128 v[84:87], v10 offset:1088
    ds_read_b128 v[88:91], v10 offset:2176
    ds_read_b128 v[92:95], v10 offset:3264
    s_waitcnt lgkmcnt(3)
    v_mfma_f32_32x32x16_bf16 v[16:31], v[80:83], v[112:115], 0
    ds_read_b128 v[80:83], v10 offset:4352
    s_waitcnt lgkmcnt(3)
    v_mfma_f32_32x32x16_bf16 v[16:31], v[84:87], v[116:119], v[16:31]
    ds_read_b128 v[84:87], v10 offset:5440
    s_waitcnt lgkmcnt(3)
    v_mfma_f32_32x32x16_bf16 v[16:31], v[88:91], v[120:123], v[16:31]
    ds_read_b128 v[88:91], v10 offset:6528
    s_waitcnt lgkmcnt(3)
    v_mfma_f32_32x32x16_bf16 v[16:31], v[92:95], v[124:127], v[16:31]
    ds_read_b128 v[92:95], v10 offset:7616
    s_waitcnt lgkmcnt(3)
    v_mfma_f32_32x32x16_bf16 v[16:31], v[80:83], v[128:131], v[16:31]
    ds_read_b128 v[80:83], v10 offset:8704
    s_waitcnt lgkmcnt(3)
    v_mfma_f32_32x32x16_bf16 v[16:31], v[84:87], v[132:135], v[16:31]
    ds_read_b128 v[84:87], v10 offset:9792
    s_waitcnt lgkmcnt(3)
    v_mfma_f32_32x32x16_bf16 v[16:31], v[88:91], v[136:139], v[16:31]
    ds_read_b128 v[88:91], v10 offset:10880
    s_waitcnt lgkmcnt(3)
    v_mfma_f32_32x32x16_bf16 v[16:31], v[92:95], v[140:143], v[16:31]
    ds_read_b128 v[92:95], v10 offset:11968
    s_waitcnt lgkmcnt(3)
    v_mfma_f32_32x32x16_bf16 v[16:31], v[80:83], v[144:147], v[16:31]
    ds_read_b128 v[80:83], v10 offset:13056
    s_waitcnt lgkmcnt(3)
    v_mfma_f32_32x32x16_bf16 v[16:31], v[84:87], v[148:151], v[16:31]
    ds_read_b128 v[84:87], v10 offset:14144
    s_waitcnt lgkmcnt(3)
    v_mfma_f32_32x32x16_bf16 v[16:31], v[88:91], v[152:155], v[16:31]
    ds_read_b128 v[88:91], v10 offset:15232
    s_waitcnt lgkmcnt(3)
    v_mfma_f32_32x32x16_bf16 v[16:31], v[92:95], v[156:159], v[16:31]
    ds_read_b128 v[92:95], v10 offset:16320
    s_waitcnt lgkmcnt(3)
    v_mfma_f32_32x32x16_bf16 v[16:31], v[80:83], v[160:163], v[16:31]
    ds_read_b128 v[80:83], v10 offset:17408
    s_waitcnt lgkmcnt(3)
    v_mfma_f32_32x32x16_bf16 v[16:31], v[84:87], v[164:167], v[16:31]
    ds_read_b128 v[84:87], v10 offset:18496
    s_waitcnt lgkmcnt(3)
    v_mfma_f32_32x32x16_bf16 v[16:31], v[88:91], v[168:171], v[16:31]
    ds_read_b128 v[88:91], v10 offset:19584
    s_waitcnt lgkmcnt(3)
    v_mfma_f32_32x32x16_bf16 v[16:31], v[92:95], v[172:175], v[16:31]
    ds_read_b128 v[92:95], v10 offset:20672
    s_waitcnt lgkmcnt(3)
    v_mfma_f32_32x32x16_bf16 v[16:31], v[80:83], v[176:179], v[16:31]
    ds_read_b128 v[80:83], v10 offset:21760
    s_waitcnt lgkmcnt(3)
    v_mfma_f32_32x32x16_bf16 v[16:31], v[84:87], v[180:183], v[16:31]
    ds_read_b128 v[84:87], v10 offset:22848
    s_waitcnt lgkmcnt(3)
    v_mfma_f32_32x32x16_bf16 v[16:31], v[88:91], v[184:187], v[16:31]
    ds_read_b128 v[88:91], v10 offset:23936
    s_waitcnt lgkmcnt(3)
    v_mfma_f32_32x32x16_bf16 v[16:31], v[92:95], v[188:191], v[16:31]
    ds_read_b128 v[92:95], v10 offset:25024
    s_waitcnt lgkmcnt(3)
    v_mfma_f32_32x32x16_bf16 v[16:31], v[80:83], v[192:195], v[16:31]
    ds_read_b128 v[80:83], v10 offset:26112
    s_waitcnt lgkmcnt(3)
    v_mfma_f32_32x32x16_bf16 v[16:31], v[84:87], v[196:199], v[16:31]
    ds_read_b128 v[84:87], v10 offset:27200
    s_waitcnt lgkmcnt(3)
    v_mfma_f32_32x32x16_bf16 v[16:31], v[88:91], v[200:203], v[16:31]
    ds_read_b128 v[88:91], v10 offset:28288
    s_waitcnt lgkmcnt(3)
    v_mfma_f32_32x32x16_bf16 v[16:31], v[92:95], v[204:207], v[16:31]
    ds_read_b128 v[92:95], v10 offset:29376
    s_waitcnt lgkmcnt(3)
    v_mfma_f32_32x32x16_bf16 v[16:31], v[80:83], v[208:211], v[16:31]
    ds_read_b128 v[80:83], v10 offset:30464
    s_waitcnt lgkmcnt(3)
    v_mfma_f32_32x32x16_bf16 v[16:31], v[84:87], v[212:215], v[16:31]
    ds_read_b128 v[84:87], v10 offset:31552
    s_waitcnt lgkmcnt(3)
    v_mfma_f32_32x32x16_bf16 v[16:31], v[88:91], v[216:219], v[16:31]
    ds_read_b128 v[88:91], v10 offset:32640
    s_waitcnt lgkmcnt(3)
    v_mfma_f32_32x32x16_bf16 v[16:31], v[92:95], v[220:223], v[16:31]
    ds_read_b128 v[92:95], v10 offset:33728
    s_waitcnt lgkmcnt(3)
    v_mfma_f32_32x32x16_bf16 v[16:31], v[80:83], v[224:227], v[16:31]
    ds_read_b128 v[80:83], v10 offset:34816
    s_waitcnt lgkmcnt(3)
    v_mfma_f32_32x32x16_bf16 v[16:31], v[84:87], v[228:231], v[16:31]
    ds_read_b128 v[84:87], v10 offset:35904
    s_waitcnt lgkmcnt(3)
    v_mfma_f32_32x32x16_bf16 v[16:31], v[88:91], v[232:235], v[16:31]
    ds_read_b128 v[88:91], v10 offset:36992
    s_waitcnt lgkmcnt(3)
    v_mfma_f32_32x32x16_bf16 v[16:31], v[92:95], v[236:239], v[16:31]
    ds_read_b128 v[92:95], v10 offset:38080
    s_waitcnt lgkmcnt(3)
    v_mfma_f32_32x32x16_bf16 v[16:31], v[80:83], v[240:243], v[16:31]
    s_waitcnt lgkmcnt(2)
    v_mfma_f32_32x32x16_bf16 v[16:31], v[84:87], v[244:247], v[16:31]
    s_waitcnt lgkmcnt(1)
    v_mfma_f32_32x32x16_bf16 v[16:31], v[88:91], v[248:251], v[16:31]
    s_waitcnt lgkmcnt(0)
    v_mfma_f32_32x32x16_bf16 v[16:31], v[92:95], v[252:255], v[16:31]
    s_nop 11
    v_cvt_pk_bf16_f32 v96, v16, v17
    v_cvt_pk_bf16_f32 v97, v18, v19
    v_cvt_pk_bf16_f32 v98, v24, v25
    v_cvt_pk_bf16_f32 v99, v26, v27
    v_cvt_pk_bf16_f32 v100, v20, v21
    v_cvt_pk_bf16_f32 v101, v22, v23
    v_cvt_pk_bf16_f32 v102, v28, v29
    v_cvt_pk_bf16_f32 v103, v30, v31
    s_lshl_b32 s19, s29, 18
    s_add_u32 s19, s19, s18
    buffer_store_dwordx4 v[96:99], v9, s[4:7], s19 offen sc1
    buffer_store_dwordx4 v[100:103], v9, s[4:7], s19 offen offset:512 sc1
    s_cmp_eq_u32 s31, 1
    s_cbranch_scc0 Lsgn_161_m
    s_waitcnt vmcnt(2)
    ds_write_b128 v32, v[40:43] offset:0
    ds_write_b128 v33, v[44:47] offset:0
    ds_write_b128 v34, v[48:51] offset:0
    ds_write_b128 v35, v[52:55] offset:0
    ds_write_b128 v36, v[56:59] offset:0
    ds_write_b128 v37, v[60:63] offset:0
    ds_write_b128 v38, v[64:67] offset:0
    ds_write_b128 v39, v[68:71] offset:0
    ds_write_b128 v76, v[72:75] offset:0
    s_cmp_le_u32 s27, 3
    s_cbranch_scc0 Lsgz_164_m
    s_waitcnt vmcnt(0) lgkmcnt(0)
    s_barrier
    s_cmp_lg_u32 s13, 0
    s_cbranch_scc1 Lfs0_165
    s_mul_i32 s98, s29, 64
    s_add_u32 s98, s98, s97
    s_lshl_b32 s98, s98, 2
    s_add_u32 s98, s98, 61959168
    v_mov_b32 v11, s90
    s_mov_b64 exec, 1
    buffer_store_dword v11, off, s[4:7], s98 offset:0 sc1
    s_mov_b64 exec, -1
Lfs0_165:
    s_mov_b32 s30, -1
    s_branch Lsgj_162_m
Lsgz_164_m:
    s_waitcnt lgkmcnt(0)
    s_barrier
    s_cmp_eq_u32 s30, -1
    s_cbranch_scc1 Lsgd_166_m
    s_cmp_lg_u32 s13, 0
    s_cbranch_scc1 Lfs0_167
    s_mul_i32 s98, s30, 64
    s_add_u32 s98, s98, s97
    s_lshl_b32 s98, s98, 2
    s_add_u32 s98, s98, 61959168
    v_mov_b32 v11, s90
    s_mov_b64 exec, 1
    buffer_store_dword v11, off, s[4:7], s98 offset:0 sc1
    s_mov_b64 exec, -1
Lfs0_167:
Lsgd_166_m:
    s_mov_b32 s30, s29
    s_branch Lsgj_162_m
Lsgn_161_m:
    s_waitcnt vmcnt(0)
    s_barrier
    s_cmp_eq_u32 s30, -1
    s_cbranch_scc1 Lsgd_168_m
    s_cmp_lg_u32 s13, 0
    s_cbranch_scc1 Lfs0_169
    s_mul_i32 s98, s30, 64
    s_add_u32 s98, s98, s97
    s_lshl_b32 s98, s98, 2
    s_add_u32 s98, s98, 61959168
    v_mov_b32 v11, s90
    s_mov_b64 exec, 1
    buffer_store_dword v11, off, s[4:7], s98 offset:0 sc1
    s_mov_b64 exec, -1
Lfs0_169:
Lsgd_168_m:
    s_cmp_lg_u32 s13, 0
    s_cbranch_scc1 Lfs0_170
    s_mul_i32 s98, s29, 64
    s_add_u32 s98, s98, s97
    s_lshl_b32 s98, s98, 2
    s_add_u32 s98, s98, 61959168
    v_mov_b32 v11, s90
    s_mov_b64 exec, 1
    buffer_store_dword v11, off, s[4:7], s98 offset:0 sc1
    s_mov_b64 exec, -1
Lfs0_170:
    s_mov_b32 s30, -1
    s_cmp_ge_u32 s17, 64
    s_cbranch_scc1 Lsge_144_m
    s_cmp_lg_u32 s13, 0
    s_cbranch_scc1 Lur_171_m
    s_cmp_lt_u32 s17, s92
    s_cbranch_scc1 Lfwok_173_m
    s_mul_i32 s98, s17, 128
    s_add_u32 s98, s98, 61949952
Lfw_172_m:
    buffer_load_dwordx4 v[108:111], v0, s[4:7], s98 offen sc1
    s_waitcnt vmcnt(0)
    v_xor_b32 v108, s90, v108
    v_xor_b32 v109, s90, v109
    v_xor_b32 v110, s90, v110
    v_xor_b32 v111, s90, v111
    v_or3_b32 v108, v108, v109, v110
    v_or_b32 v108, v108, v111
    v_cmp_ne_u32 vcc, 0, v108
    s_nop 3
    s_and_b32 vcc_lo, vcc_lo, 0xffffffff
    s_and_b32 vcc_hi, vcc_hi, 0xffffffff
    s_ff1_i32_b64 s92, vcc
    s_cmp_eq_u32 s92, -1
    s_cselect_b32 s92, 64, s92
    s_lshr_b32 s92, s92, 3
    s_cmp_lg_u32 s92, 0
    s_cbranch_scc1 Lfwg_174_m
    s_sleep 2
    s_add_u32 s99, s99, 1
    s_cmp_lt_u32 s99, 4194304
    s_cbranch_scc1 Lfw_172_m
    s_endpgm
Lfwg_174_m:
    s_add_u32 s92, s92, s17
Lfwok_173_m:
    v_mov_b32 v14, 163832
    v_mov_b32 v15, s92
    ds_write_b32 v14, v15
    s_waitcnt lgkmcnt(0)
Lur_171_m:
    s_barrier
    v_mov_b32 v14, 163832
    ds_read_b32 v15, v14
    s_waitcnt lgkmcnt(0)
    v_readfirstlane_b32 s92, v15
    s_mul_i32 s28, s17, 36864
    s_mul_i32 s19, s13, 9216
    s_add_u32 s28, s28, s19
    s_add_u32 s28, s28, 62914560
    s_add_u32 s20, s28, 4096
    s_add_u32 s21, s28, 8192
    buffer_load_dwordx4 v[40:43], v0, s[4:7], s28 offen offset:0 sc1
    buffer_load_dwordx4 v[44:47], v0, s[4:7], s28 offen offset:1024 sc1
    buffer_load_dwordx4 v[48:51], v0, s[4:7], s28 offen offset:2048 sc1
    buffer_load_dwordx4 v[52:55], v0, s[4:7], s28 offen offset:3072 sc1
    buffer_load_dwordx4 v[56:59], v0, s[4:7], s20 offen offset:0 sc1
    buffer_load_dwordx4 v[60:63], v0, s[4:7], s20 offen offset:1024 sc1
    buffer_load_dwordx4 v[64:67], v0, s[4:7], s20 offen offset:2048 sc1
    buffer_load_dwordx4 v[68:71], v0, s[4:7], s20 offen offset:3072 sc1
    buffer_load_dwordx4 v[72:75], v0, s[4:7], s21 offen offset:0 sc1
    s_waitcnt vmcnt(0)
    ds_write_b128 v32, v[40:43] offset:0
    ds_write_b128 v33, v[44:47] offset:0
    ds_write_b128 v34, v[48:51] offset:0
    ds_write_b128 v35, v[52:55] offset:0
    ds_write_b128 v36, v[56:59] offset:0
    ds_write_b128 v37, v[60:63] offset:0
    ds_write_b128 v38, v[64:67] offset:0
    ds_write_b128 v39, v[68:71] offset:0
    ds_write_b128 v76, v[72:75] offset:0
    s_waitcnt lgkmcnt(0)
    s_barrier
Lsgj_162_m:
    s_branch Lsg_143_m
Lsge_144_m:
Lqkvend_66_m:
    s_cmp_lt_u32 s97, 64
    s_cbranch_scc1 Lsprole_175_m
    s_sub_u32 s12, s97, 64
    s_mov_b32 s87, 41
    s_barrier
    s_branch Lwin_entry
Lsprole_175_m:
    s_barrier
    s_mov_b32 s12, s97
    s_mov_b32 s92, 0
    s_mov_b32 s93, 0
    s_lshr_b32 s14, s12, 3
    s_and_b32 s15, s12, 7
    s_load_dwordx2 s[8:9], s[42:43], 72
    s_waitcnt lgkmcnt(0)
    s_mov_b32 s10, 8388608
    s_mov_b32 s11, 0x20000
    v_lshrrev_b32 v1, 4, v0
    v_lshrrev_b32 v2, 5, v1
    v_mul_u32_u24 v3, 576, v2
    v_and_b32 v2, 31, v1
    v_lshl_add_u32 v3, v2, 4, v3
    s_mul_i32 s19, s13, 1152
    v_add_u32 v3, s19, v3
    v_bfe_u32 v2, v1, 4, 1
    v_mul_u32_u24 v4, 1152, v2
    v_bfe_u32 v2, v1, 1, 1
    v_mul_u32_u24 v2, 576, v2
    v_add_u32 v4, v4, v2
    v_lshrrev_b32 v2, 5, v1
    v_lshl_add_u32 v4, v2, 7, v4
    v_bfe_u32 v2, v1, 2, 2
    v_lshl_add_u32 v4, v2, 4, v4
    v_and_b32 v2, 1, v1
    v_lshl_add_u32 v4, v2, 3, v4
    v_and_b32 v2, 31, v1
    v_lshlrev_b32 v5, 12, v2
    v_lshrrev_b32 v2, 5, v1
    v_lshl_add_u32 v5, v2, 4, v5
    s_lshl_b32 s18, s14, 8
    s_lshl_b32 s19, s13, 6
    s_add_u32 s18, s18, s19
    s_lshl_b32 s18, s18, 12
    s_mov_b32 s34, 0
    s_branch Lspepi_176_m
Lspmain_177_m:
    s_mov_b32 s34, 1
    v_accvgpr_write_b32 a0, v16
    v_accvgpr_write_b32 a1, v16
    v_accvgpr_write_b32 a2, v16
    v_accvgpr_write_b32 a3, v16
    v_accvgpr_write_b32 a4, v16
    v_accvgpr_write_b32 a5, v16
    v_accvgpr_write_b32 a6, v16
    v_accvgpr_write_b32 a7, v16
    v_accvgpr_write_b32 a8, v16
    v_accvgpr_write_b32 a9, v16
    v_accvgpr_write_b32 a10, v16
    v_accvgpr_write_b32 a11, v16
    v_accvgpr_write_b32 a12, v16
    v_accvgpr_write_b32 a13, v16
    v_accvgpr_write_b32 a14, v16
    v_accvgpr_write_b32 a15, v16
    v_accvgpr_write_b32 a16, v16
    v_accvgpr_write_b32 a17, v16
    v_accvgpr_write_b32 a18, v16
    v_accvgpr_write_b32 a19, v16
    v_accvgpr_write_b32 a20, v16
    v_accvgpr_write_b32 a21, v16
    v_accvgpr_write_b32 a22, v16
    v_accvgpr_write_b32 a23, v16
    v_accvgpr_write_b32 a24, v16
    v_accvgpr_write_b32 a25, v16
    v_accvgpr_write_b32 a26, v16
    v_accvgpr_write_b32 a27, v16
    v_accvgpr_write_b32 a28, v16
    v_accvgpr_write_b32 a29, v16
    v_accvgpr_write_b32 a30, v16
    v_accvgpr_write_b32 a31, v16
    v_accvgpr_write_b32 a32, v16
    v_accvgpr_write_b32 a33, v16
    v_accvgpr_write_b32 a34, v16
    v_accvgpr_write_b32 a35, v16
    v_accvgpr_write_b32 a36, v16
    v_accvgpr_write_b32 a37, v16
    v_accvgpr_write_b32 a38, v16
    v_accvgpr_write_b32 a39, v16
    v_accvgpr_write_b32 a40, v16
    v_accvgpr_write_b32 a41, v16
    v_accvgpr_write_b32 a42, v16
    v_accvgpr_write_b32 a43, v16
    v_accvgpr_write_b32 a44, v16
    v_accvgpr_write_b32 a45, v16
    v_accvgpr_write_b32 a46, v16
    v_accvgpr_write_b32 a47, v16
    v_accvgpr_write_b32 a48, v16
    v_accvgpr_write_b32 a49, v16
    v_accvgpr_write_b32 a50, v16
    v_accvgpr_write_b32 a51, v16
    v_accvgpr_write_b32 a52, v16
    v_accvgpr_write_b32 a53, v16
    v_accvgpr_write_b32 a54, v16
    v_accvgpr_write_b32 a55, v16
    v_accvgpr_write_b32 a56, v16
    v_accvgpr_write_b32 a57, v16
    v_accvgpr_write_b32 a58, v16
    v_accvgpr_write_b32 a59, v16
    v_accvgpr_write_b32 a60, v16
    v_accvgpr_write_b32 a61, v16
    v_accvgpr_write_b32 a62, v16
    v_accvgpr_write_b32 a63, v16
    v_accvgpr_write_b32 a64, v16
    v_accvgpr_write_b32 a65, v16
    v_accvgpr_write_b32 a66, v16
    v_accvgpr_write_b32 a67, v16
    v_accvgpr_write_b32 a68, v16
    v_accvgpr_write_b32 a69, v16
    v_accvgpr_write_b32 a70, v16
    v_accvgpr_write_b32 a71, v16
    v_accvgpr_write_b32 a72, v16
    v_accvgpr_write_b32 a73, v16
    v_accvgpr_write_b32 a74, v16
    v_accvgpr_write_b32 a75, v16
    v_accvgpr_write_b32 a76, v16
    v_accvgpr_write_b32 a77, v16
    v_accvgpr_write_b32 a78, v16
    v_accvgpr_write_b32 a79, v16
    v_accvgpr_write_b32 a80, v16
    v_accvgpr_write_b32 a81, v16
    v_accvgpr_write_b32 a82, v16
    v_accvgpr_write_b32 a83, v16
    v_accvgpr_write_b32 a84, v16
    v_accvgpr_write_b32 a85, v16
    v_accvgpr_write_b32 a86, v16
    v_accvgpr_write_b32 a87, v16
    v_accvgpr_write_b32 a88, v16
    v_accvgpr_write_b32 a89, v16
    v_accvgpr_write_b32 a90, v16
    v_accvgpr_write_b32 a91, v16
    v_accvgpr_write_b32 a92, v16
    v_accvgpr_write_b32 a93, v16
    v_accvgpr_write_b32 a94, v16
    v_accvgpr_write_b32 a95, v16
    v_accvgpr_write_b32 a96, v16
    v_accvgpr_write_b32 a97, v16
    v_accvgpr_write_b32 a98, v16
    v_accvgpr_write_b32 a99, v16
    v_accvgpr_write_b32 a100, v16
    v_accvgpr_write_b32 a101, v16
    v_accvgpr_write_b32 a102, v16
    v_accvgpr_write_b32 a103, v16
    v_accvgpr_write_b32 a104, v16
    v_accvgpr_write_b32 a105, v16
    v_accvgpr_write_b32 a106, v16
    v_accvgpr_write_b32 a107, v16
    v_accvgpr_write_b32 a108, v16
    v_accvgpr_write_b32 a109, v16
    v_accvgpr_write_b32 a110, v16
    v_accvgpr_write_b32 a111, v16
    v_accvgpr_write_b32 a112, v16
    v_accvgpr_write_b32 a113, v16
    v_accvgpr_write_b32 a114, v16
    v_accvgpr_write_b32 a115, v16
    v_accvgpr_write_b32 a116, v16
    v_accvgpr_write_b32 a117, v16
    v_accvgpr_write_b32 a118, v16
    v_accvgpr_write_b32 a119, v16
    v_accvgpr_write_b32 a120, v16
    v_accvgpr_write_b32 a121, v16
    v_accvgpr_write_b32 a122, v16
    v_accvgpr_write_b32 a123, v16
    v_accvgpr_write_b32 a124, v16
    v_accvgpr_write_b32 a125, v16
    v_accvgpr_write_b32 a126, v16
    v_accvgpr_write_b32 a127, v16
    v_accvgpr_write_b32 a128, v16
    v_accvgpr_write_b32 a129, v16
    v_accvgpr_write_b32 a130, v16
    v_accvgpr_write_b32 a131, v16
    v_accvgpr_write_b32 a132, v16
    v_accvgpr_write_b32 a133, v16
    v_accvgpr_write_b32 a134, v16
    v_accvgpr_write_b32 a135, v16
    v_accvgpr_write_b32 a136, v16
    v_accvgpr_write_b32 a137, v16
    v_accvgpr_write_b32 a138, v16
    v_accvgpr_write_b32 a139, v16
    v_accvgpr_write_b32 a140, v16
    v_accvgpr_write_b32 a141, v16
    v_accvgpr_write_b32 a142, v16
    v_accvgpr_write_b32 a143, v16
    v_accvgpr_write_b32 a144, v17
    v_accvgpr_write_b32 a145, v17
    v_accvgpr_write_b32 a146, v17
    v_accvgpr_write_b32 a147, v17
    v_accvgpr_write_b32 a148, v17
    v_accvgpr_write_b32 a149, v17
    v_accvgpr_write_b32 a150, v17
    v_accvgpr_write_b32 a151, v17
    v_accvgpr_write_b32 a152, v17
    v_accvgpr_write_b32 a153, v17
    v_accvgpr_write_b32 a154, v17
    v_accvgpr_write_b32 a155, v17
    v_accvgpr_write_b32 a156, v17
    v_accvgpr_write_b32 a157, v17
    v_accvgpr_write_b32 a158, v17
    v_accvgpr_write_b32 a159, v17
    v_accvgpr_write_b32 a160, v17
    v_accvgpr_write_b32 a161, v17
    v_accvgpr_write_b32 a162, v17
    v_accvgpr_write_b32 a163, v17
    v_accvgpr_write_b32 a164, v17
    v_accvgpr_write_b32 a165, v17
    v_accvgpr_write_b32 a166, v17
    v_accvgpr_write_b32 a167, v17
    v_accvgpr_write_b32 a168, v17
    v_accvgpr_write_b32 a169, v17
    v_accvgpr_write_b32 a170, v17
    v_accvgpr_write_b32 a171, v17
    v_accvgpr_write_b32 a172, v17
    v_accvgpr_write_b32 a173, v17
    v_accvgpr_write_b32 a174, v17
    v_accvgpr_write_b32 a175, v17
    v_accvgpr_write_b32 a176, v17
    v_accvgpr_write_b32 a177, v17
    v_accvgpr_write_b32 a178, v17
    v_accvgpr_write_b32 a179, v17
    v_accvgpr_write_b32 a180, v17
    v_accvgpr_write_b32 a181, v17
    v_accvgpr_write_b32 a182, v17
    v_accvgpr_write_b32 a183, v17
    v_accvgpr_write_b32 a184, v17
    v_accvgpr_write_b32 a185, v17
    v_accvgpr_write_b32 a186, v17
    v_accvgpr_write_b32 a187, v17
    v_accvgpr_write_b32 a188, v17
    v_accvgpr_write_b32 a189, v17
    v_accvgpr_write_b32 a190, v17
    v_accvgpr_write_b32 a191, v17
    v_accvgpr_write_b32 a192, v17
    v_accvgpr_write_b32 a193, v17
    v_accvgpr_write_b32 a194, v17
    v_accvgpr_write_b32 a195, v17
    v_accvgpr_write_b32 a196, v17
    v_accvgpr_write_b32 a197, v17
    v_accvgpr_write_b32 a198, v17
    v_accvgpr_write_b32 a199, v17
    v_accvgpr_write_b32 a200, v17
    v_accvgpr_write_b32 a201, v17
    v_accvgpr_write_b32 a202, v17
    v_accvgpr_write_b32 a203, v17
    v_accvgpr_write_b32 a204, v17
    v_accvgpr_write_b32 a205, v17
    v_accvgpr_write_b32 a206, v17
    v_accvgpr_write_b32 a207, v17
    v_accvgpr_write_b32 a208, v17
    v_accvgpr_write_b32 a209, v17
    v_accvgpr_write_b32 a210, v17
    v_accvgpr_write_b32 a211, v17
    v_accvgpr_write_b32 a212, v17
    v_accvgpr_write_b32 a213, v17
    v_accvgpr_write_b32 a214, v17
    v_accvgpr_write_b32 a215, v17
    v_accvgpr_write_b32 a216, v17
    v_accvgpr_write_b32 a217, v17
    v_accvgpr_write_b32 a218, v17
    v_accvgpr_write_b32 a219, v17
    v_accvgpr_write_b32 a220, v17
    v_accvgpr_write_b32 a221, v17
    v_accvgpr_write_b32 a222, v17
    v_accvgpr_write_b32 a223, v17
    v_accvgpr_write_b32 a224, v17
    v_accvgpr_write_b32 a225, v17
    v_accvgpr_write_b32 a226, v17
    v_accvgpr_write_b32 a227, v17
    v_accvgpr_write_b32 a228, v17
    v_accvgpr_write_b32 a229, v17
    v_accvgpr_write_b32 a230, v17
    v_accvgpr_write_b32 a231, v17
    v_accvgpr_write_b32 a232, v17
    v_accvgpr_write_b32 a233, v17
    v_accvgpr_write_b32 a234, v17
    v_accvgpr_write_b32 a235, v17
    v_accvgpr_write_b32 a236, v17
    v_accvgpr_write_b32 a237, v17
    v_accvgpr_write_b32 a238, v17
    v_accvgpr_write_b32 a239, v17
    v_accvgpr_write_b32 a240, v17
    v_accvgpr_write_b32 a241, v17
    v_accvgpr_write_b32 a242, v17
    v_accvgpr_write_b32 a243, v17
    v_accvgpr_write_b32 a244, v17
    v_accvgpr_write_b32 a245, v17
    v_accvgpr_write_b32 a246, v17
    v_accvgpr_write_b32 a247, v17
    v_accvgpr_write_b32 a248, v17
    v_accvgpr_write_b32 a249, v17
    v_accvgpr_write_b32 a250, v17
    v_accvgpr_write_b32 a251, v17
    v_accvgpr_write_b32 a252, v17
    v_accvgpr_write_b32 a253, v17
    v_accvgpr_write_b32 a254, v17
    v_accvgpr_write_b32 a255, v17
    v_mov_b32 v200, v17
    v_mov_b32 v201, v17
    v_mov_b32 v202, v17
    v_mov_b32 v203, v17
    v_mov_b32 v204, v17
    v_mov_b32 v205, v17
    v_mov_b32 v206, v17
    v_mov_b32 v207, v17
    v_mov_b32 v208, v17
    v_mov_b32 v209, v17
    v_mov_b32 v210, v17
    v_mov_b32 v211, v17
    v_mov_b32 v212, v17
    v_mov_b32 v213, v17
    v_mov_b32 v214, v17
    v_mov_b32 v215, v17
    v_mov_b32 v216, v17
    v_mov_b32 v217, v17
    v_mov_b32 v218, v17
    v_mov_b32 v219, v17
    v_mov_b32 v220, v17
    v_mov_b32 v221, v17
    v_mov_b32 v222, v17
    v_mov_b32 v223, v17
    v_mov_b32 v224, v17
    v_mov_b32 v225, v17
    v_mov_b32 v226, v17
    v_mov_b32 v227, v17
    v_mov_b32 v228, v17
    v_mov_b32 v229, v17
    v_mov_b32 v230, v17
    v_mov_b32 v231, v17
    s_mov_b32 s17, 0
    s_cmp_lg_u32 s13, 0
    s_cbranch_scc1 Lur_178_m
    s_cmp_lt_u32 s17, s92
    s_cbranch_scc1 Lfwok_180_m
    s_mul_i32 s98, s17, 128
    s_add_u32 s98, s98, 62051328
Lfw_179_m:
    buffer_load_dwordx4 v[8:11], v0, s[4:7], s98 offen sc1
    s_waitcnt vmcnt(0)
    v_xor_b32 v8, s90, v8
    v_xor_b32 v9, s90, v9
    v_xor_b32 v10, s90, v10
    v_xor_b32 v11, s90, v11
    v_or3_b32 v8, v8, v9, v10
    v_or_b32 v8, v8, v11
    v_cmp_ne_u32 vcc, 0, v8
    s_nop 3
    s_and_b32 vcc_lo, vcc_lo, 0x1010101
    s_and_b32 vcc_hi, vcc_hi, 0x1010101
    s_ff1_i32_b64 s92, vcc
    s_cmp_eq_u32 s92, -1
    s_cselect_b32 s92, 64, s92
    s_lshr_b32 s92, s92, 3
    s_cmp_lg_u32 s92, 0
    s_cbranch_scc1 Lfwg_181_m
    s_sleep 2
    s_add_u32 s99, s99, 1
    s_cmp_lt_u32 s99, 4194304
    s_cbranch_scc1 Lfw_179_m
    s_endpgm
Lfwg_181_m:
    s_add_u32 s92, s92, s17
Lfwok_180_m:
    v_mov_b32 v12, 163832
    v_mov_b32 v13, s92
    ds_write_b32 v12, v13
    s_waitcnt lgkmcnt(0)
Lur_178_m:
    s_barrier
    v_mov_b32 v12, 163832
    ds_read_b32 v13, v12
    s_waitcnt lgkmcnt(0)
    v_readfirstlane_b32 s92, v13
    s_mul_i32 s27, s17, 147456
    s_add_u32 s27, s27, 134217728
    s_mul_i32 s19, s15, 18432
    s_add_u32 s27, s27, s19
    s_lshl_b32 s19, s13, 10
    s_add_u32 s27, s27, s19
    buffer_load_dwordx4 v[16:19], v0, s[4:7], s27 offen sc1
    s_add_u32 s27, s27, 4096
    buffer_load_dwordx4 v[20:23], v0, s[4:7], s27 offen sc1
    s_add_u32 s27, s27, 4096
    buffer_load_dwordx4 v[24:27], v0, s[4:7], s27 offen sc1
    s_add_u32 s27, s27, 4096
    buffer_load_dwordx4 v[28:31], v0, s[4:7], s27 offen sc1
    s_add_u32 s27, s27, 4096
    s_cmp_lt_u32 s13, 2
    s_cselect_b32 s27, s27, 0xf0000000
    buffer_load_dwordx4 v[32:35], v0, s[4:7], s27 offen sc1
    s_lshl_b32 s19, s17, 6
    s_add_u32 s19, s19, s18
    buffer_load_dwordx4 v[40:43], v5, s[8:11], s19 offen offset:0
    buffer_load_dwordx4 v[44:47], v5, s[8:11], s19 offen offset:32
    s_add_u32 s19, s19, 131072
    buffer_load_dwordx4 v[48:51], v5, s[8:11], s19 offen offset:0
    buffer_load_dwordx4 v[52:55], v5, s[8:11], s19 offen offset:32
    s_waitcnt vmcnt(0)
    ds_write_b128 v3, v[16:19] offset:0
    ds_write_b128 v3, v[20:23] offset:4608
    ds_write_b128 v3, v[24:27] offset:9216
    ds_write_b128 v3, v[28:31] offset:13824
    s_cmp_lt_u32 s13, 2
    s_cbranch_scc0 Lspw_182_m
    ds_write_b128 v3, v[32:35] offset:18432
Lspw_182_m:
    s_waitcnt lgkmcnt(0)
    s_barrier
Lsp_183_m:
    s_add_u32 s17, s17, 1
    s_mov_b32 s30, 0
    s_cmp_ge_u32 s17, 64
    s_cbranch_scc1 Lspn_185_m
    s_cmp_lt_u32 s17, s92
    s_cbranch_scc0 Lspn_185_m
    s_mul_i32 s27, s17, 147456
    s_add_u32 s27, s27, 134217728
    s_mul_i32 s19, s15, 18432
    s_add_u32 s27, s27, s19
    s_lshl_b32 s19, s13, 10
    s_add_u32 s27, s27, s19
    buffer_load_dwordx4 v[16:19], v0, s[4:7], s27 offen sc1
    s_add_u32 s27, s27, 4096
    buffer_load_dwordx4 v[20:23], v0, s[4:7], s27 offen sc1
    s_add_u32 s27, s27, 4096
    buffer_load_dwordx4 v[24:27], v0, s[4:7], s27 offen sc1
    s_add_u32 s27, s27, 4096
    buffer_load_dwordx4 v[28:31], v0, s[4:7], s27 offen sc1
    s_add_u32 s27, s27, 4096
    s_cmp_lt_u32 s13, 2
    s_cselect_b32 s27, s27, 0xf0000000
    buffer_load_dwordx4 v[32:35], v0, s[4:7], s27 offen sc1
    s_lshl_b32 s19, s17, 6
    s_add_u32 s19, s19, s18
    buffer_load_dwordx4 v[56:59], v5, s[8:11], s19 offen offset:0
    buffer_load_dwordx4 v[60:63], v5, s[8:11], s19 offen offset:32
    s_add_u32 s19, s19, 131072
    buffer_load_dwordx4 v[64:67], v5, s[8:11], s19 offen offset:0
    buffer_load_dwordx4 v[68:71], v5, s[8:11], s19 offen offset:32
    s_mov_b32 s30, 1
Lspn_185_m:
    s_cmp_lt_u32 s17, 64
    s_cbranch_scc1 Lspz1_186
    s_add_u32 s21, s29, 0
    s_mul_i32 s20, s21, 294912
    s_mul_i32 s19, s15, 18432
    s_add_u32 s20, s20, s19
    s_add_u32 s20, s20, 113246208
    s_cmp_eq_u32 s34, 0
    s_cselect_b32 s20, 209715200, s20
    buffer_load_dwordx2 v[112:113], v7, s[4:7], s20 offen offset:0 sc1
    buffer_load_dwordx2 v[114:115], v7, s[4:7], s20 offen offset:512 sc1
    buffer_load_dwordx2 v[116:117], v7, s[4:7], s20 offen offset:1024 sc1
    buffer_load_dwordx2 v[118:119], v7, s[4:7], s20 offen offset:1536 sc1
    s_add_u32 s20, s20, 2048
    buffer_load_dwordx2 v[120:121], v7, s[4:7], s20 offen offset:0 sc1
    buffer_load_dwordx2 v[122:123], v7, s[4:7], s20 offen offset:512 sc1
    buffer_load_dwordx2 v[124:125], v7, s[4:7], s20 offen offset:1024 sc1
    buffer_load_dwordx2 v[126:127], v7, s[4:7], s20 offen offset:1536 sc1
    s_add_u32 s20, s20, 2048
    buffer_load_dwordx2 v[128:129], v7, s[4:7], s20 offen offset:0 sc1
    buffer_load_dwordx2 v[130:131], v7, s[4:7], s20 offen offset:512 sc1
    buffer_load_dwordx2 v[132:133], v7, s[4:7], s20 offen offset:1024 sc1
    buffer_load_dwordx2 v[134:135], v7, s[4:7], s20 offen offset:1536 sc1
    s_add_u32 s20, s20, 2048
    buffer_load_dwordx2 v[136:137], v7, s[4:7], s20 offen offset:0 sc1
    buffer_load_dwordx2 v[138:139], v7, s[4:7], s20 offen offset:512 sc1
    buffer_load_dwordx2 v[140:141], v7, s[4:7], s20 offen offset:1024 sc1
    buffer_load_dwordx2 v[142:143], v7, s[4:7], s20 offen offset:1536 sc1
    s_add_u32 s20, s20, 2048
    buffer_load_dwordx2 v[144:145], v7, s[4:7], s20 offen offset:0 sc1
    buffer_load_dwordx2 v[146:147], v7, s[4:7], s20 offen offset:512 sc1
    buffer_load_dwordx2 v[148:149], v7, s[4:7], s20 offen offset:1024 sc1
    buffer_load_dwordx2 v[150:151], v7, s[4:7], s20 offen offset:1536 sc1
    s_add_u32 s20, s20, 2048
    buffer_load_dwordx2 v[152:153], v7, s[4:7], s20 offen offset:0 sc1
    buffer_load_dwordx2 v[154:155], v7, s[4:7], s20 offen offset:512 sc1
    buffer_load_dwordx2 v[156:157], v7, s[4:7], s20 offen offset:1024 sc1
    buffer_load_dwordx2 v[158:159], v7, s[4:7], s20 offen offset:1536 sc1
    s_add_u32 s20, s20, 2048
    buffer_load_dwordx2 v[160:161], v7, s[4:7], s20 offen offset:0 sc1
    buffer_load_dwordx2 v[162:163], v7, s[4:7], s20 offen offset:512 sc1
    buffer_load_dwordx2 v[164:165], v7, s[4:7], s20 offen offset:1024 sc1
    buffer_load_dwordx2 v[166:167], v7, s[4:7], s20 offen offset:1536 sc1
    s_add_u32 s20, s20, 2048
    buffer_load_dwordx2 v[168:169], v7, s[4:7], s20 offen offset:0 sc1
    buffer_load_dwordx2 v[170:171], v7, s[4:7], s20 offen offset:512 sc1
    buffer_load_dwordx2 v[172:173], v7, s[4:7], s20 offen offset:1024 sc1
    buffer_load_dwordx2 v[174:175], v7, s[4:7], s20 offen offset:1536 sc1
    s_add_u32 s20, s20, 2048
    buffer_load_dwordx2 v[176:177], v7, s[4:7], s20 offen offset:0 sc1
    buffer_load_dwordx2 v[178:179], v7, s[4:7], s20 offen offset:512 sc1
    buffer_load_dwordx2 v[180:181], v7, s[4:7], s20 offen offset:1024 sc1
    buffer_load_dwordx2 v[182:183], v7, s[4:7], s20 offen offset:1536 sc1
Lspz1_186:
    ds_read_b64_tr_b16 v[72:73], v4 offset:0
    ds_read_b64_tr_b16 v[74:75], v4 offset:64
    ds_read_b64_tr_b16 v[76:77], v4 offset:256
    ds_read_b64_tr_b16 v[78:79], v4 offset:320
    ds_read_b64_tr_b16 v[80:81], v4 offset:2304
    ds_read_b64_tr_b16 v[82:83], v4 offset:2368
    ds_read_b64_tr_b16 v[84:85], v4 offset:2560
    ds_read_b64_tr_b16 v[86:87], v4 offset:2624
    ds_read_b64_tr_b16 v[88:89], v4 offset:4608
    ds_read_b64_tr_b16 v[90:91], v4 offset:4672
    s_waitcnt lgkmcnt(8)
    v_mfma_f32_32x32x16_bf16 a[0:15], v[72:75], v[40:43], a[0:15]
    v_mfma_f32_32x32x16_bf16 a[144:159], v[72:75], v[48:51], a[144:159]
    ds_read_b64_tr_b16 v[92:93], v4 offset:4864
    ds_read_b64_tr_b16 v[94:95], v4 offset:4928
    s_waitcnt lgkmcnt(8)
    v_mfma_f32_32x32x16_bf16 a[0:15], v[76:79], v[44:47], a[0:15]
    v_mfma_f32_32x32x16_bf16 a[144:159], v[76:79], v[52:55], a[144:159]
    ds_read_b64_tr_b16 v[72:73], v4 offset:6912
    ds_read_b64_tr_b16 v[74:75], v4 offset:6976
    s_waitcnt lgkmcnt(8)
    v_mfma_f32_32x32x16_bf16 a[16:31], v[80:83], v[40:43], a[16:31]
    v_mfma_f32_32x32x16_bf16 a[160:175], v[80:83], v[48:51], a[160:175]
    ds_read_b64_tr_b16 v[76:77], v4 offset:7168
    ds_read_b64_tr_b16 v[78:79], v4 offset:7232
    s_waitcnt lgkmcnt(8)
    v_mfma_f32_32x32x16_bf16 a[16:31], v[84:87], v[44:47], a[16:31]
    v_mfma_f32_32x32x16_bf16 a[160:175], v[84:87], v[52:55], a[160:175]
    ds_read_b64_tr_b16 v[80:81], v4 offset:9216
    ds_read_b64_tr_b16 v[82:83], v4 offset:9280
    s_waitcnt lgkmcnt(8)
    v_mfma_f32_32x32x16_bf16 a[32:47], v[88:91], v[40:43], a[32:47]
    v_mfma_f32_32x32x16_bf16 a[176:191], v[88:91], v[48:51], a[176:191]
    ds_read_b64_tr_b16 v[84:85], v4 offset:9472
    ds_read_b64_tr_b16 v[86:87], v4 offset:9536
    s_waitcnt lgkmcnt(8)
    v_mfma_f32_32x32x16_bf16 a[32:47], v[92:95], v[44:47], a[32:47]
    v_mfma_f32_32x32x16_bf16 a[176:191], v[92:95], v[52:55], a[176:191]
    ds_read_b64_tr_b16 v[88:89], v4 offset:11520
    ds_read_b64_tr_b16 v[90:91], v4 offset:11584
    s_waitcnt lgkmcnt(8)
    v_mfma_f32_32x32x16_bf16 a[48:63], v[72:75], v[40:43], a[48:63]
    v_mfma_f32_32x32x16_bf16 a[192:207], v[72:75], v[48:51], a[192:207]
    ds_read_b64_tr_b16 v[92:93], v4 offset:11776
    ds_read_b64_tr_b16 v[94:95], v4 offset:11840
    s_waitcnt lgkmcnt(8)
    v_mfma_f32_32x32x16_bf16 a[48:63], v[76:79], v[44:47], a[48:63]
    v_mfma_f32_32x32x16_bf16 a[192:207], v[76:79], v[52:55], a[192:207]
    ds_read_b64_tr_b16 v[72:73], v4 offset:13824
    ds_read_b64_tr_b16 v[74:75], v4 offset:13888
    s_waitcnt lgkmcnt(8)
    v_mfma_f32_32x32x16_bf16 a[64:79], v[80:83], v[40:43], a[64:79]
    v_mfma_f32_32x32x16_bf16 a[208:223], v[80:83], v[48:51], a[208:223]
    ds_read_b64_tr_b16 v[76:77], v4 offset:14080
    ds_read_b64_tr_b16 v[78:79], v4 offset:14144
    s_waitcnt lgkmcnt(8)
    v_mfma_f32_32x32x16_bf16 a[64:79], v[84:87], v[44:47], a[64:79]
    v_mfma_f32_32x32x16_bf16 a[208:223], v[84:87], v[52:55], a[208:223]
    ds_read_b64_tr_b16 v[80:81], v4 offset:16128
    ds_read_b64_tr_b16 v[82:83], v4 offset:16192
    s_waitcnt lgkmcnt(8)
    v_mfma_f32_32x32x16_bf16 a[80:95], v[88:91], v[40:43], a[80:95]
    v_mfma_f32_32x32x16_bf16 a[224:239], v[88:91], v[48:51], a[224:239]
    ds_read_b64_tr_b16 v[84:85], v4 offset:16384
    ds_read_b64_tr_b16 v[86:87], v4 offset:16448
    s_waitcnt lgkmcnt(8)
    v_mfma_f32_32x32x16_bf16 a[80:95], v[92:95], v[44:47], a[80:95]
    v_mfma_f32_32x32x16_bf16 a[224:239], v[92:95], v[52:55], a[224:239]
    ds_read_b64_tr_b16 v[88:89], v4 offset:18432
    ds_read_b64_tr_b16 v[90:91], v4 offset:18496
    s_waitcnt lgkmcnt(8)
    v_mfma_f32_32x32x16_bf16 a[96:111], v[72:75], v[40:43], a[96:111]
    v_mfma_f32_32x32x16_bf16 a[240:255], v[72:75], v[48:51], a[240:255]
    ds_read_b64_tr_b16 v[92:93], v4 offset:18688
    ds_read_b64_tr_b16 v[94:95], v4 offset:18752
    s_waitcnt lgkmcnt(8)
    v_mfma_f32_32x32x16_bf16 a[96:111], v[76:79], v[44:47], a[96:111]
    v_mfma_f32_32x32x16_bf16 a[240:255], v[76:79], v[52:55], a[240:255]
    s_waitcnt lgkmcnt(6)
    v_mfma_f32_32x32x16_bf16 a[112:127], v[80:83], v[40:43], a[112:127]
    v_mfma_f32_32x32x16_bf16 v[200:215], v[80:83], v[48:51], v[200:215]
    s_waitcnt lgkmcnt(4)
    v_mfma_f32_32x32x16_bf16 a[112:127], v[84:87], v[44:47], a[112:127]
    v_mfma_f32_32x32x16_bf16 v[200:215], v[84:87], v[52:55], v[200:215]
    s_waitcnt lgkmcnt(2)
    v_mfma_f32_32x32x16_bf16 a[128:143], v[88:91], v[40:43], a[128:143]
    v_mfma_f32_32x32x16_bf16 v[216:231], v[88:91], v[48:51], v[216:231]
    s_waitcnt lgkmcnt(0)
    v_mfma_f32_32x32x16_bf16 a[128:143], v[92:95], v[44:47], a[128:143]
    v_mfma_f32_32x32x16_bf16 v[216:231], v[92:95], v[52:55], v[216:231]
    s_cmp_ge_u32 s17, 64
    s_cbranch_scc1 Lspe_184_m
    s_cmp_eq_u32 s30, 1
    s_cbranch_scc1 Lspp_187_m
    s_cmp_lg_u32 s13, 0
    s_cbranch_scc1 Lur_188_m
    s_cmp_lt_u32 s17, s92
    s_cbranch_scc1 Lfwok_190_m
    s_mul_i32 s98, s17, 128
    s_add_u32 s98, s98, 62051328
Lfw_189_m:
    buffer_load_dwordx4 v[8:11], v0, s[4:7], s98 offen sc1
    s_waitcnt vmcnt(0)
    v_xor_b32 v8, s90, v8
    v_xor_b32 v9, s90, v9
    v_xor_b32 v10, s90, v10
    v_xor_b32 v11, s90, v11
    v_or3_b32 v8, v8, v9, v10
    v_or_b32 v8, v8, v11
    v_cmp_ne_u32 vcc, 0, v8
    s_nop 3
    s_and_b32 vcc_lo, vcc_lo, 0x1010101
    s_and_b32 vcc_hi, vcc_hi, 0x1010101
    s_ff1_i32_b64 s92, vcc
    s_cmp_eq_u32 s92, -1
    s_cselect_b32 s92, 64, s92
    s_lshr_b32 s92, s92, 3
    s_cmp_lg_u32 s92, 0
    s_cbranch_scc1 Lfwg_191_m
    s_sleep 2
    s_add_u32 s99, s99, 1
    s_cmp_lt_u32 s99, 4194304
    s_cbranch_scc1 Lfw_189_m
    s_endpgm
Lfwg_191_m:
    s_add_u32 s92, s92, s17
Lfwok_190_m:
    v_mov_b32 v12, 163832
    v_mov_b32 v13, s92
    ds_write_b32 v12, v13
    s_waitcnt lgkmcnt(0)
Lur_188_m:
    s_barrier
    v_mov_b32 v12, 163832
    ds_read_b32 v13, v12
    s_waitcnt lgkmcnt(0)
    v_readfirstlane_b32 s92, v13
    s_mul_i32 s27, s17, 147456
    s_add_u32 s27, s27, 134217728
    s_mul_i32 s19, s15, 18432
    s_add_u32 s27, s27, s19
    s_lshl_b32 s19, s13, 10
    s_add_u32 s27, s27, s19
    buffer_load_dwordx4 v[16:19], v0, s[4:7], s27 offen sc1
    s_add_u32 s27, s27, 4096
    buffer_load_dwordx4 v[20:23], v0, s[4:7], s27 offen sc1
    s_add_u32 s27, s27, 4096
    buffer_load_dwordx4 v[24:27], v0, s[4:7], s27 offen sc1
    s_add_u32 s27, s27, 4096
    buffer_load_dwordx4 v[28:31], v0, s[4:7], s27 offen sc1
    s_add_u32 s27, s27, 4096
    s_cmp_lt_u32 s13, 2
    s_cselect_b32 s27, s27, 0xf0000000
    buffer_load_dwordx4 v[32:35], v0, s[4:7], s27 offen sc1
    s_lshl_b32 s19, s17, 6
    s_add_u32 s19, s19, s18
    buffer_load_dwordx4 v[56:59], v5, s[8:11], s19 offen offset:0
    buffer_load_dwordx4 v[60:63], v5, s[8:11], s19 offen offset:32
    s_add_u32 s19, s19, 131072
    buffer_load_dwordx4 v[64:67], v5, s[8:11], s19 offen offset:0
    buffer_load_dwordx4 v[68:71], v5, s[8:11], s19 offen offset:32
Lspp_187_m:
    s_waitcnt vmcnt(0)
    ds_write_b128 v3, v[16:19] offset:20736
    ds_write_b128 v3, v[20:23] offset:25344
    ds_write_b128 v3, v[24:27] offset:29952
    ds_write_b128 v3, v[28:31] offset:34560
    s_cmp_lt_u32 s13, 2
    s_cbranch_scc0 Lspw_192_m
    ds_write_b128 v3, v[32:35] offset:39168
Lspw_192_m:
    s_waitcnt lgkmcnt(0)
    s_barrier
    s_add_u32 s17, s17, 1
    s_mov_b32 s30, 0
    s_cmp_ge_u32 s17, 64
    s_cbranch_scc1 Lspn_193_m
    s_cmp_lt_u32 s17, s92
    s_cbranch_scc0 Lspn_193_m
    s_mul_i32 s27, s17, 147456
    s_add_u32 s27, s27, 134217728
    s_mul_i32 s19, s15, 18432
    s_add_u32 s27, s27, s19
    s_lshl_b32 s19, s13, 10
    s_add_u32 s27, s27, s19
    buffer_load_dwordx4 v[16:19], v0, s[4:7], s27 offen sc1
    s_add_u32 s27, s27, 4096
    buffer_load_dwordx4 v[20:23], v0, s[4:7], s27 offen sc1
    s_add_u32 s27, s27, 4096
    buffer_load_dwordx4 v[24:27], v0, s[4:7], s27 offen sc1
    s_add_u32 s27, s27, 4096
    buffer_load_dwordx4 v[28:31], v0, s[4:7], s27 offen sc1
    s_add_u32 s27, s27, 4096
    s_cmp_lt_u32 s13, 2
    s_cselect_b32 s27, s27, 0xf0000000
    buffer_load_dwordx4 v[32:35], v0, s[4:7], s27 offen sc1
    s_lshl_b32 s19, s17, 6
    s_add_u32 s19, s19, s18
    buffer_load_dwordx4 v[40:43], v5, s[8:11], s19 offen offset:0
    buffer_load_dwordx4 v[44:47], v5, s[8:11], s19 offen offset:32
    s_add_u32 s19, s19, 131072
    buffer_load_dwordx4 v[48:51], v5, s[8:11], s19 offen offset:0
    buffer_load_dwordx4 v[52:55], v5, s[8:11], s19 offen offset:32
    s_mov_b32 s30, 1
Lspn_193_m:
    s_cmp_lt_u32 s17, 64
    s_cbranch_scc1 Lspz1_194
    s_add_u32 s21, s29, 0
    s_mul_i32 s20, s21, 294912
    s_mul_i32 s19, s15, 18432
    s_add_u32 s20, s20, s19
    s_add_u32 s20, s20, 113246208
    s_cmp_eq_u32 s34, 0
    s_cselect_b32 s20, 209715200, s20
    buffer_load_dwordx2 v[112:113], v7, s[4:7], s20 offen offset:0 sc1
    buffer_load_dwordx2 v[114:115], v7, s[4:7], s20 offen offset:512 sc1
    buffer_load_dwordx2 v[116:117], v7, s[4:7], s20 offen offset:1024 sc1
    buffer_load_dwordx2 v[118:119], v7, s[4:7], s20 offen offset:1536 sc1
    s_add_u32 s20, s20, 2048
    buffer_load_dwordx2 v[120:121], v7, s[4:7], s20 offen offset:0 sc1
    buffer_load_dwordx2 v[122:123], v7, s[4:7], s20 offen offset:512 sc1
    buffer_load_dwordx2 v[124:125], v7, s[4:7], s20 offen offset:1024 sc1
    buffer_load_dwordx2 v[126:127], v7, s[4:7], s20 offen offset:1536 sc1
    s_add_u32 s20, s20, 2048
    buffer_load_dwordx2 v[128:129], v7, s[4:7], s20 offen offset:0 sc1
    buffer_load_dwordx2 v[130:131], v7, s[4:7], s20 offen offset:512 sc1
    buffer_load_dwordx2 v[132:133], v7, s[4:7], s20 offen offset:1024 sc1
    buffer_load_dwordx2 v[134:135], v7, s[4:7], s20 offen offset:1536 sc1
    s_add_u32 s20, s20, 2048
    buffer_load_dwordx2 v[136:137], v7, s[4:7], s20 offen offset:0 sc1
    buffer_load_dwordx2 v[138:139], v7, s[4:7], s20 offen offset:512 sc1
    buffer_load_dwordx2 v[140:141], v7, s[4:7], s20 offen offset:1024 sc1
    buffer_load_dwordx2 v[142:143], v7, s[4:7], s20 offen offset:1536 sc1
    s_add_u32 s20, s20, 2048
    buffer_load_dwordx2 v[144:145], v7, s[4:7], s20 offen offset:0 sc1
    buffer_load_dwordx2 v[146:147], v7, s[4:7], s20 offen offset:512 sc1
    buffer_load_dwordx2 v[148:149], v7, s[4:7], s20 offen offset:1024 sc1
    buffer_load_dwordx2 v[150:151], v7, s[4:7], s20 offen offset:1536 sc1
    s_add_u32 s20, s20, 2048
    buffer_load_dwordx2 v[152:153], v7, s[4:7], s20 offen offset:0 sc1
    buffer_load_dwordx2 v[154:155], v7, s[4:7], s20 offen offset:512 sc1
    buffer_load_dwordx2 v[156:157], v7, s[4:7], s20 offen offset:1024 sc1
    buffer_load_dwordx2 v[158:159], v7, s[4:7], s20 offen offset:1536 sc1
    s_add_u32 s20, s20, 2048
    buffer_load_dwordx2 v[160:161], v7, s[4:7], s20 offen offset:0 sc1
    buffer_load_dwordx2 v[162:163], v7, s[4:7], s20 offen offset:512 sc1
    buffer_load_dwordx2 v[164:165], v7, s[4:7], s20 offen offset:1024 sc1
    buffer_load_dwordx2 v[166:167], v7, s[4:7], s20 offen offset:1536 sc1
    s_add_u32 s20, s20, 2048
    buffer_load_dwordx2 v[168:169], v7, s[4:7], s20 offen offset:0 sc1
    buffer_load_dwordx2 v[170:171], v7, s[4:7], s20 offen offset:512 sc1
    buffer_load_dwordx2 v[172:173], v7, s[4:7], s20 offen offset:1024 sc1
    buffer_load_dwordx2 v[174:175], v7, s[4:7], s20 offen offset:1536 sc1
    s_add_u32 s20, s20, 2048
    buffer_load_dwordx2 v[176:177], v7, s[4:7], s20 offen offset:0 sc1
    buffer_load_dwordx2 v[178:179], v7, s[4:7], s20 offen offset:512 sc1
    buffer_load_dwordx2 v[180:181], v7, s[4:7], s20 offen offset:1024 sc1
    buffer_load_dwordx2 v[182:183], v7, s[4:7], s20 offen offset:1536 sc1
Lspz1_194:
    ds_read_b64_tr_b16 v[72:73], v4 offset:20736
    ds_read_b64_tr_b16 v[74:75], v4 offset:20800
    ds_read_b64_tr_b16 v[76:77], v4 offset:20992
    ds_read_b64_tr_b16 v[78:79], v4 offset:21056
    ds_read_b64_tr_b16 v[80:81], v4 offset:23040
    ds_read_b64_tr_b16 v[82:83], v4 offset:23104
    ds_read_b64_tr_b16 v[84:85], v4 offset:23296
    ds_read_b64_tr_b16 v[86:87], v4 offset:23360
    ds_read_b64_tr_b16 v[88:89], v4 offset:25344
    ds_read_b64_tr_b16 v[90:91], v4 offset:25408
    s_waitcnt lgkmcnt(8)
    v_mfma_f32_32x32x16_bf16 a[0:15], v[72:75], v[56:59], a[0:15]
    v_mfma_f32_32x32x16_bf16 a[144:159], v[72:75], v[64:67], a[144:159]
    ds_read_b64_tr_b16 v[92:93], v4 offset:25600
    ds_read_b64_tr_b16 v[94:95], v4 offset:25664
    s_waitcnt lgkmcnt(8)
    v_mfma_f32_32x32x16_bf16 a[0:15], v[76:79], v[60:63], a[0:15]
    v_mfma_f32_32x32x16_bf16 a[144:159], v[76:79], v[68:71], a[144:159]
    ds_read_b64_tr_b16 v[72:73], v4 offset:27648
    ds_read_b64_tr_b16 v[74:75], v4 offset:27712
    s_waitcnt lgkmcnt(8)
    v_mfma_f32_32x32x16_bf16 a[16:31], v[80:83], v[56:59], a[16:31]
    v_mfma_f32_32x32x16_bf16 a[160:175], v[80:83], v[64:67], a[160:175]
    ds_read_b64_tr_b16 v[76:77], v4 offset:27904
    ds_read_b64_tr_b16 v[78:79], v4 offset:27968
    s_waitcnt lgkmcnt(8)
    v_mfma_f32_32x32x16_bf16 a[16:31], v[84:87], v[60:63], a[16:31]
    v_mfma_f32_32x32x16_bf16 a[160:175], v[84:87], v[68:71], a[160:175]
    ds_read_b64_tr_b16 v[80:81], v4 offset:29952
    ds_read_b64_tr_b16 v[82:83], v4 offset:30016
    s_waitcnt lgkmcnt(8)
    v_mfma_f32_32x32x16_bf16 a[32:47], v[88:91], v[56:59], a[32:47]
    v_mfma_f32_32x32x16_bf16 a[176:191], v[88:91], v[64:67], a[176:191]
    ds_read_b64_tr_b16 v[84:85], v4 offset:30208
    ds_read_b64_tr_b16 v[86:87], v4 offset:30272
    s_waitcnt lgkmcnt(8)
    v_mfma_f32_32x32x16_bf16 a[32:47], v[92:95], v[60:63], a[32:47]
    v_mfma_f32_32x32x16_bf16 a[176:191], v[92:95], v[68:71], a[176:191]
    ds_read_b64_tr_b16 v[88:89], v4 offset:32256
    ds_read_b64_tr_b16 v[90:91], v4 offset:32320
    s_waitcnt lgkmcnt(8)
    v_mfma_f32_32x32x16_bf16 a[48:63], v[72:75], v[56:59], a[48:63]
    v_mfma_f32_32x32x16_bf16 a[192:207], v[72:75], v[64:67], a[192:207]
    ds_read_b64_tr_b16 v[92:93], v4 offset:32512
    ds_read_b64_tr_b16 v[94:95], v4 offset:32576
    s_waitcnt lgkmcnt(8)
    v_mfma_f32_32x32x16_bf16 a[48:63], v[76:79], v[60:63], a[48:63]
    v_mfma_f32_32x32x16_bf16 a[192:207], v[76:79], v[68:71], a[192:207]
    ds_read_b64_tr_b16 v[72:73], v4 offset:34560
    ds_read_b64_tr_b16 v[74:75], v4 offset:34624
    s_waitcnt lgkmcnt(8)
    v_mfma_f32_32x32x16_bf16 a[64:79], v[80:83], v[56:59], a[64:79]
    v_mfma_f32_32x32x16_bf16 a[208:223], v[80:83], v[64:67], a[208:223]
    ds_read_b64_tr_b16 v[76:77], v4 offset:34816
    ds_read_b64_tr_b16 v[78:79], v4 offset:34880
    s_waitcnt lgkmcnt(8)
    v_mfma_f32_32x32x16_bf16 a[64:79], v[84:87], v[60:63], a[64:79]
    v_mfma_f32_32x32x16_bf16 a[208:223], v[84:87], v[68:71], a[208:223]
    ds_read_b64_tr_b16 v[80:81], v4 offset:36864
    ds_read_b64_tr_b16 v[82:83], v4 offset:36928
    s_waitcnt lgkmcnt(8)
    v_mfma_f32_32x32x16_bf16 a[80:95], v[88:91], v[56:59], a[80:95]
    v_mfma_f32_32x32x16_bf16 a[224:239], v[88:91], v[64:67], a[224:239]
    ds_read_b64_tr_b16 v[84:85], v4 offset:37120
    ds_read_b64_tr_b16 v[86:87], v4 offset:37184
    s_waitcnt lgkmcnt(8)
    v_mfma_f32_32x32x16_bf16 a[80:95], v[92:95], v[60:63], a[80:95]
    v_mfma_f32_32x32x16_bf16 a[224:239], v[92:95], v[68:71], a[224:239]
    ds_read_b64_tr_b16 v[88:89], v4 offset:39168
    ds_read_b64_tr_b16 v[90:91], v4 offset:39232
    s_waitcnt lgkmcnt(8)
    v_mfma_f32_32x32x16_bf16 a[96:111], v[72:75], v[56:59], a[96:111]
    v_mfma_f32_32x32x16_bf16 a[240:255], v[72:75], v[64:67], a[240:255]
    ds_read_b64_tr_b16 v[92:93], v4 offset:39424
    ds_read_b64_tr_b16 v[94:95], v4 offset:39488
    s_waitcnt lgkmcnt(8)
    v_mfma_f32_32x32x16_bf16 a[96:111], v[76:79], v[60:63], a[96:111]
    v_mfma_f32_32x32x16_bf16 a[240:255], v[76:79], v[68:71], a[240:255]
    s_waitcnt lgkmcnt(6)
    v_mfma_f32_32x32x16_bf16 a[112:127], v[80:83], v[56:59], a[112:127]
    v_mfma_f32_32x32x16_bf16 v[200:215], v[80:83], v[64:67], v[200:215]
    s_waitcnt lgkmcnt(4)
    v_mfma_f32_32x32x16_bf16 a[112:127], v[84:87], v[60:63], a[112:127]
    v_mfma_f32_32x32x16_bf16 v[200:215], v[84:87], v[68:71], v[200:215]
    s_waitcnt lgkmcnt(2)
    v_mfma_f32_32x32x16_bf16 a[128:143], v[88:91], v[56:59], a[128:143]
    v_mfma_f32_32x32x16_bf16 v[216:231], v[88:91], v[64:67], v[216:231]
    s_waitcnt lgkmcnt(0)
    v_mfma_f32_32x32x16_bf16 a[128:143], v[92:95], v[60:63], a[128:143]
    v_mfma_f32_32x32x16_bf16 v[216:231], v[92:95], v[68:71], v[216:231]
    s_cmp_ge_u32 s17, 64
    s_cbranch_scc1 Lspe_184_m
    s_cmp_eq_u32 s30, 1
    s_cbranch_scc1 Lspp_195_m
    s_cmp_lg_u32 s13, 0
    s_cbranch_scc1 Lur_196_m
    s_cmp_lt_u32 s17, s92
    s_cbranch_scc1 Lfwok_198_m
    s_mul_i32 s98, s17, 128
    s_add_u32 s98, s98, 62051328
Lfw_197_m:
    buffer_load_dwordx4 v[8:11], v0, s[4:7], s98 offen sc1
    s_waitcnt vmcnt(0)
    v_xor_b32 v8, s90, v8
    v_xor_b32 v9, s90, v9
    v_xor_b32 v10, s90, v10
    v_xor_b32 v11, s90, v11
    v_or3_b32 v8, v8, v9, v10
    v_or_b32 v8, v8, v11
    v_cmp_ne_u32 vcc, 0, v8
    s_nop 3
    s_and_b32 vcc_lo, vcc_lo, 0x1010101
    s_and_b32 vcc_hi, vcc_hi, 0x1010101
    s_ff1_i32_b64 s92, vcc
    s_cmp_eq_u32 s92, -1
    s_cselect_b32 s92, 64, s92
    s_lshr_b32 s92, s92, 3
    s_cmp_lg_u32 s92, 0
    s_cbranch_scc1 Lfwg_199_m
    s_sleep 2
    s_add_u32 s99, s99, 1
    s_cmp_lt_u32 s99, 4194304
    s_cbranch_scc1 Lfw_197_m
    s_endpgm
Lfwg_199_m:
    s_add_u32 s92, s92, s17
Lfwok_198_m:
    v_mov_b32 v12, 163832
    v_mov_b32 v13, s92
    ds_write_b32 v12, v13
    s_waitcnt lgkmcnt(0)
Lur_196_m:
    s_barrier
    v_mov_b32 v12, 163832
    ds_read_b32 v13, v12
    s_waitcnt lgkmcnt(0)
    v_readfirstlane_b32 s92, v13
    s_mul_i32 s27, s17, 147456
    s_add_u32 s27, s27, 134217728
    s_mul_i32 s19, s15, 18432
    s_add_u32 s27, s27, s19
    s_lshl_b32 s19, s13, 10
    s_add_u32 s27, s27, s19
    buffer_load_dwordx4 v[16:19], v0, s[4:7], s27 offen sc1
    s_add_u32 s27, s27, 4096
    buffer_load_dwordx4 v[20:23], v0, s[4:7], s27 offen sc1
    s_add_u32 s27, s27, 4096
    buffer_load_dwordx4 v[24:27], v0, s[4:7], s27 offen sc1
    s_add_u32 s27, s27, 4096
    buffer_load_dwordx4 v[28:31], v0, s[4:7], s27 offen sc1
    s_add_u32 s27, s27, 4096
    s_cmp_lt_u32 s13, 2
    s_cselect_b32 s27, s27, 0xf0000000
    buffer_load_dwordx4 v[32:35], v0, s[4:7], s27 offen sc1
    s_lshl_b32 s19, s17, 6
    s_add_u32 s19, s19, s18
    buffer_load_dwordx4 v[40:43], v5, s[8:11], s19 offen offset:0
    buffer_load_dwordx4 v[44:47], v5, s[8:11], s19 offen offset:32
    s_add_u32 s19, s19, 131072
    buffer_load_dwordx4 v[48:51], v5, s[8:11], s19 offen offset:0
    buffer_load_dwordx4 v[52:55], v5, s[8:11], s19 offen offset:32
Lspp_195_m:
    s_waitcnt vmcnt(0)
    ds_write_b128 v3, v[16:19] offset:0
    ds_write_b128 v3, v[20:23] offset:4608
    ds_write_b128 v3, v[24:27] offset:9216
    ds_write_b128 v3, v[28:31] offset:13824
    s_cmp_lt_u32 s13, 2
    s_cbranch_scc0 Lspw_200_m
    ds_write_b128 v3, v[32:35] offset:18432
Lspw_200_m:
    s_waitcnt lgkmcnt(0)
    s_barrier
    s_branch Lsp_183_m
Lspe_184_m:
Lspepi_176_m:
    s_mov_b32 s35, 0xffff0000
    s_load_dwordx2 s[24:25], s[42:43], 80
    s_waitcnt lgkmcnt(0)
    s_mov_b32 s26, 4096
    s_mov_b32 s27, 0x20000
    v_and_b32 v2, 31, v1
    v_lshlrev_b32 v7, 4, v2
    v_lshlrev_b32 v20, 1, v2
    v_lshrrev_b32 v2, 5, v1
    v_lshl_add_u32 v7, v2, 3, v7
    s_lshl_b32 s29, s14, 3
    s_lshl_b32 s19, s13, 1
    s_add_u32 s29, s29, s19
    s_lshl_b32 s19, s29, 6
    buffer_load_ushort v16, v20, s[24:27], s19 offen offset:0
    buffer_load_ushort v17, v20, s[24:27], s19 offen offset:64
    s_cmp_eq_u32 s34, 1
    s_cbranch_scc1 Lspzd_201_m
    s_add_u32 s21, s29, 0
    s_mul_i32 s20, s21, 294912
    s_mul_i32 s19, s15, 18432
    s_add_u32 s20, s20, s19
    s_add_u32 s20, s20, 113246208
    s_cmp_eq_u32 s34, 0
    s_cselect_b32 s20, 209715200, s20
    buffer_load_dwordx2 v[112:113], v7, s[4:7], s20 offen offset:0 sc1
    buffer_load_dwordx2 v[114:115], v7, s[4:7], s20 offen offset:512 sc1
    buffer_load_dwordx2 v[116:117], v7, s[4:7], s20 offen offset:1024 sc1
    buffer_load_dwordx2 v[118:119], v7, s[4:7], s20 offen offset:1536 sc1
    s_add_u32 s20, s20, 2048
    buffer_load_dwordx2 v[120:121], v7, s[4:7], s20 offen offset:0 sc1
    buffer_load_dwordx2 v[122:123], v7, s[4:7], s20 offen offset:512 sc1
    buffer_load_dwordx2 v[124:125], v7, s[4:7], s20 offen offset:1024 sc1
    buffer_load_dwordx2 v[126:127], v7, s[4:7], s20 offen offset:1536 sc1
    s_add_u32 s20, s20, 2048
    buffer_load_dwordx2 v[128:129], v7, s[4:7], s20 offen offset:0 sc1
    buffer_load_dwordx2 v[130:131], v7, s[4:7], s20 offen offset:512 sc1
    buffer_load_dwordx2 v[132:133], v7, s[4:7], s20 offen offset:1024 sc1
    buffer_load_dwordx2 v[134:135], v7, s[4:7], s20 offen offset:1536 sc1
    s_add_u32 s20, s20, 2048
    buffer_load_dwordx2 v[136:137], v7, s[4:7], s20 offen offset:0 sc1
    buffer_load_dwordx2 v[138:139], v7, s[4:7], s20 offen offset:512 sc1
    buffer_load_dwordx2 v[140:141], v7, s[4:7], s20 offen offset:1024 sc1
    buffer_load_dwordx2 v[142:143], v7, s[4:7], s20 offen offset:1536 sc1
    s_add_u32 s20, s20, 2048
    buffer_load_dwordx2 v[144:145], v7, s[4:7], s20 offen offset:0 sc1
    buffer_load_dwordx2 v[146:147], v7, s[4:7], s20 offen offset:512 sc1
    buffer_load_dwordx2 v[148:149], v7, s[4:7], s20 offen offset:1024 sc1
    buffer_load_dwordx2 v[150:151], v7, s[4:7], s20 offen offset:1536 sc1
    s_add_u32 s20, s20, 2048
    buffer_load_dwordx2 v[152:153], v7, s[4:7], s20 offen offset:0 sc1
    buffer_load_dwordx2 v[154:155], v7, s[4:7], s20 offen offset:512 sc1
    buffer_load_dwordx2 v[156:157], v7, s[4:7], s20 offen offset:1024 sc1
    buffer_load_dwordx2 v[158:159], v7, s[4:7], s20 offen offset:1536 sc1
    s_add_u32 s20, s20, 2048
    buffer_load_dwordx2 v[160:161], v7, s[4:7], s20 offen offset:0 sc1
    buffer_load_dwordx2 v[162:163], v7, s[4:7], s20 offen offset:512 sc1
    buffer_load_dwordx2 v[164:165], v7, s[4:7], s20 offen offset:1024 sc1
    buffer_load_dwordx2 v[166:167], v7, s[4:7], s20 offen offset:1536 sc1
    s_add_u32 s20, s20, 2048
    buffer_load_dwordx2 v[168:169], v7, s[4:7], s20 offen offset:0 sc1
    buffer_load_dwordx2 v[170:171], v7, s[4:7], s20 offen offset:512 sc1
    buffer_load_dwordx2 v[172:173], v7, s[4:7], s20 offen offset:1024 sc1
    buffer_load_dwordx2 v[174:175], v7, s[4:7], s20 offen offset:1536 sc1
    s_add_u32 s20, s20, 2048
    buffer_load_dwordx2 v[176:177], v7, s[4:7], s20 offen offset:0 sc1
    buffer_load_dwordx2 v[178:179], v7, s[4:7], s20 offen offset:512 sc1
    buffer_load_dwordx2 v[180:181], v7, s[4:7], s20 offen offset:1024 sc1
    buffer_load_dwordx2 v[182:183], v7, s[4:7], s20 offen offset:1536 sc1
Lspzd_201_m:
    s_waitcnt vmcnt(0)
    s_add_u32 s21, s29, 1
    s_mul_i32 s20, s21, 294912
    s_mul_i32 s19, s15, 18432
    s_add_u32 s20, s20, s19
    s_add_u32 s20, s20, 113246208
    s_cmp_eq_u32 s34, 0
    s_cselect_b32 s20, 209715200, s20
    buffer_load_dwordx2 v[40:41], v7, s[4:7], s20 offen offset:0 sc1
    buffer_load_dwordx2 v[42:43], v7, s[4:7], s20 offen offset:512 sc1
    buffer_load_dwordx2 v[44:45], v7, s[4:7], s20 offen offset:1024 sc1
    buffer_load_dwordx2 v[46:47], v7, s[4:7], s20 offen offset:1536 sc1
    s_add_u32 s20, s20, 2048
    buffer_load_dwordx2 v[48:49], v7, s[4:7], s20 offen offset:0 sc1
    buffer_load_dwordx2 v[50:51], v7, s[4:7], s20 offen offset:512 sc1
    buffer_load_dwordx2 v[52:53], v7, s[4:7], s20 offen offset:1024 sc1
    buffer_load_dwordx2 v[54:55], v7, s[4:7], s20 offen offset:1536 sc1
    s_add_u32 s20, s20, 2048
    buffer_load_dwordx2 v[56:57], v7, s[4:7], s20 offen offset:0 sc1
    buffer_load_dwordx2 v[58:59], v7, s[4:7], s20 offen offset:512 sc1
    buffer_load_dwordx2 v[60:61], v7, s[4:7], s20 offen offset:1024 sc1
    buffer_load_dwordx2 v[62:63], v7, s[4:7], s20 offen offset:1536 sc1
    s_add_u32 s20, s20, 2048
    buffer_load_dwordx2 v[64:65], v7, s[4:7], s20 offen offset:0 sc1
    buffer_load_dwordx2 v[66:67], v7, s[4:7], s20 offen offset:512 sc1
    buffer_load_dwordx2 v[68:69], v7, s[4:7], s20 offen offset:1024 sc1
    buffer_load_dwordx2 v[70:71], v7, s[4:7], s20 offen offset:1536 sc1
    s_add_u32 s20, s20, 2048
    buffer_load_dwordx2 v[72:73], v7, s[4:7], s20 offen offset:0 sc1
    buffer_load_dwordx2 v[74:75], v7, s[4:7], s20 offen offset:512 sc1
    buffer_load_dwordx2 v[76:77], v7, s[4:7], s20 offen offset:1024 sc1
    buffer_load_dwordx2 v[78:79], v7, s[4:7], s20 offen offset:1536 sc1
    s_add_u32 s20, s20, 2048
    buffer_load_dwordx2 v[80:81], v7, s[4:7], s20 offen offset:0 sc1
    buffer_load_dwordx2 v[82:83], v7, s[4:7], s20 offen offset:512 sc1
    buffer_load_dwordx2 v[84:85], v7, s[4:7], s20 offen offset:1024 sc1
    buffer_load_dwordx2 v[86:87], v7, s[4:7], s20 offen offset:1536 sc1
    s_add_u32 s20, s20, 2048
    buffer_load_dwordx2 v[88:89], v7, s[4:7], s20 offen offset:0 sc1
    buffer_load_dwordx2 v[90:91], v7, s[4:7], s20 offen offset:512 sc1
    buffer_load_dwordx2 v[92:93], v7, s[4:7], s20 offen offset:1024 sc1
    buffer_load_dwordx2 v[94:95], v7, s[4:7], s20 offen offset:1536 sc1
    s_add_u32 s20, s20, 2048
    buffer_load_dwordx2 v[96:97], v7, s[4:7], s20 offen offset:0 sc1
    buffer_load_dwordx2 v[98:99], v7, s[4:7], s20 offen offset:512 sc1
    buffer_load_dwordx2 v[100:101], v7, s[4:7], s20 offen offset:1024 sc1
    buffer_load_dwordx2 v[102:103], v7, s[4:7], s20 offen offset:1536 sc1
    s_add_u32 s20, s20, 2048
    buffer_load_dwordx2 v[104:105], v7, s[4:7], s20 offen offset:0 sc1
    buffer_load_dwordx2 v[106:107], v7, s[4:7], s20 offen offset:512 sc1
    buffer_load_dwordx2 v[108:109], v7, s[4:7], s20 offen offset:1024 sc1
    buffer_load_dwordx2 v[110:111], v7, s[4:7], s20 offen offset:1536 sc1
    v_lshlrev_b32 v16, 16, v16
    v_lshlrev_b32 v17, 16, v17
    s_add_u32 s21, s29, 0
    s_mul_i32 s33, s21, 147456
    s_mul_i32 s19, s15, 18432
    s_add_u32 s33, s33, s19
    s_add_u32 s33, s33, 146800640
    s_cmp_eq_u32 s34, 0
    s_cselect_b32 s33, 209780736, s33
    v_accvgpr_read_b32 v184, a0
    v_accvgpr_read_b32 v185, a1
    v_accvgpr_read_b32 v186, a2
    v_accvgpr_read_b32 v187, a3
    v_accvgpr_read_b32 v188, a4
    v_accvgpr_read_b32 v189, a5
    v_accvgpr_read_b32 v190, a6
    v_accvgpr_read_b32 v191, a7
    v_accvgpr_read_b32 v192, a8
    v_accvgpr_read_b32 v193, a9
    v_accvgpr_read_b32 v194, a10
    v_accvgpr_read_b32 v195, a11
    v_accvgpr_read_b32 v196, a12
    v_accvgpr_read_b32 v197, a13
    v_accvgpr_read_b32 v198, a14
    v_accvgpr_read_b32 v199, a15
    v_cvt_pk_bf16_f32 v24, v184, v185
    v_cvt_pk_bf16_f32 v25, v186, v187
    v_cvt_pk_bf16_f32 v26, v188, v189
    v_cvt_pk_bf16_f32 v27, v190, v191
    v_cvt_pk_bf16_f32 v28, v192, v193
    v_cvt_pk_bf16_f32 v29, v194, v195
    v_cvt_pk_bf16_f32 v30, v196, v197
    v_cvt_pk_bf16_f32 v31, v198, v199
    v_and_b32 v20, 0xffff, v112
    v_and_b32 v21, s35, v112
    v_dot2_f32_bf16 v184, v24, v20, 0
    v_dot2_f32_bf16 v185, v24, v21, 0
    v_and_b32 v20, 0xffff, v113
    v_and_b32 v21, s35, v113
    v_dot2_f32_bf16 v186, v25, v20, 0
    v_dot2_f32_bf16 v187, v25, v21, 0
    v_and_b32 v20, 0xffff, v114
    v_and_b32 v21, s35, v114
    v_dot2_f32_bf16 v188, v26, v20, 0
    v_dot2_f32_bf16 v189, v26, v21, 0
    v_and_b32 v20, 0xffff, v115
    v_and_b32 v21, s35, v115
    v_dot2_f32_bf16 v190, v27, v20, 0
    v_dot2_f32_bf16 v191, v27, v21, 0
    v_and_b32 v20, 0xffff, v116
    v_and_b32 v21, s35, v116
    v_dot2_f32_bf16 v192, v28, v20, 0
    v_dot2_f32_bf16 v193, v28, v21, 0
    v_and_b32 v20, 0xffff, v117
    v_and_b32 v21, s35, v117
    v_dot2_f32_bf16 v194, v29, v20, 0
    v_dot2_f32_bf16 v195, v29, v21, 0
    v_and_b32 v20, 0xffff, v118
    v_and_b32 v21, s35, v118
    v_dot2_f32_bf16 v196, v30, v20, 0
    v_dot2_f32_bf16 v197, v30, v21, 0
    v_and_b32 v20, 0xffff, v119
    v_and_b32 v21, s35, v119
    v_dot2_f32_bf16 v198, v31, v20, 0
    v_dot2_f32_bf16 v199, v31, v21, 0
    v_cvt_pk_bf16_f32 v24, v184, v185
    v_cvt_pk_bf16_f32 v25, v186, v187
    v_cvt_pk_bf16_f32 v26, v188, v189
    v_cvt_pk_bf16_f32 v27, v190, v191
    v_cvt_pk_bf16_f32 v28, v192, v193
    v_cvt_pk_bf16_f32 v29, v194, v195
    v_cvt_pk_bf16_f32 v30, v196, v197
    v_cvt_pk_bf16_f32 v31, v198, v199
    v_permlane32_swap_b32 v24, v26
    v_permlane32_swap_b32 v25, v27
    v_permlane32_swap_b32 v28, v30
    v_permlane32_swap_b32 v29, v31
    buffer_store_dwordx4 v[24:27], v0, s[4:7], s33 offen sc1
    buffer_store_dwordx4 v[28:31], v0, s[4:7], s33 offen offset:1024 sc1
    s_add_u32 s33, s33, 2048
    v_accvgpr_read_b32 v184, a16
    v_accvgpr_read_b32 v185, a17
    v_accvgpr_read_b32 v186, a18
    v_accvgpr_read_b32 v187, a19
    v_accvgpr_read_b32 v188, a20
    v_accvgpr_read_b32 v189, a21
    v_accvgpr_read_b32 v190, a22
    v_accvgpr_read_b32 v191, a23
    v_accvgpr_read_b32 v192, a24
    v_accvgpr_read_b32 v193, a25
    v_accvgpr_read_b32 v194, a26
    v_accvgpr_read_b32 v195, a27
    v_accvgpr_read_b32 v196, a28
    v_accvgpr_read_b32 v197, a29
    v_accvgpr_read_b32 v198, a30
    v_accvgpr_read_b32 v199, a31
    v_cvt_pk_bf16_f32 v32, v184, v185
    v_cvt_pk_bf16_f32 v33, v186, v187
    v_cvt_pk_bf16_f32 v34, v188, v189
    v_cvt_pk_bf16_f32 v35, v190, v191
    v_cvt_pk_bf16_f32 v36, v192, v193
    v_cvt_pk_bf16_f32 v37, v194, v195
    v_cvt_pk_bf16_f32 v38, v196, v197
    v_cvt_pk_bf16_f32 v39, v198, v199
    v_and_b32 v20, 0xffff, v120
    v_and_b32 v21, s35, v120
    v_dot2_f32_bf16 v184, v32, v20, 0
    v_dot2_f32_bf16 v185, v32, v21, 0
    v_and_b32 v20, 0xffff, v121
    v_and_b32 v21, s35, v121
    v_dot2_f32_bf16 v186, v33, v20, 0
    v_dot2_f32_bf16 v187, v33, v21, 0
    v_and_b32 v20, 0xffff, v122
    v_and_b32 v21, s35, v122
    v_dot2_f32_bf16 v188, v34, v20, 0
    v_dot2_f32_bf16 v189, v34, v21, 0
    v_and_b32 v20, 0xffff, v123
    v_and_b32 v21, s35, v123
    v_dot2_f32_bf16 v190, v35, v20, 0
    v_dot2_f32_bf16 v191, v35, v21, 0
    v_and_b32 v20, 0xffff, v124
    v_and_b32 v21, s35, v124
    v_dot2_f32_bf16 v192, v36, v20, 0
    v_dot2_f32_bf16 v193, v36, v21, 0
    v_and_b32 v20, 0xffff, v125
    v_and_b32 v21, s35, v125
    v_dot2_f32_bf16 v194, v37, v20, 0
    v_dot2_f32_bf16 v195, v37, v21, 0
    v_and_b32 v20, 0xffff, v126
    v_and_b32 v21, s35, v126
    v_dot2_f32_bf16 v196, v38, v20, 0
    v_dot2_f32_bf16 v197, v38, v21, 0
    v_and_b32 v20, 0xffff, v127
    v_and_b32 v21, s35, v127
    v_dot2_f32_bf16 v198, v39, v20, 0
    v_dot2_f32_bf16 v199, v39, v21, 0
    v_cvt_pk_bf16_f32 v32, v184, v185
    v_cvt_pk_bf16_f32 v33, v186, v187
    v_cvt_pk_bf16_f32 v34, v188, v189
    v_cvt_pk_bf16_f32 v35, v190, v191
    v_cvt_pk_bf16_f32 v36, v192, v193
    v_cvt_pk_bf16_f32 v37, v194, v195
    v_cvt_pk_bf16_f32 v38, v196, v197
    v_cvt_pk_bf16_f32 v39, v198, v199
    v_permlane32_swap_b32 v32, v34
    v_permlane32_swap_b32 v33, v35
    v_permlane32_swap_b32 v36, v38
    v_permlane32_swap_b32 v37, v39
    buffer_store_dwordx4 v[32:35], v0, s[4:7], s33 offen sc1
    buffer_store_dwordx4 v[36:39], v0, s[4:7], s33 offen offset:1024 sc1
    s_add_u32 s33, s33, 2048
    v_accvgpr_read_b32 v184, a32
    v_accvgpr_read_b32 v185, a33
    v_accvgpr_read_b32 v186, a34
    v_accvgpr_read_b32 v187, a35
    v_accvgpr_read_b32 v188, a36
    v_accvgpr_read_b32 v189, a37
    v_accvgpr_read_b32 v190, a38
    v_accvgpr_read_b32 v191, a39
    v_accvgpr_read_b32 v192, a40
    v_accvgpr_read_b32 v193, a41
    v_accvgpr_read_b32 v194, a42
    v_accvgpr_read_b32 v195, a43
    v_accvgpr_read_b32 v196, a44
    v_accvgpr_read_b32 v197, a45
    v_accvgpr_read_b32 v198, a46
    v_accvgpr_read_b32 v199, a47
    v_cvt_pk_bf16_f32 v24, v184, v185
    v_cvt_pk_bf16_f32 v25, v186, v187
    v_cvt_pk_bf16_f32 v26, v188, v189
    v_cvt_pk_bf16_f32 v27, v190, v191
    v_cvt_pk_bf16_f32 v28, v192, v193
    v_cvt_pk_bf16_f32 v29, v194, v195
    v_cvt_pk_bf16_f32 v30, v196, v197
    v_cvt_pk_bf16_f32 v31, v198, v199
    v_and_b32 v20, 0xffff, v128
    v_and_b32 v21, s35, v128
    v_dot2_f32_bf16 v184, v24, v20, 0
    v_dot2_f32_bf16 v185, v24, v21, 0
    v_and_b32 v20, 0xffff, v129
    v_and_b32 v21, s35, v129
    v_dot2_f32_bf16 v186, v25, v20, 0
    v_dot2_f32_bf16 v187, v25, v21, 0
    v_and_b32 v20, 0xffff, v130
    v_and_b32 v21, s35, v130
    v_dot2_f32_bf16 v188, v26, v20, 0
    v_dot2_f32_bf16 v189, v26, v21, 0
    v_and_b32 v20, 0xffff, v131
    v_and_b32 v21, s35, v131
    v_dot2_f32_bf16 v190, v27, v20, 0
    v_dot2_f32_bf16 v191, v27, v21, 0
    v_and_b32 v20, 0xffff, v132
    v_and_b32 v21, s35, v132
    v_dot2_f32_bf16 v192, v28, v20, 0
    v_dot2_f32_bf16 v193, v28, v21, 0
    v_and_b32 v20, 0xffff, v133
    v_and_b32 v21, s35, v133
    v_dot2_f32_bf16 v194, v29, v20, 0
    v_dot2_f32_bf16 v195, v29, v21, 0
    v_and_b32 v20, 0xffff, v134
    v_and_b32 v21, s35, v134
    v_dot2_f32_bf16 v196, v30, v20, 0
    v_dot2_f32_bf16 v197, v30, v21, 0
    v_and_b32 v20, 0xffff, v135
    v_and_b32 v21, s35, v135
    v_dot2_f32_bf16 v198, v31, v20, 0
    v_dot2_f32_bf16 v199, v31, v21, 0
    v_cvt_pk_bf16_f32 v24, v184, v185
    v_cvt_pk_bf16_f32 v25, v186, v187
    v_cvt_pk_bf16_f32 v26, v188, v189
    v_cvt_pk_bf16_f32 v27, v190, v191
    v_cvt_pk_bf16_f32 v28, v192, v193
    v_cvt_pk_bf16_f32 v29, v194, v195
    v_cvt_pk_bf16_f32 v30, v196, v197
    v_cvt_pk_bf16_f32 v31, v198, v199
    v_permlane32_swap_b32 v24, v26
    v_permlane32_swap_b32 v25, v27
    v_permlane32_swap_b32 v28, v30
    v_permlane32_swap_b32 v29, v31
    buffer_store_dwordx4 v[24:27], v0, s[4:7], s33 offen sc1
    buffer_store_dwordx4 v[28:31], v0, s[4:7], s33 offen offset:1024 sc1
    s_add_u32 s33, s33, 2048
    v_accvgpr_read_b32 v184, a48
    v_accvgpr_read_b32 v185, a49
    v_accvgpr_read_b32 v186, a50
    v_accvgpr_read_b32 v187, a51
    v_accvgpr_read_b32 v188, a52
    v_accvgpr_read_b32 v189, a53
    v_accvgpr_read_b32 v190, a54
    v_accvgpr_read_b32 v191, a55
    v_accvgpr_read_b32 v192, a56
    v_accvgpr_read_b32 v193, a57
    v_accvgpr_read_b32 v194, a58
    v_accvgpr_read_b32 v195, a59
    v_accvgpr_read_b32 v196, a60
    v_accvgpr_read_b32 v197, a61
    v_accvgpr_read_b32 v198, a62
    v_accvgpr_read_b32 v199, a63
    v_cvt_pk_bf16_f32 v32, v184, v185
    v_cvt_pk_bf16_f32 v33, v186, v187
    v_cvt_pk_bf16_f32 v34, v188, v189
    v_cvt_pk_bf16_f32 v35, v190, v191
    v_cvt_pk_bf16_f32 v36, v192, v193
    v_cvt_pk_bf16_f32 v37, v194, v195
    v_cvt_pk_bf16_f32 v38, v196, v197
    v_cvt_pk_bf16_f32 v39, v198, v199
    v_and_b32 v20, 0xffff, v136
    v_and_b32 v21, s35, v136
    v_dot2_f32_bf16 v184, v32, v20, 0
    v_dot2_f32_bf16 v185, v32, v21, 0
    v_and_b32 v20, 0xffff, v137
    v_and_b32 v21, s35, v137
    v_dot2_f32_bf16 v186, v33, v20, 0
    v_dot2_f32_bf16 v187, v33, v21, 0
    v_and_b32 v20, 0xffff, v138
    v_and_b32 v21, s35, v138
    v_dot2_f32_bf16 v188, v34, v20, 0
    v_dot2_f32_bf16 v189, v34, v21, 0
    v_and_b32 v20, 0xffff, v139
    v_and_b32 v21, s35, v139
    v_dot2_f32_bf16 v190, v35, v20, 0
    v_dot2_f32_bf16 v191, v35, v21, 0
    v_and_b32 v20, 0xffff, v140
    v_and_b32 v21, s35, v140
    v_dot2_f32_bf16 v192, v36, v20, 0
    v_dot2_f32_bf16 v193, v36, v21, 0
    v_and_b32 v20, 0xffff, v141
    v_and_b32 v21, s35, v141
    v_dot2_f32_bf16 v194, v37, v20, 0
    v_dot2_f32_bf16 v195, v37, v21, 0
    v_and_b32 v20, 0xffff, v142
    v_and_b32 v21, s35, v142
    v_dot2_f32_bf16 v196, v38, v20, 0
    v_dot2_f32_bf16 v197, v38, v21, 0
    v_and_b32 v20, 0xffff, v143
    v_and_b32 v21, s35, v143
    v_dot2_f32_bf16 v198, v39, v20, 0
    v_dot2_f32_bf16 v199, v39, v21, 0
    v_cvt_pk_bf16_f32 v32, v184, v185
    v_cvt_pk_bf16_f32 v33, v186, v187
    v_cvt_pk_bf16_f32 v34, v188, v189
    v_cvt_pk_bf16_f32 v35, v190, v191
    v_cvt_pk_bf16_f32 v36, v192, v193
    v_cvt_pk_bf16_f32 v37, v194, v195
    v_cvt_pk_bf16_f32 v38, v196, v197
    v_cvt_pk_bf16_f32 v39, v198, v199
    v_permlane32_swap_b32 v32, v34
    v_permlane32_swap_b32 v33, v35
    v_permlane32_swap_b32 v36, v38
    v_permlane32_swap_b32 v37, v39
    buffer_store_dwordx4 v[32:35], v0, s[4:7], s33 offen sc1
    buffer_store_dwordx4 v[36:39], v0, s[4:7], s33 offen offset:1024 sc1
    s_add_u32 s33, s33, 2048
    v_accvgpr_read_b32 v184, a64
    v_accvgpr_read_b32 v185, a65
    v_accvgpr_read_b32 v186, a66
    v_accvgpr_read_b32 v187, a67
    v_accvgpr_read_b32 v188, a68
    v_accvgpr_read_b32 v189, a69
    v_accvgpr_read_b32 v190, a70
    v_accvgpr_read_b32 v191, a71
    v_accvgpr_read_b32 v192, a72
    v_accvgpr_read_b32 v193, a73
    v_accvgpr_read_b32 v194, a74
    v_accvgpr_read_b32 v195, a75
    v_accvgpr_read_b32 v196, a76
    v_accvgpr_read_b32 v197, a77
    v_accvgpr_read_b32 v198, a78
    v_accvgpr_read_b32 v199, a79
    v_cvt_pk_bf16_f32 v24, v184, v185
    v_cvt_pk_bf16_f32 v25, v186, v187
    v_cvt_pk_bf16_f32 v26, v188, v189
    v_cvt_pk_bf16_f32 v27, v190, v191
    v_cvt_pk_bf16_f32 v28, v192, v193
    v_cvt_pk_bf16_f32 v29, v194, v195
    v_cvt_pk_bf16_f32 v30, v196, v197
    v_cvt_pk_bf16_f32 v31, v198, v199
    v_and_b32 v20, 0xffff, v144
    v_and_b32 v21, s35, v144
    v_dot2_f32_bf16 v184, v24, v20, 0
    v_dot2_f32_bf16 v185, v24, v21, 0
    v_and_b32 v20, 0xffff, v145
    v_and_b32 v21, s35, v145
    v_dot2_f32_bf16 v186, v25, v20, 0
    v_dot2_f32_bf16 v187, v25, v21, 0
    v_and_b32 v20, 0xffff, v146
    v_and_b32 v21, s35, v146
    v_dot2_f32_bf16 v188, v26, v20, 0
    v_dot2_f32_bf16 v189, v26, v21, 0
    v_and_b32 v20, 0xffff, v147
    v_and_b32 v21, s35, v147
    v_dot2_f32_bf16 v190, v27, v20, 0
    v_dot2_f32_bf16 v191, v27, v21, 0
    v_and_b32 v20, 0xffff, v148
    v_and_b32 v21, s35, v148
    v_dot2_f32_bf16 v192, v28, v20, 0
    v_dot2_f32_bf16 v193, v28, v21, 0
    v_and_b32 v20, 0xffff, v149
    v_and_b32 v21, s35, v149
    v_dot2_f32_bf16 v194, v29, v20, 0
    v_dot2_f32_bf16 v195, v29, v21, 0
    v_and_b32 v20, 0xffff, v150
    v_and_b32 v21, s35, v150
    v_dot2_f32_bf16 v196, v30, v20, 0
    v_dot2_f32_bf16 v197, v30, v21, 0
    v_and_b32 v20, 0xffff, v151
    v_and_b32 v21, s35, v151
    v_dot2_f32_bf16 v198, v31, v20, 0
    v_dot2_f32_bf16 v199, v31, v21, 0
    v_cvt_pk_bf16_f32 v24, v184, v185
    v_cvt_pk_bf16_f32 v25, v186, v187
    v_cvt_pk_bf16_f32 v26, v188, v189
    v_cvt_pk_bf16_f32 v27, v190, v191
    v_cvt_pk_bf16_f32 v28, v192, v193
    v_cvt_pk_bf16_f32 v29, v194, v195
    v_cvt_pk_bf16_f32 v30, v196, v197
    v_cvt_pk_bf16_f32 v31, v198, v199
    v_permlane32_swap_b32 v24, v26
    v_permlane32_swap_b32 v25, v27
    v_permlane32_swap_b32 v28, v30
    v_permlane32_swap_b32 v29, v31
    buffer_store_dwordx4 v[24:27], v0, s[4:7], s33 offen sc1
    buffer_store_dwordx4 v[28:31], v0, s[4:7], s33 offen offset:1024 sc1
    s_add_u32 s33, s33, 2048
    v_accvgpr_read_b32 v184, a80
    v_accvgpr_read_b32 v185, a81
    v_accvgpr_read_b32 v186, a82
    v_accvgpr_read_b32 v187, a83
    v_accvgpr_read_b32 v188, a84
    v_accvgpr_read_b32 v189, a85
    v_accvgpr_read_b32 v190, a86
    v_accvgpr_read_b32 v191, a87
    v_accvgpr_read_b32 v192, a88
    v_accvgpr_read_b32 v193, a89
    v_accvgpr_read_b32 v194, a90
    v_accvgpr_read_b32 v195, a91
    v_accvgpr_read_b32 v196, a92
    v_accvgpr_read_b32 v197, a93
    v_accvgpr_read_b32 v198, a94
    v_accvgpr_read_b32 v199, a95
    v_cvt_pk_bf16_f32 v32, v184, v185
    v_cvt_pk_bf16_f32 v33, v186, v187
    v_cvt_pk_bf16_f32 v34, v188, v189
    v_cvt_pk_bf16_f32 v35, v190, v191
    v_cvt_pk_bf16_f32 v36, v192, v193
    v_cvt_pk_bf16_f32 v37, v194, v195
    v_cvt_pk_bf16_f32 v38, v196, v197
    v_cvt_pk_bf16_f32 v39, v198, v199
    v_and_b32 v20, 0xffff, v152
    v_and_b32 v21, s35, v152
    v_dot2_f32_bf16 v184, v32, v20, 0
    v_dot2_f32_bf16 v185, v32, v21, 0
    v_and_b32 v20, 0xffff, v153
    v_and_b32 v21, s35, v153
    v_dot2_f32_bf16 v186, v33, v20, 0
    v_dot2_f32_bf16 v187, v33, v21, 0
    v_and_b32 v20, 0xffff, v154
    v_and_b32 v21, s35, v154
    v_dot2_f32_bf16 v188, v34, v20, 0
    v_dot2_f32_bf16 v189, v34, v21, 0
    v_and_b32 v20, 0xffff, v155
    v_and_b32 v21, s35, v155
    v_dot2_f32_bf16 v190, v35, v20, 0
    v_dot2_f32_bf16 v191, v35, v21, 0
    v_and_b32 v20, 0xffff, v156
    v_and_b32 v21, s35, v156
    v_dot2_f32_bf16 v192, v36, v20, 0
    v_dot2_f32_bf16 v193, v36, v21, 0
    v_and_b32 v20, 0xffff, v157
    v_and_b32 v21, s35, v157
    v_dot2_f32_bf16 v194, v37, v20, 0
    v_dot2_f32_bf16 v195, v37, v21, 0
    v_and_b32 v20, 0xffff, v158
    v_and_b32 v21, s35, v158
    v_dot2_f32_bf16 v196, v38, v20, 0
    v_dot2_f32_bf16 v197, v38, v21, 0
    v_and_b32 v20, 0xffff, v159
    v_and_b32 v21, s35, v159
    v_dot2_f32_bf16 v198, v39, v20, 0
    v_dot2_f32_bf16 v199, v39, v21, 0
    v_cvt_pk_bf16_f32 v32, v184, v185
    v_cvt_pk_bf16_f32 v33, v186, v187
    v_cvt_pk_bf16_f32 v34, v188, v189
    v_cvt_pk_bf16_f32 v35, v190, v191
    v_cvt_pk_bf16_f32 v36, v192, v193
    v_cvt_pk_bf16_f32 v37, v194, v195
    v_cvt_pk_bf16_f32 v38, v196, v197
    v_cvt_pk_bf16_f32 v39, v198, v199
    v_permlane32_swap_b32 v32, v34
    v_permlane32_swap_b32 v33, v35
    v_permlane32_swap_b32 v36, v38
    v_permlane32_swap_b32 v37, v39
    buffer_store_dwordx4 v[32:35], v0, s[4:7], s33 offen sc1
    buffer_store_dwordx4 v[36:39], v0, s[4:7], s33 offen offset:1024 sc1
    s_add_u32 s33, s33, 2048
    v_accvgpr_read_b32 v184, a96
    v_accvgpr_read_b32 v185, a97
    v_accvgpr_read_b32 v186, a98
    v_accvgpr_read_b32 v187, a99
    v_accvgpr_read_b32 v188, a100
    v_accvgpr_read_b32 v189, a101
    v_accvgpr_read_b32 v190, a102
    v_accvgpr_read_b32 v191, a103
    v_accvgpr_read_b32 v192, a104
    v_accvgpr_read_b32 v193, a105
    v_accvgpr_read_b32 v194, a106
    v_accvgpr_read_b32 v195, a107
    v_accvgpr_read_b32 v196, a108
    v_accvgpr_read_b32 v197, a109
    v_accvgpr_read_b32 v198, a110
    v_accvgpr_read_b32 v199, a111
    v_cvt_pk_bf16_f32 v24, v184, v185
    v_cvt_pk_bf16_f32 v25, v186, v187
    v_cvt_pk_bf16_f32 v26, v188, v189
    v_cvt_pk_bf16_f32 v27, v190, v191
    v_cvt_pk_bf16_f32 v28, v192, v193
    v_cvt_pk_bf16_f32 v29, v194, v195
    v_cvt_pk_bf16_f32 v30, v196, v197
    v_cvt_pk_bf16_f32 v31, v198, v199
    v_and_b32 v20, 0xffff, v160
    v_and_b32 v21, s35, v160
    v_dot2_f32_bf16 v184, v24, v20, 0
    v_dot2_f32_bf16 v185, v24, v21, 0
    v_and_b32 v20, 0xffff, v161
    v_and_b32 v21, s35, v161
    v_dot2_f32_bf16 v186, v25, v20, 0
    v_dot2_f32_bf16 v187, v25, v21, 0
    v_and_b32 v20, 0xffff, v162
    v_and_b32 v21, s35, v162
    v_dot2_f32_bf16 v188, v26, v20, 0
    v_dot2_f32_bf16 v189, v26, v21, 0
    v_and_b32 v20, 0xffff, v163
    v_and_b32 v21, s35, v163
    v_dot2_f32_bf16 v190, v27, v20, 0
    v_dot2_f32_bf16 v191, v27, v21, 0
    v_and_b32 v20, 0xffff, v164
    v_and_b32 v21, s35, v164
    v_dot2_f32_bf16 v192, v28, v20, 0
    v_dot2_f32_bf16 v193, v28, v21, 0
    v_and_b32 v20, 0xffff, v165
    v_and_b32 v21, s35, v165
    v_dot2_f32_bf16 v194, v29, v20, 0
    v_dot2_f32_bf16 v195, v29, v21, 0
    v_and_b32 v20, 0xffff, v166
    v_and_b32 v21, s35, v166
    v_dot2_f32_bf16 v196, v30, v20, 0
    v_dot2_f32_bf16 v197, v30, v21, 0
    v_and_b32 v20, 0xffff, v167
    v_and_b32 v21, s35, v167
    v_dot2_f32_bf16 v198, v31, v20, 0
    v_dot2_f32_bf16 v199, v31, v21, 0
    v_cvt_pk_bf16_f32 v24, v184, v185
    v_cvt_pk_bf16_f32 v25, v186, v187
    v_cvt_pk_bf16_f32 v26, v188, v189
    v_cvt_pk_bf16_f32 v27, v190, v191
    v_cvt_pk_bf16_f32 v28, v192, v193
    v_cvt_pk_bf16_f32 v29, v194, v195
    v_cvt_pk_bf16_f32 v30, v196, v197
    v_cvt_pk_bf16_f32 v31, v198, v199
    v_permlane32_swap_b32 v24, v26
    v_permlane32_swap_b32 v25, v27
    v_permlane32_swap_b32 v28, v30
    v_permlane32_swap_b32 v29, v31
    buffer_store_dwordx4 v[24:27], v0, s[4:7], s33 offen sc1
    buffer_store_dwordx4 v[28:31], v0, s[4:7], s33 offen offset:1024 sc1
    s_add_u32 s33, s33, 2048
    v_accvgpr_read_b32 v184, a112
    v_accvgpr_read_b32 v185, a113
    v_accvgpr_read_b32 v186, a114
    v_accvgpr_read_b32 v187, a115
    v_accvgpr_read_b32 v188, a116
    v_accvgpr_read_b32 v189, a117
    v_accvgpr_read_b32 v190, a118
    v_accvgpr_read_b32 v191, a119
    v_accvgpr_read_b32 v192, a120
    v_accvgpr_read_b32 v193, a121
    v_accvgpr_read_b32 v194, a122
    v_accvgpr_read_b32 v195, a123
    v_accvgpr_read_b32 v196, a124
    v_accvgpr_read_b32 v197, a125
    v_accvgpr_read_b32 v198, a126
    v_accvgpr_read_b32 v199, a127
    v_cvt_pk_bf16_f32 v32, v184, v185
    v_cvt_pk_bf16_f32 v33, v186, v187
    v_cvt_pk_bf16_f32 v34, v188, v189
    v_cvt_pk_bf16_f32 v35, v190, v191
    v_cvt_pk_bf16_f32 v36, v192, v193
    v_cvt_pk_bf16_f32 v37, v194, v195
    v_cvt_pk_bf16_f32 v38, v196, v197
    v_cvt_pk_bf16_f32 v39, v198, v199
    v_and_b32 v20, 0xffff, v168
    v_and_b32 v21, s35, v168
    v_dot2_f32_bf16 v184, v32, v20, 0
    v_dot2_f32_bf16 v185, v32, v21, 0
    v_and_b32 v20, 0xffff, v169
    v_and_b32 v21, s35, v169
    v_dot2_f32_bf16 v186, v33, v20, 0
    v_dot2_f32_bf16 v187, v33, v21, 0
    v_and_b32 v20, 0xffff, v170
    v_and_b32 v21, s35, v170
    v_dot2_f32_bf16 v188, v34, v20, 0
    v_dot2_f32_bf16 v189, v34, v21, 0
    v_and_b32 v20, 0xffff, v171
    v_and_b32 v21, s35, v171
    v_dot2_f32_bf16 v190, v35, v20, 0
    v_dot2_f32_bf16 v191, v35, v21, 0
    v_and_b32 v20, 0xffff, v172
    v_and_b32 v21, s35, v172
    v_dot2_f32_bf16 v192, v36, v20, 0
    v_dot2_f32_bf16 v193, v36, v21, 0
    v_and_b32 v20, 0xffff, v173
    v_and_b32 v21, s35, v173
    v_dot2_f32_bf16 v194, v37, v20, 0
    v_dot2_f32_bf16 v195, v37, v21, 0
    v_and_b32 v20, 0xffff, v174
    v_and_b32 v21, s35, v174
    v_dot2_f32_bf16 v196, v38, v20, 0
    v_dot2_f32_bf16 v197, v38, v21, 0
    v_and_b32 v20, 0xffff, v175
    v_and_b32 v21, s35, v175
    v_dot2_f32_bf16 v198, v39, v20, 0
    v_dot2_f32_bf16 v199, v39, v21, 0
    v_cvt_pk_bf16_f32 v32, v184, v185
    v_cvt_pk_bf16_f32 v33, v186, v187
    v_cvt_pk_bf16_f32 v34, v188, v189
    v_cvt_pk_bf16_f32 v35, v190, v191
    v_cvt_pk_bf16_f32 v36, v192, v193
    v_cvt_pk_bf16_f32 v37, v194, v195
    v_cvt_pk_bf16_f32 v38, v196, v197
    v_cvt_pk_bf16_f32 v39, v198, v199
    v_permlane32_swap_b32 v32, v34
    v_permlane32_swap_b32 v33, v35
    v_permlane32_swap_b32 v36, v38
    v_permlane32_swap_b32 v37, v39
    buffer_store_dwordx4 v[32:35], v0, s[4:7], s33 offen sc1
    buffer_store_dwordx4 v[36:39], v0, s[4:7], s33 offen offset:1024 sc1
    s_add_u32 s33, s33, 2048
    v_accvgpr_read_b32 v184, a128
    v_accvgpr_read_b32 v185, a129
    v_accvgpr_read_b32 v186, a130
    v_accvgpr_read_b32 v187, a131
    v_accvgpr_read_b32 v188, a132
    v_accvgpr_read_b32 v189, a133
    v_accvgpr_read_b32 v190, a134
    v_accvgpr_read_b32 v191, a135
    v_accvgpr_read_b32 v192, a136
    v_accvgpr_read_b32 v193, a137
    v_accvgpr_read_b32 v194, a138
    v_accvgpr_read_b32 v195, a139
    v_accvgpr_read_b32 v196, a140
    v_accvgpr_read_b32 v197, a141
    v_accvgpr_read_b32 v198, a142
    v_accvgpr_read_b32 v199, a143
    v_cvt_pk_bf16_f32 v24, v184, v185
    v_cvt_pk_bf16_f32 v25, v186, v187
    v_cvt_pk_bf16_f32 v26, v188, v189
    v_cvt_pk_bf16_f32 v27, v190, v191
    v_cvt_pk_bf16_f32 v28, v192, v193
    v_cvt_pk_bf16_f32 v29, v194, v195
    v_cvt_pk_bf16_f32 v30, v196, v197
    v_cvt_pk_bf16_f32 v31, v198, v199
    v_and_b32 v20, 0xffff, v176
    v_and_b32 v21, s35, v176
    v_dot2_f32_bf16 v184, v24, v20, 0
    v_dot2_f32_bf16 v185, v24, v21, 0
    v_and_b32 v20, 0xffff, v177
    v_and_b32 v21, s35, v177
    v_dot2_f32_bf16 v186, v25, v20, 0
    v_dot2_f32_bf16 v187, v25, v21, 0
    v_and_b32 v20, 0xffff, v178
    v_and_b32 v21, s35, v178
    v_dot2_f32_bf16 v188, v26, v20, 0
    v_dot2_f32_bf16 v189, v26, v21, 0
    v_and_b32 v20, 0xffff, v179
    v_and_b32 v21, s35, v179
    v_dot2_f32_bf16 v190, v27, v20, 0
    v_dot2_f32_bf16 v191, v27, v21, 0
    v_and_b32 v20, 0xffff, v180
    v_and_b32 v21, s35, v180
    v_dot2_f32_bf16 v192, v28, v20, 0
    v_dot2_f32_bf16 v193, v28, v21, 0
    v_and_b32 v20, 0xffff, v181
    v_and_b32 v21, s35, v181
    v_dot2_f32_bf16 v194, v29, v20, 0
    v_dot2_f32_bf16 v195, v29, v21, 0
    v_and_b32 v20, 0xffff, v182
    v_and_b32 v21, s35, v182
    v_dot2_f32_bf16 v196, v30, v20, 0
    v_dot2_f32_bf16 v197, v30, v21, 0
    v_and_b32 v20, 0xffff, v183
    v_and_b32 v21, s35, v183
    v_dot2_f32_bf16 v198, v31, v20, 0
    v_dot2_f32_bf16 v199, v31, v21, 0
    v_cvt_pk_bf16_f32 v24, v184, v185
    v_cvt_pk_bf16_f32 v25, v186, v187
    v_cvt_pk_bf16_f32 v26, v188, v189
    v_cvt_pk_bf16_f32 v27, v190, v191
    v_cvt_pk_bf16_f32 v28, v192, v193
    v_cvt_pk_bf16_f32 v29, v194, v195
    v_cvt_pk_bf16_f32 v30, v196, v197
    v_cvt_pk_bf16_f32 v31, v198, v199
    v_permlane32_swap_b32 v24, v26
    v_permlane32_swap_b32 v25, v27
    v_permlane32_swap_b32 v28, v30
    v_permlane32_swap_b32 v29, v31
    buffer_store_dwordx4 v[24:27], v0, s[4:7], s33 offen sc1
    buffer_store_dwordx4 v[28:31], v0, s[4:7], s33 offen offset:1024 sc1
    s_add_u32 s21, s29, 1
    s_mul_i32 s33, s21, 147456
    s_mul_i32 s19, s15, 18432
    s_add_u32 s33, s33, s19
    s_add_u32 s33, s33, 146800640
    s_cmp_eq_u32 s34, 0
    s_cselect_b32 s33, 209780736, s33
    s_waitcnt vmcnt(18)
    v_accvgpr_read_b32 v184, a144
    v_accvgpr_read_b32 v185, a145
    v_accvgpr_read_b32 v186, a146
    v_accvgpr_read_b32 v187, a147
    v_accvgpr_read_b32 v188, a148
    v_accvgpr_read_b32 v189, a149
    v_accvgpr_read_b32 v190, a150
    v_accvgpr_read_b32 v191, a151
    v_accvgpr_read_b32 v192, a152
    v_accvgpr_read_b32 v193, a153
    v_accvgpr_read_b32 v194, a154
    v_accvgpr_read_b32 v195, a155
    v_accvgpr_read_b32 v196, a156
    v_accvgpr_read_b32 v197, a157
    v_accvgpr_read_b32 v198, a158
    v_accvgpr_read_b32 v199, a159
    v_cvt_pk_bf16_f32 v24, v184, v185
    v_cvt_pk_bf16_f32 v25, v186, v187
    v_cvt_pk_bf16_f32 v26, v188, v189
    v_cvt_pk_bf16_f32 v27, v190, v191
    v_cvt_pk_bf16_f32 v28, v192, v193
    v_cvt_pk_bf16_f32 v29, v194, v195
    v_cvt_pk_bf16_f32 v30, v196, v197
    v_cvt_pk_bf16_f32 v31, v198, v199
    v_and_b32 v20, 0xffff, v40
    v_and_b32 v21, s35, v40
    v_dot2_f32_bf16 v184, v24, v20, 0
    v_dot2_f32_bf16 v185, v24, v21, 0
    v_and_b32 v20, 0xffff, v41
    v_and_b32 v21, s35, v41
    v_dot2_f32_bf16 v186, v25, v20, 0
    v_dot2_f32_bf16 v187, v25, v21, 0
    v_and_b32 v20, 0xffff, v42
    v_and_b32 v21, s35, v42
    v_dot2_f32_bf16 v188, v26, v20, 0
    v_dot2_f32_bf16 v189, v26, v21, 0
    v_and_b32 v20, 0xffff, v43
    v_and_b32 v21, s35, v43
    v_dot2_f32_bf16 v190, v27, v20, 0
    v_dot2_f32_bf16 v191, v27, v21, 0
    v_and_b32 v20, 0xffff, v44
    v_and_b32 v21, s35, v44
    v_dot2_f32_bf16 v192, v28, v20, 0
    v_dot2_f32_bf16 v193, v28, v21, 0
    v_and_b32 v20, 0xffff, v45
    v_and_b32 v21, s35, v45
    v_dot2_f32_bf16 v194, v29, v20, 0
    v_dot2_f32_bf16 v195, v29, v21, 0
    v_and_b32 v20, 0xffff, v46
    v_and_b32 v21, s35, v46
    v_dot2_f32_bf16 v196, v30, v20, 0
    v_dot2_f32_bf16 v197, v30, v21, 0
    v_and_b32 v20, 0xffff, v47
    v_and_b32 v21, s35, v47
    v_dot2_f32_bf16 v198, v31, v20, 0
    v_dot2_f32_bf16 v199, v31, v21, 0
    v_cvt_pk_bf16_f32 v24, v184, v185
    v_cvt_pk_bf16_f32 v25, v186, v187
    v_cvt_pk_bf16_f32 v26, v188, v189
    v_cvt_pk_bf16_f32 v27, v190, v191
    v_cvt_pk_bf16_f32 v28, v192, v193
    v_cvt_pk_bf16_f32 v29, v194, v195
    v_cvt_pk_bf16_f32 v30, v196, v197
    v_cvt_pk_bf16_f32 v31, v198, v199
    v_permlane32_swap_b32 v24, v26
    v_permlane32_swap_b32 v25, v27
    v_permlane32_swap_b32 v28, v30
    v_permlane32_swap_b32 v29, v31
    buffer_store_dwordx4 v[24:27], v0, s[4:7], s33 offen sc1
    buffer_store_dwordx4 v[28:31], v0, s[4:7], s33 offen offset:1024 sc1
    s_add_u32 s33, s33, 2048
    v_accvgpr_read_b32 v184, a160
    v_accvgpr_read_b32 v185, a161
    v_accvgpr_read_b32 v186, a162
    v_accvgpr_read_b32 v187, a163
    v_accvgpr_read_b32 v188, a164
    v_accvgpr_read_b32 v189, a165
    v_accvgpr_read_b32 v190, a166
    v_accvgpr_read_b32 v191, a167
    v_accvgpr_read_b32 v192, a168
    v_accvgpr_read_b32 v193, a169
    v_accvgpr_read_b32 v194, a170
    v_accvgpr_read_b32 v195, a171
    v_accvgpr_read_b32 v196, a172
    v_accvgpr_read_b32 v197, a173
    v_accvgpr_read_b32 v198, a174
    v_accvgpr_read_b32 v199, a175
    v_cvt_pk_bf16_f32 v32, v184, v185
    v_cvt_pk_bf16_f32 v33, v186, v187
    v_cvt_pk_bf16_f32 v34, v188, v189
    v_cvt_pk_bf16_f32 v35, v190, v191
    v_cvt_pk_bf16_f32 v36, v192, v193
    v_cvt_pk_bf16_f32 v37, v194, v195
    v_cvt_pk_bf16_f32 v38, v196, v197
    v_cvt_pk_bf16_f32 v39, v198, v199
    v_and_b32 v20, 0xffff, v48
    v_and_b32 v21, s35, v48
    v_dot2_f32_bf16 v184, v32, v20, 0
    v_dot2_f32_bf16 v185, v32, v21, 0
    v_and_b32 v20, 0xffff, v49
    v_and_b32 v21, s35, v49
    v_dot2_f32_bf16 v186, v33, v20, 0
    v_dot2_f32_bf16 v187, v33, v21, 0
    v_and_b32 v20, 0xffff, v50
    v_and_b32 v21, s35, v50
    v_dot2_f32_bf16 v188, v34, v20, 0
    v_dot2_f32_bf16 v189, v34, v21, 0
    v_and_b32 v20, 0xffff, v51
    v_and_b32 v21, s35, v51
    v_dot2_f32_bf16 v190, v35, v20, 0
    v_dot2_f32_bf16 v191, v35, v21, 0
    v_and_b32 v20, 0xffff, v52
    v_and_b32 v21, s35, v52
    v_dot2_f32_bf16 v192, v36, v20, 0
    v_dot2_f32_bf16 v193, v36, v21, 0
    v_and_b32 v20, 0xffff, v53
    v_and_b32 v21, s35, v53
    v_dot2_f32_bf16 v194, v37, v20, 0
    v_dot2_f32_bf16 v195, v37, v21, 0
    v_and_b32 v20, 0xffff, v54
    v_and_b32 v21, s35, v54
    v_dot2_f32_bf16 v196, v38, v20, 0
    v_dot2_f32_bf16 v197, v38, v21, 0
    v_and_b32 v20, 0xffff, v55
    v_and_b32 v21, s35, v55
    v_dot2_f32_bf16 v198, v39, v20, 0
    v_dot2_f32_bf16 v199, v39, v21, 0
    v_cvt_pk_bf16_f32 v32, v184, v185
    v_cvt_pk_bf16_f32 v33, v186, v187
    v_cvt_pk_bf16_f32 v34, v188, v189
    v_cvt_pk_bf16_f32 v35, v190, v191
    v_cvt_pk_bf16_f32 v36, v192, v193
    v_cvt_pk_bf16_f32 v37, v194, v195
    v_cvt_pk_bf16_f32 v38, v196, v197
    v_cvt_pk_bf16_f32 v39, v198, v199
    v_permlane32_swap_b32 v32, v34
    v_permlane32_swap_b32 v33, v35
    v_permlane32_swap_b32 v36, v38
    v_permlane32_swap_b32 v37, v39
    buffer_store_dwordx4 v[32:35], v0, s[4:7], s33 offen sc1
    buffer_store_dwordx4 v[36:39], v0, s[4:7], s33 offen offset:1024 sc1
    s_add_u32 s33, s33, 2048
    v_accvgpr_read_b32 v184, a176
    v_accvgpr_read_b32 v185, a177
    v_accvgpr_read_b32 v186, a178
    v_accvgpr_read_b32 v187, a179
    v_accvgpr_read_b32 v188, a180
    v_accvgpr_read_b32 v189, a181
    v_accvgpr_read_b32 v190, a182
    v_accvgpr_read_b32 v191, a183
    v_accvgpr_read_b32 v192, a184
    v_accvgpr_read_b32 v193, a185
    v_accvgpr_read_b32 v194, a186
    v_accvgpr_read_b32 v195, a187
    v_accvgpr_read_b32 v196, a188
    v_accvgpr_read_b32 v197, a189
    v_accvgpr_read_b32 v198, a190
    v_accvgpr_read_b32 v199, a191
    v_cvt_pk_bf16_f32 v24, v184, v185
    v_cvt_pk_bf16_f32 v25, v186, v187
    v_cvt_pk_bf16_f32 v26, v188, v189
    v_cvt_pk_bf16_f32 v27, v190, v191
    v_cvt_pk_bf16_f32 v28, v192, v193
    v_cvt_pk_bf16_f32 v29, v194, v195
    v_cvt_pk_bf16_f32 v30, v196, v197
    v_cvt_pk_bf16_f32 v31, v198, v199
    v_and_b32 v20, 0xffff, v56
    v_and_b32 v21, s35, v56
    v_dot2_f32_bf16 v184, v24, v20, 0
    v_dot2_f32_bf16 v185, v24, v21, 0
    v_and_b32 v20, 0xffff, v57
    v_and_b32 v21, s35, v57
    v_dot2_f32_bf16 v186, v25, v20, 0
    v_dot2_f32_bf16 v187, v25, v21, 0
    v_and_b32 v20, 0xffff, v58
    v_and_b32 v21, s35, v58
    v_dot2_f32_bf16 v188, v26, v20, 0
    v_dot2_f32_bf16 v189, v26, v21, 0
    v_and_b32 v20, 0xffff, v59
    v_and_b32 v21, s35, v59
    v_dot2_f32_bf16 v190, v27, v20, 0
    v_dot2_f32_bf16 v191, v27, v21, 0
    v_and_b32 v20, 0xffff, v60
    v_and_b32 v21, s35, v60
    v_dot2_f32_bf16 v192, v28, v20, 0
    v_dot2_f32_bf16 v193, v28, v21, 0
    v_and_b32 v20, 0xffff, v61
    v_and_b32 v21, s35, v61
    v_dot2_f32_bf16 v194, v29, v20, 0
    v_dot2_f32_bf16 v195, v29, v21, 0
    v_and_b32 v20, 0xffff, v62
    v_and_b32 v21, s35, v62
    v_dot2_f32_bf16 v196, v30, v20, 0
    v_dot2_f32_bf16 v197, v30, v21, 0
    v_and_b32 v20, 0xffff, v63
    v_and_b32 v21, s35, v63
    v_dot2_f32_bf16 v198, v31, v20, 0
    v_dot2_f32_bf16 v199, v31, v21, 0
    v_cvt_pk_bf16_f32 v24, v184, v185
    v_cvt_pk_bf16_f32 v25, v186, v187
    v_cvt_pk_bf16_f32 v26, v188, v189
    v_cvt_pk_bf16_f32 v27, v190, v191
    v_cvt_pk_bf16_f32 v28, v192, v193
    v_cvt_pk_bf16_f32 v29, v194, v195
    v_cvt_pk_bf16_f32 v30, v196, v197
    v_cvt_pk_bf16_f32 v31, v198, v199
    v_permlane32_swap_b32 v24, v26
    v_permlane32_swap_b32 v25, v27
    v_permlane32_swap_b32 v28, v30
    v_permlane32_swap_b32 v29, v31
    buffer_store_dwordx4 v[24:27], v0, s[4:7], s33 offen sc1
    buffer_store_dwordx4 v[28:31], v0, s[4:7], s33 offen offset:1024 sc1
    s_add_u32 s33, s33, 2048
    v_accvgpr_read_b32 v184, a192
    v_accvgpr_read_b32 v185, a193
    v_accvgpr_read_b32 v186, a194
    v_accvgpr_read_b32 v187, a195
    v_accvgpr_read_b32 v188, a196
    v_accvgpr_read_b32 v189, a197
    v_accvgpr_read_b32 v190, a198
    v_accvgpr_read_b32 v191, a199
    v_accvgpr_read_b32 v192, a200
    v_accvgpr_read_b32 v193, a201
    v_accvgpr_read_b32 v194, a202
    v_accvgpr_read_b32 v195, a203
    v_accvgpr_read_b32 v196, a204
    v_accvgpr_read_b32 v197, a205
    v_accvgpr_read_b32 v198, a206
    v_accvgpr_read_b32 v199, a207
    v_cvt_pk_bf16_f32 v32, v184, v185
    v_cvt_pk_bf16_f32 v33, v186, v187
    v_cvt_pk_bf16_f32 v34, v188, v189
    v_cvt_pk_bf16_f32 v35, v190, v191
    v_cvt_pk_bf16_f32 v36, v192, v193
    v_cvt_pk_bf16_f32 v37, v194, v195
    v_cvt_pk_bf16_f32 v38, v196, v197
    v_cvt_pk_bf16_f32 v39, v198, v199
    v_and_b32 v20, 0xffff, v64
    v_and_b32 v21, s35, v64
    v_dot2_f32_bf16 v184, v32, v20, 0
    v_dot2_f32_bf16 v185, v32, v21, 0
    v_and_b32 v20, 0xffff, v65
    v_and_b32 v21, s35, v65
    v_dot2_f32_bf16 v186, v33, v20, 0
    v_dot2_f32_bf16 v187, v33, v21, 0
    v_and_b32 v20, 0xffff, v66
    v_and_b32 v21, s35, v66
    v_dot2_f32_bf16 v188, v34, v20, 0
    v_dot2_f32_bf16 v189, v34, v21, 0
    v_and_b32 v20, 0xffff, v67
    v_and_b32 v21, s35, v67
    v_dot2_f32_bf16 v190, v35, v20, 0
    v_dot2_f32_bf16 v191, v35, v21, 0
    v_and_b32 v20, 0xffff, v68
    v_and_b32 v21, s35, v68
    v_dot2_f32_bf16 v192, v36, v20, 0
    v_dot2_f32_bf16 v193, v36, v21, 0
    v_and_b32 v20, 0xffff, v69
    v_and_b32 v21, s35, v69
    v_dot2_f32_bf16 v194, v37, v20, 0
    v_dot2_f32_bf16 v195, v37, v21, 0
    v_and_b32 v20, 0xffff, v70
    v_and_b32 v21, s35, v70
    v_dot2_f32_bf16 v196, v38, v20, 0
    v_dot2_f32_bf16 v197, v38, v21, 0
    v_and_b32 v20, 0xffff, v71
    v_and_b32 v21, s35, v71
    v_dot2_f32_bf16 v198, v39, v20, 0
    v_dot2_f32_bf16 v199, v39, v21, 0
    v_cvt_pk_bf16_f32 v32, v184, v185
    v_cvt_pk_bf16_f32 v33, v186, v187
    v_cvt_pk_bf16_f32 v34, v188, v189
    v_cvt_pk_bf16_f32 v35, v190, v191
    v_cvt_pk_bf16_f32 v36, v192, v193
    v_cvt_pk_bf16_f32 v37, v194, v195
    v_cvt_pk_bf16_f32 v38, v196, v197
    v_cvt_pk_bf16_f32 v39, v198, v199
    v_permlane32_swap_b32 v32, v34
    v_permlane32_swap_b32 v33, v35
    v_permlane32_swap_b32 v36, v38
    v_permlane32_swap_b32 v37, v39
    buffer_store_dwordx4 v[32:35], v0, s[4:7], s33 offen sc1
    buffer_store_dwordx4 v[36:39], v0, s[4:7], s33 offen offset:1024 sc1
    s_add_u32 s33, s33, 2048
    v_accvgpr_read_b32 v184, a208
    v_accvgpr_read_b32 v185, a209
    v_accvgpr_read_b32 v186, a210
    v_accvgpr_read_b32 v187, a211
    v_accvgpr_read_b32 v188, a212
    v_accvgpr_read_b32 v189, a213
    v_accvgpr_read_b32 v190, a214
    v_accvgpr_read_b32 v191, a215
    v_accvgpr_read_b32 v192, a216
    v_accvgpr_read_b32 v193, a217
    v_accvgpr_read_b32 v194, a218
    v_accvgpr_read_b32 v195, a219
    v_accvgpr_read_b32 v196, a220
    v_accvgpr_read_b32 v197, a221
    v_accvgpr_read_b32 v198, a222
    v_accvgpr_read_b32 v199, a223
    v_cvt_pk_bf16_f32 v24, v184, v185
    v_cvt_pk_bf16_f32 v25, v186, v187
    v_cvt_pk_bf16_f32 v26, v188, v189
    v_cvt_pk_bf16_f32 v27, v190, v191
    v_cvt_pk_bf16_f32 v28, v192, v193
    v_cvt_pk_bf16_f32 v29, v194, v195
    v_cvt_pk_bf16_f32 v30, v196, v197
    v_cvt_pk_bf16_f32 v31, v198, v199
    v_and_b32 v20, 0xffff, v72
    v_and_b32 v21, s35, v72
    v_dot2_f32_bf16 v184, v24, v20, 0
    v_dot2_f32_bf16 v185, v24, v21, 0
    v_and_b32 v20, 0xffff, v73
    v_and_b32 v21, s35, v73
    v_dot2_f32_bf16 v186, v25, v20, 0
    v_dot2_f32_bf16 v187, v25, v21, 0
    v_and_b32 v20, 0xffff, v74
    v_and_b32 v21, s35, v74
    v_dot2_f32_bf16 v188, v26, v20, 0
    v_dot2_f32_bf16 v189, v26, v21, 0
    v_and_b32 v20, 0xffff, v75
    v_and_b32 v21, s35, v75
    v_dot2_f32_bf16 v190, v27, v20, 0
    v_dot2_f32_bf16 v191, v27, v21, 0
    v_and_b32 v20, 0xffff, v76
    v_and_b32 v21, s35, v76
    v_dot2_f32_bf16 v192, v28, v20, 0
    v_dot2_f32_bf16 v193, v28, v21, 0
    v_and_b32 v20, 0xffff, v77
    v_and_b32 v21, s35, v77
    v_dot2_f32_bf16 v194, v29, v20, 0
    v_dot2_f32_bf16 v195, v29, v21, 0
    v_and_b32 v20, 0xffff, v78
    v_and_b32 v21, s35, v78
    v_dot2_f32_bf16 v196, v30, v20, 0
    v_dot2_f32_bf16 v197, v30, v21, 0
    v_and_b32 v20, 0xffff, v79
    v_and_b32 v21, s35, v79
    v_dot2_f32_bf16 v198, v31, v20, 0
    v_dot2_f32_bf16 v199, v31, v21, 0
    v_cvt_pk_bf16_f32 v24, v184, v185
    v_cvt_pk_bf16_f32 v25, v186, v187
    v_cvt_pk_bf16_f32 v26, v188, v189
    v_cvt_pk_bf16_f32 v27, v190, v191
    v_cvt_pk_bf16_f32 v28, v192, v193
    v_cvt_pk_bf16_f32 v29, v194, v195
    v_cvt_pk_bf16_f32 v30, v196, v197
    v_cvt_pk_bf16_f32 v31, v198, v199
    v_permlane32_swap_b32 v24, v26
    v_permlane32_swap_b32 v25, v27
    v_permlane32_swap_b32 v28, v30
    v_permlane32_swap_b32 v29, v31
    buffer_store_dwordx4 v[24:27], v0, s[4:7], s33 offen sc1
    buffer_store_dwordx4 v[28:31], v0, s[4:7], s33 offen offset:1024 sc1
    s_add_u32 s33, s33, 2048
    v_accvgpr_read_b32 v184, a224
    v_accvgpr_read_b32 v185, a225
    v_accvgpr_read_b32 v186, a226
    v_accvgpr_read_b32 v187, a227
    v_accvgpr_read_b32 v188, a228
    v_accvgpr_read_b32 v189, a229
    v_accvgpr_read_b32 v190, a230
    v_accvgpr_read_b32 v191, a231
    v_accvgpr_read_b32 v192, a232
    v_accvgpr_read_b32 v193, a233
    v_accvgpr_read_b32 v194, a234
    v_accvgpr_read_b32 v195, a235
    v_accvgpr_read_b32 v196, a236
    v_accvgpr_read_b32 v197, a237
    v_accvgpr_read_b32 v198, a238
    v_accvgpr_read_b32 v199, a239
    v_cvt_pk_bf16_f32 v32, v184, v185
    v_cvt_pk_bf16_f32 v33, v186, v187
    v_cvt_pk_bf16_f32 v34, v188, v189
    v_cvt_pk_bf16_f32 v35, v190, v191
    v_cvt_pk_bf16_f32 v36, v192, v193
    v_cvt_pk_bf16_f32 v37, v194, v195
    v_cvt_pk_bf16_f32 v38, v196, v197
    v_cvt_pk_bf16_f32 v39, v198, v199
    v_and_b32 v20, 0xffff, v80
    v_and_b32 v21, s35, v80
    v_dot2_f32_bf16 v184, v32, v20, 0
    v_dot2_f32_bf16 v185, v32, v21, 0
    v_and_b32 v20, 0xffff, v81
    v_and_b32 v21, s35, v81
    v_dot2_f32_bf16 v186, v33, v20, 0
    v_dot2_f32_bf16 v187, v33, v21, 0
    v_and_b32 v20, 0xffff, v82
    v_and_b32 v21, s35, v82
    v_dot2_f32_bf16 v188, v34, v20, 0
    v_dot2_f32_bf16 v189, v34, v21, 0
    v_and_b32 v20, 0xffff, v83
    v_and_b32 v21, s35, v83
    v_dot2_f32_bf16 v190, v35, v20, 0
    v_dot2_f32_bf16 v191, v35, v21, 0
    v_and_b32 v20, 0xffff, v84
    v_and_b32 v21, s35, v84
    v_dot2_f32_bf16 v192, v36, v20, 0
    v_dot2_f32_bf16 v193, v36, v21, 0
    v_and_b32 v20, 0xffff, v85
    v_and_b32 v21, s35, v85
    v_dot2_f32_bf16 v194, v37, v20, 0
    v_dot2_f32_bf16 v195, v37, v21, 0
    v_and_b32 v20, 0xffff, v86
    v_and_b32 v21, s35, v86
    v_dot2_f32_bf16 v196, v38, v20, 0
    v_dot2_f32_bf16 v197, v38, v21, 0
    v_and_b32 v20, 0xffff, v87
    v_and_b32 v21, s35, v87
    v_dot2_f32_bf16 v198, v39, v20, 0
    v_dot2_f32_bf16 v199, v39, v21, 0
    v_cvt_pk_bf16_f32 v32, v184, v185
    v_cvt_pk_bf16_f32 v33, v186, v187
    v_cvt_pk_bf16_f32 v34, v188, v189
    v_cvt_pk_bf16_f32 v35, v190, v191
    v_cvt_pk_bf16_f32 v36, v192, v193
    v_cvt_pk_bf16_f32 v37, v194, v195
    v_cvt_pk_bf16_f32 v38, v196, v197
    v_cvt_pk_bf16_f32 v39, v198, v199
    v_permlane32_swap_b32 v32, v34
    v_permlane32_swap_b32 v33, v35
    v_permlane32_swap_b32 v36, v38
    v_permlane32_swap_b32 v37, v39
    buffer_store_dwordx4 v[32:35], v0, s[4:7], s33 offen sc1
    buffer_store_dwordx4 v[36:39], v0, s[4:7], s33 offen offset:1024 sc1
    s_add_u32 s33, s33, 2048
    v_accvgpr_read_b32 v184, a240
    v_accvgpr_read_b32 v185, a241
    v_accvgpr_read_b32 v186, a242
    v_accvgpr_read_b32 v187, a243
    v_accvgpr_read_b32 v188, a244
    v_accvgpr_read_b32 v189, a245
    v_accvgpr_read_b32 v190, a246
    v_accvgpr_read_b32 v191, a247
    v_accvgpr_read_b32 v192, a248
    v_accvgpr_read_b32 v193, a249
    v_accvgpr_read_b32 v194, a250
    v_accvgpr_read_b32 v195, a251
    v_accvgpr_read_b32 v196, a252
    v_accvgpr_read_b32 v197, a253
    v_accvgpr_read_b32 v198, a254
    v_accvgpr_read_b32 v199, a255
    v_cvt_pk_bf16_f32 v24, v184, v185
    v_cvt_pk_bf16_f32 v25, v186, v187
    v_cvt_pk_bf16_f32 v26, v188, v189
    v_cvt_pk_bf16_f32 v27, v190, v191
    v_cvt_pk_bf16_f32 v28, v192, v193
    v_cvt_pk_bf16_f32 v29, v194, v195
    v_cvt_pk_bf16_f32 v30, v196, v197
    v_cvt_pk_bf16_f32 v31, v198, v199
    v_and_b32 v20, 0xffff, v88
    v_and_b32 v21, s35, v88
    v_dot2_f32_bf16 v184, v24, v20, 0
    v_dot2_f32_bf16 v185, v24, v21, 0
    v_and_b32 v20, 0xffff, v89
    v_and_b32 v21, s35, v89
    v_dot2_f32_bf16 v186, v25, v20, 0
    v_dot2_f32_bf16 v187, v25, v21, 0
    v_and_b32 v20, 0xffff, v90
    v_and_b32 v21, s35, v90
    v_dot2_f32_bf16 v188, v26, v20, 0
    v_dot2_f32_bf16 v189, v26, v21, 0
    v_and_b32 v20, 0xffff, v91
    v_and_b32 v21, s35, v91
    v_dot2_f32_bf16 v190, v27, v20, 0
    v_dot2_f32_bf16 v191, v27, v21, 0
    v_and_b32 v20, 0xffff, v92
    v_and_b32 v21, s35, v92
    v_dot2_f32_bf16 v192, v28, v20, 0
    v_dot2_f32_bf16 v193, v28, v21, 0
    v_and_b32 v20, 0xffff, v93
    v_and_b32 v21, s35, v93
    v_dot2_f32_bf16 v194, v29, v20, 0
    v_dot2_f32_bf16 v195, v29, v21, 0
    v_and_b32 v20, 0xffff, v94
    v_and_b32 v21, s35, v94
    v_dot2_f32_bf16 v196, v30, v20, 0
    v_dot2_f32_bf16 v197, v30, v21, 0
    v_and_b32 v20, 0xffff, v95
    v_and_b32 v21, s35, v95
    v_dot2_f32_bf16 v198, v31, v20, 0
    v_dot2_f32_bf16 v199, v31, v21, 0
    v_cvt_pk_bf16_f32 v24, v184, v185
    v_cvt_pk_bf16_f32 v25, v186, v187
    v_cvt_pk_bf16_f32 v26, v188, v189
    v_cvt_pk_bf16_f32 v27, v190, v191
    v_cvt_pk_bf16_f32 v28, v192, v193
    v_cvt_pk_bf16_f32 v29, v194, v195
    v_cvt_pk_bf16_f32 v30, v196, v197
    v_cvt_pk_bf16_f32 v31, v198, v199
    v_permlane32_swap_b32 v24, v26
    v_permlane32_swap_b32 v25, v27
    v_permlane32_swap_b32 v28, v30
    v_permlane32_swap_b32 v29, v31
    buffer_store_dwordx4 v[24:27], v0, s[4:7], s33 offen sc1
    buffer_store_dwordx4 v[28:31], v0, s[4:7], s33 offen offset:1024 sc1
    s_add_u32 s33, s33, 2048
    v_cvt_pk_bf16_f32 v32, v200, v201
    v_cvt_pk_bf16_f32 v33, v202, v203
    v_cvt_pk_bf16_f32 v34, v204, v205
    v_cvt_pk_bf16_f32 v35, v206, v207
    v_cvt_pk_bf16_f32 v36, v208, v209
    v_cvt_pk_bf16_f32 v37, v210, v211
    v_cvt_pk_bf16_f32 v38, v212, v213
    v_cvt_pk_bf16_f32 v39, v214, v215
    v_and_b32 v20, 0xffff, v96
    v_and_b32 v21, s35, v96
    v_dot2_f32_bf16 v200, v32, v20, 0
    v_dot2_f32_bf16 v201, v32, v21, 0
    v_and_b32 v20, 0xffff, v97
    v_and_b32 v21, s35, v97
    v_dot2_f32_bf16 v202, v33, v20, 0
    v_dot2_f32_bf16 v203, v33, v21, 0
    v_and_b32 v20, 0xffff, v98
    v_and_b32 v21, s35, v98
    v_dot2_f32_bf16 v204, v34, v20, 0
    v_dot2_f32_bf16 v205, v34, v21, 0
    v_and_b32 v20, 0xffff, v99
    v_and_b32 v21, s35, v99
    v_dot2_f32_bf16 v206, v35, v20, 0
    v_dot2_f32_bf16 v207, v35, v21, 0
    v_and_b32 v20, 0xffff, v100
    v_and_b32 v21, s35, v100
    v_dot2_f32_bf16 v208, v36, v20, 0
    v_dot2_f32_bf16 v209, v36, v21, 0
    v_and_b32 v20, 0xffff, v101
    v_and_b32 v21, s35, v101
    v_dot2_f32_bf16 v210, v37, v20, 0
    v_dot2_f32_bf16 v211, v37, v21, 0
    v_and_b32 v20, 0xffff, v102
    v_and_b32 v21, s35, v102
    v_dot2_f32_bf16 v212, v38, v20, 0
    v_dot2_f32_bf16 v213, v38, v21, 0
    v_and_b32 v20, 0xffff, v103
    v_and_b32 v21, s35, v103
    v_dot2_f32_bf16 v214, v39, v20, 0
    v_dot2_f32_bf16 v215, v39, v21, 0
    v_cvt_pk_bf16_f32 v32, v200, v201
    v_cvt_pk_bf16_f32 v33, v202, v203
    v_cvt_pk_bf16_f32 v34, v204, v205
    v_cvt_pk_bf16_f32 v35, v206, v207
    v_cvt_pk_bf16_f32 v36, v208, v209
    v_cvt_pk_bf16_f32 v37, v210, v211
    v_cvt_pk_bf16_f32 v38, v212, v213
    v_cvt_pk_bf16_f32 v39, v214, v215
    v_permlane32_swap_b32 v32, v34
    v_permlane32_swap_b32 v33, v35
    v_permlane32_swap_b32 v36, v38
    v_permlane32_swap_b32 v37, v39
    buffer_store_dwordx4 v[32:35], v0, s[4:7], s33 offen sc1
    buffer_store_dwordx4 v[36:39], v0, s[4:7], s33 offen offset:1024 sc1
    s_add_u32 s33, s33, 2048
    v_cvt_pk_bf16_f32 v24, v216, v217
    v_cvt_pk_bf16_f32 v25, v218, v219
    v_cvt_pk_bf16_f32 v26, v220, v221
    v_cvt_pk_bf16_f32 v27, v222, v223
    v_cvt_pk_bf16_f32 v28, v224, v225
    v_cvt_pk_bf16_f32 v29, v226, v227
    v_cvt_pk_bf16_f32 v30, v228, v229
    v_cvt_pk_bf16_f32 v31, v230, v231
    v_and_b32 v20, 0xffff, v104
    v_and_b32 v21, s35, v104
    v_dot2_f32_bf16 v216, v24, v20, 0
    v_dot2_f32_bf16 v217, v24, v21, 0
    v_and_b32 v20, 0xffff, v105
    v_and_b32 v21, s35, v105
    v_dot2_f32_bf16 v218, v25, v20, 0
    v_dot2_f32_bf16 v219, v25, v21, 0
    v_and_b32 v20, 0xffff, v106
    v_and_b32 v21, s35, v106
    v_dot2_f32_bf16 v220, v26, v20, 0
    v_dot2_f32_bf16 v221, v26, v21, 0
    v_and_b32 v20, 0xffff, v107
    v_and_b32 v21, s35, v107
    v_dot2_f32_bf16 v222, v27, v20, 0
    v_dot2_f32_bf16 v223, v27, v21, 0
    v_and_b32 v20, 0xffff, v108
    v_and_b32 v21, s35, v108
    v_dot2_f32_bf16 v224, v28, v20, 0
    v_dot2_f32_bf16 v225, v28, v21, 0
    v_and_b32 v20, 0xffff, v109
    v_and_b32 v21, s35, v109
    v_dot2_f32_bf16 v226, v29, v20, 0
    v_dot2_f32_bf16 v227, v29, v21, 0
    v_and_b32 v20, 0xffff, v110
    v_and_b32 v21, s35, v110
    v_dot2_f32_bf16 v228, v30, v20, 0
    v_dot2_f32_bf16 v229, v30, v21, 0
    v_and_b32 v20, 0xffff, v111
    v_and_b32 v21, s35, v111
    v_dot2_f32_bf16 v230, v31, v20, 0
    v_dot2_f32_bf16 v231, v31, v21, 0
    v_cvt_pk_bf16_f32 v24, v216, v217
    v_cvt_pk_bf16_f32 v25, v218, v219
    v_cvt_pk_bf16_f32 v26, v220, v221
    v_cvt_pk_bf16_f32 v27, v222, v223
    v_cvt_pk_bf16_f32 v28, v224, v225
    v_cvt_pk_bf16_f32 v29, v226, v227
    v_cvt_pk_bf16_f32 v30, v228, v229
    v_cvt_pk_bf16_f32 v31, v230, v231
    v_permlane32_swap_b32 v24, v26
    v_permlane32_swap_b32 v25, v27
    v_permlane32_swap_b32 v28, v30
    v_permlane32_swap_b32 v29, v31
    buffer_store_dwordx4 v[24:27], v0, s[4:7], s33 offen sc1
    buffer_store_dwordx4 v[28:31], v0, s[4:7], s33 offen offset:1024 sc1
    s_waitcnt vmcnt(0)
    s_cmp_eq_u32 s34, 0
    s_cbranch_scc1 Lspmain_177_m
    s_lshl_b32 s20, s97, 2
    s_add_u32 s20, s20, s13
    s_lshl_b32 s98, s20, 2
    s_add_u32 s98, s98, 62069760
    v_mov_b32 v6, s90
    s_mov_b64 exec, 1
    buffer_store_dword v6, off, s[4:7], s98 offset:0 sc1
    s_mov_b64 exec, -1
    s_cmp_lt_u32 s97, 36
    s_cbranch_scc0 Ldone_main
    s_add_u32 s12, s97, 540
    s_branch Lout_main2
    s_endpgm
Lroleatt_58_m:
    s_cmp_lt_u32 s97, 120
    s_cbranch_scc1 Lisatt_202_m
    s_cmp_ge_u32 s97, 124
    s_cbranch_scc1 Lspare_203_m
    s_sub_u32 s12, s97, 88
    s_mov_b32 s87, 41
    s_branch Lwin_entry
Lspare_203_m:
    s_sub_u32 s12, s97, 64
    s_branch Lout_main
Lisatt_202_m:
    s_sub_u32 s12, s97, 96
    s_mov_b32 s91, 0
    s_lshl_b32 s14, s12, 2
    s_add_u32 s14, s14, s13
    s_and_b32 s15, s14, 31
    s_lshr_b32 s16, s14, 5
    s_mov_b32 s22, 0x3db504f3
    s_mov_b32 s23, 0x3fb8aa3b
    s_mov_b32 s52, -1
    s_mov_b32 s53, 0
    v_lshrrev_b32 v1, 4, v0
    v_and_b32 v2, 15, v1
    v_lshrrev_b32 v3, 4, v1
    v_lshl_add_u32 v4, v3, 2, 0
    v_cmp_le_u32 s[44:45], v4, v2
    v_lshl_add_u32 v4, v3, 2, 1
    v_cmp_le_u32 s[46:47], v4, v2
    v_lshl_add_u32 v4, v3, 2, 2
    v_cmp_le_u32 s[48:49], v4, v2
    v_lshl_add_u32 v4, v3, 2, 3
    v_cmp_le_u32 s[50:51], v4, v2
    s_lshl_b32 s19, s13, 12
    v_lshlrev_b32 v6, 8, v3
    v_and_b32 v4, 3, v1
    v_lshl_add_u32 v6, v4, 6, v6
    v_bfe_u32 v4, v1, 2, 2
    v_lshl_add_u32 v6, v4, 2, v6
    v_add_u32 v6, s19, v6
    v_add_u32 v7, 1024, v6
    v_bfe_u32 v4, v1, 2, 2
    v_lshl_add_u32 v8, v3, 3, v4
    v_lshlrev_b32 v8, 4, v8
    v_and_b32 v4, 1, v1
    v_lshl_add_u32 v8, v4, 3, v8
    v_add_u32 v8, s19, v8
    v_lshlrev_b32 v9, 4, v2
    v_and_b32 v4, 1, v3
    v_lshl_add_u32 v9, v4, 3, v9
    v_add_u32 v9, s19, v9
    v_lshrrev_b32 v10, 1, v3
    v_lshlrev_b32 v10, 9, v10
    v_lshl_add_u32 v10, v2, 4, v10
    v_lshl_add_u32 v10, v4, 3, v10
    v_mov_b32 v11, 0xce6e6b28
Latt_204_m:
    s_cmp_lt_u32 s16, s93
    s_cbranch_scc1 Lfwok_207_m
    s_mul_i32 s98, s16, 128
    s_add_u32 s98, s98, 61977600
Lfw_206_m:
    buffer_load_dwordx4 v[12:15], v0, s[4:7], s98 offen sc1
    s_waitcnt vmcnt(0)
    v_xor_b32 v12, s90, v12
    v_xor_b32 v13, s90, v13
    v_xor_b32 v14, s90, v14
    v_xor_b32 v15, s90, v15
    v_or3_b32 v12, v12, v13, v14
    v_or_b32 v12, v12, v15
    v_cmp_ne_u32 vcc, 0, v12
    s_nop 3
    s_and_b32 vcc_lo, vcc_lo, 0xffffffff
    s_and_b32 vcc_hi, vcc_hi, 0xffffffff
    s_ff1_i32_b64 s93, vcc
    s_cmp_eq_u32 s93, -1
    s_cselect_b32 s93, 64, s93
    s_lshr_b32 s93, s93, 3
    s_cmp_lg_u32 s93, 0
    s_cbranch_scc1 Lfwg_208_m
    s_sleep 2
    s_add_u32 s99, s99, 1
    s_cmp_lt_u32 s99, 4194304
    s_cbranch_scc1 Lfw_206_m
    s_endpgm
Lfwg_208_m:
    s_add_u32 s93, s93, s16
Lfwok_207_m:
    s_cmp_lt_u32 s16, s91
    s_cbranch_scc1 Lfwok_210_m
    s_mul_i32 s98, s16, 256
    s_add_u32 s98, s98, 61959168
Lfw_209_m:
    buffer_load_dwordx4 v[12:15], v0, s[4:7], s98 offen sc1
    s_waitcnt vmcnt(0)
    v_xor_b32 v12, s90, v12
    v_xor_b32 v13, s90, v13
    v_xor_b32 v14, s90, v14
    v_xor_b32 v15, s90, v15
    v_or3_b32 v12, v12, v13, v14
    v_or_b32 v12, v12, v15
    v_cmp_ne_u32 vcc, 0, v12
    s_nop 3
    s_and_b32 vcc_lo, vcc_lo, 0xffffffff
    s_and_b32 vcc_hi, vcc_hi, 0xffffffff
    s_ff1_i32_b64 s91, vcc
    s_cmp_eq_u32 s91, -1
    s_cselect_b32 s91, 64, s91
    s_lshr_b32 s91, s91, 4
    s_cmp_lg_u32 s91, 0
    s_cbranch_scc1 Lfwg_211_m
    s_sleep 2
    s_add_u32 s99, s99, 1
    s_cmp_lt_u32 s99, 4194304
    s_cbranch_scc1 Lfw_209_m
    s_endpgm
Lfwg_211_m:
    s_add_u32 s91, s91, s16
Lfwok_210_m:
    s_lshl_b32 s17, s16, 5
    s_add_u32 s17, s17, s15
    s_lshl_b32 s18, s17, 13
    s_add_u32 s19, s18, 33554432
    s_add_u32 s20, s19, 4096
    buffer_load_dwordx4 v[16:19], v0, s[4:7], s19 offen offset:0 sc1
    buffer_load_dwordx4 v[20:23], v0, s[4:7], s19 offen offset:1024 sc1
    buffer_load_dwordx4 v[24:27], v0, s[4:7], s19 offen offset:2048 sc1
    buffer_load_dwordx4 v[28:31], v0, s[4:7], s19 offen offset:3072 sc1
    buffer_load_dwordx4 v[32:35], v0, s[4:7], s20 offen offset:0 sc1
    buffer_load_dwordx4 v[36:39], v0, s[4:7], s20 offen offset:1024 sc1
    buffer_load_dwordx4 v[40:43], v0, s[4:7], s20 offen offset:2048 sc1
    buffer_load_dwordx4 v[44:47], v0, s[4:7], s20 offen offset:3072 sc1
    s_add_u32 s19, s18, 0
    s_add_u32 s20, s19, 4096
    buffer_load_dwordx4 v[48:51], v0, s[4:7], s19 offen offset:0 sc1
    buffer_load_dwordx4 v[52:55], v0, s[4:7], s19 offen offset:1024 sc1
    buffer_load_dwordx4 v[56:59], v0, s[4:7], s19 offen offset:2048 sc1
    buffer_load_dwordx4 v[60:63], v0, s[4:7], s19 offen offset:3072 sc1
    buffer_load_dwordx4 v[64:67], v0, s[4:7], s20 offen offset:0 sc1
    buffer_load_dwordx4 v[68:71], v0, s[4:7], s20 offen offset:1024 sc1
    buffer_load_dwordx4 v[72:75], v0, s[4:7], s20 offen offset:2048 sc1
    buffer_load_dwordx4 v[76:79], v0, s[4:7], s20 offen offset:3072 sc1
    s_add_u32 s19, s18, 16777216
    s_add_u32 s20, s19, 4096
    buffer_load_dwordx4 v[80:83], v0, s[4:7], s19 offen offset:0 sc1
    buffer_load_dwordx4 v[84:87], v0, s[4:7], s19 offen offset:1024 sc1
    buffer_load_dwordx4 v[88:91], v0, s[4:7], s19 offen offset:2048 sc1
    buffer_load_dwordx4 v[92:95], v0, s[4:7], s19 offen offset:3072 sc1
    buffer_load_dwordx4 v[96:99], v0, s[4:7], s20 offen offset:0 sc1
    buffer_load_dwordx4 v[100:103], v0, s[4:7], s20 offen offset:1024 sc1
    buffer_load_dwordx4 v[104:107], v0, s[4:7], s20 offen offset:2048 sc1
    buffer_load_dwordx4 v[108:111], v0, s[4:7], s20 offen offset:3072 sc1
    s_mul_i32 s98, s16, 32
    s_add_u32 s98, s98, s15
    s_lshl_b32 s98, s98, 2
    s_add_u32 s98, s98, 61986816
Lf1_212:
    buffer_load_dword v12, off, s[4:7], s98 sc1
    s_waitcnt vmcnt(0)
    v_cmp_ne_u32 vcc, s90, v12
    s_cbranch_vccz Lf1ok_213
    s_sleep 2
    s_add_u32 s99, s99, 1
    s_cmp_lt_u32 s99, 4194304
    s_cbranch_scc1 Lf1_212
    s_endpgm
Lf1ok_213:
    s_lshl_b32 s19, s17, 11
    s_add_u32 s19, s19, 50331648
    s_add_u32 s20, s19, 4194304
    buffer_load_dwordx4 v[144:147], v0, s[4:7], s19 offen offset:0 sc1
    buffer_load_dwordx4 v[148:151], v0, s[4:7], s19 offen offset:1024 sc1
    buffer_load_dwordx4 v[152:155], v0, s[4:7], s20 offen offset:0 sc1
    buffer_load_dwordx4 v[156:159], v0, s[4:7], s20 offen offset:1024 sc1
    s_waitcnt vmcnt(12)
    v_mfma_f32_16x16x32_bf16 v[164:167], v[48:51], v[16:19], 0
    v_mfma_f32_16x16x32_bf16 v[164:167], v[52:55], v[20:23], v[164:167]
    v_mfma_f32_16x16x32_bf16 v[164:167], v[56:59], v[24:27], v[164:167]
    v_mfma_f32_16x16x32_bf16 v[164:167], v[60:63], v[28:31], v[164:167]
    v_mfma_f32_16x16x32_bf16 v[172:175], v[48:51], v[32:35], 0
    v_mfma_f32_16x16x32_bf16 v[172:175], v[52:55], v[36:39], v[172:175]
    v_mfma_f32_16x16x32_bf16 v[172:175], v[56:59], v[40:43], v[172:175]
    v_mfma_f32_16x16x32_bf16 v[172:175], v[60:63], v[44:47], v[172:175]
    v_mfma_f32_16x16x32_bf16 v[176:179], v[64:67], v[32:35], 0
    v_mfma_f32_16x16x32_bf16 v[176:179], v[68:71], v[36:39], v[176:179]
    v_mfma_f32_16x16x32_bf16 v[176:179], v[72:75], v[40:43], v[176:179]
    v_mfma_f32_16x16x32_bf16 v[176:179], v[76:79], v[44:47], v[176:179]
    s_waitcnt vmcnt(0)
    ds_write2_b32 v6, v144, v145 offset0:0 offset1:4
    ds_write2_b32 v6, v146, v147 offset0:8 offset1:12
    ds_write2_b32 v7, v148, v149 offset0:0 offset1:4
    ds_write2_b32 v7, v150, v151 offset0:8 offset1:12
    v_add_u32 v4, 2048, v6
    ds_write2_b32 v4, v152, v153 offset0:0 offset1:4
    ds_write2_b32 v4, v154, v155 offset0:8 offset1:12
    v_add_u32 v4, 2048, v7
    ds_write2_b32 v4, v156, v157 offset0:0 offset1:4
    ds_write2_b32 v4, v158, v159 offset0:8 offset1:12
    s_waitcnt lgkmcnt(0)
    ds_read_b64_tr_b16 v[112:113], v8 offset:0
    ds_read_b64_tr_b16 v[114:115], v8 offset:64
    ds_read_b64_tr_b16 v[116:117], v8 offset:512
    ds_read_b64_tr_b16 v[118:119], v8 offset:576
    ds_read_b64_tr_b16 v[120:121], v8 offset:1024
    ds_read_b64_tr_b16 v[122:123], v8 offset:1088
    ds_read_b64_tr_b16 v[124:125], v8 offset:1536
    ds_read_b64_tr_b16 v[126:127], v8 offset:1600
    ds_read_b64 v[128:129], v9 offset:2048
    ds_read_b64 v[130:131], v9 offset:2304
    ds_read_b64 v[132:133], v9 offset:2560
    ds_read_b64 v[134:135], v9 offset:2816
    ds_read_b64 v[136:137], v9 offset:3072
    ds_read_b64 v[138:139], v9 offset:3328
    ds_read_b64 v[140:141], v9 offset:3584
    ds_read_b64 v[142:143], v9 offset:3840
    s_waitcnt lgkmcnt(0)
    v_mfma_f32_16x16x32_bf16 v[160:163], v[112:115], v[16:19], 0
    v_mfma_f32_16x16x32_bf16 v[160:163], v[116:119], v[20:23], v[160:163]
    v_mfma_f32_16x16x32_bf16 v[160:163], v[120:123], v[24:27], v[160:163]
    v_mfma_f32_16x16x32_bf16 v[160:163], v[124:127], v[28:31], v[160:163]
    v_mfma_f32_16x16x32_bf16 v[168:171], v[112:115], v[32:35], 0
    v_mfma_f32_16x16x32_bf16 v[168:171], v[116:119], v[36:39], v[168:171]
    v_mfma_f32_16x16x32_bf16 v[168:171], v[120:123], v[40:43], v[168:171]
    v_mfma_f32_16x16x32_bf16 v[168:171], v[124:127], v[44:47], v[168:171]
    s_nop 3
    v_cvt_pk_bf16_f32 v4, v160, v161
    v_lshlrev_b32 v160, 16, v4
    v_and_b32 v161, 0xffff0000, v4
    v_mul_f32 v160, s22, v160
    v_mul_f32 v161, s22, v161
    v_cvt_pk_bf16_f32 v4, v160, v161
    v_lshlrev_b32 v160, 16, v4
    v_and_b32 v161, 0xffff0000, v4
    v_cvt_pk_bf16_f32 v4, v162, v163
    v_lshlrev_b32 v162, 16, v4
    v_and_b32 v163, 0xffff0000, v4
    v_mul_f32 v162, s22, v162
    v_mul_f32 v163, s22, v163
    v_cvt_pk_bf16_f32 v4, v162, v163
    v_lshlrev_b32 v162, 16, v4
    v_and_b32 v163, 0xffff0000, v4
    v_cndmask_b32 v160, v11, v160, s[52:53]
    v_cndmask_b32 v161, v11, v161, s[52:53]
    v_cndmask_b32 v162, v11, v162, s[52:53]
    v_cndmask_b32 v163, v11, v163, s[52:53]
    v_cvt_pk_bf16_f32 v4, v164, v165
    v_lshlrev_b32 v164, 16, v4
    v_and_b32 v165, 0xffff0000, v4
    v_mul_f32 v164, s22, v164
    v_mul_f32 v165, s22, v165
    v_cvt_pk_bf16_f32 v4, v164, v165
    v_lshlrev_b32 v164, 16, v4
    v_and_b32 v165, 0xffff0000, v4
    v_cvt_pk_bf16_f32 v4, v166, v167
    v_lshlrev_b32 v166, 16, v4
    v_and_b32 v167, 0xffff0000, v4
    v_mul_f32 v166, s22, v166
    v_mul_f32 v167, s22, v167
    v_cvt_pk_bf16_f32 v4, v166, v167
    v_lshlrev_b32 v166, 16, v4
    v_and_b32 v167, 0xffff0000, v4
    v_cndmask_b32 v164, v11, v164, s[44:45]
    v_cndmask_b32 v165, v11, v165, s[46:47]
    v_cndmask_b32 v166, v11, v166, s[48:49]
    v_cndmask_b32 v167, v11, v167, s[50:51]
    v_cvt_pk_bf16_f32 v4, v168, v169
    v_lshlrev_b32 v168, 16, v4
    v_and_b32 v169, 0xffff0000, v4
    v_mul_f32 v168, s22, v168
    v_mul_f32 v169, s22, v169
    v_cvt_pk_bf16_f32 v4, v168, v169
    v_lshlrev_b32 v168, 16, v4
    v_and_b32 v169, 0xffff0000, v4
    v_cvt_pk_bf16_f32 v4, v170, v171
    v_lshlrev_b32 v170, 16, v4
    v_and_b32 v171, 0xffff0000, v4
    v_mul_f32 v170, s22, v170
    v_mul_f32 v171, s22, v171
    v_cvt_pk_bf16_f32 v4, v170, v171
    v_lshlrev_b32 v170, 16, v4
    v_and_b32 v171, 0xffff0000, v4
    v_cndmask_b32 v168, v11, v168, s[52:53]
    v_cndmask_b32 v169, v11, v169, s[52:53]
    v_cndmask_b32 v170, v11, v170, s[52:53]
    v_cndmask_b32 v171, v11, v171, s[52:53]
    v_cvt_pk_bf16_f32 v4, v172, v173
    v_lshlrev_b32 v172, 16, v4
    v_and_b32 v173, 0xffff0000, v4
    v_mul_f32 v172, s22, v172
    v_mul_f32 v173, s22, v173
    v_cvt_pk_bf16_f32 v4, v172, v173
    v_lshlrev_b32 v172, 16, v4
    v_and_b32 v173, 0xffff0000, v4
    v_cvt_pk_bf16_f32 v4, v174, v175
    v_lshlrev_b32 v174, 16, v4
    v_and_b32 v175, 0xffff0000, v4
    v_mul_f32 v174, s22, v174
    v_mul_f32 v175, s22, v175
    v_cvt_pk_bf16_f32 v4, v174, v175
    v_lshlrev_b32 v174, 16, v4
    v_and_b32 v175, 0xffff0000, v4
    v_cvt_pk_bf16_f32 v4, v176, v177
    v_lshlrev_b32 v176, 16, v4
    v_and_b32 v177, 0xffff0000, v4
    v_mul_f32 v176, s22, v176
    v_mul_f32 v177, s22, v177
    v_cvt_pk_bf16_f32 v4, v176, v177
    v_lshlrev_b32 v176, 16, v4
    v_and_b32 v177, 0xffff0000, v4
    v_cvt_pk_bf16_f32 v4, v178, v179
    v_lshlrev_b32 v178, 16, v4
    v_and_b32 v179, 0xffff0000, v4
    v_mul_f32 v178, s22, v178
    v_mul_f32 v179, s22, v179
    v_cvt_pk_bf16_f32 v4, v178, v179
    v_lshlrev_b32 v178, 16, v4
    v_and_b32 v179, 0xffff0000, v4
    v_cndmask_b32 v176, v11, v176, s[44:45]
    v_cndmask_b32 v177, v11, v177, s[46:47]
    v_cndmask_b32 v178, v11, v178, s[48:49]
    v_cndmask_b32 v179, v11, v179, s[50:51]
    v_max3_f32 v232, v160, v161, v162
    v_max3_f32 v232, v232, v163, v164
    v_max3_f32 v232, v232, v165, v166
    v_max_f32 v232, v232, v167
    v_mov_b32 v233, v232
    s_nop 1
    v_permlane32_swap_b32 v232, v233
    v_max_f32 v232, v232, v233
    v_mov_b32 v233, v232
    s_nop 1
    v_permlane16_swap_b32 v232, v233
    v_max_f32 v232, v232, v233
    v_sub_f32 v160, v160, v232
    v_mul_f32 v160, s23, v160
    v_sub_f32 v161, v161, v232
    v_mul_f32 v161, s23, v161
    v_sub_f32 v162, v162, v232
    v_mul_f32 v162, s23, v162
    v_sub_f32 v163, v163, v232
    v_mul_f32 v163, s23, v163
    v_sub_f32 v164, v164, v232
    v_mul_f32 v164, s23, v164
    v_sub_f32 v165, v165, v232
    v_mul_f32 v165, s23, v165
    v_sub_f32 v166, v166, v232
    v_mul_f32 v166, s23, v166
    v_sub_f32 v167, v167, v232
    v_mul_f32 v167, s23, v167
    v_exp_f32 v160, v160
    v_exp_f32 v161, v161
    v_exp_f32 v162, v162
    v_exp_f32 v163, v163
    v_exp_f32 v164, v164
    v_exp_f32 v165, v165
    v_exp_f32 v166, v166
    v_exp_f32 v167, v167
    v_add_f32 v234, v160, v161
    v_add_f32 v234, v234, v162
    v_add_f32 v234, v234, v163
    v_add_f32 v234, v234, v164
    v_add_f32 v234, v234, v165
    v_add_f32 v234, v234, v166
    v_add_f32 v234, v234, v167
    v_mov_b32 v233, v234
    s_nop 1
    v_permlane32_swap_b32 v234, v233
    v_add_f32 v234, v234, v233
    v_mov_b32 v233, v234
    s_nop 1
    v_permlane16_swap_b32 v234, v233
    v_add_f32 v234, v234, v233
    v_rcp_f32 v234, v234
    s_nop 0
    v_mul_f32 v160, v160, v234
    v_mul_f32 v161, v161, v234
    v_mul_f32 v162, v162, v234
    v_mul_f32 v163, v163, v234
    v_mul_f32 v164, v164, v234
    v_mul_f32 v165, v165, v234
    v_mul_f32 v166, v166, v234
    v_mul_f32 v167, v167, v234
    v_cvt_pk_bf16_f32 v184, v164, v165
    v_cvt_pk_bf16_f32 v185, v166, v167
    v_mov_b32 v186, 0
    v_mov_b32 v187, 0
    v_cvt_pk_bf16_f32 v192, v160, v161
    v_cvt_pk_bf16_f32 v193, v162, v163
    v_max3_f32 v232, v168, v169, v170
    v_max3_f32 v232, v232, v171, v172
    v_max3_f32 v232, v232, v173, v174
    v_max3_f32 v232, v232, v175, v176
    v_max3_f32 v232, v232, v177, v178
    v_max_f32 v232, v232, v179
    v_mov_b32 v233, v232
    s_nop 1
    v_permlane32_swap_b32 v232, v233
    v_max_f32 v232, v232, v233
    v_mov_b32 v233, v232
    s_nop 1
    v_permlane16_swap_b32 v232, v233
    v_max_f32 v232, v232, v233
    v_sub_f32 v168, v168, v232
    v_mul_f32 v168, s23, v168
    v_sub_f32 v169, v169, v232
    v_mul_f32 v169, s23, v169
    v_sub_f32 v170, v170, v232
    v_mul_f32 v170, s23, v170
    v_sub_f32 v171, v171, v232
    v_mul_f32 v171, s23, v171
    v_sub_f32 v172, v172, v232
    v_mul_f32 v172, s23, v172
    v_sub_f32 v173, v173, v232
    v_mul_f32 v173, s23, v173
    v_sub_f32 v174, v174, v232
    v_mul_f32 v174, s23, v174
    v_sub_f32 v175, v175, v232
    v_mul_f32 v175, s23, v175
    v_sub_f32 v176, v176, v232
    v_mul_f32 v176, s23, v176
    v_sub_f32 v177, v177, v232
    v_mul_f32 v177, s23, v177
    v_sub_f32 v178, v178, v232
    v_mul_f32 v178, s23, v178
    v_sub_f32 v179, v179, v232
    v_mul_f32 v179, s23, v179
    v_exp_f32 v168, v168
    v_exp_f32 v169, v169
    v_exp_f32 v170, v170
    v_exp_f32 v171, v171
    v_exp_f32 v172, v172
    v_exp_f32 v173, v173
    v_exp_f32 v174, v174
    v_exp_f32 v175, v175
    v_exp_f32 v176, v176
    v_exp_f32 v177, v177
    v_exp_f32 v178, v178
    v_exp_f32 v179, v179
    v_add_f32 v234, v168, v169
    v_add_f32 v234, v234, v170
    v_add_f32 v234, v234, v171
    v_add_f32 v234, v234, v172
    v_add_f32 v234, v234, v173
    v_add_f32 v234, v234, v174
    v_add_f32 v234, v234, v175
    v_add_f32 v234, v234, v176
    v_add_f32 v234, v234, v177
    v_add_f32 v234, v234, v178
    v_add_f32 v234, v234, v179
    v_mov_b32 v233, v234
    s_nop 1
    v_permlane32_swap_b32 v234, v233
    v_add_f32 v234, v234, v233
    v_mov_b32 v233, v234
    s_nop 1
    v_permlane16_swap_b32 v234, v233
    v_add_f32 v234, v234, v233
    v_rcp_f32 v234, v234
    s_nop 0
    v_mul_f32 v168, v168, v234
    v_mul_f32 v169, v169, v234
    v_mul_f32 v170, v170, v234
    v_mul_f32 v171, v171, v234
    v_mul_f32 v172, v172, v234
    v_mul_f32 v173, v173, v234
    v_mul_f32 v174, v174, v234
    v_mul_f32 v175, v175, v234
    v_mul_f32 v176, v176, v234
    v_mul_f32 v177, v177, v234
    v_mul_f32 v178, v178, v234
    v_mul_f32 v179, v179, v234
    v_cvt_pk_bf16_f32 v188, v172, v173
    v_cvt_pk_bf16_f32 v189, v174, v175
    v_cvt_pk_bf16_f32 v190, v176, v177
    v_cvt_pk_bf16_f32 v191, v178, v179
    v_cvt_pk_bf16_f32 v194, v168, v169
    v_cvt_pk_bf16_f32 v195, v170, v171
    s_lshl_b32 s18, s16, 18
    s_lshl_b32 s19, s15, 13
    s_add_u32 s18, s18, s19
    s_add_u32 s18, s18, 73400320
    s_add_u32 s19, s18, 4096
    v_mfma_f32_16x16x32_bf16 v[200:203], v[80:83], v[184:187], 0
    v_mfma_f32_16x16x32_bf16 v[204:207], v[84:87], v[184:187], 0
    v_mfma_f32_16x16x32_bf16 v[208:211], v[88:91], v[184:187], 0
    v_mfma_f32_16x16x32_bf16 v[212:215], v[92:95], v[184:187], 0
    v_mfma_f32_16x16x32_bf16 v[216:219], v[96:99], v[184:187], 0
    v_mfma_f32_16x16x32_bf16 v[220:223], v[100:103], v[184:187], 0
    v_mfma_f32_16x16x32_bf16 v[224:227], v[104:107], v[184:187], 0
    v_mfma_f32_16x16x32_bf16 v[228:231], v[108:111], v[184:187], 0
    v_mfma_f32_16x16x16_bf16 v[200:203], v[128:129], v[192:193], v[200:203]
    v_mfma_f32_16x16x16_bf16 v[204:207], v[130:131], v[192:193], v[204:207]
    v_mfma_f32_16x16x16_bf16 v[208:211], v[132:133], v[192:193], v[208:211]
    v_mfma_f32_16x16x16_bf16 v[212:215], v[134:135], v[192:193], v[212:215]
    v_mfma_f32_16x16x16_bf16 v[216:219], v[136:137], v[192:193], v[216:219]
    v_mfma_f32_16x16x16_bf16 v[220:223], v[138:139], v[192:193], v[220:223]
    v_mfma_f32_16x16x16_bf16 v[224:227], v[140:141], v[192:193], v[224:227]
    v_mfma_f32_16x16x16_bf16 v[228:231], v[142:143], v[192:193], v[228:231]
    s_nop 0
    v_cvt_pk_bf16_f32 v200, v200, v201
    v_cvt_pk_bf16_f32 v201, v202, v203
    buffer_store_dwordx2 v[200:201], v10, s[4:7], s18 offen offset:0 sc1
    v_cvt_pk_bf16_f32 v204, v204, v205
    v_cvt_pk_bf16_f32 v205, v206, v207
    buffer_store_dwordx2 v[204:205], v10, s[4:7], s18 offen offset:1024 sc1
    v_cvt_pk_bf16_f32 v208, v208, v209
    v_cvt_pk_bf16_f32 v209, v210, v211
    buffer_store_dwordx2 v[208:209], v10, s[4:7], s18 offen offset:2048 sc1
    v_cvt_pk_bf16_f32 v212, v212, v213
    v_cvt_pk_bf16_f32 v213, v214, v215
    buffer_store_dwordx2 v[212:213], v10, s[4:7], s18 offen offset:3072 sc1
    v_cvt_pk_bf16_f32 v216, v216, v217
    v_cvt_pk_bf16_f32 v217, v218, v219
    buffer_store_dwordx2 v[216:217], v10, s[4:7], s19 offen offset:0 sc1
    v_cvt_pk_bf16_f32 v220, v220, v221
    v_cvt_pk_bf16_f32 v221, v222, v223
    buffer_store_dwordx2 v[220:221], v10, s[4:7], s19 offen offset:1024 sc1
    v_cvt_pk_bf16_f32 v224, v224, v225
    v_cvt_pk_bf16_f32 v225, v226, v227
    buffer_store_dwordx2 v[224:225], v10, s[4:7], s19 offen offset:2048 sc1
    v_cvt_pk_bf16_f32 v228, v228, v229
    v_cvt_pk_bf16_f32 v229, v230, v231
    buffer_store_dwordx2 v[228:229], v10, s[4:7], s19 offen offset:3072 sc1
    v_mfma_f32_16x16x32_bf16 v[200:203], v[80:83], v[188:191], 0
    v_mfma_f32_16x16x32_bf16 v[204:207], v[84:87], v[188:191], 0
    v_mfma_f32_16x16x32_bf16 v[208:211], v[88:91], v[188:191], 0
    v_mfma_f32_16x16x32_bf16 v[212:215], v[92:95], v[188:191], 0
    v_mfma_f32_16x16x32_bf16 v[216:219], v[96:99], v[188:191], 0
    v_mfma_f32_16x16x32_bf16 v[220:223], v[100:103], v[188:191], 0
    v_mfma_f32_16x16x32_bf16 v[224:227], v[104:107], v[188:191], 0
    v_mfma_f32_16x16x32_bf16 v[228:231], v[108:111], v[188:191], 0
    v_mfma_f32_16x16x16_bf16 v[200:203], v[128:129], v[194:195], v[200:203]
    v_mfma_f32_16x16x16_bf16 v[204:207], v[130:131], v[194:195], v[204:207]
    v_mfma_f32_16x16x16_bf16 v[208:211], v[132:133], v[194:195], v[208:211]
    v_mfma_f32_16x16x16_bf16 v[212:215], v[134:135], v[194:195], v[212:215]
    v_mfma_f32_16x16x16_bf16 v[216:219], v[136:137], v[194:195], v[216:219]
    v_mfma_f32_16x16x16_bf16 v[220:223], v[138:139], v[194:195], v[220:223]
    v_mfma_f32_16x16x16_bf16 v[224:227], v[140:141], v[194:195], v[224:227]
    v_mfma_f32_16x16x16_bf16 v[228:231], v[142:143], v[194:195], v[228:231]
    s_nop 0
    v_cvt_pk_bf16_f32 v200, v200, v201
    v_cvt_pk_bf16_f32 v201, v202, v203
    buffer_store_dwordx2 v[200:201], v10, s[4:7], s18 offen offset:256 sc1
    v_cvt_pk_bf16_f32 v204, v204, v205
    v_cvt_pk_bf16_f32 v205, v206, v207
    buffer_store_dwordx2 v[204:205], v10, s[4:7], s18 offen offset:1280 sc1
    v_cvt_pk_bf16_f32 v208, v208, v209
    v_cvt_pk_bf16_f32 v209, v210, v211
    buffer_store_dwordx2 v[208:209], v10, s[4:7], s18 offen offset:2304 sc1
    v_cvt_pk_bf16_f32 v212, v212, v213
    v_cvt_pk_bf16_f32 v213, v214, v215
    buffer_store_dwordx2 v[212:213], v10, s[4:7], s18 offen offset:3328 sc1
    v_cvt_pk_bf16_f32 v216, v216, v217
    v_cvt_pk_bf16_f32 v217, v218, v219
    buffer_store_dwordx2 v[216:217], v10, s[4:7], s19 offen offset:256 sc1
    v_cvt_pk_bf16_f32 v220, v220, v221
    v_cvt_pk_bf16_f32 v221, v222, v223
    buffer_store_dwordx2 v[220:221], v10, s[4:7], s19 offen offset:1280 sc1
    v_cvt_pk_bf16_f32 v224, v224, v225
    v_cvt_pk_bf16_f32 v225, v226, v227
    buffer_store_dwordx2 v[224:225], v10, s[4:7], s19 offen offset:2304 sc1
    v_cvt_pk_bf16_f32 v228, v228, v229
    v_cvt_pk_bf16_f32 v229, v230, v231
    buffer_store_dwordx2 v[228:229], v10, s[4:7], s19 offen offset:3328 sc1
    s_waitcnt vmcnt(0)
    s_mul_i32 s98, s16, 32
    s_add_u32 s98, s98, s15
    s_lshl_b32 s98, s98, 2
    s_add_u32 s98, s98, 61996032
    v_mov_b32 v12, s90
    s_mov_b64 exec, 1
    buffer_store_dword v12, off, s[4:7], s98 offset:0 sc1
    s_mov_b64 exec, -1
    s_add_u32 s16, s16, 3
    s_cmp_lt_u32 s16, 64
    s_cbranch_scc1 Latt_204_m
Latte_205_m:
    s_sub_u32 s12, s97, 64
    s_branch Lout_main
Lrolewo_59_m:
    s_sub_u32 s12, s97, 128
    s_mul_i32 s14, s12, 7282
    s_lshr_b32 s14, s14, 16
    s_mul_i32 s19, s14, 9
    s_sub_u32 s15, s12, s19
    s_lshl_b32 s16, s14, 6
    s_mov_b32 s17, 0
    s_mov_b32 s18, 64
    v_lshrrev_b32 v1, 4, v0
    v_lshrrev_b32 v2, 4, v1
    v_mul_u32_u24 v8, 2304, v2
    v_and_b32 v2, 0xf0, v0
    v_add_u32 v8, v8, v2
    s_load_dwordx2 s[8:9], s[42:43], 40
    s_waitcnt lgkmcnt(0)
    s_mov_b32 s10, 4718592
    s_mov_b32 s11, 0x20000
    v_lshrrev_b32 v1, 4, v0
    v_lshrrev_b32 v2, 3, v1
    v_mul_u32_u24 v3, 1152, v2
    v_and_b32 v2, 7, v1
    v_lshl_add_u32 v3, v2, 4, v3
    v_lshrrev_b32 v4, 5, v1
    v_lshlrev_b32 v4, 3, v4
    v_bfe_u32 v2, v1, 2, 2
    v_add_u32 v4, v4, v2
    v_lshlrev_b32 v4, 7, v4
    v_bfe_u32 v2, v1, 4, 1
    v_lshl_add_u32 v4, v2, 5, v4
    v_and_b32 v2, 3, v1
    v_lshl_add_u32 v4, v2, 3, v4
    s_lshl_b32 s21, s13, 15
    v_add_u32 v4, s21, v4
    s_mul_i32 s19, s13, 16
    s_add_u32 s19, s19, s16
    s_add_u32 s19, s19, 0
    s_mul_i32 s19, s19, 18432
    s_lshl_b32 s20, s15, 7
    s_add_u32 s19, s19, s20
    s_mov_b32 s20, s21
    s_mov_b32 s26, 32
Ldmk_214_m:
    s_mov_b32 m0, s20
    s_nop 0
    buffer_load_dwordx4 v3, s[8:11], s19 offen lds
    s_add_u32 s19, s19, 9216
    s_add_u32 s20, s20, 1024
    s_sub_u32 s26, s26, 1
    s_cmp_lg_u32 s26, 0
    s_cbranch_scc1 Ldmk_214_m
    s_waitcnt vmcnt(0)
    ds_read_b64_tr_b16 a[0:1], v4 offset:0
    ds_read_b64_tr_b16 a[2:3], v4 offset:512
    ds_read_b64_tr_b16 a[4:5], v4 offset:64
    ds_read_b64_tr_b16 a[6:7], v4 offset:576
    ds_read_b64_tr_b16 a[8:9], v4 offset:2048
    ds_read_b64_tr_b16 a[10:11], v4 offset:2560
    ds_read_b64_tr_b16 a[12:13], v4 offset:2112
    ds_read_b64_tr_b16 a[14:15], v4 offset:2624
    s_waitcnt lgkmcnt(4)
    ds_read_b64_tr_b16 a[16:17], v4 offset:4096
    ds_read_b64_tr_b16 a[18:19], v4 offset:4608
    ds_read_b64_tr_b16 a[20:21], v4 offset:4160
    ds_read_b64_tr_b16 a[22:23], v4 offset:4672
    ds_read_b64_tr_b16 a[24:25], v4 offset:6144
    ds_read_b64_tr_b16 a[26:27], v4 offset:6656
    ds_read_b64_tr_b16 a[28:29], v4 offset:6208
    ds_read_b64_tr_b16 a[30:31], v4 offset:6720
    s_waitcnt lgkmcnt(4)
    ds_read_b64_tr_b16 a[32:33], v4 offset:8192
    ds_read_b64_tr_b16 a[34:35], v4 offset:8704
    ds_read_b64_tr_b16 a[36:37], v4 offset:8256
    ds_read_b64_tr_b16 a[38:39], v4 offset:8768
    ds_read_b64_tr_b16 a[40:41], v4 offset:10240
    ds_read_b64_tr_b16 a[42:43], v4 offset:10752
    ds_read_b64_tr_b16 a[44:45], v4 offset:10304
    ds_read_b64_tr_b16 a[46:47], v4 offset:10816
    s_waitcnt lgkmcnt(4)
    ds_read_b64_tr_b16 a[48:49], v4 offset:12288
    ds_read_b64_tr_b16 a[50:51], v4 offset:12800
    ds_read_b64_tr_b16 a[52:53], v4 offset:12352
    ds_read_b64_tr_b16 a[54:55], v4 offset:12864
    ds_read_b64_tr_b16 a[56:57], v4 offset:14336
    ds_read_b64_tr_b16 a[58:59], v4 offset:14848
    ds_read_b64_tr_b16 a[60:61], v4 offset:14400
    ds_read_b64_tr_b16 a[62:63], v4 offset:14912
    s_waitcnt lgkmcnt(4)
    ds_read_b64_tr_b16 a[64:65], v4 offset:16384
    ds_read_b64_tr_b16 a[66:67], v4 offset:16896
    ds_read_b64_tr_b16 a[68:69], v4 offset:16448
    ds_read_b64_tr_b16 a[70:71], v4 offset:16960
    ds_read_b64_tr_b16 a[72:73], v4 offset:18432
    ds_read_b64_tr_b16 a[74:75], v4 offset:18944
    ds_read_b64_tr_b16 a[76:77], v4 offset:18496
    ds_read_b64_tr_b16 a[78:79], v4 offset:19008
    s_waitcnt lgkmcnt(4)
    ds_read_b64_tr_b16 a[80:81], v4 offset:20480
    ds_read_b64_tr_b16 a[82:83], v4 offset:20992
    ds_read_b64_tr_b16 a[84:85], v4 offset:20544
    ds_read_b64_tr_b16 a[86:87], v4 offset:21056
    ds_read_b64_tr_b16 a[88:89], v4 offset:22528
    ds_read_b64_tr_b16 a[90:91], v4 offset:23040
    ds_read_b64_tr_b16 a[92:93], v4 offset:22592
    ds_read_b64_tr_b16 a[94:95], v4 offset:23104
    s_waitcnt lgkmcnt(4)
    ds_read_b64_tr_b16 a[96:97], v4 offset:24576
    ds_read_b64_tr_b16 a[98:99], v4 offset:25088
    ds_read_b64_tr_b16 a[100:101], v4 offset:24640
    ds_read_b64_tr_b16 a[102:103], v4 offset:25152
    ds_read_b64_tr_b16 a[104:105], v4 offset:26624
    ds_read_b64_tr_b16 a[106:107], v4 offset:27136
    ds_read_b64_tr_b16 a[108:109], v4 offset:26688
    ds_read_b64_tr_b16 a[110:111], v4 offset:27200
    s_waitcnt lgkmcnt(4)
    ds_read_b64_tr_b16 a[112:113], v4 offset:28672
    ds_read_b64_tr_b16 a[114:115], v4 offset:29184
    ds_read_b64_tr_b16 a[116:117], v4 offset:28736
    ds_read_b64_tr_b16 a[118:119], v4 offset:29248
    ds_read_b64_tr_b16 a[120:121], v4 offset:30720
    ds_read_b64_tr_b16 a[122:123], v4 offset:31232
    ds_read_b64_tr_b16 a[124:125], v4 offset:30784
    ds_read_b64_tr_b16 a[126:127], v4 offset:31296
    s_waitcnt lgkmcnt(4)
    s_waitcnt lgkmcnt(0)
    s_barrier
    s_mul_i32 s19, s13, 8704
    v_add_u32 v5, s19, v0
    v_bfe_u32 v2, v1, 1, 3
    v_mul_u32_u24 v6, 1088, v2
    v_and_b32 v2, 1, v1
    v_lshl_add_u32 v6, v2, 9, v6
    v_lshrrev_b32 v2, 4, v1
    v_lshl_add_u32 v6, v2, 4, v6
    s_lshl_b32 s19, s13, 7
    v_add_u32 v6, s19, v6
    s_mov_b32 s30, -1
    s_cmp_lg_u32 s13, 0
    s_cbranch_scc1 Lur_217_m
    s_cmp_lt_u32 s17, s92
    s_cbranch_scc1 Lfwok_219_m
    s_mul_i32 s98, s17, 128
    s_add_u32 s98, s98, 61996032
Lfw_218_m:
    buffer_load_dwordx4 v[10:13], v0, s[4:7], s98 offen sc1
    s_waitcnt vmcnt(0)
    v_xor_b32 v10, s90, v10
    v_xor_b32 v11, s90, v11
    v_xor_b32 v12, s90, v12
    v_xor_b32 v13, s90, v13
    v_or3_b32 v10, v10, v11, v12
    v_or_b32 v10, v10, v13
    v_cmp_ne_u32 vcc, 0, v10
    s_nop 3
    s_and_b32 vcc_lo, vcc_lo, 0xffffffff
    s_and_b32 vcc_hi, vcc_hi, 0xffffffff
    s_ff1_i32_b64 s92, vcc
    s_cmp_eq_u32 s92, -1
    s_cselect_b32 s92, 64, s92
    s_lshr_b32 s92, s92, 3
    s_cmp_lg_u32 s92, 0
    s_cbranch_scc1 Lfwg_220_m
    s_sleep 2
    s_add_u32 s99, s99, 1
    s_cmp_lt_u32 s99, 4194304
    s_cbranch_scc1 Lfw_218_m
    s_endpgm
Lfwg_220_m:
    s_add_u32 s92, s92, s17
Lfwok_219_m:
    v_mov_b32 v10, 163832
    v_mov_b32 v11, s92
    ds_write_b32 v10, v11
    s_waitcnt lgkmcnt(0)
Lur_217_m:
    s_barrier
    v_mov_b32 v10, 163832
    ds_read_b32 v11, v10
    s_waitcnt lgkmcnt(0)
    v_readfirstlane_b32 s92, v11
    s_mul_i32 s27, s17, 262144
    s_mul_i32 s19, s13, 16
    s_add_u32 s19, s19, s16
    s_lshl_b32 s19, s19, 10
    s_add_u32 s27, s27, s19
    s_add_u32 s27, s27, 73400320
    buffer_load_dwordx4 v[48:51], v0, s[4:7], s27 offen offset:0 sc1
    buffer_load_dwordx4 v[52:55], v0, s[4:7], s27 offen offset:1024 sc1
    buffer_load_dwordx4 v[56:59], v0, s[4:7], s27 offen offset:2048 sc1
    buffer_load_dwordx4 v[60:63], v0, s[4:7], s27 offen offset:3072 sc1
    s_add_u32 s27, s27, 4096
    buffer_load_dwordx4 v[64:67], v0, s[4:7], s27 offen offset:0 sc1
    buffer_load_dwordx4 v[68:71], v0, s[4:7], s27 offen offset:1024 sc1
    buffer_load_dwordx4 v[72:75], v0, s[4:7], s27 offen offset:2048 sc1
    buffer_load_dwordx4 v[76:79], v0, s[4:7], s27 offen offset:3072 sc1
    s_add_u32 s27, s27, 4096
    buffer_load_dwordx4 v[80:83], v0, s[4:7], s27 offen offset:0 sc1
    buffer_load_dwordx4 v[84:87], v0, s[4:7], s27 offen offset:1024 sc1
    buffer_load_dwordx4 v[88:91], v0, s[4:7], s27 offen offset:2048 sc1
    buffer_load_dwordx4 v[92:95], v0, s[4:7], s27 offen offset:3072 sc1
    s_add_u32 s27, s27, 4096
    buffer_load_dwordx4 v[96:99], v0, s[4:7], s27 offen offset:0 sc1
    buffer_load_dwordx4 v[100:103], v0, s[4:7], s27 offen offset:1024 sc1
    buffer_load_dwordx4 v[104:107], v0, s[4:7], s27 offen offset:2048 sc1
    buffer_load_dwordx4 v[108:111], v0, s[4:7], s27 offen offset:3072 sc1
Lks_215_m:
    s_mov_b32 s28, s17
    s_add_u32 s17, s17, 1
    s_mov_b32 s29, 0
    s_cmp_ge_u32 s17, s18
    s_cbranch_scc1 Lksn_221_m
    s_cmp_lt_u32 s17, s92
    s_cbranch_scc0 Lksn_221_m
    s_mul_i32 s27, s17, 262144
    s_mul_i32 s19, s13, 16
    s_add_u32 s19, s19, s16
    s_lshl_b32 s19, s19, 10
    s_add_u32 s27, s27, s19
    s_add_u32 s27, s27, 73400320
    buffer_load_dwordx4 v[112:115], v0, s[4:7], s27 offen offset:0 sc1
    buffer_load_dwordx4 v[116:119], v0, s[4:7], s27 offen offset:1024 sc1
    buffer_load_dwordx4 v[120:123], v0, s[4:7], s27 offen offset:2048 sc1
    buffer_load_dwordx4 v[124:127], v0, s[4:7], s27 offen offset:3072 sc1
    s_add_u32 s27, s27, 4096
    buffer_load_dwordx4 v[128:131], v0, s[4:7], s27 offen offset:0 sc1
    buffer_load_dwordx4 v[132:135], v0, s[4:7], s27 offen offset:1024 sc1
    buffer_load_dwordx4 v[136:139], v0, s[4:7], s27 offen offset:2048 sc1
    buffer_load_dwordx4 v[140:143], v0, s[4:7], s27 offen offset:3072 sc1
    s_add_u32 s27, s27, 4096
    buffer_load_dwordx4 v[144:147], v0, s[4:7], s27 offen offset:0 sc1
    buffer_load_dwordx4 v[148:151], v0, s[4:7], s27 offen offset:1024 sc1
    buffer_load_dwordx4 v[152:155], v0, s[4:7], s27 offen offset:2048 sc1
    buffer_load_dwordx4 v[156:159], v0, s[4:7], s27 offen offset:3072 sc1
    s_add_u32 s27, s27, 4096
    buffer_load_dwordx4 v[160:163], v0, s[4:7], s27 offen offset:0 sc1
    buffer_load_dwordx4 v[164:167], v0, s[4:7], s27 offen offset:1024 sc1
    buffer_load_dwordx4 v[168:171], v0, s[4:7], s27 offen offset:2048 sc1
    buffer_load_dwordx4 v[172:175], v0, s[4:7], s27 offen offset:3072 sc1
    s_mov_b32 s29, 1
    s_cmp_eq_u32 s30, -1
    s_cbranch_scc1 Lksy_224_m
    s_waitcnt vmcnt(18)
    s_branch Lksg_222_m
Lksy_224_m:
    s_waitcnt vmcnt(16)
    s_branch Lksg_222_m
Lksn_221_m:
    s_waitcnt vmcnt(15)
    v_mfma_f32_32x32x16_bf16 v[16:31], a[0:3], v[48:51], 0
    v_mfma_f32_32x32x16_bf16 v[32:47], a[4:7], v[48:51], 0
    s_waitcnt vmcnt(14)
    v_mfma_f32_32x32x16_bf16 v[16:31], a[8:11], v[52:55], v[16:31]
    v_mfma_f32_32x32x16_bf16 v[32:47], a[12:15], v[52:55], v[32:47]
    s_waitcnt vmcnt(13)
    v_mfma_f32_32x32x16_bf16 v[16:31], a[16:19], v[56:59], v[16:31]
    v_mfma_f32_32x32x16_bf16 v[32:47], a[20:23], v[56:59], v[32:47]
    s_waitcnt vmcnt(12)
    v_mfma_f32_32x32x16_bf16 v[16:31], a[24:27], v[60:63], v[16:31]
    v_mfma_f32_32x32x16_bf16 v[32:47], a[28:31], v[60:63], v[32:47]
    s_waitcnt vmcnt(11)
    v_mfma_f32_32x32x16_bf16 v[16:31], a[32:35], v[64:67], v[16:31]
    v_mfma_f32_32x32x16_bf16 v[32:47], a[36:39], v[64:67], v[32:47]
    s_waitcnt vmcnt(10)
    v_mfma_f32_32x32x16_bf16 v[16:31], a[40:43], v[68:71], v[16:31]
    v_mfma_f32_32x32x16_bf16 v[32:47], a[44:47], v[68:71], v[32:47]
    s_waitcnt vmcnt(9)
    v_mfma_f32_32x32x16_bf16 v[16:31], a[48:51], v[72:75], v[16:31]
    v_mfma_f32_32x32x16_bf16 v[32:47], a[52:55], v[72:75], v[32:47]
    s_waitcnt vmcnt(8)
    v_mfma_f32_32x32x16_bf16 v[16:31], a[56:59], v[76:79], v[16:31]
    v_mfma_f32_32x32x16_bf16 v[32:47], a[60:63], v[76:79], v[32:47]
    s_waitcnt vmcnt(7)
    v_mfma_f32_32x32x16_bf16 v[16:31], a[64:67], v[80:83], v[16:31]
    v_mfma_f32_32x32x16_bf16 v[32:47], a[68:71], v[80:83], v[32:47]
    s_waitcnt vmcnt(6)
    v_mfma_f32_32x32x16_bf16 v[16:31], a[72:75], v[84:87], v[16:31]
    v_mfma_f32_32x32x16_bf16 v[32:47], a[76:79], v[84:87], v[32:47]
    s_waitcnt vmcnt(5)
    v_mfma_f32_32x32x16_bf16 v[16:31], a[80:83], v[88:91], v[16:31]
    v_mfma_f32_32x32x16_bf16 v[32:47], a[84:87], v[88:91], v[32:47]
    s_waitcnt vmcnt(4)
    v_mfma_f32_32x32x16_bf16 v[16:31], a[88:91], v[92:95], v[16:31]
    v_mfma_f32_32x32x16_bf16 v[32:47], a[92:95], v[92:95], v[32:47]
    s_waitcnt vmcnt(3)
    v_mfma_f32_32x32x16_bf16 v[16:31], a[96:99], v[96:99], v[16:31]
    v_mfma_f32_32x32x16_bf16 v[32:47], a[100:103], v[96:99], v[32:47]
    s_waitcnt vmcnt(2)
    v_mfma_f32_32x32x16_bf16 v[16:31], a[104:107], v[100:103], v[16:31]
    v_mfma_f32_32x32x16_bf16 v[32:47], a[108:111], v[100:103], v[32:47]
    s_waitcnt vmcnt(1)
    v_mfma_f32_32x32x16_bf16 v[16:31], a[112:115], v[104:107], v[16:31]
    v_mfma_f32_32x32x16_bf16 v[32:47], a[116:119], v[104:107], v[32:47]
    s_waitcnt vmcnt(0)
    v_mfma_f32_32x32x16_bf16 v[16:31], a[120:123], v[108:111], v[16:31]
    v_mfma_f32_32x32x16_bf16 v[32:47], a[124:127], v[108:111], v[32:47]
    s_branch Lksd_223_m
Lksg_222_m:
    s_nop 7
    v_mfma_f32_32x32x16_bf16 v[16:31], a[0:3], v[48:51], 0
    v_mfma_f32_32x32x16_bf16 v[32:47], a[4:7], v[48:51], 0
    v_mfma_f32_32x32x16_bf16 v[16:31], a[8:11], v[52:55], v[16:31]
    v_mfma_f32_32x32x16_bf16 v[32:47], a[12:15], v[52:55], v[32:47]
    v_mfma_f32_32x32x16_bf16 v[16:31], a[16:19], v[56:59], v[16:31]
    v_mfma_f32_32x32x16_bf16 v[32:47], a[20:23], v[56:59], v[32:47]
    v_mfma_f32_32x32x16_bf16 v[16:31], a[24:27], v[60:63], v[16:31]
    v_mfma_f32_32x32x16_bf16 v[32:47], a[28:31], v[60:63], v[32:47]
    v_mfma_f32_32x32x16_bf16 v[16:31], a[32:35], v[64:67], v[16:31]
    v_mfma_f32_32x32x16_bf16 v[32:47], a[36:39], v[64:67], v[32:47]
    v_mfma_f32_32x32x16_bf16 v[16:31], a[40:43], v[68:71], v[16:31]
    v_mfma_f32_32x32x16_bf16 v[32:47], a[44:47], v[68:71], v[32:47]
    v_mfma_f32_32x32x16_bf16 v[16:31], a[48:51], v[72:75], v[16:31]
    v_mfma_f32_32x32x16_bf16 v[32:47], a[52:55], v[72:75], v[32:47]
    v_mfma_f32_32x32x16_bf16 v[16:31], a[56:59], v[76:79], v[16:31]
    v_mfma_f32_32x32x16_bf16 v[32:47], a[60:63], v[76:79], v[32:47]
    v_mfma_f32_32x32x16_bf16 v[16:31], a[64:67], v[80:83], v[16:31]
    v_mfma_f32_32x32x16_bf16 v[32:47], a[68:71], v[80:83], v[32:47]
    v_mfma_f32_32x32x16_bf16 v[16:31], a[72:75], v[84:87], v[16:31]
    v_mfma_f32_32x32x16_bf16 v[32:47], a[76:79], v[84:87], v[32:47]
    v_mfma_f32_32x32x16_bf16 v[16:31], a[80:83], v[88:91], v[16:31]
    v_mfma_f32_32x32x16_bf16 v[32:47], a[84:87], v[88:91], v[32:47]
    v_mfma_f32_32x32x16_bf16 v[16:31], a[88:91], v[92:95], v[16:31]
    v_mfma_f32_32x32x16_bf16 v[32:47], a[92:95], v[92:95], v[32:47]
    v_mfma_f32_32x32x16_bf16 v[16:31], a[96:99], v[96:99], v[16:31]
    v_mfma_f32_32x32x16_bf16 v[32:47], a[100:103], v[96:99], v[32:47]
    v_mfma_f32_32x32x16_bf16 v[16:31], a[104:107], v[100:103], v[16:31]
    v_mfma_f32_32x32x16_bf16 v[32:47], a[108:111], v[100:103], v[32:47]
    v_mfma_f32_32x32x16_bf16 v[16:31], a[112:115], v[104:107], v[16:31]
    v_mfma_f32_32x32x16_bf16 v[32:47], a[116:119], v[104:107], v[32:47]
    v_mfma_f32_32x32x16_bf16 v[16:31], a[120:123], v[108:111], v[16:31]
    v_mfma_f32_32x32x16_bf16 v[32:47], a[124:127], v[108:111], v[32:47]
Lksd_223_m:
    s_cmp_eq_u32 s29, 1
    s_cbranch_scc1 Lksw_225_m
    s_waitcnt vmcnt(0)
    s_branch Lksx_226_m
Lksw_225_m:
    s_waitcnt vmcnt(16)
Lksx_226_m:
    s_barrier
    s_cmp_eq_u32 s30, -1
    s_cbranch_scc1 Lksq_227_m
    s_cmp_lg_u32 s13, 0
    s_cbranch_scc1 Lfs0_228
    s_mul_i32 s98, s30, 64
    s_add_u32 s98, s98, s12
    s_lshl_b32 s98, s98, 2
    s_add_u32 s98, s98, 62005248
    v_mov_b32 v7, s90
    s_mov_b64 exec, 1
    buffer_store_dword v7, off, s[4:7], s98 offset:0 sc1
    s_mov_b64 exec, -1
Lfs0_228:
    s_mov_b32 s30, -1
Lksq_227_m:
    ds_write_b128 v5, v[16:19] offset:0
    ds_write_b128 v5, v[20:23] offset:1088
    ds_write_b128 v5, v[24:27] offset:2176
    ds_write_b128 v5, v[28:31] offset:3264
    ds_write_b128 v5, v[32:35] offset:4352
    ds_write_b128 v5, v[36:39] offset:5440
    ds_write_b128 v5, v[40:43] offset:6528
    ds_write_b128 v5, v[44:47] offset:7616
    s_waitcnt lgkmcnt(0)
    s_barrier
    ds_read_b128 v[16:19], v6 offset:0
    ds_read_b128 v[20:23], v6 offset:8704
    ds_read_b128 v[24:27], v6 offset:17408
    ds_read_b128 v[28:31], v6 offset:26112
    ds_read_b128 v[32:35], v6 offset:64
    ds_read_b128 v[36:39], v6 offset:8768
    ds_read_b128 v[40:43], v6 offset:17472
    ds_read_b128 v[44:47], v6 offset:26176
    s_waitcnt lgkmcnt(0)
    v_pk_add_f32 v[16:17], v[16:17], v[20:21]
    v_pk_add_f32 v[18:19], v[18:19], v[22:23]
    v_pk_add_f32 v[16:17], v[16:17], v[24:25]
    v_pk_add_f32 v[18:19], v[18:19], v[26:27]
    v_pk_add_f32 v[16:17], v[16:17], v[28:29]
    v_pk_add_f32 v[18:19], v[18:19], v[30:31]
    v_pk_add_f32 v[32:33], v[32:33], v[36:37]
    v_pk_add_f32 v[34:35], v[34:35], v[38:39]
    v_pk_add_f32 v[32:33], v[32:33], v[40:41]
    v_pk_add_f32 v[34:35], v[34:35], v[42:43]
    v_pk_add_f32 v[32:33], v[32:33], v[44:45]
    v_pk_add_f32 v[34:35], v[34:35], v[46:47]
    s_lshl_b32 s19, s14, 6
    s_add_u32 s19, s19, s28
    s_lshl_b32 s19, s19, 2
    s_add_u32 s19, s19, s13
    s_mul_i32 s19, s19, 18432
    s_lshl_b32 s20, s15, 8
    s_add_u32 s19, s19, s20
    s_add_u32 s19, s19, 92274688
    s_add_u32 s20, s19, 9216
    buffer_store_dwordx4 v[16:19], v8, s[4:7], s19 offen sc1
    buffer_store_dwordx4 v[32:35], v8, s[4:7], s20 offen sc1
    s_mov_b32 s30, s28
    s_cmp_eq_u32 s29, 1
    s_cbranch_scc1 Lksp_229_m
    s_cmp_lg_u32 s13, 0
    s_cbranch_scc1 Lfa_231_m
    s_mul_i32 s88, s17, 128
    s_add_u32 s88, s88, 61996032
    buffer_load_dwordx4 v[10:13], v0, s[4:7], s88 offen sc1
    s_waitcnt vmcnt(1)
    s_branch Lfb_232_m
Lfa_231_m:
    s_waitcnt vmcnt(0)
Lfb_232_m:
    s_barrier
    s_cmp_lg_u32 s13, 0
    s_cbranch_scc1 Lfs0_234
    s_mul_i32 s98, s28, 64
    s_add_u32 s98, s98, s12
    s_lshl_b32 s98, s98, 2
    s_add_u32 s98, s98, 62005248
    v_mov_b32 v7, s90
    s_mov_b64 exec, 1
    buffer_store_dword v7, off, s[4:7], s98 offset:0 sc1
    s_mov_b64 exec, -1
Lfs0_234:
    s_mov_b32 s30, -1
    s_cmp_ge_u32 s17, s18
    s_cbranch_scc1 Lkse_216_m
    s_cmp_lg_u32 s13, 0
    s_cbranch_scc1 Lfc_233_m
    s_waitcnt vmcnt(0)
    s_branch Lfpm_237_m
Lfp_235_m:
    buffer_load_dwordx4 v[10:13], v0, s[4:7], s88 offen sc1
    s_waitcnt vmcnt(0)
Lfpm_237_m:
    v_xor_b32 v10, s90, v10
    v_xor_b32 v11, s90, v11
    v_xor_b32 v12, s90, v12
    v_xor_b32 v13, s90, v13
    v_or3_b32 v10, v10, v11, v12
    v_or_b32 v10, v10, v13
    v_cmp_ne_u32 vcc, 0, v10
    s_nop 3
    s_and_b32 vcc_lo, vcc_lo, 0xffffffff
    s_and_b32 vcc_hi, vcc_hi, 0xffffffff
    s_ff1_i32_b64 s92, vcc
    s_cmp_eq_u32 s92, -1
    s_cselect_b32 s92, 64, s92
    s_lshr_b32 s92, s92, 3
    s_cmp_lg_u32 s92, 0
    s_cbranch_scc1 Lfpg_236_m
    s_sleep 2
    s_add_u32 s99, s99, 1
    s_cmp_lt_u32 s99, 4194304
    s_cbranch_scc1 Lfp_235_m
    s_endpgm
Lfpg_236_m:
    s_add_u32 s92, s92, s17
    v_mov_b32 v14, 163832
    v_mov_b32 v15, s92
    ds_write_b32 v14, v15
    s_waitcnt lgkmcnt(0)
Lfc_233_m:
    s_barrier
    v_mov_b32 v14, 163832
    ds_read_b32 v15, v14
    s_waitcnt lgkmcnt(0)
    v_readfirstlane_b32 s92, v15
    s_mul_i32 s27, s17, 262144
    s_mul_i32 s19, s13, 16
    s_add_u32 s19, s19, s16
    s_lshl_b32 s19, s19, 10
    s_add_u32 s27, s27, s19
    s_add_u32 s27, s27, 73400320
    buffer_load_dwordx4 v[112:115], v0, s[4:7], s27 offen offset:0 sc1
    buffer_load_dwordx4 v[116:119], v0, s[4:7], s27 offen offset:1024 sc1
    buffer_load_dwordx4 v[120:123], v0, s[4:7], s27 offen offset:2048 sc1
    buffer_load_dwordx4 v[124:127], v0, s[4:7], s27 offen offset:3072 sc1
    s_add_u32 s27, s27, 4096
    buffer_load_dwordx4 v[128:131], v0, s[4:7], s27 offen offset:0 sc1
    buffer_load_dwordx4 v[132:135], v0, s[4:7], s27 offen offset:1024 sc1
    buffer_load_dwordx4 v[136:139], v0, s[4:7], s27 offen offset:2048 sc1
    buffer_load_dwordx4 v[140:143], v0, s[4:7], s27 offen offset:3072 sc1
    s_add_u32 s27, s27, 4096
    buffer_load_dwordx4 v[144:147], v0, s[4:7], s27 offen offset:0 sc1
    buffer_load_dwordx4 v[148:151], v0, s[4:7], s27 offen offset:1024 sc1
    buffer_load_dwordx4 v[152:155], v0, s[4:7], s27 offen offset:2048 sc1
    buffer_load_dwordx4 v[156:159], v0, s[4:7], s27 offen offset:3072 sc1
    s_add_u32 s27, s27, 4096
    buffer_load_dwordx4 v[160:163], v0, s[4:7], s27 offen offset:0 sc1
    buffer_load_dwordx4 v[164:167], v0, s[4:7], s27 offen offset:1024 sc1
    buffer_load_dwordx4 v[168:171], v0, s[4:7], s27 offen offset:2048 sc1
    buffer_load_dwordx4 v[172:175], v0, s[4:7], s27 offen offset:3072 sc1
Lksp_229_m:
    s_mov_b32 s28, s17
    s_add_u32 s17, s17, 1
    s_mov_b32 s29, 0
    s_cmp_ge_u32 s17, s18
    s_cbranch_scc1 Lksn_238_m
    s_cmp_lt_u32 s17, s92
    s_cbranch_scc0 Lksn_238_m
    s_mul_i32 s27, s17, 262144
    s_mul_i32 s19, s13, 16
    s_add_u32 s19, s19, s16
    s_lshl_b32 s19, s19, 10
    s_add_u32 s27, s27, s19
    s_add_u32 s27, s27, 73400320
    buffer_load_dwordx4 v[48:51], v0, s[4:7], s27 offen offset:0 sc1
    buffer_load_dwordx4 v[52:55], v0, s[4:7], s27 offen offset:1024 sc1
    buffer_load_dwordx4 v[56:59], v0, s[4:7], s27 offen offset:2048 sc1
    buffer_load_dwordx4 v[60:63], v0, s[4:7], s27 offen offset:3072 sc1
    s_add_u32 s27, s27, 4096
    buffer_load_dwordx4 v[64:67], v0, s[4:7], s27 offen offset:0 sc1
    buffer_load_dwordx4 v[68:71], v0, s[4:7], s27 offen offset:1024 sc1
    buffer_load_dwordx4 v[72:75], v0, s[4:7], s27 offen offset:2048 sc1
    buffer_load_dwordx4 v[76:79], v0, s[4:7], s27 offen offset:3072 sc1
    s_add_u32 s27, s27, 4096
    buffer_load_dwordx4 v[80:83], v0, s[4:7], s27 offen offset:0 sc1
    buffer_load_dwordx4 v[84:87], v0, s[4:7], s27 offen offset:1024 sc1
    buffer_load_dwordx4 v[88:91], v0, s[4:7], s27 offen offset:2048 sc1
    buffer_load_dwordx4 v[92:95], v0, s[4:7], s27 offen offset:3072 sc1
    s_add_u32 s27, s27, 4096
    buffer_load_dwordx4 v[96:99], v0, s[4:7], s27 offen offset:0 sc1
    buffer_load_dwordx4 v[100:103], v0, s[4:7], s27 offen offset:1024 sc1
    buffer_load_dwordx4 v[104:107], v0, s[4:7], s27 offen offset:2048 sc1
    buffer_load_dwordx4 v[108:111], v0, s[4:7], s27 offen offset:3072 sc1
    s_mov_b32 s29, 1
    s_cmp_eq_u32 s30, -1
    s_cbranch_scc1 Lksy_241_m
    s_waitcnt vmcnt(18)
    s_branch Lksg_239_m
Lksy_241_m:
    s_waitcnt vmcnt(16)
    s_branch Lksg_239_m
Lksn_238_m:
    s_waitcnt vmcnt(15)
    v_mfma_f32_32x32x16_bf16 v[16:31], a[0:3], v[112:115], 0
    v_mfma_f32_32x32x16_bf16 v[32:47], a[4:7], v[112:115], 0
    s_waitcnt vmcnt(14)
    v_mfma_f32_32x32x16_bf16 v[16:31], a[8:11], v[116:119], v[16:31]
    v_mfma_f32_32x32x16_bf16 v[32:47], a[12:15], v[116:119], v[32:47]
    s_waitcnt vmcnt(13)
    v_mfma_f32_32x32x16_bf16 v[16:31], a[16:19], v[120:123], v[16:31]
    v_mfma_f32_32x32x16_bf16 v[32:47], a[20:23], v[120:123], v[32:47]
    s_waitcnt vmcnt(12)
    v_mfma_f32_32x32x16_bf16 v[16:31], a[24:27], v[124:127], v[16:31]
    v_mfma_f32_32x32x16_bf16 v[32:47], a[28:31], v[124:127], v[32:47]
    s_waitcnt vmcnt(11)
    v_mfma_f32_32x32x16_bf16 v[16:31], a[32:35], v[128:131], v[16:31]
    v_mfma_f32_32x32x16_bf16 v[32:47], a[36:39], v[128:131], v[32:47]
    s_waitcnt vmcnt(10)
    v_mfma_f32_32x32x16_bf16 v[16:31], a[40:43], v[132:135], v[16:31]
    v_mfma_f32_32x32x16_bf16 v[32:47], a[44:47], v[132:135], v[32:47]
    s_waitcnt vmcnt(9)
    v_mfma_f32_32x32x16_bf16 v[16:31], a[48:51], v[136:139], v[16:31]
    v_mfma_f32_32x32x16_bf16 v[32:47], a[52:55], v[136:139], v[32:47]
    s_waitcnt vmcnt(8)
    v_mfma_f32_32x32x16_bf16 v[16:31], a[56:59], v[140:143], v[16:31]
    v_mfma_f32_32x32x16_bf16 v[32:47], a[60:63], v[140:143], v[32:47]
    s_waitcnt vmcnt(7)
    v_mfma_f32_32x32x16_bf16 v[16:31], a[64:67], v[144:147], v[16:31]
    v_mfma_f32_32x32x16_bf16 v[32:47], a[68:71], v[144:147], v[32:47]
    s_waitcnt vmcnt(6)
    v_mfma_f32_32x32x16_bf16 v[16:31], a[72:75], v[148:151], v[16:31]
    v_mfma_f32_32x32x16_bf16 v[32:47], a[76:79], v[148:151], v[32:47]
    s_waitcnt vmcnt(5)
    v_mfma_f32_32x32x16_bf16 v[16:31], a[80:83], v[152:155], v[16:31]
    v_mfma_f32_32x32x16_bf16 v[32:47], a[84:87], v[152:155], v[32:47]
    s_waitcnt vmcnt(4)
    v_mfma_f32_32x32x16_bf16 v[16:31], a[88:91], v[156:159], v[16:31]
    v_mfma_f32_32x32x16_bf16 v[32:47], a[92:95], v[156:159], v[32:47]
    s_waitcnt vmcnt(3)
    v_mfma_f32_32x32x16_bf16 v[16:31], a[96:99], v[160:163], v[16:31]
    v_mfma_f32_32x32x16_bf16 v[32:47], a[100:103], v[160:163], v[32:47]
    s_waitcnt vmcnt(2)
    v_mfma_f32_32x32x16_bf16 v[16:31], a[104:107], v[164:167], v[16:31]
    v_mfma_f32_32x32x16_bf16 v[32:47], a[108:111], v[164:167], v[32:47]
    s_waitcnt vmcnt(1)
    v_mfma_f32_32x32x16_bf16 v[16:31], a[112:115], v[168:171], v[16:31]
    v_mfma_f32_32x32x16_bf16 v[32:47], a[116:119], v[168:171], v[32:47]
    s_waitcnt vmcnt(0)
    v_mfma_f32_32x32x16_bf16 v[16:31], a[120:123], v[172:175], v[16:31]
    v_mfma_f32_32x32x16_bf16 v[32:47], a[124:127], v[172:175], v[32:47]
    s_branch Lksd_240_m
Lksg_239_m:
    s_nop 7
    v_mfma_f32_32x32x16_bf16 v[16:31], a[0:3], v[112:115], 0
    v_mfma_f32_32x32x16_bf16 v[32:47], a[4:7], v[112:115], 0
    v_mfma_f32_32x32x16_bf16 v[16:31], a[8:11], v[116:119], v[16:31]
    v_mfma_f32_32x32x16_bf16 v[32:47], a[12:15], v[116:119], v[32:47]
    v_mfma_f32_32x32x16_bf16 v[16:31], a[16:19], v[120:123], v[16:31]
    v_mfma_f32_32x32x16_bf16 v[32:47], a[20:23], v[120:123], v[32:47]
    v_mfma_f32_32x32x16_bf16 v[16:31], a[24:27], v[124:127], v[16:31]
    v_mfma_f32_32x32x16_bf16 v[32:47], a[28:31], v[124:127], v[32:47]
    v_mfma_f32_32x32x16_bf16 v[16:31], a[32:35], v[128:131], v[16:31]
    v_mfma_f32_32x32x16_bf16 v[32:47], a[36:39], v[128:131], v[32:47]
    v_mfma_f32_32x32x16_bf16 v[16:31], a[40:43], v[132:135], v[16:31]
    v_mfma_f32_32x32x16_bf16 v[32:47], a[44:47], v[132:135], v[32:47]
    v_mfma_f32_32x32x16_bf16 v[16:31], a[48:51], v[136:139], v[16:31]
    v_mfma_f32_32x32x16_bf16 v[32:47], a[52:55], v[136:139], v[32:47]
    v_mfma_f32_32x32x16_bf16 v[16:31], a[56:59], v[140:143], v[16:31]
    v_mfma_f32_32x32x16_bf16 v[32:47], a[60:63], v[140:143], v[32:47]
    v_mfma_f32_32x32x16_bf16 v[16:31], a[64:67], v[144:147], v[16:31]
    v_mfma_f32_32x32x16_bf16 v[32:47], a[68:71], v[144:147], v[32:47]
    v_mfma_f32_32x32x16_bf16 v[16:31], a[72:75], v[148:151], v[16:31]
    v_mfma_f32_32x32x16_bf16 v[32:47], a[76:79], v[148:151], v[32:47]
    v_mfma_f32_32x32x16_bf16 v[16:31], a[80:83], v[152:155], v[16:31]
    v_mfma_f32_32x32x16_bf16 v[32:47], a[84:87], v[152:155], v[32:47]
    v_mfma_f32_32x32x16_bf16 v[16:31], a[88:91], v[156:159], v[16:31]
    v_mfma_f32_32x32x16_bf16 v[32:47], a[92:95], v[156:159], v[32:47]
    v_mfma_f32_32x32x16_bf16 v[16:31], a[96:99], v[160:163], v[16:31]
    v_mfma_f32_32x32x16_bf16 v[32:47], a[100:103], v[160:163], v[32:47]
    v_mfma_f32_32x32x16_bf16 v[16:31], a[104:107], v[164:167], v[16:31]
    v_mfma_f32_32x32x16_bf16 v[32:47], a[108:111], v[164:167], v[32:47]
    v_mfma_f32_32x32x16_bf16 v[16:31], a[112:115], v[168:171], v[16:31]
    v_mfma_f32_32x32x16_bf16 v[32:47], a[116:119], v[168:171], v[32:47]
    v_mfma_f32_32x32x16_bf16 v[16:31], a[120:123], v[172:175], v[16:31]
    v_mfma_f32_32x32x16_bf16 v[32:47], a[124:127], v[172:175], v[32:47]
Lksd_240_m:
    s_cmp_eq_u32 s29, 1
    s_cbranch_scc1 Lksw_242_m
    s_waitcnt vmcnt(0)
    s_branch Lksx_243_m
Lksw_242_m:
    s_waitcnt vmcnt(16)
Lksx_243_m:
    s_barrier
    s_cmp_eq_u32 s30, -1
    s_cbranch_scc1 Lksq_244_m
    s_cmp_lg_u32 s13, 0
    s_cbranch_scc1 Lfs0_245
    s_mul_i32 s98, s30, 64
    s_add_u32 s98, s98, s12
    s_lshl_b32 s98, s98, 2
    s_add_u32 s98, s98, 62005248
    v_mov_b32 v7, s90
    s_mov_b64 exec, 1
    buffer_store_dword v7, off, s[4:7], s98 offset:0 sc1
    s_mov_b64 exec, -1
Lfs0_245:
    s_mov_b32 s30, -1
Lksq_244_m:
    ds_write_b128 v5, v[16:19] offset:0
    ds_write_b128 v5, v[20:23] offset:1088
    ds_write_b128 v5, v[24:27] offset:2176
    ds_write_b128 v5, v[28:31] offset:3264
    ds_write_b128 v5, v[32:35] offset:4352
    ds_write_b128 v5, v[36:39] offset:5440
    ds_write_b128 v5, v[40:43] offset:6528
    ds_write_b128 v5, v[44:47] offset:7616
    s_waitcnt lgkmcnt(0)
    s_barrier
    ds_read_b128 v[16:19], v6 offset:0
    ds_read_b128 v[20:23], v6 offset:8704
    ds_read_b128 v[24:27], v6 offset:17408
    ds_read_b128 v[28:31], v6 offset:26112
    ds_read_b128 v[32:35], v6 offset:64
    ds_read_b128 v[36:39], v6 offset:8768
    ds_read_b128 v[40:43], v6 offset:17472
    ds_read_b128 v[44:47], v6 offset:26176
    s_waitcnt lgkmcnt(0)
    v_pk_add_f32 v[16:17], v[16:17], v[20:21]
    v_pk_add_f32 v[18:19], v[18:19], v[22:23]
    v_pk_add_f32 v[16:17], v[16:17], v[24:25]
    v_pk_add_f32 v[18:19], v[18:19], v[26:27]
    v_pk_add_f32 v[16:17], v[16:17], v[28:29]
    v_pk_add_f32 v[18:19], v[18:19], v[30:31]
    v_pk_add_f32 v[32:33], v[32:33], v[36:37]
    v_pk_add_f32 v[34:35], v[34:35], v[38:39]
    v_pk_add_f32 v[32:33], v[32:33], v[40:41]
    v_pk_add_f32 v[34:35], v[34:35], v[42:43]
    v_pk_add_f32 v[32:33], v[32:33], v[44:45]
    v_pk_add_f32 v[34:35], v[34:35], v[46:47]
    s_lshl_b32 s19, s14, 6
    s_add_u32 s19, s19, s28
    s_lshl_b32 s19, s19, 2
    s_add_u32 s19, s19, s13
    s_mul_i32 s19, s19, 18432
    s_lshl_b32 s20, s15, 8
    s_add_u32 s19, s19, s20
    s_add_u32 s19, s19, 92274688
    s_add_u32 s20, s19, 9216
    buffer_store_dwordx4 v[16:19], v8, s[4:7], s19 offen sc1
    buffer_store_dwordx4 v[32:35], v8, s[4:7], s20 offen sc1
    s_mov_b32 s30, s28
    s_cmp_eq_u32 s29, 1
    s_cbranch_scc1 Lksp_246_m
    s_cmp_lg_u32 s13, 0
    s_cbranch_scc1 Lfa_248_m
    s_mul_i32 s88, s17, 128
    s_add_u32 s88, s88, 61996032
    buffer_load_dwordx4 v[10:13], v0, s[4:7], s88 offen sc1
    s_waitcnt vmcnt(1)
    s_branch Lfb_249_m
Lfa_248_m:
    s_waitcnt vmcnt(0)
Lfb_249_m:
    s_barrier
    s_cmp_lg_u32 s13, 0
    s_cbranch_scc1 Lfs0_251
    s_mul_i32 s98, s28, 64
    s_add_u32 s98, s98, s12
    s_lshl_b32 s98, s98, 2
    s_add_u32 s98, s98, 62005248
    v_mov_b32 v7, s90
    s_mov_b64 exec, 1
    buffer_store_dword v7, off, s[4:7], s98 offset:0 sc1
    s_mov_b64 exec, -1
Lfs0_251:
    s_mov_b32 s30, -1
    s_cmp_ge_u32 s17, s18
    s_cbranch_scc1 Lkse_216_m
    s_cmp_lg_u32 s13, 0
    s_cbranch_scc1 Lfc_250_m
    s_waitcnt vmcnt(0)
    s_branch Lfpm_254_m
Lfp_252_m:
    buffer_load_dwordx4 v[10:13], v0, s[4:7], s88 offen sc1
    s_waitcnt vmcnt(0)
Lfpm_254_m:
    v_xor_b32 v10, s90, v10
    v_xor_b32 v11, s90, v11
    v_xor_b32 v12, s90, v12
    v_xor_b32 v13, s90, v13
    v_or3_b32 v10, v10, v11, v12
    v_or_b32 v10, v10, v13
    v_cmp_ne_u32 vcc, 0, v10
    s_nop 3
    s_and_b32 vcc_lo, vcc_lo, 0xffffffff
    s_and_b32 vcc_hi, vcc_hi, 0xffffffff
    s_ff1_i32_b64 s92, vcc
    s_cmp_eq_u32 s92, -1
    s_cselect_b32 s92, 64, s92
    s_lshr_b32 s92, s92, 3
    s_cmp_lg_u32 s92, 0
    s_cbranch_scc1 Lfpg_253_m
    s_sleep 2
    s_add_u32 s99, s99, 1
    s_cmp_lt_u32 s99, 4194304
    s_cbranch_scc1 Lfp_252_m
    s_endpgm
Lfpg_253_m:
    s_add_u32 s92, s92, s17
    v_mov_b32 v14, 163832
    v_mov_b32 v15, s92
    ds_write_b32 v14, v15
    s_waitcnt lgkmcnt(0)
Lfc_250_m:
    s_barrier
    v_mov_b32 v14, 163832
    ds_read_b32 v15, v14
    s_waitcnt lgkmcnt(0)
    v_readfirstlane_b32 s92, v15
    s_mul_i32 s27, s17, 262144
    s_mul_i32 s19, s13, 16
    s_add_u32 s19, s19, s16
    s_lshl_b32 s19, s19, 10
    s_add_u32 s27, s27, s19
    s_add_u32 s27, s27, 73400320
    buffer_load_dwordx4 v[48:51], v0, s[4:7], s27 offen offset:0 sc1
    buffer_load_dwordx4 v[52:55], v0, s[4:7], s27 offen offset:1024 sc1
    buffer_load_dwordx4 v[56:59], v0, s[4:7], s27 offen offset:2048 sc1
    buffer_load_dwordx4 v[60:63], v0, s[4:7], s27 offen offset:3072 sc1
    s_add_u32 s27, s27, 4096
    buffer_load_dwordx4 v[64:67], v0, s[4:7], s27 offen offset:0 sc1
    buffer_load_dwordx4 v[68:71], v0, s[4:7], s27 offen offset:1024 sc1
    buffer_load_dwordx4 v[72:75], v0, s[4:7], s27 offen offset:2048 sc1
    buffer_load_dwordx4 v[76:79], v0, s[4:7], s27 offen offset:3072 sc1
    s_add_u32 s27, s27, 4096
    buffer_load_dwordx4 v[80:83], v0, s[4:7], s27 offen offset:0 sc1
    buffer_load_dwordx4 v[84:87], v0, s[4:7], s27 offen offset:1024 sc1
    buffer_load_dwordx4 v[88:91], v0, s[4:7], s27 offen offset:2048 sc1
    buffer_load_dwordx4 v[92:95], v0, s[4:7], s27 offen offset:3072 sc1
    s_add_u32 s27, s27, 4096
    buffer_load_dwordx4 v[96:99], v0, s[4:7], s27 offen offset:0 sc1
    buffer_load_dwordx4 v[100:103], v0, s[4:7], s27 offen offset:1024 sc1
    buffer_load_dwordx4 v[104:107], v0, s[4:7], s27 offen offset:2048 sc1
    buffer_load_dwordx4 v[108:111], v0, s[4:7], s27 offen offset:3072 sc1
Lksp_246_m:
    s_branch Lks_215_m
Lkse_216_m:
    s_sub_u32 s12, s97, 64
    s_branch Lout_main
Lrolewin_60_m:
    s_sub_u32 s12, s97, 164
    s_mov_b32 s87, 0
Lwin_entry:
    s_mov_b32 s92, 0
    s_mov_b32 s93, 0
    s_load_dwordx2 s[8:9], s[42:43], 64
    s_waitcnt lgkmcnt(0)
    s_mov_b32 s10, 5308416
    s_mov_b32 s11, 0x20000
    s_lshl_b32 s18, s12, 8
    v_lshrrev_b32 v1, 4, v0
    v_lshrrev_b32 v2, 4, v1
    v_bfe_u32 v3, v1, 2, 2
    v_xor_b32 v3, v3, v2
    v_lshlrev_b32 v3, 6, v3
    v_and_b32 v4, 3, v1
    v_lshl_add_u32 v3, v4, 4, v3
    s_mov_b32 s19, 9216
    v_mul_lo_u32 v5, v2, s19
    v_add_u32 v5, v5, v3
    s_mul_i32 s19, s13, 1327104
    s_add_u32 s19, s19, s18
    s_mul_i32 s20, s13, 36864
    s_mov_b32 s21, 36
Ldmw_255_m:
    s_mov_b32 m0, s20
    s_nop 0
    buffer_load_dwordx4 v5, s[8:11], s19 offen lds
    s_add_u32 s19, s19, 36864
    s_add_u32 s20, s20, 1024
    s_sub_u32 s21, s21, 1
    s_cmp_lg_u32 s21, 0
    s_cbranch_scc1 Ldmw_255_m
    v_lshrrev_b32 v2, 5, v1
    v_lshlrev_b32 v2, 3, v2
    v_bfe_u32 v3, v1, 2, 2
    v_add_u32 v2, v2, v3
    v_lshlrev_b32 v6, 8, v2
    v_xor_b32 v3, s13, v3
    v_lshl_add_u32 v6, v3, 6, v6
    v_bfe_u32 v4, v1, 4, 1
    v_lshl_add_u32 v6, v4, 5, v6
    v_and_b32 v4, 3, v1
    v_lshl_add_u32 v6, v4, 3, v6
    v_add_u32 v7, 0x10000, v6
    v_add_u32 v8, 0x20000, v6
    s_waitcnt vmcnt(0)
    s_barrier
    ds_read_b64_tr_b16 v[112:113], v6 offset:0
    ds_read_b64_tr_b16 v[114:115], v6 offset:1024
    ds_read_b64_tr_b16 v[116:117], v6 offset:4096
    ds_read_b64_tr_b16 v[118:119], v6 offset:5120
    ds_read_b64_tr_b16 v[120:121], v6 offset:8192
    ds_read_b64_tr_b16 v[122:123], v6 offset:9216
    ds_read_b64_tr_b16 v[124:125], v6 offset:12288
    ds_read_b64_tr_b16 v[126:127], v6 offset:13312
    s_waitcnt lgkmcnt(4)
    ds_read_b64_tr_b16 v[128:129], v6 offset:16384
    ds_read_b64_tr_b16 v[130:131], v6 offset:17408
    ds_read_b64_tr_b16 v[132:133], v6 offset:20480
    ds_read_b64_tr_b16 v[134:135], v6 offset:21504
    ds_read_b64_tr_b16 v[136:137], v6 offset:24576
    ds_read_b64_tr_b16 v[138:139], v6 offset:25600
    ds_read_b64_tr_b16 v[140:141], v6 offset:28672
    ds_read_b64_tr_b16 v[142:143], v6 offset:29696
    s_waitcnt lgkmcnt(4)
    ds_read_b64_tr_b16 v[144:145], v6 offset:32768
    ds_read_b64_tr_b16 v[146:147], v6 offset:33792
    ds_read_b64_tr_b16 v[148:149], v6 offset:36864
    ds_read_b64_tr_b16 v[150:151], v6 offset:37888
    ds_read_b64_tr_b16 v[152:153], v6 offset:40960
    ds_read_b64_tr_b16 v[154:155], v6 offset:41984
    ds_read_b64_tr_b16 v[156:157], v6 offset:45056
    ds_read_b64_tr_b16 v[158:159], v6 offset:46080
    s_waitcnt lgkmcnt(4)
    ds_read_b64_tr_b16 v[160:161], v6 offset:49152
    ds_read_b64_tr_b16 v[162:163], v6 offset:50176
    ds_read_b64_tr_b16 v[164:165], v6 offset:53248
    ds_read_b64_tr_b16 v[166:167], v6 offset:54272
    ds_read_b64_tr_b16 v[168:169], v6 offset:57344
    ds_read_b64_tr_b16 v[170:171], v6 offset:58368
    ds_read_b64_tr_b16 v[172:173], v6 offset:61440
    ds_read_b64_tr_b16 v[174:175], v6 offset:62464
    s_waitcnt lgkmcnt(4)
    ds_read_b64_tr_b16 v[176:177], v7 offset:0
    ds_read_b64_tr_b16 v[178:179], v7 offset:1024
    ds_read_b64_tr_b16 v[180:181], v7 offset:4096
    ds_read_b64_tr_b16 v[182:183], v7 offset:5120
    ds_read_b64_tr_b16 v[184:185], v7 offset:8192
    ds_read_b64_tr_b16 v[186:187], v7 offset:9216
    ds_read_b64_tr_b16 v[188:189], v7 offset:12288
    ds_read_b64_tr_b16 v[190:191], v7 offset:13312
    s_waitcnt lgkmcnt(4)
    ds_read_b64_tr_b16 v[192:193], v7 offset:16384
    ds_read_b64_tr_b16 v[194:195], v7 offset:17408
    ds_read_b64_tr_b16 v[196:197], v7 offset:20480
    ds_read_b64_tr_b16 v[198:199], v7 offset:21504
    ds_read_b64_tr_b16 v[200:201], v7 offset:24576
    ds_read_b64_tr_b16 v[202:203], v7 offset:25600
    ds_read_b64_tr_b16 v[204:205], v7 offset:28672
    ds_read_b64_tr_b16 v[206:207], v7 offset:29696
    s_waitcnt lgkmcnt(4)
    ds_read_b64_tr_b16 v[208:209], v7 offset:32768
    ds_read_b64_tr_b16 v[210:211], v7 offset:33792
    ds_read_b64_tr_b16 v[212:213], v7 offset:36864
    ds_read_b64_tr_b16 v[214:215], v7 offset:37888
    ds_read_b64_tr_b16 v[216:217], v7 offset:40960
    ds_read_b64_tr_b16 v[218:219], v7 offset:41984
    ds_read_b64_tr_b16 v[220:221], v7 offset:45056
    ds_read_b64_tr_b16 v[222:223], v7 offset:46080
    s_waitcnt lgkmcnt(4)
    ds_read_b64_tr_b16 v[224:225], v7 offset:49152
    ds_read_b64_tr_b16 v[226:227], v7 offset:50176
    ds_read_b64_tr_b16 v[228:229], v7 offset:53248
    ds_read_b64_tr_b16 v[230:231], v7 offset:54272
    ds_read_b64_tr_b16 v[232:233], v7 offset:57344
    ds_read_b64_tr_b16 v[234:235], v7 offset:58368
    ds_read_b64_tr_b16 v[236:237], v7 offset:61440
    ds_read_b64_tr_b16 v[238:239], v7 offset:62464
    s_waitcnt lgkmcnt(4)
    ds_read_b64_tr_b16 v[240:241], v8 offset:0
    ds_read_b64_tr_b16 v[242:243], v8 offset:1024
    ds_read_b64_tr_b16 v[244:245], v8 offset:4096
    ds_read_b64_tr_b16 v[246:247], v8 offset:5120
    ds_read_b64_tr_b16 v[248:249], v8 offset:8192
    ds_read_b64_tr_b16 v[250:251], v8 offset:9216
    ds_read_b64_tr_b16 v[252:253], v8 offset:12288
    ds_read_b64_tr_b16 v[254:255], v8 offset:13312
    s_waitcnt lgkmcnt(4)
    s_waitcnt lgkmcnt(0)
    s_barrier
    s_lshl_b32 s18, s12, 3
    s_lshl_b32 s19, s13, 1
    s_add_u32 s18, s18, s19
    s_lshl_b32 s18, s18, 10
    s_add_u32 s18, s18, 113246208
    s_mov_b32 s17, s87
    s_mov_b32 s22, 0xc0135761
    s_mov_b32 s23, 0xbdd2d3e8
    v_and_b32 v77, 0x1f0, v0
    v_lshrrev_b32 v77, 1, v77
    v_lshrrev_b32 v10, 9, v0
    v_mul_u32_u24 v12, 544, v10
    v_and_b32 v10, 0x1f0, v0
    v_add_u32 v12, v12, v10
    v_add_u32 v10, 39168, v12
    v_lshrrev_b32 v7, 4, v0
    s_mul_i32 s19, s13, 576
    s_add_u32 s19, s19, 0
    v_add_u32 v7, s19, v7
    v_mul_u32_u24 v32, 3641, v7
    v_lshrrev_b32 v32, 18, v32
    v_mul_u32_u24 v13, 72, v32
    v_sub_u32 v7, v7, v13
    v_lshlrev_b32 v32, 4, v32
    v_mul_u32_u24 v13, 544, v7
    v_add_u32 v32, v32, v13
    v_lshrrev_b32 v7, 4, v0
    s_mul_i32 s19, s13, 576
    s_add_u32 s19, s19, 64
    v_add_u32 v7, s19, v7
    v_mul_u32_u24 v33, 3641, v7
    v_lshrrev_b32 v33, 18, v33
    v_mul_u32_u24 v13, 72, v33
    v_sub_u32 v7, v7, v13
    v_lshlrev_b32 v33, 4, v33
    v_mul_u32_u24 v13, 544, v7
    v_add_u32 v33, v33, v13
    v_lshrrev_b32 v7, 4, v0
    s_mul_i32 s19, s13, 576
    s_add_u32 s19, s19, 128
    v_add_u32 v7, s19, v7
    v_mul_u32_u24 v34, 3641, v7
    v_lshrrev_b32 v34, 18, v34
    v_mul_u32_u24 v13, 72, v34
    v_sub_u32 v7, v7, v13
    v_lshlrev_b32 v34, 4, v34
    v_mul_u32_u24 v13, 544, v7
    v_add_u32 v34, v34, v13
    v_lshrrev_b32 v7, 4, v0
    s_mul_i32 s19, s13, 576
    s_add_u32 s19, s19, 192
    v_add_u32 v7, s19, v7
    v_mul_u32_u24 v35, 3641, v7
    v_lshrrev_b32 v35, 18, v35
    v_mul_u32_u24 v13, 72, v35
    v_sub_u32 v7, v7, v13
    v_lshlrev_b32 v35, 4, v35
    v_mul_u32_u24 v13, 544, v7
    v_add_u32 v35, v35, v13
    v_lshrrev_b32 v7, 4, v0
    s_mul_i32 s19, s13, 576
    s_add_u32 s19, s19, 256
    v_add_u32 v7, s19, v7
    v_mul_u32_u24 v36, 3641, v7
    v_lshrrev_b32 v36, 18, v36
    v_mul_u32_u24 v13, 72, v36
    v_sub_u32 v7, v7, v13
    v_lshlrev_b32 v36, 4, v36
    v_mul_u32_u24 v13, 544, v7
    v_add_u32 v36, v36, v13
    v_lshrrev_b32 v7, 4, v0
    s_mul_i32 s19, s13, 576
    s_add_u32 s19, s19, 320
    v_add_u32 v7, s19, v7
    v_mul_u32_u24 v37, 3641, v7
    v_lshrrev_b32 v37, 18, v37
    v_mul_u32_u24 v13, 72, v37
    v_sub_u32 v7, v7, v13
    v_lshlrev_b32 v37, 4, v37
    v_mul_u32_u24 v13, 544, v7
    v_add_u32 v37, v37, v13
    v_lshrrev_b32 v7, 4, v0
    s_mul_i32 s19, s13, 576
    s_add_u32 s19, s19, 384
    v_add_u32 v7, s19, v7
    v_mul_u32_u24 v38, 3641, v7
    v_lshrrev_b32 v38, 18, v38
    v_mul_u32_u24 v13, 72, v38
    v_sub_u32 v7, v7, v13
    v_lshlrev_b32 v38, 4, v38
    v_mul_u32_u24 v13, 544, v7
    v_add_u32 v38, v38, v13
    v_lshrrev_b32 v7, 4, v0
    s_mul_i32 s19, s13, 576
    s_add_u32 s19, s19, 448
    v_add_u32 v7, s19, v7
    v_mul_u32_u24 v39, 3641, v7
    v_lshrrev_b32 v39, 18, v39
    v_mul_u32_u24 v13, 72, v39
    v_sub_u32 v7, v7, v13
    v_lshlrev_b32 v39, 4, v39
    v_mul_u32_u24 v13, 544, v7
    v_add_u32 v39, v39, v13
    v_lshrrev_b32 v7, 4, v0
    s_mul_i32 s19, s13, 576
    s_add_u32 s19, s19, 512
    v_add_u32 v7, s19, v7
    v_mul_u32_u24 v76, 3641, v7
    v_lshrrev_b32 v76, 18, v76
    v_mul_u32_u24 v13, 72, v76
    v_sub_u32 v7, v7, v13
    v_lshlrev_b32 v76, 4, v76
    v_mul_u32_u24 v13, 544, v7
    v_add_u32 v76, v76, v13
    s_mov_b32 s27, 0
    s_mov_b32 s30, -1
    s_cmp_lg_u32 s13, 0
    s_cbranch_scc1 Lur_256_m
    s_cmp_lt_u32 s17, s92
    s_cbranch_scc1 Lfwok_258_m
    s_mul_i32 s98, s17, 128
    s_add_u32 s98, s98, 62023680
Lfw_257_m:
    buffer_load_dwordx4 v[108:111], v0, s[4:7], s98 offen sc1
    s_waitcnt vmcnt(0)
    v_xor_b32 v108, s90, v108
    v_xor_b32 v109, s90, v109
    v_xor_b32 v110, s90, v110
    v_xor_b32 v111, s90, v111
    v_or3_b32 v108, v108, v109, v110
    v_or_b32 v108, v108, v111
    v_cmp_ne_u32 vcc, 0, v108
    s_nop 3
    s_and_b32 vcc_lo, vcc_lo, 0xffffffff
    s_and_b32 vcc_hi, vcc_hi, 0xffffffff
    s_ff1_i32_b64 s92, vcc
    s_cmp_eq_u32 s92, -1
    s_cselect_b32 s92, 64, s92
    s_lshr_b32 s92, s92, 3
    s_cmp_lg_u32 s92, 0
    s_cbranch_scc1 Lfwg_259_m
    s_sleep 2
    s_add_u32 s99, s99, 1
    s_cmp_lt_u32 s99, 4194304
    s_cbranch_scc1 Lfw_257_m
    s_endpgm
Lfwg_259_m:
    s_add_u32 s92, s92, s17
Lfwok_258_m:
    v_mov_b32 v14, 163832
    v_mov_b32 v15, s92
    ds_write_b32 v14, v15
    s_waitcnt lgkmcnt(0)
Lur_256_m:
    s_barrier
    v_mov_b32 v14, 163832
    ds_read_b32 v15, v14
    s_waitcnt lgkmcnt(0)
    v_readfirstlane_b32 s92, v15
    s_mul_i32 s28, s17, 36864
    s_mul_i32 s19, s13, 9216
    s_add_u32 s28, s28, s19
    s_add_u32 s28, s28, 66060288
    s_add_u32 s20, s28, 4096
    s_add_u32 s21, s28, 8192
    buffer_load_dwordx4 v[40:43], v0, s[4:7], s28 offen offset:0 sc1
    buffer_load_dwordx4 v[44:47], v0, s[4:7], s28 offen offset:1024 sc1
    buffer_load_dwordx4 v[48:51], v0, s[4:7], s28 offen offset:2048 sc1
    buffer_load_dwordx4 v[52:55], v0, s[4:7], s28 offen offset:3072 sc1
    buffer_load_dwordx4 v[56:59], v0, s[4:7], s20 offen offset:0 sc1
    buffer_load_dwordx4 v[60:63], v0, s[4:7], s20 offen offset:1024 sc1
    buffer_load_dwordx4 v[64:67], v0, s[4:7], s20 offen offset:2048 sc1
    buffer_load_dwordx4 v[68:71], v0, s[4:7], s20 offen offset:3072 sc1
    buffer_load_dwordx4 v[72:75], v0, s[4:7], s21 offen offset:0 sc1
    s_waitcnt vmcnt(0)
    ds_write_b128 v32, v[40:43] offset:0
    ds_write_b128 v33, v[44:47] offset:0
    ds_write_b128 v34, v[48:51] offset:0
    ds_write_b128 v35, v[52:55] offset:0
    ds_write_b128 v36, v[56:59] offset:0
    ds_write_b128 v37, v[60:63] offset:0
    ds_write_b128 v38, v[64:67] offset:0
    ds_write_b128 v39, v[68:71] offset:0
    ds_write_b128 v76, v[72:75] offset:0
    s_waitcnt lgkmcnt(0)
    s_barrier
Lsg_260_m:
    s_add_u32 s27, s27, 1
    s_mov_b32 s29, s17
    s_mov_b32 s31, 0
    s_cmp_ge_u32 s17, 40
    s_cselect_b32 s19, 2, 1
    s_add_u32 s17, s17, s19
    s_cmp_ge_u32 s17, 64
    s_cbranch_scc1 Lsgl_262_m
    s_cmp_lt_u32 s17, s92
    s_cbranch_scc0 Lsgl_262_m
    s_mul_i32 s28, s17, 36864
    s_mul_i32 s19, s13, 9216
    s_add_u32 s28, s28, s19
    s_add_u32 s28, s28, 66060288
    s_add_u32 s20, s28, 4096
    s_add_u32 s21, s28, 8192
    buffer_load_dwordx4 v[40:43], v0, s[4:7], s28 offen offset:0 sc1
    buffer_load_dwordx4 v[44:47], v0, s[4:7], s28 offen offset:1024 sc1
    buffer_load_dwordx4 v[48:51], v0, s[4:7], s28 offen offset:2048 sc1
    buffer_load_dwordx4 v[52:55], v0, s[4:7], s28 offen offset:3072 sc1
    buffer_load_dwordx4 v[56:59], v0, s[4:7], s20 offen offset:0 sc1
    buffer_load_dwordx4 v[60:63], v0, s[4:7], s20 offen offset:1024 sc1
    buffer_load_dwordx4 v[64:67], v0, s[4:7], s20 offen offset:2048 sc1
    buffer_load_dwordx4 v[68:71], v0, s[4:7], s20 offen offset:3072 sc1
    buffer_load_dwordx4 v[72:75], v0, s[4:7], s21 offen offset:0 sc1
    s_mov_b32 s31, 1
Lsgl_262_m:
    ds_read_b128 v[80:83], v12 offset:0
    ds_read_b128 v[84:87], v12 offset:1088
    ds_read_b128 v[88:91], v12 offset:2176
    ds_read_b128 v[92:95], v12 offset:3264
    s_waitcnt lgkmcnt(3)
    v_mfma_f32_32x32x16_bf16 v[16:31], v[112:115], v[80:83], 0
    ds_read_b128 v[80:83], v12 offset:4352
    s_waitcnt lgkmcnt(3)
    v_mfma_f32_32x32x16_bf16 v[16:31], v[116:119], v[84:87], v[16:31]
    ds_read_b128 v[84:87], v12 offset:5440
    s_waitcnt lgkmcnt(3)
    v_mfma_f32_32x32x16_bf16 v[16:31], v[120:123], v[88:91], v[16:31]
    ds_read_b128 v[88:91], v12 offset:6528
    s_waitcnt lgkmcnt(3)
    v_mfma_f32_32x32x16_bf16 v[16:31], v[124:127], v[92:95], v[16:31]
    ds_read_b128 v[92:95], v12 offset:7616
    s_waitcnt lgkmcnt(3)
    v_mfma_f32_32x32x16_bf16 v[16:31], v[128:131], v[80:83], v[16:31]
    ds_read_b128 v[80:83], v12 offset:8704
    s_waitcnt lgkmcnt(3)
    v_mfma_f32_32x32x16_bf16 v[16:31], v[132:135], v[84:87], v[16:31]
    ds_read_b128 v[84:87], v12 offset:9792
    s_waitcnt lgkmcnt(3)
    v_mfma_f32_32x32x16_bf16 v[16:31], v[136:139], v[88:91], v[16:31]
    ds_read_b128 v[88:91], v12 offset:10880
    s_waitcnt lgkmcnt(3)
    v_mfma_f32_32x32x16_bf16 v[16:31], v[140:143], v[92:95], v[16:31]
    ds_read_b128 v[92:95], v12 offset:11968
    s_waitcnt lgkmcnt(3)
    v_mfma_f32_32x32x16_bf16 v[16:31], v[144:147], v[80:83], v[16:31]
    ds_read_b128 v[80:83], v12 offset:13056
    s_waitcnt lgkmcnt(3)
    v_mfma_f32_32x32x16_bf16 v[16:31], v[148:151], v[84:87], v[16:31]
    ds_read_b128 v[84:87], v12 offset:14144
    s_waitcnt lgkmcnt(3)
    v_mfma_f32_32x32x16_bf16 v[16:31], v[152:155], v[88:91], v[16:31]
    ds_read_b128 v[88:91], v12 offset:15232
    s_waitcnt lgkmcnt(3)
    v_mfma_f32_32x32x16_bf16 v[16:31], v[156:159], v[92:95], v[16:31]
    ds_read_b128 v[92:95], v12 offset:16320
    s_waitcnt lgkmcnt(3)
    v_mfma_f32_32x32x16_bf16 v[16:31], v[160:163], v[80:83], v[16:31]
    ds_read_b128 v[80:83], v12 offset:17408
    s_waitcnt lgkmcnt(3)
    v_mfma_f32_32x32x16_bf16 v[16:31], v[164:167], v[84:87], v[16:31]
    ds_read_b128 v[84:87], v12 offset:18496
    s_waitcnt lgkmcnt(3)
    v_mfma_f32_32x32x16_bf16 v[16:31], v[168:171], v[88:91], v[16:31]
    ds_read_b128 v[88:91], v12 offset:19584
    s_waitcnt lgkmcnt(3)
    v_mfma_f32_32x32x16_bf16 v[16:31], v[172:175], v[92:95], v[16:31]
    ds_read_b128 v[92:95], v12 offset:20672
    s_waitcnt lgkmcnt(3)
    v_mfma_f32_32x32x16_bf16 v[16:31], v[176:179], v[80:83], v[16:31]
    ds_read_b128 v[80:83], v12 offset:21760
    s_waitcnt lgkmcnt(3)
    v_mfma_f32_32x32x16_bf16 v[16:31], v[180:183], v[84:87], v[16:31]
    ds_read_b128 v[84:87], v12 offset:22848
    s_waitcnt lgkmcnt(3)
    v_mfma_f32_32x32x16_bf16 v[16:31], v[184:187], v[88:91], v[16:31]
    ds_read_b128 v[88:91], v12 offset:23936
    s_waitcnt lgkmcnt(3)
    v_mfma_f32_32x32x16_bf16 v[16:31], v[188:191], v[92:95], v[16:31]
    ds_read_b128 v[92:95], v12 offset:25024
    s_waitcnt lgkmcnt(3)
    v_mfma_f32_32x32x16_bf16 v[16:31], v[192:195], v[80:83], v[16:31]
    ds_read_b128 v[80:83], v12 offset:26112
    s_waitcnt lgkmcnt(3)
    v_mfma_f32_32x32x16_bf16 v[16:31], v[196:199], v[84:87], v[16:31]
    ds_read_b128 v[84:87], v12 offset:27200
    s_waitcnt lgkmcnt(3)
    v_mfma_f32_32x32x16_bf16 v[16:31], v[200:203], v[88:91], v[16:31]
    ds_read_b128 v[88:91], v12 offset:28288
    s_waitcnt lgkmcnt(3)
    v_mfma_f32_32x32x16_bf16 v[16:31], v[204:207], v[92:95], v[16:31]
    ds_read_b128 v[92:95], v12 offset:29376
    s_waitcnt lgkmcnt(3)
    v_mfma_f32_32x32x16_bf16 v[16:31], v[208:211], v[80:83], v[16:31]
    ds_read_b128 v[80:83], v12 offset:30464
    s_waitcnt lgkmcnt(3)
    v_mfma_f32_32x32x16_bf16 v[16:31], v[212:215], v[84:87], v[16:31]
    ds_read_b128 v[84:87], v12 offset:31552
    s_waitcnt lgkmcnt(3)
    v_mfma_f32_32x32x16_bf16 v[16:31], v[216:219], v[88:91], v[16:31]
    ds_read_b128 v[88:91], v12 offset:32640
    s_waitcnt lgkmcnt(3)
    v_mfma_f32_32x32x16_bf16 v[16:31], v[220:223], v[92:95], v[16:31]
    ds_read_b128 v[92:95], v12 offset:33728
    s_waitcnt lgkmcnt(3)
    v_mfma_f32_32x32x16_bf16 v[16:31], v[224:227], v[80:83], v[16:31]
    ds_read_b128 v[80:83], v12 offset:34816
    s_waitcnt lgkmcnt(3)
    v_mfma_f32_32x32x16_bf16 v[16:31], v[228:231], v[84:87], v[16:31]
    ds_read_b128 v[84:87], v12 offset:35904
    s_waitcnt lgkmcnt(3)
    v_mfma_f32_32x32x16_bf16 v[16:31], v[232:235], v[88:91], v[16:31]
    ds_read_b128 v[88:91], v12 offset:36992
    s_waitcnt lgkmcnt(3)
    v_mfma_f32_32x32x16_bf16 v[16:31], v[236:239], v[92:95], v[16:31]
    ds_read_b128 v[92:95], v12 offset:38080
    s_waitcnt lgkmcnt(3)
    v_mfma_f32_32x32x16_bf16 v[16:31], v[240:243], v[80:83], v[16:31]
    s_waitcnt lgkmcnt(2)
    v_mfma_f32_32x32x16_bf16 v[16:31], v[244:247], v[84:87], v[16:31]
    s_waitcnt lgkmcnt(1)
    v_mfma_f32_32x32x16_bf16 v[16:31], v[248:251], v[88:91], v[16:31]
    s_waitcnt lgkmcnt(0)
    v_mfma_f32_32x32x16_bf16 v[16:31], v[252:255], v[92:95], v[16:31]
    v_mov_b32 v106, s22
    s_nop 10
    v_cvt_pk_bf16_f32 v104, v16, v17
    v_lshlrev_b32 v16, 16, v104
    v_and_b32 v17, 0xffff0000, v104
    v_cvt_pk_bf16_f32 v104, v18, v19
    v_lshlrev_b32 v18, 16, v104
    v_and_b32 v19, 0xffff0000, v104
    v_cvt_pk_bf16_f32 v104, v20, v21
    v_lshlrev_b32 v20, 16, v104
    v_and_b32 v21, 0xffff0000, v104
    v_cvt_pk_bf16_f32 v104, v22, v23
    v_lshlrev_b32 v22, 16, v104
    v_and_b32 v23, 0xffff0000, v104
    v_cvt_pk_bf16_f32 v104, v24, v25
    v_lshlrev_b32 v24, 16, v104
    v_and_b32 v25, 0xffff0000, v104
    v_cvt_pk_bf16_f32 v104, v26, v27
    v_lshlrev_b32 v26, 16, v104
    v_and_b32 v27, 0xffff0000, v104
    v_cvt_pk_bf16_f32 v104, v28, v29
    v_lshlrev_b32 v28, 16, v104
    v_and_b32 v29, 0xffff0000, v104
    v_cvt_pk_bf16_f32 v104, v30, v31
    v_lshlrev_b32 v30, 16, v104
    v_and_b32 v31, 0xffff0000, v104
    v_mul_f32 v104, v16, v16
    v_fma_f32 v104, v104, s23, v106
    v_mul_f32 v104, v16, v104
    v_exp_f32 v104, v104
    s_nop 0
    v_add_f32 v104, 1.0, v104
    v_rcp_f32 v104, v104
    s_nop 0
    v_mul_f32 v16, v16, v104
    v_mul_f32 v104, v17, v17
    v_fma_f32 v104, v104, s23, v106
    v_mul_f32 v104, v17, v104
    v_exp_f32 v104, v104
    s_nop 0
    v_add_f32 v104, 1.0, v104
    v_rcp_f32 v104, v104
    s_nop 0
    v_mul_f32 v17, v17, v104
    v_mul_f32 v104, v18, v18
    v_fma_f32 v104, v104, s23, v106
    v_mul_f32 v104, v18, v104
    v_exp_f32 v104, v104
    s_nop 0
    v_add_f32 v104, 1.0, v104
    v_rcp_f32 v104, v104
    s_nop 0
    v_mul_f32 v18, v18, v104
    v_mul_f32 v104, v19, v19
    v_fma_f32 v104, v104, s23, v106
    v_mul_f32 v104, v19, v104
    v_exp_f32 v104, v104
    s_nop 0
    v_add_f32 v104, 1.0, v104
    v_rcp_f32 v104, v104
    s_nop 0
    v_mul_f32 v19, v19, v104
    v_mul_f32 v104, v20, v20
    v_fma_f32 v104, v104, s23, v106
    v_mul_f32 v104, v20, v104
    v_exp_f32 v104, v104
    s_nop 0
    v_add_f32 v104, 1.0, v104
    v_rcp_f32 v104, v104
    s_nop 0
    v_mul_f32 v20, v20, v104
    v_mul_f32 v104, v21, v21
    v_fma_f32 v104, v104, s23, v106
    v_mul_f32 v104, v21, v104
    v_exp_f32 v104, v104
    s_nop 0
    v_add_f32 v104, 1.0, v104
    v_rcp_f32 v104, v104
    s_nop 0
    v_mul_f32 v21, v21, v104
    v_mul_f32 v104, v22, v22
    v_fma_f32 v104, v104, s23, v106
    v_mul_f32 v104, v22, v104
    v_exp_f32 v104, v104
    s_nop 0
    v_add_f32 v104, 1.0, v104
    v_rcp_f32 v104, v104
    s_nop 0
    v_mul_f32 v22, v22, v104
    v_mul_f32 v104, v23, v23
    v_fma_f32 v104, v104, s23, v106
    v_mul_f32 v104, v23, v104
    v_exp_f32 v104, v104
    s_nop 0
    v_add_f32 v104, 1.0, v104
    v_rcp_f32 v104, v104
    s_nop 0
    v_mul_f32 v23, v23, v104
    v_mul_f32 v104, v24, v24
    v_fma_f32 v104, v104, s23, v106
    v_mul_f32 v104, v24, v104
    v_exp_f32 v104, v104
    s_nop 0
    v_add_f32 v104, 1.0, v104
    v_rcp_f32 v104, v104
    s_nop 0
    v_mul_f32 v24, v24, v104
    v_mul_f32 v104, v25, v25
    v_fma_f32 v104, v104, s23, v106
    v_mul_f32 v104, v25, v104
    v_exp_f32 v104, v104
    s_nop 0
    v_add_f32 v104, 1.0, v104
    v_rcp_f32 v104, v104
    s_nop 0
    v_mul_f32 v25, v25, v104
    v_mul_f32 v104, v26, v26
    v_fma_f32 v104, v104, s23, v106
    v_mul_f32 v104, v26, v104
    v_exp_f32 v104, v104
    s_nop 0
    v_add_f32 v104, 1.0, v104
    v_rcp_f32 v104, v104
    s_nop 0
    v_mul_f32 v26, v26, v104
    v_mul_f32 v104, v27, v27
    v_fma_f32 v104, v104, s23, v106
    v_mul_f32 v104, v27, v104
    v_exp_f32 v104, v104
    s_nop 0
    v_add_f32 v104, 1.0, v104
    v_rcp_f32 v104, v104
    s_nop 0
    v_mul_f32 v27, v27, v104
    v_mul_f32 v104, v28, v28
    v_fma_f32 v104, v104, s23, v106
    v_mul_f32 v104, v28, v104
    v_exp_f32 v104, v104
    s_nop 0
    v_add_f32 v104, 1.0, v104
    v_rcp_f32 v104, v104
    s_nop 0
    v_mul_f32 v28, v28, v104
    v_mul_f32 v104, v29, v29
    v_fma_f32 v104, v104, s23, v106
    v_mul_f32 v104, v29, v104
    v_exp_f32 v104, v104
    s_nop 0
    v_add_f32 v104, 1.0, v104
    v_rcp_f32 v104, v104
    s_nop 0
    v_mul_f32 v29, v29, v104
    v_mul_f32 v104, v30, v30
    v_fma_f32 v104, v104, s23, v106
    v_mul_f32 v104, v30, v104
    v_exp_f32 v104, v104
    s_nop 0
    v_add_f32 v104, 1.0, v104
    v_rcp_f32 v104, v104
    s_nop 0
    v_mul_f32 v30, v30, v104
    v_mul_f32 v104, v31, v31
    v_fma_f32 v104, v104, s23, v106
    v_mul_f32 v104, v31, v104
    v_exp_f32 v104, v104
    s_nop 0
    v_add_f32 v104, 1.0, v104
    v_rcp_f32 v104, v104
    s_nop 0
    v_mul_f32 v31, v31, v104
    v_cvt_pk_bf16_f32 v96, v16, v17
    v_cvt_pk_bf16_f32 v97, v18, v19
    v_cvt_pk_bf16_f32 v98, v20, v21
    v_cvt_pk_bf16_f32 v99, v22, v23
    v_cvt_pk_bf16_f32 v100, v24, v25
    v_cvt_pk_bf16_f32 v101, v26, v27
    v_cvt_pk_bf16_f32 v102, v28, v29
    v_cvt_pk_bf16_f32 v103, v30, v31
    v_permlane32_swap_b32 v96, v98
    v_permlane32_swap_b32 v97, v99
    v_permlane32_swap_b32 v100, v102
    v_permlane32_swap_b32 v101, v103
    s_mul_i32 s19, s29, 294912
    s_add_u32 s19, s19, s18
    buffer_store_dwordx4 v[96:99], v0, s[4:7], s19 offen sc1
    buffer_store_dwordx4 v[100:103], v0, s[4:7], s19 offen offset:1024 sc1
    s_cmp_eq_u32 s31, 1
    s_cbranch_scc0 Lsgn_263_m
    s_waitcnt vmcnt(2)
    ds_write_b128 v32, v[40:43] offset:39168
    ds_write_b128 v33, v[44:47] offset:39168
    ds_write_b128 v34, v[48:51] offset:39168
    ds_write_b128 v35, v[52:55] offset:39168
    ds_write_b128 v36, v[56:59] offset:39168
    ds_write_b128 v37, v[60:63] offset:39168
    ds_write_b128 v38, v[64:67] offset:39168
    ds_write_b128 v39, v[68:71] offset:39168
    ds_write_b128 v76, v[72:75] offset:39168
    s_cmp_le_u32 s27, 3
    s_cbranch_scc0 Lsgz_266_m
    s_waitcnt vmcnt(0) lgkmcnt(0)
    s_barrier
    s_cmp_lg_u32 s13, 0
    s_cbranch_scc1 Lfs0_267
    s_mul_i32 s98, s29, 64
    s_add_u32 s98, s98, s12
    s_lshl_b32 s98, s98, 2
    s_add_u32 s98, s98, 62032896
    v_mov_b32 v11, s90
    s_mov_b64 exec, 1
    buffer_store_dword v11, off, s[4:7], s98 offset:0 sc1
    s_mov_b64 exec, -1
Lfs0_267:
    s_mov_b32 s30, -1
    s_branch Lsgj_264_m
Lsgz_266_m:
    s_waitcnt lgkmcnt(0)
    s_barrier
    s_cmp_eq_u32 s30, -1
    s_cbranch_scc1 Lsgd_268_m
    s_cmp_lg_u32 s13, 0
    s_cbranch_scc1 Lfs0_269
    s_mul_i32 s98, s30, 64
    s_add_u32 s98, s98, s12
    s_lshl_b32 s98, s98, 2
    s_add_u32 s98, s98, 62032896
    v_mov_b32 v11, s90
    s_mov_b64 exec, 1
    buffer_store_dword v11, off, s[4:7], s98 offset:0 sc1
    s_mov_b64 exec, -1
Lfs0_269:
Lsgd_268_m:
    s_mov_b32 s30, s29
    s_branch Lsgj_264_m
Lsgn_263_m:
    s_cmp_lg_u32 s13, 0
    s_cbranch_scc1 Lfa_270_m
    s_mul_i32 s88, s17, 128
    s_add_u32 s88, s88, 62023680
    buffer_load_dwordx4 v[108:111], v0, s[4:7], s88 offen sc1
    s_waitcnt vmcnt(1)
    s_branch Lfb_271_m
Lfa_270_m:
    s_waitcnt vmcnt(0)
Lfb_271_m:
    s_barrier
    s_cmp_eq_u32 s30, -1
    s_cbranch_scc1 Lsgd_273_m
    s_cmp_lg_u32 s13, 0
    s_cbranch_scc1 Lfs0_274
    s_mul_i32 s98, s30, 64
    s_add_u32 s98, s98, s12
    s_lshl_b32 s98, s98, 2
    s_add_u32 s98, s98, 62032896
    v_mov_b32 v11, s90
    s_mov_b64 exec, 1
    buffer_store_dword v11, off, s[4:7], s98 offset:0 sc1
    s_mov_b64 exec, -1
Lfs0_274:
Lsgd_273_m:
    s_cmp_lg_u32 s13, 0
    s_cbranch_scc1 Lfs0_275
    s_mul_i32 s98, s29, 64
    s_add_u32 s98, s98, s12
    s_lshl_b32 s98, s98, 2
    s_add_u32 s98, s98, 62032896
    v_mov_b32 v11, s90
    s_mov_b64 exec, 1
    buffer_store_dword v11, off, s[4:7], s98 offset:0 sc1
    s_mov_b64 exec, -1
Lfs0_275:
    s_mov_b32 s30, -1
    s_cmp_ge_u32 s17, 64
    s_cbranch_scc1 Lsge_261_m
    s_cmp_lg_u32 s13, 0
    s_cbranch_scc1 Lfc_272_m
    s_waitcnt vmcnt(0)
    s_branch Lfpm_278_m
Lfp_276_m:
    buffer_load_dwordx4 v[108:111], v0, s[4:7], s88 offen sc1
    s_waitcnt vmcnt(0)
Lfpm_278_m:
    v_xor_b32 v108, s90, v108
    v_xor_b32 v109, s90, v109
    v_xor_b32 v110, s90, v110
    v_xor_b32 v111, s90, v111
    v_or3_b32 v108, v108, v109, v110
    v_or_b32 v108, v108, v111
    v_cmp_ne_u32 vcc, 0, v108
    s_nop 3
    s_and_b32 vcc_lo, vcc_lo, 0xffffffff
    s_and_b32 vcc_hi, vcc_hi, 0xffffffff
    s_ff1_i32_b64 s92, vcc
    s_cmp_eq_u32 s92, -1
    s_cselect_b32 s92, 64, s92
    s_lshr_b32 s92, s92, 3
    s_cmp_lg_u32 s92, 0
    s_cbranch_scc1 Lfpg_277_m
    s_sleep 2
    s_add_u32 s99, s99, 1
    s_cmp_lt_u32 s99, 4194304
    s_cbranch_scc1 Lfp_276_m
    s_endpgm
Lfpg_277_m:
    s_add_u32 s92, s92, s17
    v_mov_b32 v14, 163832
    v_mov_b32 v15, s92
    ds_write_b32 v14, v15
    s_waitcnt lgkmcnt(0)
Lfc_272_m:
    s_barrier
    v_mov_b32 v14, 163832
    ds_read_b32 v15, v14
    s_waitcnt lgkmcnt(0)
    v_readfirstlane_b32 s92, v15
    s_mul_i32 s28, s17, 36864
    s_mul_i32 s19, s13, 9216
    s_add_u32 s28, s28, s19
    s_add_u32 s28, s28, 66060288
    s_add_u32 s20, s28, 4096
    s_add_u32 s21, s28, 8192
    buffer_load_dwordx4 v[40:43], v0, s[4:7], s28 offen offset:0 sc1
    buffer_load_dwordx4 v[44:47], v0, s[4:7], s28 offen offset:1024 sc1
    buffer_load_dwordx4 v[48:51], v0, s[4:7], s28 offen offset:2048 sc1
    buffer_load_dwordx4 v[52:55], v0, s[4:7], s28 offen offset:3072 sc1
    buffer_load_dwordx4 v[56:59], v0, s[4:7], s20 offen offset:0 sc1
    buffer_load_dwordx4 v[60:63], v0, s[4:7], s20 offen offset:1024 sc1
    buffer_load_dwordx4 v[64:67], v0, s[4:7], s20 offen offset:2048 sc1
    buffer_load_dwordx4 v[68:71], v0, s[4:7], s20 offen offset:3072 sc1
    buffer_load_dwordx4 v[72:75], v0, s[4:7], s21 offen offset:0 sc1
    s_waitcnt vmcnt(0)
    ds_write_b128 v32, v[40:43] offset:39168
    ds_write_b128 v33, v[44:47] offset:39168
    ds_write_b128 v34, v[48:51] offset:39168
    ds_write_b128 v35, v[52:55] offset:39168
    ds_write_b128 v36, v[56:59] offset:39168
    ds_write_b128 v37, v[60:63] offset:39168
    ds_write_b128 v38, v[64:67] offset:39168
    ds_write_b128 v39, v[68:71] offset:39168
    ds_write_b128 v76, v[72:75] offset:39168
    s_waitcnt lgkmcnt(0)
    s_barrier
Lsgj_264_m:
    s_add_u32 s27, s27, 1
    s_mov_b32 s29, s17
    s_mov_b32 s31, 0
    s_cmp_ge_u32 s17, 40
    s_cselect_b32 s19, 2, 1
    s_add_u32 s17, s17, s19
    s_cmp_ge_u32 s17, 64
    s_cbranch_scc1 Lsgl_279_m
    s_cmp_lt_u32 s17, s92
    s_cbranch_scc0 Lsgl_279_m
    s_mul_i32 s28, s17, 36864
    s_mul_i32 s19, s13, 9216
    s_add_u32 s28, s28, s19
    s_add_u32 s28, s28, 66060288
    s_add_u32 s20, s28, 4096
    s_add_u32 s21, s28, 8192
    buffer_load_dwordx4 v[40:43], v0, s[4:7], s28 offen offset:0 sc1
    buffer_load_dwordx4 v[44:47], v0, s[4:7], s28 offen offset:1024 sc1
    buffer_load_dwordx4 v[48:51], v0, s[4:7], s28 offen offset:2048 sc1
    buffer_load_dwordx4 v[52:55], v0, s[4:7], s28 offen offset:3072 sc1
    buffer_load_dwordx4 v[56:59], v0, s[4:7], s20 offen offset:0 sc1
    buffer_load_dwordx4 v[60:63], v0, s[4:7], s20 offen offset:1024 sc1
    buffer_load_dwordx4 v[64:67], v0, s[4:7], s20 offen offset:2048 sc1
    buffer_load_dwordx4 v[68:71], v0, s[4:7], s20 offen offset:3072 sc1
    buffer_load_dwordx4 v[72:75], v0, s[4:7], s21 offen offset:0 sc1
    s_mov_b32 s31, 1
Lsgl_279_m:
    ds_read_b128 v[80:83], v10 offset:0
    ds_read_b128 v[84:87], v10 offset:1088
    ds_read_b128 v[88:91], v10 offset:2176
    ds_read_b128 v[92:95], v10 offset:3264
    s_waitcnt lgkmcnt(3)
    v_mfma_f32_32x32x16_bf16 v[16:31], v[112:115], v[80:83], 0
    ds_read_b128 v[80:83], v10 offset:4352
    s_waitcnt lgkmcnt(3)
    v_mfma_f32_32x32x16_bf16 v[16:31], v[116:119], v[84:87], v[16:31]
    ds_read_b128 v[84:87], v10 offset:5440
    s_waitcnt lgkmcnt(3)
    v_mfma_f32_32x32x16_bf16 v[16:31], v[120:123], v[88:91], v[16:31]
    ds_read_b128 v[88:91], v10 offset:6528
    s_waitcnt lgkmcnt(3)
    v_mfma_f32_32x32x16_bf16 v[16:31], v[124:127], v[92:95], v[16:31]
    ds_read_b128 v[92:95], v10 offset:7616
    s_waitcnt lgkmcnt(3)
    v_mfma_f32_32x32x16_bf16 v[16:31], v[128:131], v[80:83], v[16:31]
    ds_read_b128 v[80:83], v10 offset:8704
    s_waitcnt lgkmcnt(3)
    v_mfma_f32_32x32x16_bf16 v[16:31], v[132:135], v[84:87], v[16:31]
    ds_read_b128 v[84:87], v10 offset:9792
    s_waitcnt lgkmcnt(3)
    v_mfma_f32_32x32x16_bf16 v[16:31], v[136:139], v[88:91], v[16:31]
    ds_read_b128 v[88:91], v10 offset:10880
    s_waitcnt lgkmcnt(3)
    v_mfma_f32_32x32x16_bf16 v[16:31], v[140:143], v[92:95], v[16:31]
    ds_read_b128 v[92:95], v10 offset:11968
    s_waitcnt lgkmcnt(3)
    v_mfma_f32_32x32x16_bf16 v[16:31], v[144:147], v[80:83], v[16:31]
    ds_read_b128 v[80:83], v10 offset:13056
    s_waitcnt lgkmcnt(3)
    v_mfma_f32_32x32x16_bf16 v[16:31], v[148:151], v[84:87], v[16:31]
    ds_read_b128 v[84:87], v10 offset:14144
    s_waitcnt lgkmcnt(3)
    v_mfma_f32_32x32x16_bf16 v[16:31], v[152:155], v[88:91], v[16:31]
    ds_read_b128 v[88:91], v10 offset:15232
    s_waitcnt lgkmcnt(3)
    v_mfma_f32_32x32x16_bf16 v[16:31], v[156:159], v[92:95], v[16:31]
    ds_read_b128 v[92:95], v10 offset:16320
    s_waitcnt lgkmcnt(3)
    v_mfma_f32_32x32x16_bf16 v[16:31], v[160:163], v[80:83], v[16:31]
    ds_read_b128 v[80:83], v10 offset:17408
    s_waitcnt lgkmcnt(3)
    v_mfma_f32_32x32x16_bf16 v[16:31], v[164:167], v[84:87], v[16:31]
    ds_read_b128 v[84:87], v10 offset:18496
    s_waitcnt lgkmcnt(3)
    v_mfma_f32_32x32x16_bf16 v[16:31], v[168:171], v[88:91], v[16:31]
    ds_read_b128 v[88:91], v10 offset:19584
    s_waitcnt lgkmcnt(3)
    v_mfma_f32_32x32x16_bf16 v[16:31], v[172:175], v[92:95], v[16:31]
    ds_read_b128 v[92:95], v10 offset:20672
    s_waitcnt lgkmcnt(3)
    v_mfma_f32_32x32x16_bf16 v[16:31], v[176:179], v[80:83], v[16:31]
    ds_read_b128 v[80:83], v10 offset:21760
    s_waitcnt lgkmcnt(3)
    v_mfma_f32_32x32x16_bf16 v[16:31], v[180:183], v[84:87], v[16:31]
    ds_read_b128 v[84:87], v10 offset:22848
    s_waitcnt lgkmcnt(3)
    v_mfma_f32_32x32x16_bf16 v[16:31], v[184:187], v[88:91], v[16:31]
    ds_read_b128 v[88:91], v10 offset:23936
    s_waitcnt lgkmcnt(3)
    v_mfma_f32_32x32x16_bf16 v[16:31], v[188:191], v[92:95], v[16:31]
    ds_read_b128 v[92:95], v10 offset:25024
    s_waitcnt lgkmcnt(3)
    v_mfma_f32_32x32x16_bf16 v[16:31], v[192:195], v[80:83], v[16:31]
    ds_read_b128 v[80:83], v10 offset:26112
    s_waitcnt lgkmcnt(3)
    v_mfma_f32_32x32x16_bf16 v[16:31], v[196:199], v[84:87], v[16:31]
    ds_read_b128 v[84:87], v10 offset:27200
    s_waitcnt lgkmcnt(3)
    v_mfma_f32_32x32x16_bf16 v[16:31], v[200:203], v[88:91], v[16:31]
    ds_read_b128 v[88:91], v10 offset:28288
    s_waitcnt lgkmcnt(3)
    v_mfma_f32_32x32x16_bf16 v[16:31], v[204:207], v[92:95], v[16:31]
    ds_read_b128 v[92:95], v10 offset:29376
    s_waitcnt lgkmcnt(3)
    v_mfma_f32_32x32x16_bf16 v[16:31], v[208:211], v[80:83], v[16:31]
    ds_read_b128 v[80:83], v10 offset:30464
    s_waitcnt lgkmcnt(3)
    v_mfma_f32_32x32x16_bf16 v[16:31], v[212:215], v[84:87], v[16:31]
    ds_read_b128 v[84:87], v10 offset:31552
    s_waitcnt lgkmcnt(3)
    v_mfma_f32_32x32x16_bf16 v[16:31], v[216:219], v[88:91], v[16:31]
    ds_read_b128 v[88:91], v10 offset:32640
    s_waitcnt lgkmcnt(3)
    v_mfma_f32_32x32x16_bf16 v[16:31], v[220:223], v[92:95], v[16:31]
    ds_read_b128 v[92:95], v10 offset:33728
    s_waitcnt lgkmcnt(3)
    v_mfma_f32_32x32x16_bf16 v[16:31], v[224:227], v[80:83], v[16:31]
    ds_read_b128 v[80:83], v10 offset:34816
    s_waitcnt lgkmcnt(3)
    v_mfma_f32_32x32x16_bf16 v[16:31], v[228:231], v[84:87], v[16:31]
    ds_read_b128 v[84:87], v10 offset:35904
    s_waitcnt lgkmcnt(3)
    v_mfma_f32_32x32x16_bf16 v[16:31], v[232:235], v[88:91], v[16:31]
    ds_read_b128 v[88:91], v10 offset:36992
    s_waitcnt lgkmcnt(3)
    v_mfma_f32_32x32x16_bf16 v[16:31], v[236:239], v[92:95], v[16:31]
    ds_read_b128 v[92:95], v10 offset:38080
    s_waitcnt lgkmcnt(3)
    v_mfma_f32_32x32x16_bf16 v[16:31], v[240:243], v[80:83], v[16:31]
    s_waitcnt lgkmcnt(2)
    v_mfma_f32_32x32x16_bf16 v[16:31], v[244:247], v[84:87], v[16:31]
    s_waitcnt lgkmcnt(1)
    v_mfma_f32_32x32x16_bf16 v[16:31], v[248:251], v[88:91], v[16:31]
    s_waitcnt lgkmcnt(0)
    v_mfma_f32_32x32x16_bf16 v[16:31], v[252:255], v[92:95], v[16:31]
    v_mov_b32 v106, s22
    s_nop 10
    v_cvt_pk_bf16_f32 v104, v16, v17
    v_lshlrev_b32 v16, 16, v104
    v_and_b32 v17, 0xffff0000, v104
    v_cvt_pk_bf16_f32 v104, v18, v19
    v_lshlrev_b32 v18, 16, v104
    v_and_b32 v19, 0xffff0000, v104
    v_cvt_pk_bf16_f32 v104, v20, v21
    v_lshlrev_b32 v20, 16, v104
    v_and_b32 v21, 0xffff0000, v104
    v_cvt_pk_bf16_f32 v104, v22, v23
    v_lshlrev_b32 v22, 16, v104
    v_and_b32 v23, 0xffff0000, v104
    v_cvt_pk_bf16_f32 v104, v24, v25
    v_lshlrev_b32 v24, 16, v104
    v_and_b32 v25, 0xffff0000, v104
    v_cvt_pk_bf16_f32 v104, v26, v27
    v_lshlrev_b32 v26, 16, v104
    v_and_b32 v27, 0xffff0000, v104
    v_cvt_pk_bf16_f32 v104, v28, v29
    v_lshlrev_b32 v28, 16, v104
    v_and_b32 v29, 0xffff0000, v104
    v_cvt_pk_bf16_f32 v104, v30, v31
    v_lshlrev_b32 v30, 16, v104
    v_and_b32 v31, 0xffff0000, v104
    v_mul_f32 v104, v16, v16
    v_fma_f32 v104, v104, s23, v106
    v_mul_f32 v104, v16, v104
    v_exp_f32 v104, v104
    s_nop 0
    v_add_f32 v104, 1.0, v104
    v_rcp_f32 v104, v104
    s_nop 0
    v_mul_f32 v16, v16, v104
    v_mul_f32 v104, v17, v17
    v_fma_f32 v104, v104, s23, v106
    v_mul_f32 v104, v17, v104
    v_exp_f32 v104, v104
    s_nop 0
    v_add_f32 v104, 1.0, v104
    v_rcp_f32 v104, v104
    s_nop 0
    v_mul_f32 v17, v17, v104
    v_mul_f32 v104, v18, v18
    v_fma_f32 v104, v104, s23, v106
    v_mul_f32 v104, v18, v104
    v_exp_f32 v104, v104
    s_nop 0
    v_add_f32 v104, 1.0, v104
    v_rcp_f32 v104, v104
    s_nop 0
    v_mul_f32 v18, v18, v104
    v_mul_f32 v104, v19, v19
    v_fma_f32 v104, v104, s23, v106
    v_mul_f32 v104, v19, v104
    v_exp_f32 v104, v104
    s_nop 0
    v_add_f32 v104, 1.0, v104
    v_rcp_f32 v104, v104
    s_nop 0
    v_mul_f32 v19, v19, v104
    v_mul_f32 v104, v20, v20
    v_fma_f32 v104, v104, s23, v106
    v_mul_f32 v104, v20, v104
    v_exp_f32 v104, v104
    s_nop 0
    v_add_f32 v104, 1.0, v104
    v_rcp_f32 v104, v104
    s_nop 0
    v_mul_f32 v20, v20, v104
    v_mul_f32 v104, v21, v21
    v_fma_f32 v104, v104, s23, v106
    v_mul_f32 v104, v21, v104
    v_exp_f32 v104, v104
    s_nop 0
    v_add_f32 v104, 1.0, v104
    v_rcp_f32 v104, v104
    s_nop 0
    v_mul_f32 v21, v21, v104
    v_mul_f32 v104, v22, v22
    v_fma_f32 v104, v104, s23, v106
    v_mul_f32 v104, v22, v104
    v_exp_f32 v104, v104
    s_nop 0
    v_add_f32 v104, 1.0, v104
    v_rcp_f32 v104, v104
    s_nop 0
    v_mul_f32 v22, v22, v104
    v_mul_f32 v104, v23, v23
    v_fma_f32 v104, v104, s23, v106
    v_mul_f32 v104, v23, v104
    v_exp_f32 v104, v104
    s_nop 0
    v_add_f32 v104, 1.0, v104
    v_rcp_f32 v104, v104
    s_nop 0
    v_mul_f32 v23, v23, v104
    v_mul_f32 v104, v24, v24
    v_fma_f32 v104, v104, s23, v106
    v_mul_f32 v104, v24, v104
    v_exp_f32 v104, v104
    s_nop 0
    v_add_f32 v104, 1.0, v104
    v_rcp_f32 v104, v104
    s_nop 0
    v_mul_f32 v24, v24, v104
    v_mul_f32 v104, v25, v25
    v_fma_f32 v104, v104, s23, v106
    v_mul_f32 v104, v25, v104
    v_exp_f32 v104, v104
    s_nop 0
    v_add_f32 v104, 1.0, v104
    v_rcp_f32 v104, v104
    s_nop 0
    v_mul_f32 v25, v25, v104
    v_mul_f32 v104, v26, v26
    v_fma_f32 v104, v104, s23, v106
    v_mul_f32 v104, v26, v104
    v_exp_f32 v104, v104
    s_nop 0
    v_add_f32 v104, 1.0, v104
    v_rcp_f32 v104, v104
    s_nop 0
    v_mul_f32 v26, v26, v104
    v_mul_f32 v104, v27, v27
    v_fma_f32 v104, v104, s23, v106
    v_mul_f32 v104, v27, v104
    v_exp_f32 v104, v104
    s_nop 0
    v_add_f32 v104, 1.0, v104
    v_rcp_f32 v104, v104
    s_nop 0
    v_mul_f32 v27, v27, v104
    v_mul_f32 v104, v28, v28
    v_fma_f32 v104, v104, s23, v106
    v_mul_f32 v104, v28, v104
    v_exp_f32 v104, v104
    s_nop 0
    v_add_f32 v104, 1.0, v104
    v_rcp_f32 v104, v104
    s_nop 0
    v_mul_f32 v28, v28, v104
    v_mul_f32 v104, v29, v29
    v_fma_f32 v104, v104, s23, v106
    v_mul_f32 v104, v29, v104
    v_exp_f32 v104, v104
    s_nop 0
    v_add_f32 v104, 1.0, v104
    v_rcp_f32 v104, v104
    s_nop 0
    v_mul_f32 v29, v29, v104
    v_mul_f32 v104, v30, v30
    v_fma_f32 v104, v104, s23, v106
    v_mul_f32 v104, v30, v104
    v_exp_f32 v104, v104
    s_nop 0
    v_add_f32 v104, 1.0, v104
    v_rcp_f32 v104, v104
    s_nop 0
    v_mul_f32 v30, v30, v104
    v_mul_f32 v104, v31, v31
    v_fma_f32 v104, v104, s23, v106
    v_mul_f32 v104, v31, v104
    v_exp_f32 v104, v104
    s_nop 0
    v_add_f32 v104, 1.0, v104
    v_rcp_f32 v104, v104
    s_nop 0
    v_mul_f32 v31, v31, v104
    v_cvt_pk_bf16_f32 v96, v16, v17
    v_cvt_pk_bf16_f32 v97, v18, v19
    v_cvt_pk_bf16_f32 v98, v20, v21
    v_cvt_pk_bf16_f32 v99, v22, v23
    v_cvt_pk_bf16_f32 v100, v24, v25
    v_cvt_pk_bf16_f32 v101, v26, v27
    v_cvt_pk_bf16_f32 v102, v28, v29
    v_cvt_pk_bf16_f32 v103, v30, v31
    v_permlane32_swap_b32 v96, v98
    v_permlane32_swap_b32 v97, v99
    v_permlane32_swap_b32 v100, v102
    v_permlane32_swap_b32 v101, v103
    s_mul_i32 s19, s29, 294912
    s_add_u32 s19, s19, s18
    buffer_store_dwordx4 v[96:99], v0, s[4:7], s19 offen sc1
    buffer_store_dwordx4 v[100:103], v0, s[4:7], s19 offen offset:1024 sc1
    s_cmp_eq_u32 s31, 1
    s_cbranch_scc0 Lsgn_280_m
    s_waitcnt vmcnt(2)
    ds_write_b128 v32, v[40:43] offset:0
    ds_write_b128 v33, v[44:47] offset:0
    ds_write_b128 v34, v[48:51] offset:0
    ds_write_b128 v35, v[52:55] offset:0
    ds_write_b128 v36, v[56:59] offset:0
    ds_write_b128 v37, v[60:63] offset:0
    ds_write_b128 v38, v[64:67] offset:0
    ds_write_b128 v39, v[68:71] offset:0
    ds_write_b128 v76, v[72:75] offset:0
    s_cmp_le_u32 s27, 3
    s_cbranch_scc0 Lsgz_283_m
    s_waitcnt vmcnt(0) lgkmcnt(0)
    s_barrier
    s_cmp_lg_u32 s13, 0
    s_cbranch_scc1 Lfs0_284
    s_mul_i32 s98, s29, 64
    s_add_u32 s98, s98, s12
    s_lshl_b32 s98, s98, 2
    s_add_u32 s98, s98, 62032896
    v_mov_b32 v11, s90
    s_mov_b64 exec, 1
    buffer_store_dword v11, off, s[4:7], s98 offset:0 sc1
    s_mov_b64 exec, -1
Lfs0_284:
    s_mov_b32 s30, -1
    s_branch Lsgj_281_m
Lsgz_283_m:
    s_waitcnt lgkmcnt(0)
    s_barrier
    s_cmp_eq_u32 s30, -1
    s_cbranch_scc1 Lsgd_285_m
    s_cmp_lg_u32 s13, 0
    s_cbranch_scc1 Lfs0_286
    s_mul_i32 s98, s30, 64
    s_add_u32 s98, s98, s12
    s_lshl_b32 s98, s98, 2
    s_add_u32 s98, s98, 62032896
    v_mov_b32 v11, s90
    s_mov_b64 exec, 1
    buffer_store_dword v11, off, s[4:7], s98 offset:0 sc1
    s_mov_b64 exec, -1
Lfs0_286:
Lsgd_285_m:
    s_mov_b32 s30, s29
    s_branch Lsgj_281_m
Lsgn_280_m:
    s_cmp_lg_u32 s13, 0
    s_cbranch_scc1 Lfa_287_m
    s_mul_i32 s88, s17, 128
    s_add_u32 s88, s88, 62023680
    buffer_load_dwordx4 v[108:111], v0, s[4:7], s88 offen sc1
    s_waitcnt vmcnt(1)
    s_branch Lfb_288_m
Lfa_287_m:
    s_waitcnt vmcnt(0)
Lfb_288_m:
    s_barrier
    s_cmp_eq_u32 s30, -1
    s_cbranch_scc1 Lsgd_290_m
    s_cmp_lg_u32 s13, 0
    s_cbranch_scc1 Lfs0_291
    s_mul_i32 s98, s30, 64
    s_add_u32 s98, s98, s12
    s_lshl_b32 s98, s98, 2
    s_add_u32 s98, s98, 62032896
    v_mov_b32 v11, s90
    s_mov_b64 exec, 1
    buffer_store_dword v11, off, s[4:7], s98 offset:0 sc1
    s_mov_b64 exec, -1
Lfs0_291:
Lsgd_290_m:
    s_cmp_lg_u32 s13, 0
    s_cbranch_scc1 Lfs0_292
    s_mul_i32 s98, s29, 64
    s_add_u32 s98, s98, s12
    s_lshl_b32 s98, s98, 2
    s_add_u32 s98, s98, 62032896
    v_mov_b32 v11, s90
    s_mov_b64 exec, 1
    buffer_store_dword v11, off, s[4:7], s98 offset:0 sc1
    s_mov_b64 exec, -1
Lfs0_292:
    s_mov_b32 s30, -1
    s_cmp_ge_u32 s17, 64
    s_cbranch_scc1 Lsge_261_m
    s_cmp_lg_u32 s13, 0
    s_cbranch_scc1 Lfc_289_m
    s_waitcnt vmcnt(0)
    s_branch Lfpm_295_m
Lfp_293_m:
    buffer_load_dwordx4 v[108:111], v0, s[4:7], s88 offen sc1
    s_waitcnt vmcnt(0)
Lfpm_295_m:
    v_xor_b32 v108, s90, v108
    v_xor_b32 v109, s90, v109
    v_xor_b32 v110, s90, v110
    v_xor_b32 v111, s90, v111
    v_or3_b32 v108, v108, v109, v110
    v_or_b32 v108, v108, v111
    v_cmp_ne_u32 vcc, 0, v108
    s_nop 3
    s_and_b32 vcc_lo, vcc_lo, 0xffffffff
    s_and_b32 vcc_hi, vcc_hi, 0xffffffff
    s_ff1_i32_b64 s92, vcc
    s_cmp_eq_u32 s92, -1
    s_cselect_b32 s92, 64, s92
    s_lshr_b32 s92, s92, 3
    s_cmp_lg_u32 s92, 0
    s_cbranch_scc1 Lfpg_294_m
    s_sleep 2
    s_add_u32 s99, s99, 1
    s_cmp_lt_u32 s99, 4194304
    s_cbranch_scc1 Lfp_293_m
    s_endpgm
Lfpg_294_m:
    s_add_u32 s92, s92, s17
    v_mov_b32 v14, 163832
    v_mov_b32 v15, s92
    ds_write_b32 v14, v15
    s_waitcnt lgkmcnt(0)
Lfc_289_m:
    s_barrier
    v_mov_b32 v14, 163832
    ds_read_b32 v15, v14
    s_waitcnt lgkmcnt(0)
    v_readfirstlane_b32 s92, v15
    s_mul_i32 s28, s17, 36864
    s_mul_i32 s19, s13, 9216
    s_add_u32 s28, s28, s19
    s_add_u32 s28, s28, 66060288
    s_add_u32 s20, s28, 4096
    s_add_u32 s21, s28, 8192
    buffer_load_dwordx4 v[40:43], v0, s[4:7], s28 offen offset:0 sc1
    buffer_load_dwordx4 v[44:47], v0, s[4:7], s28 offen offset:1024 sc1
    buffer_load_dwordx4 v[48:51], v0, s[4:7], s28 offen offset:2048 sc1
    buffer_load_dwordx4 v[52:55], v0, s[4:7], s28 offen offset:3072 sc1
    buffer_load_dwordx4 v[56:59], v0, s[4:7], s20 offen offset:0 sc1
    buffer_load_dwordx4 v[60:63], v0, s[4:7], s20 offen offset:1024 sc1
    buffer_load_dwordx4 v[64:67], v0, s[4:7], s20 offen offset:2048 sc1
    buffer_load_dwordx4 v[68:71], v0, s[4:7], s20 offen offset:3072 sc1
    buffer_load_dwordx4 v[72:75], v0, s[4:7], s21 offen offset:0 sc1
    s_waitcnt vmcnt(0)
    ds_write_b128 v32, v[40:43] offset:0
    ds_write_b128 v33, v[44:47] offset:0
    ds_write_b128 v34, v[48:51] offset:0
    ds_write_b128 v35, v[52:55] offset:0
    ds_write_b128 v36, v[56:59] offset:0
    ds_write_b128 v37, v[60:63] offset:0
    ds_write_b128 v38, v[64:67] offset:0
    ds_write_b128 v39, v[68:71] offset:0
    ds_write_b128 v76, v[72:75] offset:0
    s_waitcnt lgkmcnt(0)
    s_barrier
Lsgj_281_m:
    s_branch Lsg_260_m
Lsge_261_m:
    s_sub_u32 s12, s97, 64
    s_branch Lout_main
Lrolelntwo_61_m:
    s_sub_u32 s12, s97, 200
    s_load_dwordx2 s[8:9], s[42:43], 0
    s_waitcnt lgkmcnt(0)
    s_mov_b32 s10, 2359296
    s_mov_b32 s11, 0x20000
    v_lshrrev_b32 v1, 4, v0
    v_cmp_gt_u32 vcc, 36, v1
    v_mov_b32 v8, 0x70000000
    s_nop 0
    v_cndmask_b32 v2, v8, v0, vcc
    v_lshlrev_b32 v3, 1, v0
    v_cndmask_b32 v3, v8, v3, vcc
    v_mov_b32 v8, 1.0
    v_cndmask_b32 v4, 0, v8, vcc
    s_mov_b32 s98, 61931520
Lfw_296_m:
    s_mov_b64 exec, 0x3fff
    buffer_load_dwordx4 v[160:163], v0, s[4:7], s98 offen sc1
    s_waitcnt vmcnt(0)
    v_xor_b32 v160, s90, v160
    v_xor_b32 v161, s90, v161
    v_xor_b32 v162, s90, v162
    v_xor_b32 v163, s90, v163
    v_or3_b32 v160, v160, v161, v162
    v_or_b32 v160, v160, v163
    v_cmp_ne_u32 vcc, 0, v160
    s_mov_b64 exec, -1
    s_nop 2
    s_and_b32 vcc_lo, vcc_lo, 0x3fff
    s_and_b32 vcc_hi, vcc_hi, 0x0
    s_ff1_i32_b64 s89, vcc
    s_cmp_eq_u32 s89, -1
    s_cselect_b32 s89, 16, s89
    s_lshr_b32 s89, s89, 4
    s_cmp_lg_u32 s89, 0
    s_cbranch_scc1 Lfwg_298_m
    s_sleep 2
    s_add_u32 s99, s99, 1
    s_cmp_lt_u32 s99, 4194304
    s_cbranch_scc1 Lfw_296_m
    s_endpgm
Lfwg_298_m:
Lfwok_297_m:
    s_mov_b32 s19, 61870592
    buffer_load_dwordx4 v[32:35], v3, s[4:7], s19 offen offset:0 sc1
    buffer_load_dwordx4 v[36:39], v3, s[4:7], s19 offen offset:16 sc1
    buffer_load_dwordx4 v[40:43], v3, s[4:7], s19 offen offset:1152 sc1
    buffer_load_dwordx4 v[44:47], v3, s[4:7], s19 offen offset:1168 sc1
    s_mov_b32 s19, 61875200
    buffer_load_dwordx4 v[48:51], v3, s[4:7], s19 offen offset:0 sc1
    buffer_load_dwordx4 v[52:55], v3, s[4:7], s19 offen offset:16 sc1
    buffer_load_dwordx4 v[56:59], v3, s[4:7], s19 offen offset:1152 sc1
    buffer_load_dwordx4 v[60:63], v3, s[4:7], s19 offen offset:1168 sc1
    s_mov_b32 s19, 61872896
    buffer_load_dwordx4 v[64:67], v3, s[4:7], s19 offen offset:0 sc1
    buffer_load_dwordx4 v[68:71], v3, s[4:7], s19 offen offset:16 sc1
    buffer_load_dwordx4 v[72:75], v3, s[4:7], s19 offen offset:1152 sc1
    buffer_load_dwordx4 v[76:79], v3, s[4:7], s19 offen offset:1168 sc1
    s_waitcnt vmcnt(0)
    v_add_f32 v48, 1.0, v48
    v_add_f32 v49, 1.0, v49
    v_add_f32 v50, 1.0, v50
    v_add_f32 v51, 1.0, v51
    v_add_f32 v52, 1.0, v52
    v_add_f32 v53, 1.0, v53
    v_add_f32 v54, 1.0, v54
    v_add_f32 v55, 1.0, v55
    v_add_f32 v56, 1.0, v56
    v_add_f32 v57, 1.0, v57
    v_add_f32 v58, 1.0, v58
    v_add_f32 v59, 1.0, v59
    v_add_f32 v60, 1.0, v60
    v_add_f32 v61, 1.0, v61
    v_add_f32 v62, 1.0, v62
    v_add_f32 v63, 1.0, v63
    v_cvt_pk_bf16_f32 v8, v48, v49
    v_lshlrev_b32 v48, 16, v8
    v_and_b32 v49, 0xffff0000, v8
    v_cvt_pk_bf16_f32 v8, v50, v51
    v_lshlrev_b32 v50, 16, v8
    v_and_b32 v51, 0xffff0000, v8
    v_cvt_pk_bf16_f32 v8, v52, v53
    v_lshlrev_b32 v52, 16, v8
    v_and_b32 v53, 0xffff0000, v8
    v_cvt_pk_bf16_f32 v8, v54, v55
    v_lshlrev_b32 v54, 16, v8
    v_and_b32 v55, 0xffff0000, v8
    v_cvt_pk_bf16_f32 v8, v56, v57
    v_lshlrev_b32 v56, 16, v8
    v_and_b32 v57, 0xffff0000, v8
    v_cvt_pk_bf16_f32 v8, v58, v59
    v_lshlrev_b32 v58, 16, v8
    v_and_b32 v59, 0xffff0000, v8
    v_cvt_pk_bf16_f32 v8, v60, v61
    v_lshlrev_b32 v60, 16, v8
    v_and_b32 v61, 0xffff0000, v8
    v_cvt_pk_bf16_f32 v8, v62, v63
    v_lshlrev_b32 v62, 16, v8
    v_and_b32 v63, 0xffff0000, v8
    s_lshl_b32 s14, s12, 2
    s_add_u32 s14, s14, s13
    s_and_b32 s15, s14, 31
    s_lshr_b32 s16, s14, 5
Llntwo_299_m:
    s_lshl_b32 s17, s16, 5
    s_add_u32 s17, s17, s15
    s_mul_i32 s19, s17, 1152
    buffer_load_dwordx4 v[144:147], v2, s[8:11], s19 offen offset:0
    buffer_load_dwordx4 v[148:151], v2, s[8:11], s19 offen offset:576
    s_cmp_lt_u32 s16, s92
    s_cbranch_scc1 Lfwok_301_m
    s_mul_i32 s98, s16, 256
    s_add_u32 s98, s98, 62005248
Lfw_300_m:
    s_mov_b64 exec, 0x1ff
    buffer_load_dwordx4 v[160:163], v0, s[4:7], s98 offen sc1
    s_waitcnt vmcnt(0)
    v_xor_b32 v160, s90, v160
    v_xor_b32 v161, s90, v161
    v_xor_b32 v162, s90, v162
    v_xor_b32 v163, s90, v163
    v_or3_b32 v160, v160, v161, v162
    v_or_b32 v160, v160, v163
    v_cmp_ne_u32 vcc, 0, v160
    s_mov_b64 exec, -1
    s_nop 2
    s_and_b32 vcc_lo, vcc_lo, 0x1ff
    s_and_b32 vcc_hi, vcc_hi, 0x0
    s_ff1_i32_b64 s92, vcc
    s_cmp_eq_u32 s92, -1
    s_cselect_b32 s92, 16, s92
    s_lshr_b32 s92, s92, 4
    s_cmp_lg_u32 s92, 0
    s_cbranch_scc1 Lfwg_302_m
    s_sleep 2
    s_add_u32 s99, s99, 1
    s_cmp_lt_u32 s99, 4194304
    s_cbranch_scc1 Lfw_300_m
    s_endpgm
Lfwg_302_m:
    s_add_u32 s92, s92, s16
Lfwok_301_m:
    s_mul_i32 s20, s17, 2304
    s_add_u32 s20, s20, 92274688
    buffer_load_dwordx4 v[80:83], v3, s[4:7], s20 offen offset:0 sc1
    buffer_load_dwordx4 v[84:87], v3, s[4:7], s20 offen offset:16 sc1
    buffer_load_dwordx4 v[88:91], v3, s[4:7], s20 offen offset:1152 sc1
    buffer_load_dwordx4 v[92:95], v3, s[4:7], s20 offen offset:1168 sc1
    s_add_u32 s20, s20, 4718592
    buffer_load_dwordx4 v[96:99], v3, s[4:7], s20 offen offset:0 sc1
    buffer_load_dwordx4 v[100:103], v3, s[4:7], s20 offen offset:16 sc1
    buffer_load_dwordx4 v[104:107], v3, s[4:7], s20 offen offset:1152 sc1
    buffer_load_dwordx4 v[108:111], v3, s[4:7], s20 offen offset:1168 sc1
    s_add_u32 s20, s20, 4718592
    buffer_load_dwordx4 v[112:115], v3, s[4:7], s20 offen offset:0 sc1
    buffer_load_dwordx4 v[116:119], v3, s[4:7], s20 offen offset:16 sc1
    buffer_load_dwordx4 v[120:123], v3, s[4:7], s20 offen offset:1152 sc1
    buffer_load_dwordx4 v[124:127], v3, s[4:7], s20 offen offset:1168 sc1
    s_add_u32 s20, s20, 4718592
    buffer_load_dwordx4 v[128:131], v3, s[4:7], s20 offen offset:0 sc1
    buffer_load_dwordx4 v[132:135], v3, s[4:7], s20 offen offset:16 sc1
    buffer_load_dwordx4 v[136:139], v3, s[4:7], s20 offen offset:1152 sc1
    buffer_load_dwordx4 v[140:143], v3, s[4:7], s20 offen offset:1168 sc1
    s_waitcnt vmcnt(0)
    v_pk_add_f32 v[80:81], v[80:81], v[96:97]
    v_pk_add_f32 v[112:113], v[112:113], v[128:129]
    v_pk_add_f32 v[16:17], v[80:81], v[112:113]
    v_pk_add_f32 v[82:83], v[82:83], v[98:99]
    v_pk_add_f32 v[114:115], v[114:115], v[130:131]
    v_pk_add_f32 v[18:19], v[82:83], v[114:115]
    v_pk_add_f32 v[84:85], v[84:85], v[100:101]
    v_pk_add_f32 v[116:117], v[116:117], v[132:133]
    v_pk_add_f32 v[20:21], v[84:85], v[116:117]
    v_pk_add_f32 v[86:87], v[86:87], v[102:103]
    v_pk_add_f32 v[118:119], v[118:119], v[134:135]
    v_pk_add_f32 v[22:23], v[86:87], v[118:119]
    v_pk_add_f32 v[88:89], v[88:89], v[104:105]
    v_pk_add_f32 v[120:121], v[120:121], v[136:137]
    v_pk_add_f32 v[24:25], v[88:89], v[120:121]
    v_pk_add_f32 v[90:91], v[90:91], v[106:107]
    v_pk_add_f32 v[122:123], v[122:123], v[138:139]
    v_pk_add_f32 v[26:27], v[90:91], v[122:123]
    v_pk_add_f32 v[92:93], v[92:93], v[108:109]
    v_pk_add_f32 v[124:125], v[124:125], v[140:141]
    v_pk_add_f32 v[28:29], v[92:93], v[124:125]
    v_pk_add_f32 v[94:95], v[94:95], v[110:111]
    v_pk_add_f32 v[126:127], v[126:127], v[142:143]
    v_pk_add_f32 v[30:31], v[94:95], v[126:127]
    v_cvt_pk_bf16_f32 v8, v16, v17
    v_lshlrev_b32 v16, 16, v8
    v_and_b32 v17, 0xffff0000, v8
    v_pk_mul_f32 v[16:17], v[16:17], v[32:33]
    v_cvt_pk_bf16_f32 v8, v16, v17
    v_lshlrev_b32 v16, 16, v8
    v_and_b32 v17, 0xffff0000, v8
    v_lshlrev_b32 v10, 16, v144
    v_and_b32 v11, 0xffff0000, v144
    v_pk_add_f32 v[16:17], v[16:17], v[10:11]
    v_cvt_pk_bf16_f32 v152, v16, v17
    v_lshlrev_b32 v16, 16, v152
    v_and_b32 v17, 0xffff0000, v152
    v_cvt_pk_bf16_f32 v8, v18, v19
    v_lshlrev_b32 v18, 16, v8
    v_and_b32 v19, 0xffff0000, v8
    v_pk_mul_f32 v[18:19], v[18:19], v[34:35]
    v_cvt_pk_bf16_f32 v8, v18, v19
    v_lshlrev_b32 v18, 16, v8
    v_and_b32 v19, 0xffff0000, v8
    v_lshlrev_b32 v10, 16, v145
    v_and_b32 v11, 0xffff0000, v145
    v_pk_add_f32 v[18:19], v[18:19], v[10:11]
    v_cvt_pk_bf16_f32 v153, v18, v19
    v_lshlrev_b32 v18, 16, v153
    v_and_b32 v19, 0xffff0000, v153
    v_cvt_pk_bf16_f32 v8, v20, v21
    v_lshlrev_b32 v20, 16, v8
    v_and_b32 v21, 0xffff0000, v8
    v_pk_mul_f32 v[20:21], v[20:21], v[36:37]
    v_cvt_pk_bf16_f32 v8, v20, v21
    v_lshlrev_b32 v20, 16, v8
    v_and_b32 v21, 0xffff0000, v8
    v_lshlrev_b32 v10, 16, v146
    v_and_b32 v11, 0xffff0000, v146
    v_pk_add_f32 v[20:21], v[20:21], v[10:11]
    v_cvt_pk_bf16_f32 v154, v20, v21
    v_lshlrev_b32 v20, 16, v154
    v_and_b32 v21, 0xffff0000, v154
    v_cvt_pk_bf16_f32 v8, v22, v23
    v_lshlrev_b32 v22, 16, v8
    v_and_b32 v23, 0xffff0000, v8
    v_pk_mul_f32 v[22:23], v[22:23], v[38:39]
    v_cvt_pk_bf16_f32 v8, v22, v23
    v_lshlrev_b32 v22, 16, v8
    v_and_b32 v23, 0xffff0000, v8
    v_lshlrev_b32 v10, 16, v147
    v_and_b32 v11, 0xffff0000, v147
    v_pk_add_f32 v[22:23], v[22:23], v[10:11]
    v_cvt_pk_bf16_f32 v155, v22, v23
    v_lshlrev_b32 v22, 16, v155
    v_and_b32 v23, 0xffff0000, v155
    v_cvt_pk_bf16_f32 v8, v24, v25
    v_lshlrev_b32 v24, 16, v8
    v_and_b32 v25, 0xffff0000, v8
    v_pk_mul_f32 v[24:25], v[24:25], v[40:41]
    v_cvt_pk_bf16_f32 v8, v24, v25
    v_lshlrev_b32 v24, 16, v8
    v_and_b32 v25, 0xffff0000, v8
    v_lshlrev_b32 v10, 16, v148
    v_and_b32 v11, 0xffff0000, v148
    v_pk_add_f32 v[24:25], v[24:25], v[10:11]
    v_cvt_pk_bf16_f32 v156, v24, v25
    v_lshlrev_b32 v24, 16, v156
    v_and_b32 v25, 0xffff0000, v156
    v_cvt_pk_bf16_f32 v8, v26, v27
    v_lshlrev_b32 v26, 16, v8
    v_and_b32 v27, 0xffff0000, v8
    v_pk_mul_f32 v[26:27], v[26:27], v[42:43]
    v_cvt_pk_bf16_f32 v8, v26, v27
    v_lshlrev_b32 v26, 16, v8
    v_and_b32 v27, 0xffff0000, v8
    v_lshlrev_b32 v10, 16, v149
    v_and_b32 v11, 0xffff0000, v149
    v_pk_add_f32 v[26:27], v[26:27], v[10:11]
    v_cvt_pk_bf16_f32 v157, v26, v27
    v_lshlrev_b32 v26, 16, v157
    v_and_b32 v27, 0xffff0000, v157
    v_cvt_pk_bf16_f32 v8, v28, v29
    v_lshlrev_b32 v28, 16, v8
    v_and_b32 v29, 0xffff0000, v8
    v_pk_mul_f32 v[28:29], v[28:29], v[44:45]
    v_cvt_pk_bf16_f32 v8, v28, v29
    v_lshlrev_b32 v28, 16, v8
    v_and_b32 v29, 0xffff0000, v8
    v_lshlrev_b32 v10, 16, v150
    v_and_b32 v11, 0xffff0000, v150
    v_pk_add_f32 v[28:29], v[28:29], v[10:11]
    v_cvt_pk_bf16_f32 v158, v28, v29
    v_lshlrev_b32 v28, 16, v158
    v_and_b32 v29, 0xffff0000, v158
    v_cvt_pk_bf16_f32 v8, v30, v31
    v_lshlrev_b32 v30, 16, v8
    v_and_b32 v31, 0xffff0000, v8
    v_pk_mul_f32 v[30:31], v[30:31], v[46:47]
    v_cvt_pk_bf16_f32 v8, v30, v31
    v_lshlrev_b32 v30, 16, v8
    v_and_b32 v31, 0xffff0000, v8
    v_lshlrev_b32 v10, 16, v151
    v_and_b32 v11, 0xffff0000, v151
    v_pk_add_f32 v[30:31], v[30:31], v[10:11]
    v_cvt_pk_bf16_f32 v159, v30, v31
    v_lshlrev_b32 v30, 16, v159
    v_and_b32 v31, 0xffff0000, v159
    s_add_u32 s20, s19, 69206016
    buffer_store_dwordx4 v[152:155], v2, s[4:7], s20 offen offset:0 sc1
    buffer_store_dwordx4 v[156:159], v2, s[4:7], s20 offen offset:576 sc1
    v_add_f32 v8, v16, v17
    v_add_f32 v8, v8, v18
    v_add_f32 v8, v8, v19
    v_add_f32 v8, v8, v20
    v_add_f32 v8, v8, v21
    v_add_f32 v8, v8, v22
    v_add_f32 v8, v8, v23
    v_add_f32 v8, v8, v24
    v_add_f32 v8, v8, v25
    v_add_f32 v8, v8, v26
    v_add_f32 v8, v8, v27
    v_add_f32 v8, v8, v28
    v_add_f32 v8, v8, v29
    v_add_f32 v8, v8, v30
    v_add_f32 v8, v8, v31
    s_nop 1
    v_add_f32_dpp v8, v8, v8 quad_perm:[1,0,3,2] row_mask:0xf bank_mask:0xf
    s_nop 1
    v_add_f32_dpp v8, v8, v8 quad_perm:[2,3,0,1] row_mask:0xf bank_mask:0xf
    s_nop 1
    v_add_f32_dpp v8, v8, v8 row_half_mirror row_mask:0xf bank_mask:0xf
    s_nop 1
    v_add_f32_dpp v8, v8, v8 row_mirror row_mask:0xf bank_mask:0xf
    v_mov_b32 v12, v8
    s_nop 1
    v_permlane16_swap_b32 v8, v12
    v_add_f32 v8, v8, v12
    v_mov_b32 v12, v8
    s_nop 1
    v_permlane32_swap_b32 v8, v12
    v_add_f32 v8, v8, v12
    v_mul_f32 v10, 0x3ae38e39, v8
    v_mul_f32 v13, v10, v4
    v_sub_f32 v12, v16, v13
    v_mul_f32 v9, v12, v12
    v_sub_f32 v12, v17, v13
    v_fmac_f32 v9, v12, v12
    v_sub_f32 v12, v18, v13
    v_fmac_f32 v9, v12, v12
    v_sub_f32 v12, v19, v13
    v_fmac_f32 v9, v12, v12
    v_sub_f32 v12, v20, v13
    v_fmac_f32 v9, v12, v12
    v_sub_f32 v12, v21, v13
    v_fmac_f32 v9, v12, v12
    v_sub_f32 v12, v22, v13
    v_fmac_f32 v9, v12, v12
    v_sub_f32 v12, v23, v13
    v_fmac_f32 v9, v12, v12
    v_sub_f32 v12, v24, v13
    v_fmac_f32 v9, v12, v12
    v_sub_f32 v12, v25, v13
    v_fmac_f32 v9, v12, v12
    v_sub_f32 v12, v26, v13
    v_fmac_f32 v9, v12, v12
    v_sub_f32 v12, v27, v13
    v_fmac_f32 v9, v12, v12
    v_sub_f32 v12, v28, v13
    v_fmac_f32 v9, v12, v12
    v_sub_f32 v12, v29, v13
    v_fmac_f32 v9, v12, v12
    v_sub_f32 v12, v30, v13
    v_fmac_f32 v9, v12, v12
    v_sub_f32 v12, v31, v13
    v_fmac_f32 v9, v12, v12
    s_nop 1
    v_add_f32_dpp v9, v9, v9 quad_perm:[1,0,3,2] row_mask:0xf bank_mask:0xf
    s_nop 1
    v_add_f32_dpp v9, v9, v9 quad_perm:[2,3,0,1] row_mask:0xf bank_mask:0xf
    s_nop 1
    v_add_f32_dpp v9, v9, v9 row_half_mirror row_mask:0xf bank_mask:0xf
    s_nop 1
    v_add_f32_dpp v9, v9, v9 row_mirror row_mask:0xf bank_mask:0xf
    v_mov_b32 v12, v9
    s_nop 1
    v_permlane16_swap_b32 v9, v12
    v_add_f32 v9, v9, v12
    v_mov_b32 v12, v9
    s_nop 1
    v_permlane32_swap_b32 v9, v12
    v_add_f32 v9, v9, v12
    v_mul_f32 v9, 0x3ae38e39, v9
    v_cvt_pk_bf16_f32 v12, v9, v9
    v_lshlrev_b32 v9, 16, v12
    v_add_f32 v9, 0x3727c5ac, v9
    v_cvt_pk_bf16_f32 v12, v9, v9
    v_lshlrev_b32 v9, 16, v12
    v_sqrt_f32 v9, v9
    s_nop 0
    v_cvt_pk_bf16_f32 v12, v9, v9
    v_lshlrev_b32 v9, 16, v12
    v_rcp_f32 v11, v9
    v_cvt_pk_bf16_f32 v12, v10, v10
    v_lshlrev_b32 v10, 16, v12
    v_sub_f32 v16, v16, v10
    v_sub_f32 v17, v17, v10
    v_cvt_pk_bf16_f32 v12, v16, v17
    v_lshlrev_b32 v16, 16, v12
    v_and_b32 v17, 0xffff0000, v12
    v_mul_f32 v16, v16, v11
    v_mul_f32 v17, v17, v11
    v_cvt_pk_bf16_f32 v12, v16, v17
    v_lshlrev_b32 v16, 16, v12
    v_and_b32 v17, 0xffff0000, v12
    v_pk_mul_f32 v[16:17], v[16:17], v[48:49]
    v_cvt_pk_bf16_f32 v12, v16, v17
    v_lshlrev_b32 v16, 16, v12
    v_and_b32 v17, 0xffff0000, v12
    v_pk_add_f32 v[16:17], v[16:17], v[64:65]
    v_cvt_pk_bf16_f32 v144, v16, v17
    v_sub_f32 v18, v18, v10
    v_sub_f32 v19, v19, v10
    v_cvt_pk_bf16_f32 v12, v18, v19
    v_lshlrev_b32 v18, 16, v12
    v_and_b32 v19, 0xffff0000, v12
    v_mul_f32 v18, v18, v11
    v_mul_f32 v19, v19, v11
    v_cvt_pk_bf16_f32 v12, v18, v19
    v_lshlrev_b32 v18, 16, v12
    v_and_b32 v19, 0xffff0000, v12
    v_pk_mul_f32 v[18:19], v[18:19], v[50:51]
    v_cvt_pk_bf16_f32 v12, v18, v19
    v_lshlrev_b32 v18, 16, v12
    v_and_b32 v19, 0xffff0000, v12
    v_pk_add_f32 v[18:19], v[18:19], v[66:67]
    v_cvt_pk_bf16_f32 v145, v18, v19
    v_sub_f32 v20, v20, v10
    v_sub_f32 v21, v21, v10
    v_cvt_pk_bf16_f32 v12, v20, v21
    v_lshlrev_b32 v20, 16, v12
    v_and_b32 v21, 0xffff0000, v12
    v_mul_f32 v20, v20, v11
    v_mul_f32 v21, v21, v11
    v_cvt_pk_bf16_f32 v12, v20, v21
    v_lshlrev_b32 v20, 16, v12
    v_and_b32 v21, 0xffff0000, v12
    v_pk_mul_f32 v[20:21], v[20:21], v[52:53]
    v_cvt_pk_bf16_f32 v12, v20, v21
    v_lshlrev_b32 v20, 16, v12
    v_and_b32 v21, 0xffff0000, v12
    v_pk_add_f32 v[20:21], v[20:21], v[68:69]
    v_cvt_pk_bf16_f32 v146, v20, v21
    v_sub_f32 v22, v22, v10
    v_sub_f32 v23, v23, v10
    v_cvt_pk_bf16_f32 v12, v22, v23
    v_lshlrev_b32 v22, 16, v12
    v_and_b32 v23, 0xffff0000, v12
    v_mul_f32 v22, v22, v11
    v_mul_f32 v23, v23, v11
    v_cvt_pk_bf16_f32 v12, v22, v23
    v_lshlrev_b32 v22, 16, v12
    v_and_b32 v23, 0xffff0000, v12
    v_pk_mul_f32 v[22:23], v[22:23], v[54:55]
    v_cvt_pk_bf16_f32 v12, v22, v23
    v_lshlrev_b32 v22, 16, v12
    v_and_b32 v23, 0xffff0000, v12
    v_pk_add_f32 v[22:23], v[22:23], v[70:71]
    v_cvt_pk_bf16_f32 v147, v22, v23
    v_sub_f32 v24, v24, v10
    v_sub_f32 v25, v25, v10
    v_cvt_pk_bf16_f32 v12, v24, v25
    v_lshlrev_b32 v24, 16, v12
    v_and_b32 v25, 0xffff0000, v12
    v_mul_f32 v24, v24, v11
    v_mul_f32 v25, v25, v11
    v_cvt_pk_bf16_f32 v12, v24, v25
    v_lshlrev_b32 v24, 16, v12
    v_and_b32 v25, 0xffff0000, v12
    v_pk_mul_f32 v[24:25], v[24:25], v[56:57]
    v_cvt_pk_bf16_f32 v12, v24, v25
    v_lshlrev_b32 v24, 16, v12
    v_and_b32 v25, 0xffff0000, v12
    v_pk_add_f32 v[24:25], v[24:25], v[72:73]
    v_cvt_pk_bf16_f32 v148, v24, v25
    v_sub_f32 v26, v26, v10
    v_sub_f32 v27, v27, v10
    v_cvt_pk_bf16_f32 v12, v26, v27
    v_lshlrev_b32 v26, 16, v12
    v_and_b32 v27, 0xffff0000, v12
    v_mul_f32 v26, v26, v11
    v_mul_f32 v27, v27, v11
    v_cvt_pk_bf16_f32 v12, v26, v27
    v_lshlrev_b32 v26, 16, v12
    v_and_b32 v27, 0xffff0000, v12
    v_pk_mul_f32 v[26:27], v[26:27], v[58:59]
    v_cvt_pk_bf16_f32 v12, v26, v27
    v_lshlrev_b32 v26, 16, v12
    v_and_b32 v27, 0xffff0000, v12
    v_pk_add_f32 v[26:27], v[26:27], v[74:75]
    v_cvt_pk_bf16_f32 v149, v26, v27
    v_sub_f32 v28, v28, v10
    v_sub_f32 v29, v29, v10
    v_cvt_pk_bf16_f32 v12, v28, v29
    v_lshlrev_b32 v28, 16, v12
    v_and_b32 v29, 0xffff0000, v12
    v_mul_f32 v28, v28, v11
    v_mul_f32 v29, v29, v11
    v_cvt_pk_bf16_f32 v12, v28, v29
    v_lshlrev_b32 v28, 16, v12
    v_and_b32 v29, 0xffff0000, v12
    v_pk_mul_f32 v[28:29], v[28:29], v[60:61]
    v_cvt_pk_bf16_f32 v12, v28, v29
    v_lshlrev_b32 v28, 16, v12
    v_and_b32 v29, 0xffff0000, v12
    v_pk_add_f32 v[28:29], v[28:29], v[76:77]
    v_cvt_pk_bf16_f32 v150, v28, v29
    v_sub_f32 v30, v30, v10
    v_sub_f32 v31, v31, v10
    v_cvt_pk_bf16_f32 v12, v30, v31
    v_lshlrev_b32 v30, 16, v12
    v_and_b32 v31, 0xffff0000, v12
    v_mul_f32 v30, v30, v11
    v_mul_f32 v31, v31, v11
    v_cvt_pk_bf16_f32 v12, v30, v31
    v_lshlrev_b32 v30, 16, v12
    v_and_b32 v31, 0xffff0000, v12
    v_pk_mul_f32 v[30:31], v[30:31], v[62:63]
    v_cvt_pk_bf16_f32 v12, v30, v31
    v_lshlrev_b32 v30, 16, v12
    v_and_b32 v31, 0xffff0000, v12
    v_pk_add_f32 v[30:31], v[30:31], v[78:79]
    v_cvt_pk_bf16_f32 v151, v30, v31
    s_add_u32 s20, s19, 66060288
    buffer_store_dwordx4 v[144:147], v2, s[4:7], s20 offen offset:0 sc1
    buffer_store_dwordx4 v[148:151], v2, s[4:7], s20 offen offset:576 sc1
    s_waitcnt vmcnt(0)
    s_mul_i32 s98, s16, 32
    s_add_u32 s98, s98, s15
    s_lshl_b32 s98, s98, 2
    s_add_u32 s98, s98, 62023680
    v_mov_b32 v7, s90
    s_mov_b64 exec, 1
    buffer_store_dword v7, off, s[4:7], s98 offset:0 sc1
    s_mov_b64 exec, -1
    s_add_u32 s16, s16, 2
    s_cmp_lt_u32 s16, 64
    s_cbranch_scc1 Llntwo_299_m
    s_sub_u32 s12, s97, 64
    s_branch Lout_main
Lrolelnz_62_m:
    s_sub_u32 s12, s97, 216
    v_lshrrev_b32 v1, 4, v0
    v_lshrrev_b32 v2, 3, v1
    v_and_b32 v3, 7, v1
    v_lshrrev_b32 v4, 1, v3
    v_lshlrev_b32 v4, 10, v4
    v_and_b32 v8, 1, v3
    v_lshl_add_u32 v4, v8, 9, v4
    v_lshl_add_u32 v4, v2, 4, v4
    s_mul_i32 s19, s13, 36864
    v_add_u32 v4, s19, v4
    v_lshlrev_b32 v5, 4, v2
    s_mov_b32 s14, s12
Llnz_303_m:
    s_lshr_b32 s15, s14, 2
    s_cmp_lt_u32 s15, s92
    s_cbranch_scc1 Lfwok_305_m
    s_mul_i32 s98, s15, 256
    s_add_u32 s98, s98, 62032896
Lfw_304_m:
    s_mov_b64 exec, 0x1ff
    buffer_load_dwordx4 v[132:135], v0, s[4:7], s98 offen sc1
    s_waitcnt vmcnt(0)
    v_xor_b32 v132, s90, v132
    v_xor_b32 v133, s90, v133
    v_xor_b32 v134, s90, v134
    v_xor_b32 v135, s90, v135
    v_or3_b32 v132, v132, v133, v134
    v_or_b32 v132, v132, v135
    v_cmp_ne_u32 vcc, 0, v132
    s_mov_b64 exec, -1
    s_nop 2
    s_and_b32 vcc_lo, vcc_lo, 0x1ff
    s_and_b32 vcc_hi, vcc_hi, 0x0
    s_ff1_i32_b64 s92, vcc
    s_cmp_eq_u32 s92, -1
    s_cselect_b32 s92, 16, s92
    s_lshr_b32 s92, s92, 4
    s_cmp_lg_u32 s92, 0
    s_cbranch_scc1 Lfwg_306_m
    s_sleep 2
    s_add_u32 s99, s99, 1
    s_cmp_lt_u32 s99, 4194304
    s_cbranch_scc1 Lfw_304_m
    s_endpgm
Lfwg_306_m:
    s_add_u32 s92, s92, s15
Lfwok_305_m:
    s_mul_i32 s19, s15, 294912
    s_and_b32 s20, s14, 3
    s_lshl_b32 s20, s20, 7
    s_add_u32 s19, s19, s20
    s_add_u32 s19, s19, 113393664
    buffer_load_dwordx4 v[16:19], v4, s[4:7], s19 offen sc1
    s_add_u32 s19, s19, 4096
    buffer_load_dwordx4 v[20:23], v4, s[4:7], s19 offen sc1
    s_add_u32 s19, s19, 4096
    buffer_load_dwordx4 v[24:27], v4, s[4:7], s19 offen sc1
    s_add_u32 s19, s19, 4096
    buffer_load_dwordx4 v[28:31], v4, s[4:7], s19 offen sc1
    s_add_u32 s19, s19, 4096
    buffer_load_dwordx4 v[32:35], v4, s[4:7], s19 offen sc1
    s_add_u32 s19, s19, 4096
    buffer_load_dwordx4 v[36:39], v4, s[4:7], s19 offen sc1
    s_add_u32 s19, s19, 4096
    buffer_load_dwordx4 v[40:43], v4, s[4:7], s19 offen sc1
    s_add_u32 s19, s19, 4096
    buffer_load_dwordx4 v[44:47], v4, s[4:7], s19 offen sc1
    s_add_u32 s19, s19, 4096
    buffer_load_dwordx4 v[48:51], v4, s[4:7], s19 offen sc1
    s_waitcnt vmcnt(0)
    v_lshlrev_b32 v56, 16, v16
    v_and_b32 v57, 0xffff0000, v16
    v_lshlrev_b32 v58, 16, v17
    v_and_b32 v59, 0xffff0000, v17
    v_lshlrev_b32 v60, 16, v18
    v_and_b32 v61, 0xffff0000, v18
    v_lshlrev_b32 v62, 16, v19
    v_and_b32 v63, 0xffff0000, v19
    v_lshlrev_b32 v64, 16, v20
    v_and_b32 v65, 0xffff0000, v20
    v_lshlrev_b32 v66, 16, v21
    v_and_b32 v67, 0xffff0000, v21
    v_lshlrev_b32 v68, 16, v22
    v_and_b32 v69, 0xffff0000, v22
    v_lshlrev_b32 v70, 16, v23
    v_and_b32 v71, 0xffff0000, v23
    v_lshlrev_b32 v72, 16, v24
    v_and_b32 v73, 0xffff0000, v24
    v_lshlrev_b32 v74, 16, v25
    v_and_b32 v75, 0xffff0000, v25
    v_lshlrev_b32 v76, 16, v26
    v_and_b32 v77, 0xffff0000, v26
    v_lshlrev_b32 v78, 16, v27
    v_and_b32 v79, 0xffff0000, v27
    v_lshlrev_b32 v80, 16, v28
    v_and_b32 v81, 0xffff0000, v28
    v_lshlrev_b32 v82, 16, v29
    v_and_b32 v83, 0xffff0000, v29
    v_lshlrev_b32 v84, 16, v30
    v_and_b32 v85, 0xffff0000, v30
    v_lshlrev_b32 v86, 16, v31
    v_and_b32 v87, 0xffff0000, v31
    v_lshlrev_b32 v88, 16, v32
    v_and_b32 v89, 0xffff0000, v32
    v_lshlrev_b32 v90, 16, v33
    v_and_b32 v91, 0xffff0000, v33
    v_lshlrev_b32 v92, 16, v34
    v_and_b32 v93, 0xffff0000, v34
    v_lshlrev_b32 v94, 16, v35
    v_and_b32 v95, 0xffff0000, v35
    v_lshlrev_b32 v96, 16, v36
    v_and_b32 v97, 0xffff0000, v36
    v_lshlrev_b32 v98, 16, v37
    v_and_b32 v99, 0xffff0000, v37
    v_lshlrev_b32 v100, 16, v38
    v_and_b32 v101, 0xffff0000, v38
    v_lshlrev_b32 v102, 16, v39
    v_and_b32 v103, 0xffff0000, v39
    v_lshlrev_b32 v104, 16, v40
    v_and_b32 v105, 0xffff0000, v40
    v_lshlrev_b32 v106, 16, v41
    v_and_b32 v107, 0xffff0000, v41
    v_lshlrev_b32 v108, 16, v42
    v_and_b32 v109, 0xffff0000, v42
    v_lshlrev_b32 v110, 16, v43
    v_and_b32 v111, 0xffff0000, v43
    v_lshlrev_b32 v112, 16, v44
    v_and_b32 v113, 0xffff0000, v44
    v_lshlrev_b32 v114, 16, v45
    v_and_b32 v115, 0xffff0000, v45
    v_lshlrev_b32 v116, 16, v46
    v_and_b32 v117, 0xffff0000, v46
    v_lshlrev_b32 v118, 16, v47
    v_and_b32 v119, 0xffff0000, v47
    v_lshlrev_b32 v120, 16, v48
    v_and_b32 v121, 0xffff0000, v48
    v_lshlrev_b32 v122, 16, v49
    v_and_b32 v123, 0xffff0000, v49
    v_lshlrev_b32 v124, 16, v50
    v_and_b32 v125, 0xffff0000, v50
    v_lshlrev_b32 v126, 16, v51
    v_and_b32 v127, 0xffff0000, v51
    v_add_f32 v8, v56, v57
    v_add_f32 v8, v8, v58
    v_add_f32 v8, v8, v59
    v_add_f32 v8, v8, v60
    v_add_f32 v8, v8, v61
    v_add_f32 v8, v8, v62
    v_add_f32 v8, v8, v63
    v_add_f32 v8, v8, v64
    v_add_f32 v8, v8, v65
    v_add_f32 v8, v8, v66
    v_add_f32 v8, v8, v67
    v_add_f32 v8, v8, v68
    v_add_f32 v8, v8, v69
    v_add_f32 v8, v8, v70
    v_add_f32 v8, v8, v71
    v_add_f32 v8, v8, v72
    v_add_f32 v8, v8, v73
    v_add_f32 v8, v8, v74
    v_add_f32 v8, v8, v75
    v_add_f32 v8, v8, v76
    v_add_f32 v8, v8, v77
    v_add_f32 v8, v8, v78
    v_add_f32 v8, v8, v79
    v_add_f32 v8, v8, v80
    v_add_f32 v8, v8, v81
    v_add_f32 v8, v8, v82
    v_add_f32 v8, v8, v83
    v_add_f32 v8, v8, v84
    v_add_f32 v8, v8, v85
    v_add_f32 v8, v8, v86
    v_add_f32 v8, v8, v87
    v_add_f32 v8, v8, v88
    v_add_f32 v8, v8, v89
    v_add_f32 v8, v8, v90
    v_add_f32 v8, v8, v91
    v_add_f32 v8, v8, v92
    v_add_f32 v8, v8, v93
    v_add_f32 v8, v8, v94
    v_add_f32 v8, v8, v95
    v_add_f32 v8, v8, v96
    v_add_f32 v8, v8, v97
    v_add_f32 v8, v8, v98
    v_add_f32 v8, v8, v99
    v_add_f32 v8, v8, v100
    v_add_f32 v8, v8, v101
    v_add_f32 v8, v8, v102
    v_add_f32 v8, v8, v103
    v_add_f32 v8, v8, v104
    v_add_f32 v8, v8, v105
    v_add_f32 v8, v8, v106
    v_add_f32 v8, v8, v107
    v_add_f32 v8, v8, v108
    v_add_f32 v8, v8, v109
    v_add_f32 v8, v8, v110
    v_add_f32 v8, v8, v111
    v_add_f32 v8, v8, v112
    v_add_f32 v8, v8, v113
    v_add_f32 v8, v8, v114
    v_add_f32 v8, v8, v115
    v_add_f32 v8, v8, v116
    v_add_f32 v8, v8, v117
    v_add_f32 v8, v8, v118
    v_add_f32 v8, v8, v119
    v_add_f32 v8, v8, v120
    v_add_f32 v8, v8, v121
    v_add_f32 v8, v8, v122
    v_add_f32 v8, v8, v123
    v_add_f32 v8, v8, v124
    v_add_f32 v8, v8, v125
    v_add_f32 v8, v8, v126
    v_add_f32 v8, v8, v127
    s_nop 1
    v_add_f32_dpp v8, v8, v8 quad_perm:[1,0,3,2] row_mask:0xf bank_mask:0xf
    s_nop 1
    v_add_f32_dpp v8, v8, v8 quad_perm:[2,3,0,1] row_mask:0xf bank_mask:0xf
    s_nop 1
    v_add_f32_dpp v8, v8, v8 row_half_mirror row_mask:0xf bank_mask:0xf
    s_lshl_b32 s21, s13, 2
    v_add_u32 v13, s21, v5
    ds_write_b32 v13, v8 offset:0
    s_waitcnt lgkmcnt(0)
    s_barrier
    ds_read_b128 v[128:131], v5 offset:0
    s_waitcnt lgkmcnt(0)
    v_add_f32 v128, v128, v129
    v_add_f32 v130, v130, v131
    v_add_f32 v8, v128, v130
    v_mul_f32 v10, 0x39e38e39, v8
    v_sub_f32 v12, v56, v10
    v_mul_f32 v9, v12, v12
    v_sub_f32 v14, v57, v10
    v_fmac_f32 v9, v14, v14
    v_sub_f32 v12, v58, v10
    v_fmac_f32 v9, v12, v12
    v_sub_f32 v14, v59, v10
    v_fmac_f32 v9, v14, v14
    v_sub_f32 v12, v60, v10
    v_fmac_f32 v9, v12, v12
    v_sub_f32 v14, v61, v10
    v_fmac_f32 v9, v14, v14
    v_sub_f32 v12, v62, v10
    v_fmac_f32 v9, v12, v12
    v_sub_f32 v14, v63, v10
    v_fmac_f32 v9, v14, v14
    v_sub_f32 v12, v64, v10
    v_fmac_f32 v9, v12, v12
    v_sub_f32 v14, v65, v10
    v_fmac_f32 v9, v14, v14
    v_sub_f32 v12, v66, v10
    v_fmac_f32 v9, v12, v12
    v_sub_f32 v14, v67, v10
    v_fmac_f32 v9, v14, v14
    v_sub_f32 v12, v68, v10
    v_fmac_f32 v9, v12, v12
    v_sub_f32 v14, v69, v10
    v_fmac_f32 v9, v14, v14
    v_sub_f32 v12, v70, v10
    v_fmac_f32 v9, v12, v12
    v_sub_f32 v14, v71, v10
    v_fmac_f32 v9, v14, v14
    v_sub_f32 v12, v72, v10
    v_fmac_f32 v9, v12, v12
    v_sub_f32 v14, v73, v10
    v_fmac_f32 v9, v14, v14
    v_sub_f32 v12, v74, v10
    v_fmac_f32 v9, v12, v12
    v_sub_f32 v14, v75, v10
    v_fmac_f32 v9, v14, v14
    v_sub_f32 v12, v76, v10
    v_fmac_f32 v9, v12, v12
    v_sub_f32 v14, v77, v10
    v_fmac_f32 v9, v14, v14
    v_sub_f32 v12, v78, v10
    v_fmac_f32 v9, v12, v12
    v_sub_f32 v14, v79, v10
    v_fmac_f32 v9, v14, v14
    v_sub_f32 v12, v80, v10
    v_fmac_f32 v9, v12, v12
    v_sub_f32 v14, v81, v10
    v_fmac_f32 v9, v14, v14
    v_sub_f32 v12, v82, v10
    v_fmac_f32 v9, v12, v12
    v_sub_f32 v14, v83, v10
    v_fmac_f32 v9, v14, v14
    v_sub_f32 v12, v84, v10
    v_fmac_f32 v9, v12, v12
    v_sub_f32 v14, v85, v10
    v_fmac_f32 v9, v14, v14
    v_sub_f32 v12, v86, v10
    v_fmac_f32 v9, v12, v12
    v_sub_f32 v14, v87, v10
    v_fmac_f32 v9, v14, v14
    v_sub_f32 v12, v88, v10
    v_fmac_f32 v9, v12, v12
    v_sub_f32 v14, v89, v10
    v_fmac_f32 v9, v14, v14
    v_sub_f32 v12, v90, v10
    v_fmac_f32 v9, v12, v12
    v_sub_f32 v14, v91, v10
    v_fmac_f32 v9, v14, v14
    v_sub_f32 v12, v92, v10
    v_fmac_f32 v9, v12, v12
    v_sub_f32 v14, v93, v10
    v_fmac_f32 v9, v14, v14
    v_sub_f32 v12, v94, v10
    v_fmac_f32 v9, v12, v12
    v_sub_f32 v14, v95, v10
    v_fmac_f32 v9, v14, v14
    v_sub_f32 v12, v96, v10
    v_fmac_f32 v9, v12, v12
    v_sub_f32 v14, v97, v10
    v_fmac_f32 v9, v14, v14
    v_sub_f32 v12, v98, v10
    v_fmac_f32 v9, v12, v12
    v_sub_f32 v14, v99, v10
    v_fmac_f32 v9, v14, v14
    v_sub_f32 v12, v100, v10
    v_fmac_f32 v9, v12, v12
    v_sub_f32 v14, v101, v10
    v_fmac_f32 v9, v14, v14
    v_sub_f32 v12, v102, v10
    v_fmac_f32 v9, v12, v12
    v_sub_f32 v14, v103, v10
    v_fmac_f32 v9, v14, v14
    v_sub_f32 v12, v104, v10
    v_fmac_f32 v9, v12, v12
    v_sub_f32 v14, v105, v10
    v_fmac_f32 v9, v14, v14
    v_sub_f32 v12, v106, v10
    v_fmac_f32 v9, v12, v12
    v_sub_f32 v14, v107, v10
    v_fmac_f32 v9, v14, v14
    v_sub_f32 v12, v108, v10
    v_fmac_f32 v9, v12, v12
    v_sub_f32 v14, v109, v10
    v_fmac_f32 v9, v14, v14
    v_sub_f32 v12, v110, v10
    v_fmac_f32 v9, v12, v12
    v_sub_f32 v14, v111, v10
    v_fmac_f32 v9, v14, v14
    v_sub_f32 v12, v112, v10
    v_fmac_f32 v9, v12, v12
    v_sub_f32 v14, v113, v10
    v_fmac_f32 v9, v14, v14
    v_sub_f32 v12, v114, v10
    v_fmac_f32 v9, v12, v12
    v_sub_f32 v14, v115, v10
    v_fmac_f32 v9, v14, v14
    v_sub_f32 v12, v116, v10
    v_fmac_f32 v9, v12, v12
    v_sub_f32 v14, v117, v10
    v_fmac_f32 v9, v14, v14
    v_sub_f32 v12, v118, v10
    v_fmac_f32 v9, v12, v12
    v_sub_f32 v14, v119, v10
    v_fmac_f32 v9, v14, v14
    v_sub_f32 v12, v120, v10
    v_fmac_f32 v9, v12, v12
    v_sub_f32 v14, v121, v10
    v_fmac_f32 v9, v14, v14
    v_sub_f32 v12, v122, v10
    v_fmac_f32 v9, v12, v12
    v_sub_f32 v14, v123, v10
    v_fmac_f32 v9, v14, v14
    v_sub_f32 v12, v124, v10
    v_fmac_f32 v9, v12, v12
    v_sub_f32 v14, v125, v10
    v_fmac_f32 v9, v14, v14
    v_sub_f32 v12, v126, v10
    v_fmac_f32 v9, v12, v12
    v_sub_f32 v14, v127, v10
    v_fmac_f32 v9, v14, v14
    s_nop 1
    v_add_f32_dpp v9, v9, v9 quad_perm:[1,0,3,2] row_mask:0xf bank_mask:0xf
    s_nop 1
    v_add_f32_dpp v9, v9, v9 quad_perm:[2,3,0,1] row_mask:0xf bank_mask:0xf
    s_nop 1
    v_add_f32_dpp v9, v9, v9 row_half_mirror row_mask:0xf bank_mask:0xf
    s_lshl_b32 s21, s13, 2
    v_add_u32 v13, s21, v5
    ds_write_b32 v13, v9 offset:128
    s_waitcnt lgkmcnt(0)
    s_barrier
    ds_read_b128 v[128:131], v5 offset:128
    s_waitcnt lgkmcnt(0)
    v_add_f32 v128, v128, v129
    v_add_f32 v130, v130, v131
    v_add_f32 v9, v128, v130
    v_mul_f32 v9, 0x39e38e39, v9
    v_cvt_pk_bf16_f32 v12, v9, v9
    v_lshlrev_b32 v9, 16, v12
    v_add_f32 v9, 0x3727c5ac, v9
    v_cvt_pk_bf16_f32 v12, v9, v9
    v_lshlrev_b32 v9, 16, v12
    v_sqrt_f32 v9, v9
    s_nop 0
    v_cvt_pk_bf16_f32 v12, v9, v9
    v_lshlrev_b32 v9, 16, v12
    v_rcp_f32 v11, v9
    v_cvt_pk_bf16_f32 v12, v10, v10
    v_lshlrev_b32 v10, 16, v12
    s_mul_i32 s19, s15, 147456
    s_add_u32 s19, s19, s20
    s_add_u32 s19, s19, 134217728
    v_sub_f32 v56, v56, v10
    v_sub_f32 v57, v57, v10
    v_cvt_pk_bf16_f32 v12, v56, v57
    v_lshlrev_b32 v56, 16, v12
    v_and_b32 v57, 0xffff0000, v12
    v_mul_f32 v56, v56, v11
    v_mul_f32 v57, v57, v11
    v_cvt_pk_bf16_f32 v16, v56, v57
    v_sub_f32 v58, v58, v10
    v_sub_f32 v59, v59, v10
    v_cvt_pk_bf16_f32 v12, v58, v59
    v_lshlrev_b32 v58, 16, v12
    v_and_b32 v59, 0xffff0000, v12
    v_mul_f32 v58, v58, v11
    v_mul_f32 v59, v59, v11
    v_cvt_pk_bf16_f32 v17, v58, v59
    v_sub_f32 v60, v60, v10
    v_sub_f32 v61, v61, v10
    v_cvt_pk_bf16_f32 v12, v60, v61
    v_lshlrev_b32 v60, 16, v12
    v_and_b32 v61, 0xffff0000, v12
    v_mul_f32 v60, v60, v11
    v_mul_f32 v61, v61, v11
    v_cvt_pk_bf16_f32 v18, v60, v61
    v_sub_f32 v62, v62, v10
    v_sub_f32 v63, v63, v10
    v_cvt_pk_bf16_f32 v12, v62, v63
    v_lshlrev_b32 v62, 16, v12
    v_and_b32 v63, 0xffff0000, v12
    v_mul_f32 v62, v62, v11
    v_mul_f32 v63, v63, v11
    v_cvt_pk_bf16_f32 v19, v62, v63
    buffer_store_dwordx4 v[16:19], v4, s[4:7], s19 offen sc1
    s_add_u32 s19, s19, 4096
    v_sub_f32 v64, v64, v10
    v_sub_f32 v65, v65, v10
    v_cvt_pk_bf16_f32 v12, v64, v65
    v_lshlrev_b32 v64, 16, v12
    v_and_b32 v65, 0xffff0000, v12
    v_mul_f32 v64, v64, v11
    v_mul_f32 v65, v65, v11
    v_cvt_pk_bf16_f32 v20, v64, v65
    v_sub_f32 v66, v66, v10
    v_sub_f32 v67, v67, v10
    v_cvt_pk_bf16_f32 v12, v66, v67
    v_lshlrev_b32 v66, 16, v12
    v_and_b32 v67, 0xffff0000, v12
    v_mul_f32 v66, v66, v11
    v_mul_f32 v67, v67, v11
    v_cvt_pk_bf16_f32 v21, v66, v67
    v_sub_f32 v68, v68, v10
    v_sub_f32 v69, v69, v10
    v_cvt_pk_bf16_f32 v12, v68, v69
    v_lshlrev_b32 v68, 16, v12
    v_and_b32 v69, 0xffff0000, v12
    v_mul_f32 v68, v68, v11
    v_mul_f32 v69, v69, v11
    v_cvt_pk_bf16_f32 v22, v68, v69
    v_sub_f32 v70, v70, v10
    v_sub_f32 v71, v71, v10
    v_cvt_pk_bf16_f32 v12, v70, v71
    v_lshlrev_b32 v70, 16, v12
    v_and_b32 v71, 0xffff0000, v12
    v_mul_f32 v70, v70, v11
    v_mul_f32 v71, v71, v11
    v_cvt_pk_bf16_f32 v23, v70, v71
    buffer_store_dwordx4 v[20:23], v4, s[4:7], s19 offen sc1
    s_add_u32 s19, s19, 4096
    v_sub_f32 v72, v72, v10
    v_sub_f32 v73, v73, v10
    v_cvt_pk_bf16_f32 v12, v72, v73
    v_lshlrev_b32 v72, 16, v12
    v_and_b32 v73, 0xffff0000, v12
    v_mul_f32 v72, v72, v11
    v_mul_f32 v73, v73, v11
    v_cvt_pk_bf16_f32 v24, v72, v73
    v_sub_f32 v74, v74, v10
    v_sub_f32 v75, v75, v10
    v_cvt_pk_bf16_f32 v12, v74, v75
    v_lshlrev_b32 v74, 16, v12
    v_and_b32 v75, 0xffff0000, v12
    v_mul_f32 v74, v74, v11
    v_mul_f32 v75, v75, v11
    v_cvt_pk_bf16_f32 v25, v74, v75
    v_sub_f32 v76, v76, v10
    v_sub_f32 v77, v77, v10
    v_cvt_pk_bf16_f32 v12, v76, v77
    v_lshlrev_b32 v76, 16, v12
    v_and_b32 v77, 0xffff0000, v12
    v_mul_f32 v76, v76, v11
    v_mul_f32 v77, v77, v11
    v_cvt_pk_bf16_f32 v26, v76, v77
    v_sub_f32 v78, v78, v10
    v_sub_f32 v79, v79, v10
    v_cvt_pk_bf16_f32 v12, v78, v79
    v_lshlrev_b32 v78, 16, v12
    v_and_b32 v79, 0xffff0000, v12
    v_mul_f32 v78, v78, v11
    v_mul_f32 v79, v79, v11
    v_cvt_pk_bf16_f32 v27, v78, v79
    buffer_store_dwordx4 v[24:27], v4, s[4:7], s19 offen sc1
    s_add_u32 s19, s19, 4096
    v_sub_f32 v80, v80, v10
    v_sub_f32 v81, v81, v10
    v_cvt_pk_bf16_f32 v12, v80, v81
    v_lshlrev_b32 v80, 16, v12
    v_and_b32 v81, 0xffff0000, v12
    v_mul_f32 v80, v80, v11
    v_mul_f32 v81, v81, v11
    v_cvt_pk_bf16_f32 v28, v80, v81
    v_sub_f32 v82, v82, v10
    v_sub_f32 v83, v83, v10
    v_cvt_pk_bf16_f32 v12, v82, v83
    v_lshlrev_b32 v82, 16, v12
    v_and_b32 v83, 0xffff0000, v12
    v_mul_f32 v82, v82, v11
    v_mul_f32 v83, v83, v11
    v_cvt_pk_bf16_f32 v29, v82, v83
    v_sub_f32 v84, v84, v10
    v_sub_f32 v85, v85, v10
    v_cvt_pk_bf16_f32 v12, v84, v85
    v_lshlrev_b32 v84, 16, v12
    v_and_b32 v85, 0xffff0000, v12
    v_mul_f32 v84, v84, v11
    v_mul_f32 v85, v85, v11
    v_cvt_pk_bf16_f32 v30, v84, v85
    v_sub_f32 v86, v86, v10
    v_sub_f32 v87, v87, v10
    v_cvt_pk_bf16_f32 v12, v86, v87
    v_lshlrev_b32 v86, 16, v12
    v_and_b32 v87, 0xffff0000, v12
    v_mul_f32 v86, v86, v11
    v_mul_f32 v87, v87, v11
    v_cvt_pk_bf16_f32 v31, v86, v87
    buffer_store_dwordx4 v[28:31], v4, s[4:7], s19 offen sc1
    s_add_u32 s19, s19, 4096
    v_sub_f32 v88, v88, v10
    v_sub_f32 v89, v89, v10
    v_cvt_pk_bf16_f32 v12, v88, v89
    v_lshlrev_b32 v88, 16, v12
    v_and_b32 v89, 0xffff0000, v12
    v_mul_f32 v88, v88, v11
    v_mul_f32 v89, v89, v11
    v_cvt_pk_bf16_f32 v32, v88, v89
    v_sub_f32 v90, v90, v10
    v_sub_f32 v91, v91, v10
    v_cvt_pk_bf16_f32 v12, v90, v91
    v_lshlrev_b32 v90, 16, v12
    v_and_b32 v91, 0xffff0000, v12
    v_mul_f32 v90, v90, v11
    v_mul_f32 v91, v91, v11
    v_cvt_pk_bf16_f32 v33, v90, v91
    v_sub_f32 v92, v92, v10
    v_sub_f32 v93, v93, v10
    v_cvt_pk_bf16_f32 v12, v92, v93
    v_lshlrev_b32 v92, 16, v12
    v_and_b32 v93, 0xffff0000, v12
    v_mul_f32 v92, v92, v11
    v_mul_f32 v93, v93, v11
    v_cvt_pk_bf16_f32 v34, v92, v93
    v_sub_f32 v94, v94, v10
    v_sub_f32 v95, v95, v10
    v_cvt_pk_bf16_f32 v12, v94, v95
    v_lshlrev_b32 v94, 16, v12
    v_and_b32 v95, 0xffff0000, v12
    v_mul_f32 v94, v94, v11
    v_mul_f32 v95, v95, v11
    v_cvt_pk_bf16_f32 v35, v94, v95
    buffer_store_dwordx4 v[32:35], v4, s[4:7], s19 offen sc1
    s_add_u32 s19, s19, 4096
    v_sub_f32 v96, v96, v10
    v_sub_f32 v97, v97, v10
    v_cvt_pk_bf16_f32 v12, v96, v97
    v_lshlrev_b32 v96, 16, v12
    v_and_b32 v97, 0xffff0000, v12
    v_mul_f32 v96, v96, v11
    v_mul_f32 v97, v97, v11
    v_cvt_pk_bf16_f32 v36, v96, v97
    v_sub_f32 v98, v98, v10
    v_sub_f32 v99, v99, v10
    v_cvt_pk_bf16_f32 v12, v98, v99
    v_lshlrev_b32 v98, 16, v12
    v_and_b32 v99, 0xffff0000, v12
    v_mul_f32 v98, v98, v11
    v_mul_f32 v99, v99, v11
    v_cvt_pk_bf16_f32 v37, v98, v99
    v_sub_f32 v100, v100, v10
    v_sub_f32 v101, v101, v10
    v_cvt_pk_bf16_f32 v12, v100, v101
    v_lshlrev_b32 v100, 16, v12
    v_and_b32 v101, 0xffff0000, v12
    v_mul_f32 v100, v100, v11
    v_mul_f32 v101, v101, v11
    v_cvt_pk_bf16_f32 v38, v100, v101
    v_sub_f32 v102, v102, v10
    v_sub_f32 v103, v103, v10
    v_cvt_pk_bf16_f32 v12, v102, v103
    v_lshlrev_b32 v102, 16, v12
    v_and_b32 v103, 0xffff0000, v12
    v_mul_f32 v102, v102, v11
    v_mul_f32 v103, v103, v11
    v_cvt_pk_bf16_f32 v39, v102, v103
    buffer_store_dwordx4 v[36:39], v4, s[4:7], s19 offen sc1
    s_add_u32 s19, s19, 4096
    v_sub_f32 v104, v104, v10
    v_sub_f32 v105, v105, v10
    v_cvt_pk_bf16_f32 v12, v104, v105
    v_lshlrev_b32 v104, 16, v12
    v_and_b32 v105, 0xffff0000, v12
    v_mul_f32 v104, v104, v11
    v_mul_f32 v105, v105, v11
    v_cvt_pk_bf16_f32 v40, v104, v105
    v_sub_f32 v106, v106, v10
    v_sub_f32 v107, v107, v10
    v_cvt_pk_bf16_f32 v12, v106, v107
    v_lshlrev_b32 v106, 16, v12
    v_and_b32 v107, 0xffff0000, v12
    v_mul_f32 v106, v106, v11
    v_mul_f32 v107, v107, v11
    v_cvt_pk_bf16_f32 v41, v106, v107
    v_sub_f32 v108, v108, v10
    v_sub_f32 v109, v109, v10
    v_cvt_pk_bf16_f32 v12, v108, v109
    v_lshlrev_b32 v108, 16, v12
    v_and_b32 v109, 0xffff0000, v12
    v_mul_f32 v108, v108, v11
    v_mul_f32 v109, v109, v11
    v_cvt_pk_bf16_f32 v42, v108, v109
    v_sub_f32 v110, v110, v10
    v_sub_f32 v111, v111, v10
    v_cvt_pk_bf16_f32 v12, v110, v111
    v_lshlrev_b32 v110, 16, v12
    v_and_b32 v111, 0xffff0000, v12
    v_mul_f32 v110, v110, v11
    v_mul_f32 v111, v111, v11
    v_cvt_pk_bf16_f32 v43, v110, v111
    buffer_store_dwordx4 v[40:43], v4, s[4:7], s19 offen sc1
    s_add_u32 s19, s19, 4096
    v_sub_f32 v112, v112, v10
    v_sub_f32 v113, v113, v10
    v_cvt_pk_bf16_f32 v12, v112, v113
    v_lshlrev_b32 v112, 16, v12
    v_and_b32 v113, 0xffff0000, v12
    v_mul_f32 v112, v112, v11
    v_mul_f32 v113, v113, v11
    v_cvt_pk_bf16_f32 v44, v112, v113
    v_sub_f32 v114, v114, v10
    v_sub_f32 v115, v115, v10
    v_cvt_pk_bf16_f32 v12, v114, v115
    v_lshlrev_b32 v114, 16, v12
    v_and_b32 v115, 0xffff0000, v12
    v_mul_f32 v114, v114, v11
    v_mul_f32 v115, v115, v11
    v_cvt_pk_bf16_f32 v45, v114, v115
    v_sub_f32 v116, v116, v10
    v_sub_f32 v117, v117, v10
    v_cvt_pk_bf16_f32 v12, v116, v117
    v_lshlrev_b32 v116, 16, v12
    v_and_b32 v117, 0xffff0000, v12
    v_mul_f32 v116, v116, v11
    v_mul_f32 v117, v117, v11
    v_cvt_pk_bf16_f32 v46, v116, v117
    v_sub_f32 v118, v118, v10
    v_sub_f32 v119, v119, v10
    v_cvt_pk_bf16_f32 v12, v118, v119
    v_lshlrev_b32 v118, 16, v12
    v_and_b32 v119, 0xffff0000, v12
    v_mul_f32 v118, v118, v11
    v_mul_f32 v119, v119, v11
    v_cvt_pk_bf16_f32 v47, v118, v119
    buffer_store_dwordx4 v[44:47], v4, s[4:7], s19 offen sc1
    s_add_u32 s19, s19, 4096
    v_sub_f32 v120, v120, v10
    v_sub_f32 v121, v121, v10
    v_cvt_pk_bf16_f32 v12, v120, v121
    v_lshlrev_b32 v120, 16, v12
    v_and_b32 v121, 0xffff0000, v12
    v_mul_f32 v120, v120, v11
    v_mul_f32 v121, v121, v11
    v_cvt_pk_bf16_f32 v48, v120, v121
    v_sub_f32 v122, v122, v10
    v_sub_f32 v123, v123, v10
    v_cvt_pk_bf16_f32 v12, v122, v123
    v_lshlrev_b32 v122, 16, v12
    v_and_b32 v123, 0xffff0000, v12
    v_mul_f32 v122, v122, v11
    v_mul_f32 v123, v123, v11
    v_cvt_pk_bf16_f32 v49, v122, v123
    v_sub_f32 v124, v124, v10
    v_sub_f32 v125, v125, v10
    v_cvt_pk_bf16_f32 v12, v124, v125
    v_lshlrev_b32 v124, 16, v12
    v_and_b32 v125, 0xffff0000, v12
    v_mul_f32 v124, v124, v11
    v_mul_f32 v125, v125, v11
    v_cvt_pk_bf16_f32 v50, v124, v125
    v_sub_f32 v126, v126, v10
    v_sub_f32 v127, v127, v10
    v_cvt_pk_bf16_f32 v12, v126, v127
    v_lshlrev_b32 v126, 16, v12
    v_and_b32 v127, 0xffff0000, v12
    v_mul_f32 v126, v126, v11
    v_mul_f32 v127, v127, v11
    v_cvt_pk_bf16_f32 v51, v126, v127
    buffer_store_dwordx4 v[48:51], v4, s[4:7], s19 offen sc1
    s_waitcnt vmcnt(0)
    s_barrier
    s_and_b32 s20, s14, 3
    s_cmp_lg_u32 s13, 0
    s_cbranch_scc1 Lfs0_307
    s_mul_i32 s98, s15, 32
    s_add_u32 s98, s98, s20
    s_lshl_b32 s98, s98, 2
    s_add_u32 s98, s98, 62051328
    v_mov_b32 v7, s90
    s_mov_b64 exec, 1
    buffer_store_dword v7, off, s[4:7], s98 offset:0 sc1
    s_mov_b64 exec, -1
Lfs0_307:
    s_add_u32 s14, s14, 8
    s_cmp_lt_u32 s14, 256
    s_cbranch_scc1 Llnz_303_m
    s_endpgm
Lout_main:
    s_cmp_ge_u32 s12, 180
    s_cbranch_scc1 Ldone_main
Lout_main2:
    s_barrier
    s_mov_b32 s92, 0
    s_mov_b32 s93, 0
    s_mov_b32 s98, 61931520
Lfw_308_m:
    s_mov_b64 exec, 0x3fff
    buffer_load_dwordx4 v[192:195], v0, s[4:7], s98 offen sc1
    s_waitcnt vmcnt(0)
    v_xor_b32 v192, s90, v192
    v_xor_b32 v193, s90, v193
    v_xor_b32 v194, s90, v194
    v_xor_b32 v195, s90, v195
    v_or3_b32 v192, v192, v193, v194
    v_or_b32 v192, v192, v195
    v_cmp_ne_u32 vcc, 0, v192
    s_mov_b64 exec, -1
    s_nop 2
    s_and_b32 vcc_lo, vcc_lo, 0x3fff
    s_and_b32 vcc_hi, vcc_hi, 0x0
    s_ff1_i32_b64 s89, vcc
    s_cmp_eq_u32 s89, -1
    s_cselect_b32 s89, 16, s89
    s_lshr_b32 s89, s89, 4
    s_cmp_lg_u32 s89, 0
    s_cbranch_scc1 Lfwg_310_m
    s_sleep 2
    s_add_u32 s99, s99, 1
    s_cmp_lt_u32 s99, 4194304
    s_cbranch_scc1 Lfw_308_m
    s_endpgm
Lfwg_310_m:
Lfwok_309_m:
    s_mul_i32 s17, s12, 7282
    s_lshr_b32 s17, s17, 16
    s_mul_i32 s19, s17, 9
    s_sub_u32 s15, s12, s19
    s_mov_b32 s16, 0
    s_cmp_ge_u32 s17, 60
    s_cselect_b32 s18, 64, 60
    s_load_dwordx2 s[32:33], s[42:43], 112
    s_waitcnt lgkmcnt(0)
    s_mov_b32 s34, 2359296
    s_mov_b32 s35, 0x20000
    v_lshrrev_b32 v1, 4, v0
    v_and_b32 v2, 7, v1
    v_lshlrev_b32 v7, 5, v2
    s_lshl_b32 s19, s15, 8
    s_add_u32 s19, s19, 61877504
    buffer_load_dwordx4 v[8:11], v7, s[4:7], s19 offen sc1
    buffer_load_dwordx4 v[12:15], v7, s[4:7], s19 offen offset:16 sc1
    v_lshlrev_b32 v7, 4, v2
    v_lshrrev_b32 v2, 3, v1
    v_mul_u32_u24 v2, 1152, v2
    v_add_u32 v7, v7, v2
    s_waitcnt vmcnt(0)
    s_load_dwordx2 s[8:9], s[42:43], 88
    s_waitcnt lgkmcnt(0)
    s_mov_b32 s10, 2654208
    s_mov_b32 s11, 0x20000
    v_lshrrev_b32 v2, 3, v1
    v_mul_u32_u24 v3, 1152, v2
    v_and_b32 v2, 7, v1
    v_lshl_add_u32 v3, v2, 4, v3
    v_lshrrev_b32 v4, 5, v1
    v_lshlrev_b32 v4, 3, v4
    v_bfe_u32 v2, v1, 2, 2
    v_add_u32 v4, v4, v2
    v_lshlrev_b32 v4, 7, v4
    v_bfe_u32 v2, v1, 4, 1
    v_lshl_add_u32 v4, v2, 5, v4
    v_and_b32 v2, 3, v1
    v_lshl_add_u32 v4, v2, 3, v4
    s_lshl_b32 s21, s13, 15
    v_add_u32 v4, s21, v4
    s_mul_i32 s19, s13, 36
    s_add_u32 s19, s19, 0
    s_mul_i32 s19, s19, 18432
    s_lshl_b32 s20, s15, 7
    s_add_u32 s19, s19, s20
    s_mov_b32 s20, s21
    s_mov_b32 s26, 32
Ldmo_311_m:
    s_mov_b32 m0, s20
    s_nop 0
    buffer_load_dwordx4 v3, s[8:11], s19 offen lds
    s_add_u32 s19, s19, 9216
    s_add_u32 s20, s20, 1024
    s_sub_u32 s26, s26, 1
    s_cmp_lg_u32 s26, 0
    s_cbranch_scc1 Ldmo_311_m
    s_waitcnt vmcnt(0)
    ds_read_b64_tr_b16 a[0:1], v4 offset:0
    ds_read_b64_tr_b16 a[2:3], v4 offset:512
    ds_read_b64_tr_b16 a[4:5], v4 offset:64
    ds_read_b64_tr_b16 a[6:7], v4 offset:576
    ds_read_b64_tr_b16 a[8:9], v4 offset:2048
    ds_read_b64_tr_b16 a[10:11], v4 offset:2560
    ds_read_b64_tr_b16 a[12:13], v4 offset:2112
    ds_read_b64_tr_b16 a[14:15], v4 offset:2624
    s_waitcnt lgkmcnt(4)
    ds_read_b64_tr_b16 a[16:17], v4 offset:4096
    ds_read_b64_tr_b16 a[18:19], v4 offset:4608
    ds_read_b64_tr_b16 a[20:21], v4 offset:4160
    ds_read_b64_tr_b16 a[22:23], v4 offset:4672
    ds_read_b64_tr_b16 a[24:25], v4 offset:6144
    ds_read_b64_tr_b16 a[26:27], v4 offset:6656
    ds_read_b64_tr_b16 a[28:29], v4 offset:6208
    ds_read_b64_tr_b16 a[30:31], v4 offset:6720
    s_waitcnt lgkmcnt(4)
    ds_read_b64_tr_b16 a[32:33], v4 offset:8192
    ds_read_b64_tr_b16 a[34:35], v4 offset:8704
    ds_read_b64_tr_b16 a[36:37], v4 offset:8256
    ds_read_b64_tr_b16 a[38:39], v4 offset:8768
    ds_read_b64_tr_b16 a[40:41], v4 offset:10240
    ds_read_b64_tr_b16 a[42:43], v4 offset:10752
    ds_read_b64_tr_b16 a[44:45], v4 offset:10304
    ds_read_b64_tr_b16 a[46:47], v4 offset:10816
    s_waitcnt lgkmcnt(4)
    ds_read_b64_tr_b16 a[48:49], v4 offset:12288
    ds_read_b64_tr_b16 a[50:51], v4 offset:12800
    ds_read_b64_tr_b16 a[52:53], v4 offset:12352
    ds_read_b64_tr_b16 a[54:55], v4 offset:12864
    ds_read_b64_tr_b16 a[56:57], v4 offset:14336
    ds_read_b64_tr_b16 a[58:59], v4 offset:14848
    ds_read_b64_tr_b16 a[60:61], v4 offset:14400
    ds_read_b64_tr_b16 a[62:63], v4 offset:14912
    s_waitcnt lgkmcnt(4)
    ds_read_b64_tr_b16 a[64:65], v4 offset:16384
    ds_read_b64_tr_b16 a[66:67], v4 offset:16896
    ds_read_b64_tr_b16 a[68:69], v4 offset:16448
    ds_read_b64_tr_b16 a[70:71], v4 offset:16960
    ds_read_b64_tr_b16 a[72:73], v4 offset:18432
    ds_read_b64_tr_b16 a[74:75], v4 offset:18944
    ds_read_b64_tr_b16 a[76:77], v4 offset:18496
    ds_read_b64_tr_b16 a[78:79], v4 offset:19008
    s_waitcnt lgkmcnt(4)
    ds_read_b64_tr_b16 a[80:81], v4 offset:20480
    ds_read_b64_tr_b16 a[82:83], v4 offset:20992
    ds_read_b64_tr_b16 a[84:85], v4 offset:20544
    ds_read_b64_tr_b16 a[86:87], v4 offset:21056
    ds_read_b64_tr_b16 a[88:89], v4 offset:22528
    ds_read_b64_tr_b16 a[90:91], v4 offset:23040
    ds_read_b64_tr_b16 a[92:93], v4 offset:22592
    ds_read_b64_tr_b16 a[94:95], v4 offset:23104
    s_waitcnt lgkmcnt(4)
    ds_read_b64_tr_b16 a[96:97], v4 offset:24576
    ds_read_b64_tr_b16 a[98:99], v4 offset:25088
    ds_read_b64_tr_b16 a[100:101], v4 offset:24640
    ds_read_b64_tr_b16 a[102:103], v4 offset:25152
    ds_read_b64_tr_b16 a[104:105], v4 offset:26624
    ds_read_b64_tr_b16 a[106:107], v4 offset:27136
    ds_read_b64_tr_b16 a[108:109], v4 offset:26688
    ds_read_b64_tr_b16 a[110:111], v4 offset:27200
    s_waitcnt lgkmcnt(4)
    ds_read_b64_tr_b16 a[112:113], v4 offset:28672
    ds_read_b64_tr_b16 a[114:115], v4 offset:29184
    ds_read_b64_tr_b16 a[116:117], v4 offset:28736
    ds_read_b64_tr_b16 a[118:119], v4 offset:29248
    ds_read_b64_tr_b16 a[120:121], v4 offset:30720
    ds_read_b64_tr_b16 a[122:123], v4 offset:31232
    ds_read_b64_tr_b16 a[124:125], v4 offset:30784
    ds_read_b64_tr_b16 a[126:127], v4 offset:31296
    s_waitcnt lgkmcnt(4)
    s_waitcnt lgkmcnt(0)
    s_mul_i32 s19, s13, 36
    s_add_u32 s19, s19, 16
    s_mul_i32 s19, s19, 18432
    s_lshl_b32 s20, s15, 7
    s_add_u32 s19, s19, s20
    s_mov_b32 s20, s21
    s_mov_b32 s26, 32
Ldmo_312_m:
    s_mov_b32 m0, s20
    s_nop 0
    buffer_load_dwordx4 v3, s[8:11], s19 offen lds
    s_add_u32 s19, s19, 9216
    s_add_u32 s20, s20, 1024
    s_sub_u32 s26, s26, 1
    s_cmp_lg_u32 s26, 0
    s_cbranch_scc1 Ldmo_312_m
    s_waitcnt vmcnt(0)
    ds_read_b64_tr_b16 a[128:129], v4 offset:0
    ds_read_b64_tr_b16 a[130:131], v4 offset:512
    ds_read_b64_tr_b16 a[132:133], v4 offset:64
    ds_read_b64_tr_b16 a[134:135], v4 offset:576
    ds_read_b64_tr_b16 a[136:137], v4 offset:2048
    ds_read_b64_tr_b16 a[138:139], v4 offset:2560
    ds_read_b64_tr_b16 a[140:141], v4 offset:2112
    ds_read_b64_tr_b16 a[142:143], v4 offset:2624
    s_waitcnt lgkmcnt(4)
    ds_read_b64_tr_b16 a[144:145], v4 offset:4096
    ds_read_b64_tr_b16 a[146:147], v4 offset:4608
    ds_read_b64_tr_b16 a[148:149], v4 offset:4160
    ds_read_b64_tr_b16 a[150:151], v4 offset:4672
    ds_read_b64_tr_b16 a[152:153], v4 offset:6144
    ds_read_b64_tr_b16 a[154:155], v4 offset:6656
    ds_read_b64_tr_b16 a[156:157], v4 offset:6208
    ds_read_b64_tr_b16 a[158:159], v4 offset:6720
    s_waitcnt lgkmcnt(4)
    ds_read_b64_tr_b16 a[160:161], v4 offset:8192
    ds_read_b64_tr_b16 a[162:163], v4 offset:8704
    ds_read_b64_tr_b16 a[164:165], v4 offset:8256
    ds_read_b64_tr_b16 a[166:167], v4 offset:8768
    ds_read_b64_tr_b16 a[168:169], v4 offset:10240
    ds_read_b64_tr_b16 a[170:171], v4 offset:10752
    ds_read_b64_tr_b16 a[172:173], v4 offset:10304
    ds_read_b64_tr_b16 a[174:175], v4 offset:10816
    s_waitcnt lgkmcnt(4)
    ds_read_b64_tr_b16 a[176:177], v4 offset:12288
    ds_read_b64_tr_b16 a[178:179], v4 offset:12800
    ds_read_b64_tr_b16 a[180:181], v4 offset:12352
    ds_read_b64_tr_b16 a[182:183], v4 offset:12864
    ds_read_b64_tr_b16 a[184:185], v4 offset:14336
    ds_read_b64_tr_b16 a[186:187], v4 offset:14848
    ds_read_b64_tr_b16 a[188:189], v4 offset:14400
    ds_read_b64_tr_b16 a[190:191], v4 offset:14912
    s_waitcnt lgkmcnt(4)
    ds_read_b64_tr_b16 a[192:193], v4 offset:16384
    ds_read_b64_tr_b16 a[194:195], v4 offset:16896
    ds_read_b64_tr_b16 a[196:197], v4 offset:16448
    ds_read_b64_tr_b16 a[198:199], v4 offset:16960
    ds_read_b64_tr_b16 a[200:201], v4 offset:18432
    ds_read_b64_tr_b16 a[202:203], v4 offset:18944
    ds_read_b64_tr_b16 a[204:205], v4 offset:18496
    ds_read_b64_tr_b16 a[206:207], v4 offset:19008
    s_waitcnt lgkmcnt(4)
    ds_read_b64_tr_b16 a[208:209], v4 offset:20480
    ds_read_b64_tr_b16 a[210:211], v4 offset:20992
    ds_read_b64_tr_b16 a[212:213], v4 offset:20544
    ds_read_b64_tr_b16 a[214:215], v4 offset:21056
    ds_read_b64_tr_b16 a[216:217], v4 offset:22528
    ds_read_b64_tr_b16 a[218:219], v4 offset:23040
    ds_read_b64_tr_b16 a[220:221], v4 offset:22592
    ds_read_b64_tr_b16 a[222:223], v4 offset:23104
    s_waitcnt lgkmcnt(4)
    ds_read_b64_tr_b16 a[224:225], v4 offset:24576
    ds_read_b64_tr_b16 a[226:227], v4 offset:25088
    ds_read_b64_tr_b16 a[228:229], v4 offset:24640
    ds_read_b64_tr_b16 a[230:231], v4 offset:25152
    ds_read_b64_tr_b16 a[232:233], v4 offset:26624
    ds_read_b64_tr_b16 a[234:235], v4 offset:27136
    ds_read_b64_tr_b16 a[236:237], v4 offset:26688
    ds_read_b64_tr_b16 a[238:239], v4 offset:27200
    s_waitcnt lgkmcnt(4)
    ds_read_b64_tr_b16 a[240:241], v4 offset:28672
    ds_read_b64_tr_b16 a[242:243], v4 offset:29184
    ds_read_b64_tr_b16 a[244:245], v4 offset:28736
    ds_read_b64_tr_b16 a[246:247], v4 offset:29248
    ds_read_b64_tr_b16 a[248:249], v4 offset:30720
    ds_read_b64_tr_b16 a[250:251], v4 offset:31232
    ds_read_b64_tr_b16 a[252:253], v4 offset:30784
    ds_read_b64_tr_b16 a[254:255], v4 offset:31296
    s_waitcnt lgkmcnt(4)
    s_waitcnt lgkmcnt(0)
    s_mul_i32 s19, s13, 36
    s_add_u32 s19, s19, 32
    s_mul_i32 s19, s19, 18432
    s_lshl_b32 s20, s15, 7
    s_add_u32 s19, s19, s20
    s_mov_b32 s20, s21
    s_mov_b32 s26, 8
Ldmo_313_m:
    s_mov_b32 m0, s20
    s_nop 0
    buffer_load_dwordx4 v3, s[8:11], s19 offen lds
    s_add_u32 s19, s19, 9216
    s_add_u32 s20, s20, 1024
    s_sub_u32 s26, s26, 1
    s_cmp_lg_u32 s26, 0
    s_cbranch_scc1 Ldmo_313_m
    s_waitcnt vmcnt(0)
    ds_read_b64_tr_b16 v[200:201], v4 offset:0
    ds_read_b64_tr_b16 v[202:203], v4 offset:512
    ds_read_b64_tr_b16 v[204:205], v4 offset:64
    ds_read_b64_tr_b16 v[206:207], v4 offset:576
    ds_read_b64_tr_b16 v[208:209], v4 offset:2048
    ds_read_b64_tr_b16 v[210:211], v4 offset:2560
    ds_read_b64_tr_b16 v[212:213], v4 offset:2112
    ds_read_b64_tr_b16 v[214:215], v4 offset:2624
    s_waitcnt lgkmcnt(4)
    ds_read_b64_tr_b16 v[216:217], v4 offset:4096
    ds_read_b64_tr_b16 v[218:219], v4 offset:4608
    ds_read_b64_tr_b16 v[220:221], v4 offset:4160
    ds_read_b64_tr_b16 v[222:223], v4 offset:4672
    ds_read_b64_tr_b16 v[224:225], v4 offset:6144
    ds_read_b64_tr_b16 v[226:227], v4 offset:6656
    ds_read_b64_tr_b16 v[228:229], v4 offset:6208
    ds_read_b64_tr_b16 v[230:231], v4 offset:6720
    s_waitcnt lgkmcnt(4)
    s_waitcnt lgkmcnt(0)
    s_barrier
    s_mul_i32 s19, s13, 8704
    v_add_u32 v5, s19, v0
    v_and_b32 v2, 7, v1
    v_mul_u32_u24 v6, 1088, v2
    v_lshrrev_b32 v2, 3, v1
    v_lshl_add_u32 v6, v2, 4, v6
    s_lshl_b32 s19, s13, 7
    v_add_u32 v6, s19, v6
    s_cmp_lg_u32 s13, 0
    s_cbranch_scc1 Lur_314_m
    s_mov_b32 s98, 62069760
Lfw_315_m:
    buffer_load_dwordx4 v[192:195], v0, s[4:7], s98 offen sc1
    s_waitcnt vmcnt(0)
    v_xor_b32 v192, s90, v192
    v_xor_b32 v193, s90, v193
    v_xor_b32 v194, s90, v194
    v_xor_b32 v195, s90, v195
    v_or3_b32 v192, v192, v193, v194
    v_or_b32 v192, v192, v195
    v_cmp_ne_u32 vcc, 0, v192
    s_nop 3
    s_and_b32 vcc_lo, vcc_lo, 0xffffffff
    s_and_b32 vcc_hi, vcc_hi, 0xffffffff
    s_ff1_i32_b64 s92, vcc
    s_cmp_eq_u32 s92, -1
    s_cselect_b32 s92, 64, s92
    s_lshr_b32 s92, s92, 6
    s_cmp_lg_u32 s92, 0
    s_cbranch_scc1 Lfwg_317_m
    s_sleep 2
    s_add_u32 s99, s99, 1
    s_cmp_lt_u32 s99, 4194304
    s_cbranch_scc1 Lfw_315_m
    s_endpgm
Lfwg_317_m:
Lfwok_316_m:
    s_mov_b32 s92, 64
    v_mov_b32 v198, 163832
    v_mov_b32 v199, s92
    ds_write_b32 v198, v199
    s_waitcnt lgkmcnt(0)
Lur_314_m:
    s_barrier
    v_mov_b32 v198, 163832
    ds_read_b32 v199, v198
    s_waitcnt lgkmcnt(0)
    v_readfirstlane_b32 s92, v199
    s_mul_i32 s27, s17, 147456
    s_mul_i32 s19, s13, 36864
    s_add_u32 s27, s27, s19
    s_add_u32 s27, s27, 146800640
    buffer_load_dwordx4 v[48:51], v0, s[4:7], s27 offen offset:0 sc1
    buffer_load_dwordx4 v[52:55], v0, s[4:7], s27 offen offset:1024 sc1
    buffer_load_dwordx4 v[56:59], v0, s[4:7], s27 offen offset:2048 sc1
    buffer_load_dwordx4 v[60:63], v0, s[4:7], s27 offen offset:3072 sc1
    s_add_u32 s27, s27, 4096
    buffer_load_dwordx4 v[64:67], v0, s[4:7], s27 offen offset:0 sc1
    buffer_load_dwordx4 v[68:71], v0, s[4:7], s27 offen offset:1024 sc1
    buffer_load_dwordx4 v[72:75], v0, s[4:7], s27 offen offset:2048 sc1
    buffer_load_dwordx4 v[76:79], v0, s[4:7], s27 offen offset:3072 sc1
    s_add_u32 s27, s27, 4096
    buffer_load_dwordx4 v[80:83], v0, s[4:7], s27 offen offset:0 sc1
    buffer_load_dwordx4 v[84:87], v0, s[4:7], s27 offen offset:1024 sc1
    buffer_load_dwordx4 v[88:91], v0, s[4:7], s27 offen offset:2048 sc1
    buffer_load_dwordx4 v[92:95], v0, s[4:7], s27 offen offset:3072 sc1
    s_add_u32 s27, s27, 4096
    buffer_load_dwordx4 v[96:99], v0, s[4:7], s27 offen offset:0 sc1
    buffer_load_dwordx4 v[100:103], v0, s[4:7], s27 offen offset:1024 sc1
    buffer_load_dwordx4 v[104:107], v0, s[4:7], s27 offen offset:2048 sc1
    buffer_load_dwordx4 v[108:111], v0, s[4:7], s27 offen offset:3072 sc1
    s_add_u32 s27, s27, 4096
    buffer_load_dwordx4 v[112:115], v0, s[4:7], s27 offen offset:0 sc1
    buffer_load_dwordx4 v[116:119], v0, s[4:7], s27 offen offset:1024 sc1
    buffer_load_dwordx4 v[120:123], v0, s[4:7], s27 offen offset:2048 sc1
    buffer_load_dwordx4 v[124:127], v0, s[4:7], s27 offen offset:3072 sc1
    s_add_u32 s27, s27, 4096
    buffer_load_dwordx4 v[128:131], v0, s[4:7], s27 offen offset:0 sc1
    buffer_load_dwordx4 v[132:135], v0, s[4:7], s27 offen offset:1024 sc1
    buffer_load_dwordx4 v[136:139], v0, s[4:7], s27 offen offset:2048 sc1
    buffer_load_dwordx4 v[140:143], v0, s[4:7], s27 offen offset:3072 sc1
    s_add_u32 s27, s27, 4096
    buffer_load_dwordx4 v[144:147], v0, s[4:7], s27 offen offset:0 sc1
    buffer_load_dwordx4 v[148:151], v0, s[4:7], s27 offen offset:1024 sc1
    buffer_load_dwordx4 v[152:155], v0, s[4:7], s27 offen offset:2048 sc1
    buffer_load_dwordx4 v[156:159], v0, s[4:7], s27 offen offset:3072 sc1
    s_add_u32 s27, s27, 4096
    buffer_load_dwordx4 v[160:163], v0, s[4:7], s27 offen offset:0 sc1
    buffer_load_dwordx4 v[164:167], v0, s[4:7], s27 offen offset:1024 sc1
    buffer_load_dwordx4 v[168:171], v0, s[4:7], s27 offen offset:2048 sc1
    buffer_load_dwordx4 v[172:175], v0, s[4:7], s27 offen offset:3072 sc1
    s_add_u32 s27, s27, 4096
    buffer_load_dwordx4 v[176:179], v0, s[4:7], s27 offen offset:0 sc1
    buffer_load_dwordx4 v[180:183], v0, s[4:7], s27 offen offset:1024 sc1
    buffer_load_dwordx4 v[184:187], v0, s[4:7], s27 offen offset:2048 sc1
    buffer_load_dwordx4 v[188:191], v0, s[4:7], s27 offen offset:3072 sc1
    s_mov_b32 s28, s17
    s_add_u32 s17, s17, 20
    s_cmp_lt_u32 s17, s18
    s_cbranch_scc1 Lo2m_318
    s_waitcnt vmcnt(35)
    v_mfma_f32_32x32x16_bf16 v[16:31], a[0:3], v[48:51], 0
    v_mfma_f32_32x32x16_bf16 v[32:47], a[4:7], v[48:51], 0
    s_waitcnt vmcnt(34)
    v_mfma_f32_32x32x16_bf16 v[16:31], a[8:11], v[52:55], v[16:31]
    v_mfma_f32_32x32x16_bf16 v[32:47], a[12:15], v[52:55], v[32:47]
    s_waitcnt vmcnt(33)
    v_mfma_f32_32x32x16_bf16 v[16:31], a[16:19], v[56:59], v[16:31]
    v_mfma_f32_32x32x16_bf16 v[32:47], a[20:23], v[56:59], v[32:47]
    s_waitcnt vmcnt(32)
    v_mfma_f32_32x32x16_bf16 v[16:31], a[24:27], v[60:63], v[16:31]
    v_mfma_f32_32x32x16_bf16 v[32:47], a[28:31], v[60:63], v[32:47]
    s_waitcnt vmcnt(31)
    v_mfma_f32_32x32x16_bf16 v[16:31], a[32:35], v[64:67], v[16:31]
    v_mfma_f32_32x32x16_bf16 v[32:47], a[36:39], v[64:67], v[32:47]
    s_waitcnt vmcnt(30)
    v_mfma_f32_32x32x16_bf16 v[16:31], a[40:43], v[68:71], v[16:31]
    v_mfma_f32_32x32x16_bf16 v[32:47], a[44:47], v[68:71], v[32:47]
    s_waitcnt vmcnt(29)
    v_mfma_f32_32x32x16_bf16 v[16:31], a[48:51], v[72:75], v[16:31]
    v_mfma_f32_32x32x16_bf16 v[32:47], a[52:55], v[72:75], v[32:47]
    s_waitcnt vmcnt(28)
    v_mfma_f32_32x32x16_bf16 v[16:31], a[56:59], v[76:79], v[16:31]
    v_mfma_f32_32x32x16_bf16 v[32:47], a[60:63], v[76:79], v[32:47]
    s_waitcnt vmcnt(27)
    v_mfma_f32_32x32x16_bf16 v[16:31], a[64:67], v[80:83], v[16:31]
    v_mfma_f32_32x32x16_bf16 v[32:47], a[68:71], v[80:83], v[32:47]
    s_waitcnt vmcnt(26)
    v_mfma_f32_32x32x16_bf16 v[16:31], a[72:75], v[84:87], v[16:31]
    v_mfma_f32_32x32x16_bf16 v[32:47], a[76:79], v[84:87], v[32:47]
    s_waitcnt vmcnt(25)
    v_mfma_f32_32x32x16_bf16 v[16:31], a[80:83], v[88:91], v[16:31]
    v_mfma_f32_32x32x16_bf16 v[32:47], a[84:87], v[88:91], v[32:47]
    s_waitcnt vmcnt(24)
    v_mfma_f32_32x32x16_bf16 v[16:31], a[88:91], v[92:95], v[16:31]
    v_mfma_f32_32x32x16_bf16 v[32:47], a[92:95], v[92:95], v[32:47]
    s_waitcnt vmcnt(23)
    v_mfma_f32_32x32x16_bf16 v[16:31], a[96:99], v[96:99], v[16:31]
    v_mfma_f32_32x32x16_bf16 v[32:47], a[100:103], v[96:99], v[32:47]
    s_waitcnt vmcnt(22)
    v_mfma_f32_32x32x16_bf16 v[16:31], a[104:107], v[100:103], v[16:31]
    v_mfma_f32_32x32x16_bf16 v[32:47], a[108:111], v[100:103], v[32:47]
    s_waitcnt vmcnt(21)
    v_mfma_f32_32x32x16_bf16 v[16:31], a[112:115], v[104:107], v[16:31]
    v_mfma_f32_32x32x16_bf16 v[32:47], a[116:119], v[104:107], v[32:47]
    s_waitcnt vmcnt(20)
    v_mfma_f32_32x32x16_bf16 v[16:31], a[120:123], v[108:111], v[16:31]
    v_mfma_f32_32x32x16_bf16 v[32:47], a[124:127], v[108:111], v[32:47]
    s_waitcnt vmcnt(19)
    v_mfma_f32_32x32x16_bf16 v[16:31], a[128:131], v[112:115], v[16:31]
    v_mfma_f32_32x32x16_bf16 v[32:47], a[132:135], v[112:115], v[32:47]
    s_waitcnt vmcnt(18)
    v_mfma_f32_32x32x16_bf16 v[16:31], a[136:139], v[116:119], v[16:31]
    v_mfma_f32_32x32x16_bf16 v[32:47], a[140:143], v[116:119], v[32:47]
    s_waitcnt vmcnt(17)
    v_mfma_f32_32x32x16_bf16 v[16:31], a[144:147], v[120:123], v[16:31]
    v_mfma_f32_32x32x16_bf16 v[32:47], a[148:151], v[120:123], v[32:47]
    s_waitcnt vmcnt(16)
    v_mfma_f32_32x32x16_bf16 v[16:31], a[152:155], v[124:127], v[16:31]
    v_mfma_f32_32x32x16_bf16 v[32:47], a[156:159], v[124:127], v[32:47]
    s_waitcnt vmcnt(15)
    v_mfma_f32_32x32x16_bf16 v[16:31], a[160:163], v[128:131], v[16:31]
    v_mfma_f32_32x32x16_bf16 v[32:47], a[164:167], v[128:131], v[32:47]
    s_waitcnt vmcnt(14)
    v_mfma_f32_32x32x16_bf16 v[16:31], a[168:171], v[132:135], v[16:31]
    v_mfma_f32_32x32x16_bf16 v[32:47], a[172:175], v[132:135], v[32:47]
    s_waitcnt vmcnt(13)
    v_mfma_f32_32x32x16_bf16 v[16:31], a[176:179], v[136:139], v[16:31]
    v_mfma_f32_32x32x16_bf16 v[32:47], a[180:183], v[136:139], v[32:47]
    s_waitcnt vmcnt(12)
    v_mfma_f32_32x32x16_bf16 v[16:31], a[184:187], v[140:143], v[16:31]
    v_mfma_f32_32x32x16_bf16 v[32:47], a[188:191], v[140:143], v[32:47]
    s_waitcnt vmcnt(11)
    v_mfma_f32_32x32x16_bf16 v[16:31], a[192:195], v[144:147], v[16:31]
    v_mfma_f32_32x32x16_bf16 v[32:47], a[196:199], v[144:147], v[32:47]
    s_waitcnt vmcnt(10)
    v_mfma_f32_32x32x16_bf16 v[16:31], a[200:203], v[148:151], v[16:31]
    v_mfma_f32_32x32x16_bf16 v[32:47], a[204:207], v[148:151], v[32:47]
    s_waitcnt vmcnt(9)
    v_mfma_f32_32x32x16_bf16 v[16:31], a[208:211], v[152:155], v[16:31]
    v_mfma_f32_32x32x16_bf16 v[32:47], a[212:215], v[152:155], v[32:47]
    s_waitcnt vmcnt(8)
    v_mfma_f32_32x32x16_bf16 v[16:31], a[216:219], v[156:159], v[16:31]
    v_mfma_f32_32x32x16_bf16 v[32:47], a[220:223], v[156:159], v[32:47]
    s_waitcnt vmcnt(7)
    v_mfma_f32_32x32x16_bf16 v[16:31], a[224:227], v[160:163], v[16:31]
    v_mfma_f32_32x32x16_bf16 v[32:47], a[228:231], v[160:163], v[32:47]
    s_waitcnt vmcnt(6)
    v_mfma_f32_32x32x16_bf16 v[16:31], a[232:235], v[164:167], v[16:31]
    v_mfma_f32_32x32x16_bf16 v[32:47], a[236:239], v[164:167], v[32:47]
    s_waitcnt vmcnt(5)
    v_mfma_f32_32x32x16_bf16 v[16:31], a[240:243], v[168:171], v[16:31]
    v_mfma_f32_32x32x16_bf16 v[32:47], a[244:247], v[168:171], v[32:47]
    s_waitcnt vmcnt(4)
    v_mfma_f32_32x32x16_bf16 v[16:31], a[248:251], v[172:175], v[16:31]
    v_mfma_f32_32x32x16_bf16 v[32:47], a[252:255], v[172:175], v[32:47]
    s_waitcnt vmcnt(3)
    v_mfma_f32_32x32x16_bf16 v[16:31], v[200:203], v[176:179], v[16:31]
    v_mfma_f32_32x32x16_bf16 v[32:47], v[204:207], v[176:179], v[32:47]
    s_waitcnt vmcnt(2)
    v_mfma_f32_32x32x16_bf16 v[16:31], v[208:211], v[180:183], v[16:31]
    v_mfma_f32_32x32x16_bf16 v[32:47], v[212:215], v[180:183], v[32:47]
    s_waitcnt vmcnt(1)
    v_mfma_f32_32x32x16_bf16 v[16:31], v[216:219], v[184:187], v[16:31]
    v_mfma_f32_32x32x16_bf16 v[32:47], v[220:223], v[184:187], v[32:47]
    s_waitcnt vmcnt(0)
    v_mfma_f32_32x32x16_bf16 v[16:31], v[224:227], v[188:191], v[16:31]
    v_mfma_f32_32x32x16_bf16 v[32:47], v[228:231], v[188:191], v[32:47]
    s_branch Lo2f_321
Lo2m_318:
    s_mul_i32 s27, s17, 147456
    s_mul_i32 s19, s13, 36864
    s_add_u32 s27, s27, s19
    s_add_u32 s27, s27, 146800640
    s_waitcnt vmcnt(35)
    s_nop 2
    v_mfma_f32_32x32x16_bf16 v[16:31], a[0:3], v[48:51], 0
    v_mfma_f32_32x32x16_bf16 v[32:47], a[4:7], v[48:51], 0
    buffer_load_dwordx4 v[48:51], v0, s[4:7], s27 offen offset:0 sc1
    s_waitcnt vmcnt(35)
    v_mfma_f32_32x32x16_bf16 v[16:31], a[8:11], v[52:55], v[16:31]
    v_mfma_f32_32x32x16_bf16 v[32:47], a[12:15], v[52:55], v[32:47]
    buffer_load_dwordx4 v[52:55], v0, s[4:7], s27 offen offset:1024 sc1
    s_waitcnt vmcnt(35)
    v_mfma_f32_32x32x16_bf16 v[16:31], a[16:19], v[56:59], v[16:31]
    v_mfma_f32_32x32x16_bf16 v[32:47], a[20:23], v[56:59], v[32:47]
    buffer_load_dwordx4 v[56:59], v0, s[4:7], s27 offen offset:2048 sc1
    s_waitcnt vmcnt(35)
    v_mfma_f32_32x32x16_bf16 v[16:31], a[24:27], v[60:63], v[16:31]
    v_mfma_f32_32x32x16_bf16 v[32:47], a[28:31], v[60:63], v[32:47]
    buffer_load_dwordx4 v[60:63], v0, s[4:7], s27 offen offset:3072 sc1
    s_add_u32 s27, s27, 4096
    s_waitcnt vmcnt(35)
    v_mfma_f32_32x32x16_bf16 v[16:31], a[32:35], v[64:67], v[16:31]
    v_mfma_f32_32x32x16_bf16 v[32:47], a[36:39], v[64:67], v[32:47]
    buffer_load_dwordx4 v[64:67], v0, s[4:7], s27 offen offset:0 sc1
    s_waitcnt vmcnt(35)
    v_mfma_f32_32x32x16_bf16 v[16:31], a[40:43], v[68:71], v[16:31]
    v_mfma_f32_32x32x16_bf16 v[32:47], a[44:47], v[68:71], v[32:47]
    buffer_load_dwordx4 v[68:71], v0, s[4:7], s27 offen offset:1024 sc1
    s_waitcnt vmcnt(35)
    v_mfma_f32_32x32x16_bf16 v[16:31], a[48:51], v[72:75], v[16:31]
    v_mfma_f32_32x32x16_bf16 v[32:47], a[52:55], v[72:75], v[32:47]
    buffer_load_dwordx4 v[72:75], v0, s[4:7], s27 offen offset:2048 sc1
    s_waitcnt vmcnt(35)
    v_mfma_f32_32x32x16_bf16 v[16:31], a[56:59], v[76:79], v[16:31]
    v_mfma_f32_32x32x16_bf16 v[32:47], a[60:63], v[76:79], v[32:47]
    buffer_load_dwordx4 v[76:79], v0, s[4:7], s27 offen offset:3072 sc1
    s_add_u32 s27, s27, 4096
    s_waitcnt vmcnt(35)
    v_mfma_f32_32x32x16_bf16 v[16:31], a[64:67], v[80:83], v[16:31]
    v_mfma_f32_32x32x16_bf16 v[32:47], a[68:71], v[80:83], v[32:47]
    buffer_load_dwordx4 v[80:83], v0, s[4:7], s27 offen offset:0 sc1
    s_waitcnt vmcnt(35)
    v_mfma_f32_32x32x16_bf16 v[16:31], a[72:75], v[84:87], v[16:31]
    v_mfma_f32_32x32x16_bf16 v[32:47], a[76:79], v[84:87], v[32:47]
    buffer_load_dwordx4 v[84:87], v0, s[4:7], s27 offen offset:1024 sc1
    s_waitcnt vmcnt(35)
    v_mfma_f32_32x32x16_bf16 v[16:31], a[80:83], v[88:91], v[16:31]
    v_mfma_f32_32x32x16_bf16 v[32:47], a[84:87], v[88:91], v[32:47]
    buffer_load_dwordx4 v[88:91], v0, s[4:7], s27 offen offset:2048 sc1
    s_waitcnt vmcnt(35)
    v_mfma_f32_32x32x16_bf16 v[16:31], a[88:91], v[92:95], v[16:31]
    v_mfma_f32_32x32x16_bf16 v[32:47], a[92:95], v[92:95], v[32:47]
    buffer_load_dwordx4 v[92:95], v0, s[4:7], s27 offen offset:3072 sc1
    s_add_u32 s27, s27, 4096
    s_waitcnt vmcnt(35)
    v_mfma_f32_32x32x16_bf16 v[16:31], a[96:99], v[96:99], v[16:31]
    v_mfma_f32_32x32x16_bf16 v[32:47], a[100:103], v[96:99], v[32:47]
    buffer_load_dwordx4 v[96:99], v0, s[4:7], s27 offen offset:0 sc1
    s_waitcnt vmcnt(35)
    v_mfma_f32_32x32x16_bf16 v[16:31], a[104:107], v[100:103], v[16:31]
    v_mfma_f32_32x32x16_bf16 v[32:47], a[108:111], v[100:103], v[32:47]
    buffer_load_dwordx4 v[100:103], v0, s[4:7], s27 offen offset:1024 sc1
    s_waitcnt vmcnt(35)
    v_mfma_f32_32x32x16_bf16 v[16:31], a[112:115], v[104:107], v[16:31]
    v_mfma_f32_32x32x16_bf16 v[32:47], a[116:119], v[104:107], v[32:47]
    buffer_load_dwordx4 v[104:107], v0, s[4:7], s27 offen offset:2048 sc1
    s_waitcnt vmcnt(35)
    v_mfma_f32_32x32x16_bf16 v[16:31], a[120:123], v[108:111], v[16:31]
    v_mfma_f32_32x32x16_bf16 v[32:47], a[124:127], v[108:111], v[32:47]
    buffer_load_dwordx4 v[108:111], v0, s[4:7], s27 offen offset:3072 sc1
    s_add_u32 s27, s27, 4096
    s_waitcnt vmcnt(35)
    v_mfma_f32_32x32x16_bf16 v[16:31], a[128:131], v[112:115], v[16:31]
    v_mfma_f32_32x32x16_bf16 v[32:47], a[132:135], v[112:115], v[32:47]
    buffer_load_dwordx4 v[112:115], v0, s[4:7], s27 offen offset:0 sc1
    s_waitcnt vmcnt(35)
    v_mfma_f32_32x32x16_bf16 v[16:31], a[136:139], v[116:119], v[16:31]
    v_mfma_f32_32x32x16_bf16 v[32:47], a[140:143], v[116:119], v[32:47]
    buffer_load_dwordx4 v[116:119], v0, s[4:7], s27 offen offset:1024 sc1
    s_waitcnt vmcnt(35)
    v_mfma_f32_32x32x16_bf16 v[16:31], a[144:147], v[120:123], v[16:31]
    v_mfma_f32_32x32x16_bf16 v[32:47], a[148:151], v[120:123], v[32:47]
    buffer_load_dwordx4 v[120:123], v0, s[4:7], s27 offen offset:2048 sc1
    s_waitcnt vmcnt(35)
    v_mfma_f32_32x32x16_bf16 v[16:31], a[152:155], v[124:127], v[16:31]
    v_mfma_f32_32x32x16_bf16 v[32:47], a[156:159], v[124:127], v[32:47]
    buffer_load_dwordx4 v[124:127], v0, s[4:7], s27 offen offset:3072 sc1
    s_add_u32 s27, s27, 4096
    s_waitcnt vmcnt(35)
    v_mfma_f32_32x32x16_bf16 v[16:31], a[160:163], v[128:131], v[16:31]
    v_mfma_f32_32x32x16_bf16 v[32:47], a[164:167], v[128:131], v[32:47]
    buffer_load_dwordx4 v[128:131], v0, s[4:7], s27 offen offset:0 sc1
    s_waitcnt vmcnt(35)
    v_mfma_f32_32x32x16_bf16 v[16:31], a[168:171], v[132:135], v[16:31]
    v_mfma_f32_32x32x16_bf16 v[32:47], a[172:175], v[132:135], v[32:47]
    buffer_load_dwordx4 v[132:135], v0, s[4:7], s27 offen offset:1024 sc1
    s_waitcnt vmcnt(35)
    v_mfma_f32_32x32x16_bf16 v[16:31], a[176:179], v[136:139], v[16:31]
    v_mfma_f32_32x32x16_bf16 v[32:47], a[180:183], v[136:139], v[32:47]
    buffer_load_dwordx4 v[136:139], v0, s[4:7], s27 offen offset:2048 sc1
    s_waitcnt vmcnt(35)
    v_mfma_f32_32x32x16_bf16 v[16:31], a[184:187], v[140:143], v[16:31]
    v_mfma_f32_32x32x16_bf16 v[32:47], a[188:191], v[140:143], v[32:47]
    buffer_load_dwordx4 v[140:143], v0, s[4:7], s27 offen offset:3072 sc1
    s_add_u32 s27, s27, 4096
    s_waitcnt vmcnt(35)
    v_mfma_f32_32x32x16_bf16 v[16:31], a[192:195], v[144:147], v[16:31]
    v_mfma_f32_32x32x16_bf16 v[32:47], a[196:199], v[144:147], v[32:47]
    buffer_load_dwordx4 v[144:147], v0, s[4:7], s27 offen offset:0 sc1
    s_waitcnt vmcnt(35)
    v_mfma_f32_32x32x16_bf16 v[16:31], a[200:203], v[148:151], v[16:31]
    v_mfma_f32_32x32x16_bf16 v[32:47], a[204:207], v[148:151], v[32:47]
    buffer_load_dwordx4 v[148:151], v0, s[4:7], s27 offen offset:1024 sc1
    s_waitcnt vmcnt(35)
    v_mfma_f32_32x32x16_bf16 v[16:31], a[208:211], v[152:155], v[16:31]
    v_mfma_f32_32x32x16_bf16 v[32:47], a[212:215], v[152:155], v[32:47]
    buffer_load_dwordx4 v[152:155], v0, s[4:7], s27 offen offset:2048 sc1
    s_waitcnt vmcnt(35)
    v_mfma_f32_32x32x16_bf16 v[16:31], a[216:219], v[156:159], v[16:31]
    v_mfma_f32_32x32x16_bf16 v[32:47], a[220:223], v[156:159], v[32:47]
    buffer_load_dwordx4 v[156:159], v0, s[4:7], s27 offen offset:3072 sc1
    s_add_u32 s27, s27, 4096
    s_waitcnt vmcnt(35)
    v_mfma_f32_32x32x16_bf16 v[16:31], a[224:227], v[160:163], v[16:31]
    v_mfma_f32_32x32x16_bf16 v[32:47], a[228:231], v[160:163], v[32:47]
    buffer_load_dwordx4 v[160:163], v0, s[4:7], s27 offen offset:0 sc1
    s_waitcnt vmcnt(35)
    v_mfma_f32_32x32x16_bf16 v[16:31], a[232:235], v[164:167], v[16:31]
    v_mfma_f32_32x32x16_bf16 v[32:47], a[236:239], v[164:167], v[32:47]
    buffer_load_dwordx4 v[164:167], v0, s[4:7], s27 offen offset:1024 sc1
    s_waitcnt vmcnt(35)
    v_mfma_f32_32x32x16_bf16 v[16:31], a[240:243], v[168:171], v[16:31]
    v_mfma_f32_32x32x16_bf16 v[32:47], a[244:247], v[168:171], v[32:47]
    buffer_load_dwordx4 v[168:171], v0, s[4:7], s27 offen offset:2048 sc1
    s_waitcnt vmcnt(35)
    v_mfma_f32_32x32x16_bf16 v[16:31], a[248:251], v[172:175], v[16:31]
    v_mfma_f32_32x32x16_bf16 v[32:47], a[252:255], v[172:175], v[32:47]
    buffer_load_dwordx4 v[172:175], v0, s[4:7], s27 offen offset:3072 sc1
    s_add_u32 s27, s27, 4096
    s_waitcnt vmcnt(35)
    v_mfma_f32_32x32x16_bf16 v[16:31], v[200:203], v[176:179], v[16:31]
    v_mfma_f32_32x32x16_bf16 v[32:47], v[204:207], v[176:179], v[32:47]
    buffer_load_dwordx4 v[176:179], v0, s[4:7], s27 offen offset:0 sc1
    s_waitcnt vmcnt(35)
    v_mfma_f32_32x32x16_bf16 v[16:31], v[208:211], v[180:183], v[16:31]
    v_mfma_f32_32x32x16_bf16 v[32:47], v[212:215], v[180:183], v[32:47]
    buffer_load_dwordx4 v[180:183], v0, s[4:7], s27 offen offset:1024 sc1
    s_waitcnt vmcnt(35)
    v_mfma_f32_32x32x16_bf16 v[16:31], v[216:219], v[184:187], v[16:31]
    v_mfma_f32_32x32x16_bf16 v[32:47], v[220:223], v[184:187], v[32:47]
    buffer_load_dwordx4 v[184:187], v0, s[4:7], s27 offen offset:2048 sc1
    s_waitcnt vmcnt(35)
    v_mfma_f32_32x32x16_bf16 v[16:31], v[224:227], v[188:191], v[16:31]
    v_mfma_f32_32x32x16_bf16 v[32:47], v[228:231], v[188:191], v[32:47]
    buffer_load_dwordx4 v[188:191], v0, s[4:7], s27 offen offset:3072 sc1
Lo2t_320:
    s_nop 11
    s_barrier
    ds_write_b128 v5, v[16:19] offset:0
    ds_write_b128 v5, v[20:23] offset:1088
    ds_write_b128 v5, v[24:27] offset:2176
    ds_write_b128 v5, v[28:31] offset:3264
    ds_write_b128 v5, v[32:35] offset:4352
    ds_write_b128 v5, v[36:39] offset:5440
    ds_write_b128 v5, v[40:43] offset:6528
    ds_write_b128 v5, v[44:47] offset:7616
    s_lshl_b32 s19, s28, 5
    s_lshl_b32 s20, s13, 3
    s_add_u32 s19, s19, s20
    s_mul_i32 s19, s19, 1152
    s_lshl_b32 s20, s15, 7
    s_add_u32 s31, s19, s20
    s_add_u32 s20, s31, 69206016
    buffer_load_dwordx4 v[192:195], v7, s[4:7], s20 offen sc1
    s_mov_b32 s29, s28
    s_mov_b32 s28, s17
    s_add_u32 s17, s17, 20
    s_cmp_lt_u32 s17, s18
    s_cbranch_scc0 Lo2l_319
    s_mul_i32 s27, s17, 147456
    s_mul_i32 s19, s13, 36864
    s_add_u32 s27, s27, s19
    s_add_u32 s27, s27, 146800640
    s_waitcnt vmcnt(36)
    v_mfma_f32_32x32x16_bf16 v[16:31], a[0:3], v[48:51], 0
    v_mfma_f32_32x32x16_bf16 v[32:47], a[4:7], v[48:51], 0
    buffer_load_dwordx4 v[48:51], v0, s[4:7], s27 offen offset:0 sc1
    s_waitcnt vmcnt(36)
    v_mfma_f32_32x32x16_bf16 v[16:31], a[8:11], v[52:55], v[16:31]
    v_mfma_f32_32x32x16_bf16 v[32:47], a[12:15], v[52:55], v[32:47]
    buffer_load_dwordx4 v[52:55], v0, s[4:7], s27 offen offset:1024 sc1
    s_waitcnt vmcnt(36)
    v_mfma_f32_32x32x16_bf16 v[16:31], a[16:19], v[56:59], v[16:31]
    v_mfma_f32_32x32x16_bf16 v[32:47], a[20:23], v[56:59], v[32:47]
    buffer_load_dwordx4 v[56:59], v0, s[4:7], s27 offen offset:2048 sc1
    s_waitcnt vmcnt(36)
    v_mfma_f32_32x32x16_bf16 v[16:31], a[24:27], v[60:63], v[16:31]
    v_mfma_f32_32x32x16_bf16 v[32:47], a[28:31], v[60:63], v[32:47]
    buffer_load_dwordx4 v[60:63], v0, s[4:7], s27 offen offset:3072 sc1
    s_add_u32 s27, s27, 4096
    s_waitcnt lgkmcnt(0)
    s_barrier
    s_waitcnt vmcnt(36)
    v_mfma_f32_32x32x16_bf16 v[16:31], a[32:35], v[64:67], v[16:31]
    v_mfma_f32_32x32x16_bf16 v[32:47], a[36:39], v[64:67], v[32:47]
    buffer_load_dwordx4 v[64:67], v0, s[4:7], s27 offen offset:0 sc1
    s_waitcnt vmcnt(36)
    v_mfma_f32_32x32x16_bf16 v[16:31], a[40:43], v[68:71], v[16:31]
    v_mfma_f32_32x32x16_bf16 v[32:47], a[44:47], v[68:71], v[32:47]
    buffer_load_dwordx4 v[68:71], v0, s[4:7], s27 offen offset:1024 sc1
    s_waitcnt vmcnt(36)
    v_mfma_f32_32x32x16_bf16 v[16:31], a[48:51], v[72:75], v[16:31]
    v_mfma_f32_32x32x16_bf16 v[32:47], a[52:55], v[72:75], v[32:47]
    buffer_load_dwordx4 v[72:75], v0, s[4:7], s27 offen offset:2048 sc1
    ds_read_b128 v[232:235], v6 offset:0
    ds_read_b128 v[236:239], v6 offset:8704
    ds_read_b128 v[240:243], v6 offset:17408
    ds_read_b128 v[244:247], v6 offset:26112
    s_waitcnt vmcnt(36)
    v_mfma_f32_32x32x16_bf16 v[16:31], a[56:59], v[76:79], v[16:31]
    v_mfma_f32_32x32x16_bf16 v[32:47], a[60:63], v[76:79], v[32:47]
    buffer_load_dwordx4 v[76:79], v0, s[4:7], s27 offen offset:3072 sc1
    s_add_u32 s27, s27, 4096
    s_waitcnt vmcnt(36)
    v_mfma_f32_32x32x16_bf16 v[16:31], a[64:67], v[80:83], v[16:31]
    v_mfma_f32_32x32x16_bf16 v[32:47], a[68:71], v[80:83], v[32:47]
    buffer_load_dwordx4 v[80:83], v0, s[4:7], s27 offen offset:0 sc1
    s_waitcnt vmcnt(36)
    v_mfma_f32_32x32x16_bf16 v[16:31], a[72:75], v[84:87], v[16:31]
    v_mfma_f32_32x32x16_bf16 v[32:47], a[76:79], v[84:87], v[32:47]
    buffer_load_dwordx4 v[84:87], v0, s[4:7], s27 offen offset:1024 sc1
    s_waitcnt lgkmcnt(0)
    v_pk_add_f32 v[232:233], v[232:233], v[236:237]
    v_pk_add_f32 v[234:235], v[234:235], v[238:239]
    v_pk_add_f32 v[240:241], v[240:241], v[244:245]
    v_pk_add_f32 v[242:243], v[242:243], v[246:247]
    v_pk_add_f32 v[248:249], v[232:233], v[240:241]
    v_pk_add_f32 v[250:251], v[234:235], v[242:243]
    s_waitcnt vmcnt(36)
    v_mfma_f32_32x32x16_bf16 v[16:31], a[80:83], v[88:91], v[16:31]
    v_mfma_f32_32x32x16_bf16 v[32:47], a[84:87], v[88:91], v[32:47]
    buffer_load_dwordx4 v[88:91], v0, s[4:7], s27 offen offset:2048 sc1
    s_waitcnt vmcnt(36)
    v_mfma_f32_32x32x16_bf16 v[16:31], a[88:91], v[92:95], v[16:31]
    v_mfma_f32_32x32x16_bf16 v[32:47], a[92:95], v[92:95], v[32:47]
    buffer_load_dwordx4 v[92:95], v0, s[4:7], s27 offen offset:3072 sc1
    s_add_u32 s27, s27, 4096
    ds_read_b128 v[232:235], v6 offset:512
    ds_read_b128 v[236:239], v6 offset:9216
    ds_read_b128 v[240:243], v6 offset:17920
    ds_read_b128 v[244:247], v6 offset:26624
    s_waitcnt vmcnt(36)
    v_mfma_f32_32x32x16_bf16 v[16:31], a[96:99], v[96:99], v[16:31]
    v_mfma_f32_32x32x16_bf16 v[32:47], a[100:103], v[96:99], v[32:47]
    buffer_load_dwordx4 v[96:99], v0, s[4:7], s27 offen offset:0 sc1
    s_waitcnt vmcnt(36)
    v_mfma_f32_32x32x16_bf16 v[16:31], a[104:107], v[100:103], v[16:31]
    v_mfma_f32_32x32x16_bf16 v[32:47], a[108:111], v[100:103], v[32:47]
    buffer_load_dwordx4 v[100:103], v0, s[4:7], s27 offen offset:1024 sc1
    s_waitcnt vmcnt(36)
    v_mfma_f32_32x32x16_bf16 v[16:31], a[112:115], v[104:107], v[16:31]
    v_mfma_f32_32x32x16_bf16 v[32:47], a[116:119], v[104:107], v[32:47]
    buffer_load_dwordx4 v[104:107], v0, s[4:7], s27 offen offset:2048 sc1
    s_waitcnt lgkmcnt(0)
    v_pk_add_f32 v[232:233], v[232:233], v[236:237]
    v_pk_add_f32 v[234:235], v[234:235], v[238:239]
    v_pk_add_f32 v[240:241], v[240:241], v[244:245]
    v_pk_add_f32 v[242:243], v[242:243], v[246:247]
    v_pk_add_f32 v[252:253], v[232:233], v[240:241]
    v_pk_add_f32 v[254:255], v[234:235], v[242:243]
    s_waitcnt vmcnt(36)
    v_mfma_f32_32x32x16_bf16 v[16:31], a[120:123], v[108:111], v[16:31]
    v_mfma_f32_32x32x16_bf16 v[32:47], a[124:127], v[108:111], v[32:47]
    buffer_load_dwordx4 v[108:111], v0, s[4:7], s27 offen offset:3072 sc1
    s_add_u32 s27, s27, 4096
    s_waitcnt vmcnt(36)
    v_mfma_f32_32x32x16_bf16 v[16:31], a[128:131], v[112:115], v[16:31]
    v_mfma_f32_32x32x16_bf16 v[32:47], a[132:135], v[112:115], v[32:47]
    buffer_load_dwordx4 v[112:115], v0, s[4:7], s27 offen offset:0 sc1
    s_waitcnt vmcnt(36)
    v_mfma_f32_32x32x16_bf16 v[16:31], a[136:139], v[116:119], v[16:31]
    v_mfma_f32_32x32x16_bf16 v[32:47], a[140:143], v[116:119], v[32:47]
    buffer_load_dwordx4 v[116:119], v0, s[4:7], s27 offen offset:1024 sc1
    v_cvt_pk_bf16_f32 v196, v248, v249
    v_lshlrev_b32 v248, 16, v196
    v_and_b32 v249, 0xffff0000, v196
    v_cvt_pk_bf16_f32 v196, v250, v251
    v_lshlrev_b32 v250, 16, v196
    v_and_b32 v251, 0xffff0000, v196
    v_cvt_pk_bf16_f32 v196, v252, v253
    v_lshlrev_b32 v252, 16, v196
    v_and_b32 v253, 0xffff0000, v196
    v_cvt_pk_bf16_f32 v196, v254, v255
    v_lshlrev_b32 v254, 16, v196
    v_and_b32 v255, 0xffff0000, v196
    s_waitcnt vmcnt(36)
    v_mfma_f32_32x32x16_bf16 v[16:31], a[144:147], v[120:123], v[16:31]
    v_mfma_f32_32x32x16_bf16 v[32:47], a[148:151], v[120:123], v[32:47]
    buffer_load_dwordx4 v[120:123], v0, s[4:7], s27 offen offset:2048 sc1
    s_waitcnt vmcnt(36)
    v_mfma_f32_32x32x16_bf16 v[16:31], a[152:155], v[124:127], v[16:31]
    v_mfma_f32_32x32x16_bf16 v[32:47], a[156:159], v[124:127], v[32:47]
    buffer_load_dwordx4 v[124:127], v0, s[4:7], s27 offen offset:3072 sc1
    s_add_u32 s27, s27, 4096
    s_waitcnt vmcnt(36)
    v_mfma_f32_32x32x16_bf16 v[16:31], a[160:163], v[128:131], v[16:31]
    v_mfma_f32_32x32x16_bf16 v[32:47], a[164:167], v[128:131], v[32:47]
    buffer_load_dwordx4 v[128:131], v0, s[4:7], s27 offen offset:0 sc1
    v_pk_mul_f32 v[248:249], v[248:249], v[8:9]
    v_pk_mul_f32 v[250:251], v[250:251], v[10:11]
    v_pk_mul_f32 v[252:253], v[252:253], v[12:13]
    v_pk_mul_f32 v[254:255], v[254:255], v[14:15]
    s_waitcnt vmcnt(36)
    v_mfma_f32_32x32x16_bf16 v[16:31], a[168:171], v[132:135], v[16:31]
    v_mfma_f32_32x32x16_bf16 v[32:47], a[172:175], v[132:135], v[32:47]
    buffer_load_dwordx4 v[132:135], v0, s[4:7], s27 offen offset:1024 sc1
    s_waitcnt vmcnt(36)
    v_mfma_f32_32x32x16_bf16 v[16:31], a[176:179], v[136:139], v[16:31]
    v_mfma_f32_32x32x16_bf16 v[32:47], a[180:183], v[136:139], v[32:47]
    buffer_load_dwordx4 v[136:139], v0, s[4:7], s27 offen offset:2048 sc1
    s_waitcnt vmcnt(36)
    v_mfma_f32_32x32x16_bf16 v[16:31], a[184:187], v[140:143], v[16:31]
    v_mfma_f32_32x32x16_bf16 v[32:47], a[188:191], v[140:143], v[32:47]
    buffer_load_dwordx4 v[140:143], v0, s[4:7], s27 offen offset:3072 sc1
    s_add_u32 s27, s27, 4096
    v_cvt_pk_bf16_f32 v196, v248, v249
    v_lshlrev_b32 v248, 16, v196
    v_and_b32 v249, 0xffff0000, v196
    v_cvt_pk_bf16_f32 v196, v250, v251
    v_lshlrev_b32 v250, 16, v196
    v_and_b32 v251, 0xffff0000, v196
    v_cvt_pk_bf16_f32 v196, v252, v253
    v_lshlrev_b32 v252, 16, v196
    v_and_b32 v253, 0xffff0000, v196
    v_cvt_pk_bf16_f32 v196, v254, v255
    v_lshlrev_b32 v254, 16, v196
    v_and_b32 v255, 0xffff0000, v196
    s_waitcnt vmcnt(36)
    v_mfma_f32_32x32x16_bf16 v[16:31], a[192:195], v[144:147], v[16:31]
    v_mfma_f32_32x32x16_bf16 v[32:47], a[196:199], v[144:147], v[32:47]
    buffer_load_dwordx4 v[144:147], v0, s[4:7], s27 offen offset:0 sc1
    s_waitcnt vmcnt(36)
    v_mfma_f32_32x32x16_bf16 v[16:31], a[200:203], v[148:151], v[16:31]
    v_mfma_f32_32x32x16_bf16 v[32:47], a[204:207], v[148:151], v[32:47]
    buffer_load_dwordx4 v[148:151], v0, s[4:7], s27 offen offset:1024 sc1
    s_waitcnt vmcnt(36)
    v_mfma_f32_32x32x16_bf16 v[16:31], a[208:211], v[152:155], v[16:31]
    v_mfma_f32_32x32x16_bf16 v[32:47], a[212:215], v[152:155], v[32:47]
    buffer_load_dwordx4 v[152:155], v0, s[4:7], s27 offen offset:2048 sc1
    s_waitcnt vmcnt(36)
    v_mfma_f32_32x32x16_bf16 v[16:31], a[216:219], v[156:159], v[16:31]
    v_mfma_f32_32x32x16_bf16 v[32:47], a[220:223], v[156:159], v[32:47]
    buffer_load_dwordx4 v[156:159], v0, s[4:7], s27 offen offset:3072 sc1
    s_add_u32 s27, s27, 4096
    s_waitcnt vmcnt(28)
    v_lshlrev_b32 v196, 16, v192
    v_and_b32 v197, 0xffff0000, v192
    v_pk_add_f32 v[248:249], v[248:249], v[196:197]
    v_cvt_pk_bf16_f32 v192, v248, v249
    v_lshlrev_b32 v196, 16, v193
    v_and_b32 v197, 0xffff0000, v193
    v_pk_add_f32 v[250:251], v[250:251], v[196:197]
    v_cvt_pk_bf16_f32 v193, v250, v251
    v_lshlrev_b32 v196, 16, v194
    v_and_b32 v197, 0xffff0000, v194
    v_pk_add_f32 v[252:253], v[252:253], v[196:197]
    v_cvt_pk_bf16_f32 v194, v252, v253
    v_lshlrev_b32 v196, 16, v195
    v_and_b32 v197, 0xffff0000, v195
    v_pk_add_f32 v[254:255], v[254:255], v[196:197]
    v_cvt_pk_bf16_f32 v195, v254, v255
    buffer_store_dwordx4 v[192:195], v7, s[32:35], s31 offen
    s_waitcnt vmcnt(36)
    v_mfma_f32_32x32x16_bf16 v[16:31], a[224:227], v[160:163], v[16:31]
    v_mfma_f32_32x32x16_bf16 v[32:47], a[228:231], v[160:163], v[32:47]
    buffer_load_dwordx4 v[160:163], v0, s[4:7], s27 offen offset:0 sc1
    s_waitcnt vmcnt(36)
    v_mfma_f32_32x32x16_bf16 v[16:31], a[232:235], v[164:167], v[16:31]
    v_mfma_f32_32x32x16_bf16 v[32:47], a[236:239], v[164:167], v[32:47]
    buffer_load_dwordx4 v[164:167], v0, s[4:7], s27 offen offset:1024 sc1
    s_waitcnt vmcnt(36)
    v_mfma_f32_32x32x16_bf16 v[16:31], a[240:243], v[168:171], v[16:31]
    v_mfma_f32_32x32x16_bf16 v[32:47], a[244:247], v[168:171], v[32:47]
    buffer_load_dwordx4 v[168:171], v0, s[4:7], s27 offen offset:2048 sc1
    s_waitcnt vmcnt(36)
    v_mfma_f32_32x32x16_bf16 v[16:31], a[248:251], v[172:175], v[16:31]
    v_mfma_f32_32x32x16_bf16 v[32:47], a[252:255], v[172:175], v[32:47]
    buffer_load_dwordx4 v[172:175], v0, s[4:7], s27 offen offset:3072 sc1
    s_add_u32 s27, s27, 4096
    s_waitcnt vmcnt(36)
    v_mfma_f32_32x32x16_bf16 v[16:31], v[200:203], v[176:179], v[16:31]
    v_mfma_f32_32x32x16_bf16 v[32:47], v[204:207], v[176:179], v[32:47]
    buffer_load_dwordx4 v[176:179], v0, s[4:7], s27 offen offset:0 sc1
    s_waitcnt vmcnt(36)
    v_mfma_f32_32x32x16_bf16 v[16:31], v[208:211], v[180:183], v[16:31]
    v_mfma_f32_32x32x16_bf16 v[32:47], v[212:215], v[180:183], v[32:47]
    buffer_load_dwordx4 v[180:183], v0, s[4:7], s27 offen offset:1024 sc1
    s_waitcnt vmcnt(36)
    v_mfma_f32_32x32x16_bf16 v[16:31], v[216:219], v[184:187], v[16:31]
    v_mfma_f32_32x32x16_bf16 v[32:47], v[220:223], v[184:187], v[32:47]
    buffer_load_dwordx4 v[184:187], v0, s[4:7], s27 offen offset:2048 sc1
    s_waitcnt vmcnt(36)
    v_mfma_f32_32x32x16_bf16 v[16:31], v[224:227], v[188:191], v[16:31]
    v_mfma_f32_32x32x16_bf16 v[32:47], v[228:231], v[188:191], v[32:47]
    buffer_load_dwordx4 v[188:191], v0, s[4:7], s27 offen offset:3072 sc1
    s_branch Lo2t_320
Lo2l_319:
    s_waitcnt vmcnt(36)
    s_nop 5
    v_mfma_f32_32x32x16_bf16 v[16:31], a[0:3], v[48:51], 0
    v_mfma_f32_32x32x16_bf16 v[32:47], a[4:7], v[48:51], 0
    s_waitcnt vmcnt(35)
    v_mfma_f32_32x32x16_bf16 v[16:31], a[8:11], v[52:55], v[16:31]
    v_mfma_f32_32x32x16_bf16 v[32:47], a[12:15], v[52:55], v[32:47]
    s_waitcnt vmcnt(34)
    v_mfma_f32_32x32x16_bf16 v[16:31], a[16:19], v[56:59], v[16:31]
    v_mfma_f32_32x32x16_bf16 v[32:47], a[20:23], v[56:59], v[32:47]
    s_waitcnt vmcnt(33)
    v_mfma_f32_32x32x16_bf16 v[16:31], a[24:27], v[60:63], v[16:31]
    v_mfma_f32_32x32x16_bf16 v[32:47], a[28:31], v[60:63], v[32:47]
    s_waitcnt lgkmcnt(0)
    s_barrier
    s_waitcnt vmcnt(32)
    v_mfma_f32_32x32x16_bf16 v[16:31], a[32:35], v[64:67], v[16:31]
    v_mfma_f32_32x32x16_bf16 v[32:47], a[36:39], v[64:67], v[32:47]
    s_waitcnt vmcnt(31)
    v_mfma_f32_32x32x16_bf16 v[16:31], a[40:43], v[68:71], v[16:31]
    v_mfma_f32_32x32x16_bf16 v[32:47], a[44:47], v[68:71], v[32:47]
    s_waitcnt vmcnt(30)
    v_mfma_f32_32x32x16_bf16 v[16:31], a[48:51], v[72:75], v[16:31]
    v_mfma_f32_32x32x16_bf16 v[32:47], a[52:55], v[72:75], v[32:47]
    ds_read_b128 v[232:235], v6 offset:0
    ds_read_b128 v[236:239], v6 offset:8704
    ds_read_b128 v[240:243], v6 offset:17408
    ds_read_b128 v[244:247], v6 offset:26112
    s_waitcnt vmcnt(29)
    v_mfma_f32_32x32x16_bf16 v[16:31], a[56:59], v[76:79], v[16:31]
    v_mfma_f32_32x32x16_bf16 v[32:47], a[60:63], v[76:79], v[32:47]
    s_waitcnt vmcnt(28)
    v_mfma_f32_32x32x16_bf16 v[16:31], a[64:67], v[80:83], v[16:31]
    v_mfma_f32_32x32x16_bf16 v[32:47], a[68:71], v[80:83], v[32:47]
    s_waitcnt vmcnt(27)
    v_mfma_f32_32x32x16_bf16 v[16:31], a[72:75], v[84:87], v[16:31]
    v_mfma_f32_32x32x16_bf16 v[32:47], a[76:79], v[84:87], v[32:47]
    s_waitcnt lgkmcnt(0)
    v_pk_add_f32 v[232:233], v[232:233], v[236:237]
    v_pk_add_f32 v[234:235], v[234:235], v[238:239]
    v_pk_add_f32 v[240:241], v[240:241], v[244:245]
    v_pk_add_f32 v[242:243], v[242:243], v[246:247]
    v_pk_add_f32 v[248:249], v[232:233], v[240:241]
    v_pk_add_f32 v[250:251], v[234:235], v[242:243]
    s_waitcnt vmcnt(26)
    v_mfma_f32_32x32x16_bf16 v[16:31], a[80:83], v[88:91], v[16:31]
    v_mfma_f32_32x32x16_bf16 v[32:47], a[84:87], v[88:91], v[32:47]
    s_waitcnt vmcnt(25)
    v_mfma_f32_32x32x16_bf16 v[16:31], a[88:91], v[92:95], v[16:31]
    v_mfma_f32_32x32x16_bf16 v[32:47], a[92:95], v[92:95], v[32:47]
    ds_read_b128 v[232:235], v6 offset:512
    ds_read_b128 v[236:239], v6 offset:9216
    ds_read_b128 v[240:243], v6 offset:17920
    ds_read_b128 v[244:247], v6 offset:26624
    s_waitcnt vmcnt(24)
    v_mfma_f32_32x32x16_bf16 v[16:31], a[96:99], v[96:99], v[16:31]
    v_mfma_f32_32x32x16_bf16 v[32:47], a[100:103], v[96:99], v[32:47]
    s_waitcnt vmcnt(23)
    v_mfma_f32_32x32x16_bf16 v[16:31], a[104:107], v[100:103], v[16:31]
    v_mfma_f32_32x32x16_bf16 v[32:47], a[108:111], v[100:103], v[32:47]
    s_waitcnt vmcnt(22)
    v_mfma_f32_32x32x16_bf16 v[16:31], a[112:115], v[104:107], v[16:31]
    v_mfma_f32_32x32x16_bf16 v[32:47], a[116:119], v[104:107], v[32:47]
    s_waitcnt lgkmcnt(0)
    v_pk_add_f32 v[232:233], v[232:233], v[236:237]
    v_pk_add_f32 v[234:235], v[234:235], v[238:239]
    v_pk_add_f32 v[240:241], v[240:241], v[244:245]
    v_pk_add_f32 v[242:243], v[242:243], v[246:247]
    v_pk_add_f32 v[252:253], v[232:233], v[240:241]
    v_pk_add_f32 v[254:255], v[234:235], v[242:243]
    s_waitcnt vmcnt(21)
    v_mfma_f32_32x32x16_bf16 v[16:31], a[120:123], v[108:111], v[16:31]
    v_mfma_f32_32x32x16_bf16 v[32:47], a[124:127], v[108:111], v[32:47]
    s_waitcnt vmcnt(20)
    v_mfma_f32_32x32x16_bf16 v[16:31], a[128:131], v[112:115], v[16:31]
    v_mfma_f32_32x32x16_bf16 v[32:47], a[132:135], v[112:115], v[32:47]
    s_waitcnt vmcnt(19)
    v_mfma_f32_32x32x16_bf16 v[16:31], a[136:139], v[116:119], v[16:31]
    v_mfma_f32_32x32x16_bf16 v[32:47], a[140:143], v[116:119], v[32:47]
    v_cvt_pk_bf16_f32 v196, v248, v249
    v_lshlrev_b32 v248, 16, v196
    v_and_b32 v249, 0xffff0000, v196
    v_cvt_pk_bf16_f32 v196, v250, v251
    v_lshlrev_b32 v250, 16, v196
    v_and_b32 v251, 0xffff0000, v196
    v_cvt_pk_bf16_f32 v196, v252, v253
    v_lshlrev_b32 v252, 16, v196
    v_and_b32 v253, 0xffff0000, v196
    v_cvt_pk_bf16_f32 v196, v254, v255
    v_lshlrev_b32 v254, 16, v196
    v_and_b32 v255, 0xffff0000, v196
    s_waitcnt vmcnt(18)
    v_mfma_f32_32x32x16_bf16 v[16:31], a[144:147], v[120:123], v[16:31]
    v_mfma_f32_32x32x16_bf16 v[32:47], a[148:151], v[120:123], v[32:47]
    s_waitcnt vmcnt(17)
    v_mfma_f32_32x32x16_bf16 v[16:31], a[152:155], v[124:127], v[16:31]
    v_mfma_f32_32x32x16_bf16 v[32:47], a[156:159], v[124:127], v[32:47]
    s_waitcnt vmcnt(16)
    v_mfma_f32_32x32x16_bf16 v[16:31], a[160:163], v[128:131], v[16:31]
    v_mfma_f32_32x32x16_bf16 v[32:47], a[164:167], v[128:131], v[32:47]
    v_pk_mul_f32 v[248:249], v[248:249], v[8:9]
    v_pk_mul_f32 v[250:251], v[250:251], v[10:11]
    v_pk_mul_f32 v[252:253], v[252:253], v[12:13]
    v_pk_mul_f32 v[254:255], v[254:255], v[14:15]
    s_waitcnt vmcnt(15)
    v_mfma_f32_32x32x16_bf16 v[16:31], a[168:171], v[132:135], v[16:31]
    v_mfma_f32_32x32x16_bf16 v[32:47], a[172:175], v[132:135], v[32:47]
    s_waitcnt vmcnt(14)
    v_mfma_f32_32x32x16_bf16 v[16:31], a[176:179], v[136:139], v[16:31]
    v_mfma_f32_32x32x16_bf16 v[32:47], a[180:183], v[136:139], v[32:47]
    s_waitcnt vmcnt(13)
    v_mfma_f32_32x32x16_bf16 v[16:31], a[184:187], v[140:143], v[16:31]
    v_mfma_f32_32x32x16_bf16 v[32:47], a[188:191], v[140:143], v[32:47]
    v_cvt_pk_bf16_f32 v196, v248, v249
    v_lshlrev_b32 v248, 16, v196
    v_and_b32 v249, 0xffff0000, v196
    v_cvt_pk_bf16_f32 v196, v250, v251
    v_lshlrev_b32 v250, 16, v196
    v_and_b32 v251, 0xffff0000, v196
    v_cvt_pk_bf16_f32 v196, v252, v253
    v_lshlrev_b32 v252, 16, v196
    v_and_b32 v253, 0xffff0000, v196
    v_cvt_pk_bf16_f32 v196, v254, v255
    v_lshlrev_b32 v254, 16, v196
    v_and_b32 v255, 0xffff0000, v196
    s_waitcnt vmcnt(12)
    v_mfma_f32_32x32x16_bf16 v[16:31], a[192:195], v[144:147], v[16:31]
    v_mfma_f32_32x32x16_bf16 v[32:47], a[196:199], v[144:147], v[32:47]
    s_waitcnt vmcnt(11)
    v_mfma_f32_32x32x16_bf16 v[16:31], a[200:203], v[148:151], v[16:31]
    v_mfma_f32_32x32x16_bf16 v[32:47], a[204:207], v[148:151], v[32:47]
    s_waitcnt vmcnt(10)
    v_mfma_f32_32x32x16_bf16 v[16:31], a[208:211], v[152:155], v[16:31]
    v_mfma_f32_32x32x16_bf16 v[32:47], a[212:215], v[152:155], v[32:47]
    s_waitcnt vmcnt(9)
    v_mfma_f32_32x32x16_bf16 v[16:31], a[216:219], v[156:159], v[16:31]
    v_mfma_f32_32x32x16_bf16 v[32:47], a[220:223], v[156:159], v[32:47]
    s_waitcnt vmcnt(0)
    v_lshlrev_b32 v196, 16, v192
    v_and_b32 v197, 0xffff0000, v192
    v_pk_add_f32 v[248:249], v[248:249], v[196:197]
    v_cvt_pk_bf16_f32 v192, v248, v249
    v_lshlrev_b32 v196, 16, v193
    v_and_b32 v197, 0xffff0000, v193
    v_pk_add_f32 v[250:251], v[250:251], v[196:197]
    v_cvt_pk_bf16_f32 v193, v250, v251
    v_lshlrev_b32 v196, 16, v194
    v_and_b32 v197, 0xffff0000, v194
    v_pk_add_f32 v[252:253], v[252:253], v[196:197]
    v_cvt_pk_bf16_f32 v194, v252, v253
    v_lshlrev_b32 v196, 16, v195
    v_and_b32 v197, 0xffff0000, v195
    v_pk_add_f32 v[254:255], v[254:255], v[196:197]
    v_cvt_pk_bf16_f32 v195, v254, v255
    buffer_store_dwordx4 v[192:195], v7, s[32:35], s31 offen
    s_waitcnt vmcnt(8)
    v_mfma_f32_32x32x16_bf16 v[16:31], a[224:227], v[160:163], v[16:31]
    v_mfma_f32_32x32x16_bf16 v[32:47], a[228:231], v[160:163], v[32:47]
    s_waitcnt vmcnt(7)
    v_mfma_f32_32x32x16_bf16 v[16:31], a[232:235], v[164:167], v[16:31]
    v_mfma_f32_32x32x16_bf16 v[32:47], a[236:239], v[164:167], v[32:47]
    s_waitcnt vmcnt(6)
    v_mfma_f32_32x32x16_bf16 v[16:31], a[240:243], v[168:171], v[16:31]
    v_mfma_f32_32x32x16_bf16 v[32:47], a[244:247], v[168:171], v[32:47]
    s_waitcnt vmcnt(5)
    v_mfma_f32_32x32x16_bf16 v[16:31], a[248:251], v[172:175], v[16:31]
    v_mfma_f32_32x32x16_bf16 v[32:47], a[252:255], v[172:175], v[32:47]
    s_waitcnt vmcnt(4)
    v_mfma_f32_32x32x16_bf16 v[16:31], v[200:203], v[176:179], v[16:31]
    v_mfma_f32_32x32x16_bf16 v[32:47], v[204:207], v[176:179], v[32:47]
    s_waitcnt vmcnt(3)
    v_mfma_f32_32x32x16_bf16 v[16:31], v[208:211], v[180:183], v[16:31]
    v_mfma_f32_32x32x16_bf16 v[32:47], v[212:215], v[180:183], v[32:47]
    s_waitcnt vmcnt(2)
    v_mfma_f32_32x32x16_bf16 v[16:31], v[216:219], v[184:187], v[16:31]
    v_mfma_f32_32x32x16_bf16 v[32:47], v[220:223], v[184:187], v[32:47]
    s_waitcnt vmcnt(1)
    v_mfma_f32_32x32x16_bf16 v[16:31], v[224:227], v[188:191], v[16:31]
    v_mfma_f32_32x32x16_bf16 v[32:47], v[228:231], v[188:191], v[32:47]
Lo2f_321:
    s_nop 11
    s_barrier
    ds_write_b128 v5, v[16:19] offset:0
    ds_write_b128 v5, v[20:23] offset:1088
    ds_write_b128 v5, v[24:27] offset:2176
    ds_write_b128 v5, v[28:31] offset:3264
    ds_write_b128 v5, v[32:35] offset:4352
    ds_write_b128 v5, v[36:39] offset:5440
    ds_write_b128 v5, v[40:43] offset:6528
    ds_write_b128 v5, v[44:47] offset:7616
    s_lshl_b32 s19, s28, 5
    s_lshl_b32 s20, s13, 3
    s_add_u32 s19, s19, s20
    s_mul_i32 s19, s19, 1152
    s_lshl_b32 s20, s15, 7
    s_add_u32 s31, s19, s20
    s_add_u32 s20, s31, 69206016
    buffer_load_dwordx4 v[192:195], v7, s[4:7], s20 offen sc1
    s_waitcnt lgkmcnt(0)
    s_barrier
    ds_read_b128 v[232:235], v6 offset:0
    ds_read_b128 v[236:239], v6 offset:8704
    ds_read_b128 v[240:243], v6 offset:17408
    ds_read_b128 v[244:247], v6 offset:26112
    s_waitcnt lgkmcnt(0)
    v_pk_add_f32 v[232:233], v[232:233], v[236:237]
    v_pk_add_f32 v[234:235], v[234:235], v[238:239]
    v_pk_add_f32 v[240:241], v[240:241], v[244:245]
    v_pk_add_f32 v[242:243], v[242:243], v[246:247]
    v_pk_add_f32 v[248:249], v[232:233], v[240:241]
    v_pk_add_f32 v[250:251], v[234:235], v[242:243]
    ds_read_b128 v[232:235], v6 offset:512
    ds_read_b128 v[236:239], v6 offset:9216
    ds_read_b128 v[240:243], v6 offset:17920
    ds_read_b128 v[244:247], v6 offset:26624
    s_waitcnt lgkmcnt(0)
    v_pk_add_f32 v[232:233], v[232:233], v[236:237]
    v_pk_add_f32 v[234:235], v[234:235], v[238:239]
    v_pk_add_f32 v[240:241], v[240:241], v[244:245]
    v_pk_add_f32 v[242:243], v[242:243], v[246:247]
    v_pk_add_f32 v[252:253], v[232:233], v[240:241]
    v_pk_add_f32 v[254:255], v[234:235], v[242:243]
    v_cvt_pk_bf16_f32 v196, v248, v249
    v_lshlrev_b32 v248, 16, v196
    v_and_b32 v249, 0xffff0000, v196
    v_cvt_pk_bf16_f32 v196, v250, v251
    v_lshlrev_b32 v250, 16, v196
    v_and_b32 v251, 0xffff0000, v196
    v_cvt_pk_bf16_f32 v196, v252, v253
    v_lshlrev_b32 v252, 16, v196
    v_and_b32 v253, 0xffff0000, v196
    v_cvt_pk_bf16_f32 v196, v254, v255
    v_lshlrev_b32 v254, 16, v196
    v_and_b32 v255, 0xffff0000, v196
    v_pk_mul_f32 v[248:249], v[248:249], v[8:9]
    v_pk_mul_f32 v[250:251], v[250:251], v[10:11]
    v_pk_mul_f32 v[252:253], v[252:253], v[12:13]
    v_pk_mul_f32 v[254:255], v[254:255], v[14:15]
    v_cvt_pk_bf16_f32 v196, v248, v249
    v_lshlrev_b32 v248, 16, v196
    v_and_b32 v249, 0xffff0000, v196
    v_cvt_pk_bf16_f32 v196, v250, v251
    v_lshlrev_b32 v250, 16, v196
    v_and_b32 v251, 0xffff0000, v196
    v_cvt_pk_bf16_f32 v196, v252, v253
    v_lshlrev_b32 v252, 16, v196
    v_and_b32 v253, 0xffff0000, v196
    v_cvt_pk_bf16_f32 v196, v254, v255
    v_lshlrev_b32 v254, 16, v196
    v_and_b32 v255, 0xffff0000, v196
    s_waitcnt vmcnt(0)
    v_lshlrev_b32 v196, 16, v192
    v_and_b32 v197, 0xffff0000, v192
    v_pk_add_f32 v[248:249], v[248:249], v[196:197]
    v_cvt_pk_bf16_f32 v192, v248, v249
    v_lshlrev_b32 v196, 16, v193
    v_and_b32 v197, 0xffff0000, v193
    v_pk_add_f32 v[250:251], v[250:251], v[196:197]
    v_cvt_pk_bf16_f32 v193, v250, v251
    v_lshlrev_b32 v196, 16, v194
    v_and_b32 v197, 0xffff0000, v194
    v_pk_add_f32 v[252:253], v[252:253], v[196:197]
    v_cvt_pk_bf16_f32 v194, v252, v253
    v_lshlrev_b32 v196, 16, v195
    v_and_b32 v197, 0xffff0000, v195
    v_pk_add_f32 v[254:255], v[254:255], v[196:197]
    v_cvt_pk_bf16_f32 v195, v254, v255
    buffer_store_dwordx4 v[192:195], v7, s[32:35], s31 offen
Ldone_main:
    s_endpgm
Lcode_end:

.section .rodata,"a"
.p2align 6
.amdhsa_kernel main_kernel
  .amdhsa_next_free_vgpr 512
  .amdhsa_next_free_sgpr 100
  .amdhsa_accum_offset 256
  .amdhsa_group_segment_fixed_size 0
  .amdhsa_kernarg_size 136
  .amdhsa_user_sgpr_count 2
  .amdhsa_user_sgpr_kernarg_segment_ptr 1
  .amdhsa_system_sgpr_workgroup_id_x 1
.end_amdhsa_kernel
.text
```
